```python
import torch

def _softmax(x, axis=-1):
    return torch.softmax(x, dim=axis)

def _gelu(x):
    return torch.nn.functional.gelu(x, approximate='tanh')

def _silu(x):
    return torch.nn.functional.silu(x)

def _sigmoid(x):
    return torch.sigmoid(x)

def _layernorm(x, axis=-1, eps=1e-05):
    m = x.mean(dim=axis, keepdim=True)
    v = x.var(dim=axis, keepdim=True, unbiased=False)
    return (x - m) / torch.sqrt(v + eps)

def _scatter_add(tgt, idx, src, axis=0):
    return tgt.clone().index_add_(axis, idx, src)

def _segment_sum(src, seg, n):
    out = torch.zeros((n,) + src.shape[1:], dtype=src.dtype)
    return out.index_add_(0, seg, src)

def _pad(x, pw):
    flat = tuple((v for pair in reversed(pw) for v in pair))
    return torch.nn.functional.pad(x, flat)
kernel_name = 'adaLN_cond__compressed_kv_cla__glu_gated_swiglu__prompt'

def setup_inputs():

    _w = lambda a: (lambda t: t.to(torch.bfloat16) if t.is_floating_point() else t)(torch.as_tensor(a))

    def _A_setup():
        B, H, Sq, Sk, D, M = (1, 32, 2048, 2048, 128, 512)
        Dc = 4 * D
        return {'x': _w((lambda *s: torch.randn(*s, dtype=torch.bfloat16) * 0.05)(B, Sq, M)), 'c_kv': _w((lambda *s: torch.randn(*s, dtype=torch.bfloat16) * 0.8)(B, Sk, Dc)), 'w_q': _w((lambda *s: torch.randn(*s, dtype=torch.bfloat16) * 1.6)(M, H, D) * M ** (-0.5)), 'w_uk': _w((lambda *s: torch.randn(*s, dtype=torch.bfloat16) * 1.6)(Dc, H, D) * Dc ** (-0.5)), 'w_uv': _w((lambda *s: torch.randn(*s, dtype=torch.bfloat16) * 0.8)(Dc, H, D) * Dc ** (-0.5)), 'w_o': _w((lambda *s: torch.randn(*s, dtype=torch.bfloat16) * 0.8)(H, D, M) * (H * D) ** (-0.5))}
    _A_in = _A_setup()

    def _B_setup():
        B, S, D, F = (1, 2048, 512, 1792)
        return {'x': _w((lambda *s: torch.randn(*s, dtype=torch.bfloat16) * 0.05)(B, S, D)), 'w1': _w((lambda *s: torch.randn(*s, dtype=torch.bfloat16) * 0.4)(D, F) * (2.0 / D) ** 0.5), 'w3': _w((lambda *s: torch.randn(*s, dtype=torch.bfloat16) * 0.4)(D, F) * (2.0 / D) ** 0.5), 'w2': _w((lambda *s: torch.randn(*s, dtype=torch.bfloat16) * 0.4)(F, D) * (2.0 / F) ** 0.5)}
    _B_in = _B_setup()
    return {'A_x': _A_in['x'], 'A_c_kv': _A_in['c_kv'], 'A_w_q': _A_in['w_q'], 'A_w_uk': _A_in['w_uk'], 'A_w_uv': _A_in['w_uv'], 'A_w_o': _A_in['w_o'], 'B_x': _B_in['x'], 'B_w1': _B_in['w1'], 'B_w3': _B_in['w3'], 'B_w2': _B_in['w2'], 'c': _w((lambda *s: torch.randn(*s, dtype=torch.bfloat16) * 0.1)(1, 512) * 8.0), 'w_mod': _w((lambda *s: torch.randn(*s, dtype=torch.bfloat16) * 0.1)(512, 6 * 512) * 512 ** (-0.5) * 8.0)}

def reference(A_x, A_c_kv, A_w_q, A_w_uk, A_w_uv, A_w_o, B_x, B_w1, B_w3, B_w2, c, w_mod):

    def _A_ref(x, c_kv, w_q, w_uk, w_uv, w_o):
        B, Sq, M = (x.shape[0], x.shape[1], x.shape[2])
        Sk = c_kv.shape[1]
        H, D = (w_q.shape[1], w_q.shape[2])
        q = torch.einsum('bqm,mhd->bhqd', x, w_q)
        k = torch.einsum('bkc,chd->bhkd', c_kv, w_uk)
        v = torch.einsum('bkc,chd->bhkd', c_kv, w_uv)
        scores = torch.einsum('bhqd,bhkd->bhqk', q, k) * D ** (-0.5)
        off = Sk - Sq
        qi = torch.arange(Sq)[:, None]
        kj = torch.arange(Sk)[None, :]
        cmask = kj <= qi + off
        scores = torch.where(cmask[None, None], scores, -1000000000.0)
        p = _softmax(scores, axis=-1)
        ctx = torch.einsum('bhqk,bhkd->bhqd', p, v)
        return torch.einsum('bhqd,hdm->bqm', ctx, w_o)

    def _B_ref(x, w1, w3, w2):
        gate = torch.einsum('bsd,df->bsf', x, w1)
        up = torch.einsum('bsd,df->bsf', x, w3)
        h = _silu(gate) * up
        out = torch.einsum('bsf,fd->bsd', h, w2)
        return out
    x = A_x
    mod = (_silu(c) @ w_mod).reshape(c.shape[0], 6, 1, -1)
    sa, ca, ga, sb, cb, gb = (mod[:, 0].clone(), mod[:, 1].clone(), mod[:, 2].clone(), mod[:, 3].clone(), mod[:, 4].clone(), mod[:, 5].clone())
    h = _layernorm(x, axis=-1) * (1 + ca) + sa
    x = x + ga * _A_ref(h, A_c_kv, A_w_q, A_w_uk, A_w_uv, A_w_o)
    h = _layernorm(x, axis=-1) * (1 + cb) + sb
    x = x + gb * _B_ref(h, B_w1, B_w3, B_w2)
    return x
```

```asm
; @launch kernel=fused_kernel grid=(256,1,1) block=(512,1,1) lds=163840
.amdgcn_target "amdgcn-amd-amdhsa--gfx950"
.text
.globl fused_kernel
.p2align 8
.type fused_kernel,@function
fused_kernel:
  s_cmp_ge_u32 s2, 256
  s_cbranch_scc1 fused_kernel_end
  s_load_dwordx2 s[44:45], s[0:1], 8
  s_load_dwordx2 s[4:5], s[0:1], 24
  s_load_dwordx2 s[6:7], s[0:1], 32
  s_load_dwordx2 s[8:9], s[0:1], 16
  s_load_dwordx2 s[10:11], s[0:1], 112
  s_load_dwordx2 s[46:47], s[0:1], 0
  s_load_dwordx2 s[48:49], s[0:1], 80
  s_load_dwordx2 s[50:51], s[0:1], 88
  s_load_dwordx2 s[52:53], s[0:1], 104
  v_and_b32 v1, 63, v0
  v_lshrrev_b32 v2, 6, v0
  s_mov_b32 s74, 1
  v_readfirstlane_b32 s3, v2
  v_lshlrev_b32 v2, 4, v1
  s_and_b32 s55, s2, 7
  s_lshr_b32 s54, s2, 3
  s_and_b32 s64, s54, 3
  s_lshl_b32 s41, s55, 2
  s_add_u32 s41, s41, s64
  s_lshr_b32 s65, s54, 2
  s_lshl_b32 s66, s64, 1
  s_add_u32 s66, s66, s65
  s_and_b32 s66, s66, 7
  s_lshr_b32 s66, s64, 1
  s_add_u32 s66, s66, s65
  s_and_b32 s66, s66, 7
  s_lshl_b32 s56, s66, 19
  s_lshl_b32 s57, s66, 7
  s_lshl_b32 s58, s66, 12
  v_lshrrev_b32 v3, 3, v1
  v_lshlrev_b32 v5, 10, v3
  v_lshrrev_b32 v6, 4, v1
  v_and_b32 v7, 7, v1
  v_xor_b32 v6, v6, v7
  v_lshl_add_u32 v5, v6, 4, v5
  s_lshl_b32 s67, s3, 3
  s_add_u32 s67, s67, s65
  s_lshl_b32 s66, s67, 15
  v_add_u32 v5, s66, v5
  s_lshl_b32 s60, s3, 12
  v_bfe_u32 v6, v1, 2, 3
  v_lshlrev_b32 v4, 13, v6
  v_lshrrev_b32 v6, 5, v1
  v_lshl_add_u32 v4, v6, 6, v4
  s_and_b32 s66, s3, 1
  s_lshl_b32 s66, s66, 1
  v_and_b32 v6, 3, v1
  v_xor_b32 v6, s66, v6
  v_lshl_add_u32 v4, v6, 4, v4
  s_lshl_b32 s66, s3, 16
  s_lshl_b32 s59, s41, 8
  s_add_u32 s66, s66, s59
  v_add_u32 v4, s66, v4
  s_lshl_b32 s59, s3, 11
  s_add_u32 s59, s59, 81920
  s_waitcnt lgkmcnt(0)
  s_mov_b32 s32, s44
  s_mov_b32 s33, s45
  s_mov_b32 s34, 0x200000
  s_mov_b32 s35, 0x20000
  s_mov_b32 s12, s4
  s_mov_b32 s13, s5
  s_mov_b32 s14, 0x400000
  s_mov_b32 s15, 0x20000
  s_lshr_b32 s44, s54, 2
  s_mul_i32 s5, s2, 1366
  s_lshr_b32 s5, s5, 16
  s_mul_i32 s4, s5, 48
  s_sub_u32 s4, s2, s4
  s_lshl_b32 s66, s5, 7
  s_lshl_b32 s40, s3, 4
  s_add_u32 s66, s66, s40
  v_add_u32 v3, s66, v3
  s_mov_b32 s68, s50
  s_mov_b32 s69, s51
  s_mov_b32 s70, 0x300000
  s_mov_b32 s71, 0x20000
  v_mul_u32_u24 v6, 6144, v3
  v_and_b32 v7, 7, v1
  v_lshl_add_u32 v6, v7, 4, v6
  s_lshl_b32 s66, s4, 7
  s_add_u32 s40, s66, 49152
  buffer_load_dwordx4 v[208:211], v6, s[68:71], s66 offen
  buffer_load_dwordx4 v[212:215], v6, s[68:71], s40 offen
  s_mov_b32 s24, s48
  s_mov_b32 s25, s49
  s_mov_b32 s26, 0x400
  s_mov_b32 s27, 0x20000
  v_lshlrev_b32 v7, 1, v3
  buffer_load_ushort v232, v7, s[24:27], 0 offen offset:0
  buffer_load_ushort v233, v7, s[24:27], 0 offen offset:16
  s_add_u32 m0, s60, 0
  s_add_u32 s64, s57, 0
  buffer_load_dwordx4 v5, s[32:35], s64 offen offset:0 lds
  s_add_u32 m0, s60, 0
  s_add_u32 s64, s57, 7168
  buffer_load_dwordx4 v5, s[32:35], s64 offen offset:1024 lds
  s_add_u32 m0, s60, 0
  s_add_u32 s64, s57, 14336
  buffer_load_dwordx4 v5, s[32:35], s64 offen offset:2048 lds
  s_add_u32 m0, s60, 0
  s_add_u32 s64, s57, 21504
  buffer_load_dwordx4 v5, s[32:35], s64 offen offset:3072 lds
  s_add_u32 s57, s57, 128
  s_and_b32 s57, s57, 0x3ff
  s_add_u32 m0, s59, 16384
  s_nop 0
  buffer_load_dwordx4 v4, s[12:15], s56 offen lds
  s_add_u32 m0, s59, 17280
  s_add_u32 s65, s56, 0x80000
  buffer_load_dwordx4 v4, s[12:15], s56 offen offset:128 lds
  s_and_b32 s56, s65, 0x3fffff
  s_mov_b32 s16, s6
  s_mov_b32 s17, s7
  s_mov_b32 s18, 0x400000
  s_mov_b32 s19, 0x20000
  s_mov_b32 s28, s8
  s_mov_b32 s29, s9
  s_mov_b32 s30, 0x400000
  s_mov_b32 s31, 0x20000
  s_barrier
  s_add_u32 m0, s59, 32768
  s_nop 0
  buffer_load_dwordx4 v4, s[12:15], s56 offen lds
  s_add_u32 m0, s59, 33664
  s_add_u32 s65, s56, 0x80000
  buffer_load_dwordx4 v4, s[12:15], s56 offen offset:128 lds
  s_and_b32 s56, s65, 0x3fffff
  s_lshl_b32 s40, s2, 3
  s_add_u32 s40, s40, s3
  s_lshl_b32 s42, s40, 10
  s_mov_b32 s24, s46
  s_mov_b32 s25, s47
  s_mov_b32 s26, 0x200000
  s_mov_b32 s27, 0x20000
  buffer_load_dwordx4 v[12:15], v2, s[24:27], s42 offen
  s_add_u32 s20, s10, 0x2000000
  s_addc_u32 s21, s11, 0
  s_mov_b32 s22, 0x2000000
  s_mov_b32 s23, 0x20000
  s_mov_b32 s36, s10
  s_mov_b32 s37, s11
  s_mov_b32 s38, 0x500000
  s_mov_b32 s39, 0x20000
  s_mov_b32 s68, s52
  s_mov_b32 s69, s53
  s_mov_b32 s70, 0x100
  s_mov_b32 s71, 0x20000
  v_lshrrev_b32 v6, 4, v1
  v_and_b32 v7, 15, v1
  v_lshlrev_b32 v8, 11, v6
  v_bfe_u32 v9, v1, 2, 2
  v_lshl_add_u32 v8, v9, 6, v8
  v_bfe_u32 v9, v1, 4, 1
  v_lshl_add_u32 v8, v9, 5, v8
  v_and_b32 v9, 3, v1
  v_lshl_add_u32 v8, v9, 3, v8
  v_add_u32 v8, 81920, v8
  v_xor_b32 v9, 32, v8
  v_lshlrev_b32 v10, 9, v6
  v_lshl_add_u32 v10, v7, 4, v10
  v_and_b32 v6, 15, v1
  v_lshlrev_b32 v6, 7, v6
  v_lshrrev_b32 v7, 4, v1
  v_bfe_u32 v3, v1, 1, 2
  v_xor_b32 v7, v7, v3
  v_lshl_add_u32 v6, v7, 4, v6
  v_add_u32 v6, s60, v6
  s_lshl_b32 s61, s41, 20
  s_lshr_b32 s66, s67, 1
  s_lshl_b32 s66, s66, 15
  s_add_u32 s61, s61, s66
  s_and_b32 s66, s67, 1
  s_lshl_b32 s66, s66, 13
  s_add_u32 s61, s61, s66
  s_cmp_eq_u32 s3, 0
  s_cselect_b32 s72, s61, 0x40000000
  s_cselect_b32 s73, 0x40000000, s61
  s_lshl_b32 s75, s41, 7
  s_add_u32 s75, s75, 0x12000
  s_lshr_b32 s40, s3, 2
  s_and_b32 s52, s3, 3
  s_lshl_b32 s52, s52, 12
  s_lshl_b32 s46, s40, 16
  s_sub_u32 s43, 15, s44
  s_lshl_b32 s42, s43, 2
  s_add_u32 s42, s42, s3
  s_lshl_b32 s47, s44, 2
  s_add_u32 s47, s47, 7
  s_sub_u32 s47, s47, s3
  s_cmp_eq_u32 s40, 0
  s_cselect_b32 s42, s42, s47
  s_lshl_b32 s44, s43, 1
  s_add_u32 s44, s44, 2
  s_lshr_b32 s43, s42, 1
  s_lshl_b32 s47, s42, 15
  s_add_u32 s47, s47, 0x300000
  v_add_u32 v7, s47, v10
  s_lshl_b32 s47, s41, 20
  s_add_u32 s48, s44, 1
  s_lshl_b32 s48, s48, 15
  s_add_u32 s48, s48, s47
  s_add_u32 s47, s47, s52
  s_add_u32 s47, s47, s46
  s_mov_b32 s45, 0
  s_mov_b32 s54, 0x40000000
  s_mov_b32 s51, 0x49800000
  s_mov_b32 s62, 32768
  s_mov_b32 s63, 163840
  s_waitcnt vmcnt(9)
  v_lshlrev_b32 v232, 16, v232
  v_mul_f32 v234, 0xbfb8aa3b, v232
  v_lshlrev_b32 v233, 16, v233
  v_mul_f32 v235, 0xbfb8aa3b, v233
  v_exp_f32 v234, v234
  v_exp_f32 v235, v235
  v_lshlrev_b32 v216, 16, v208
  v_and_b32 v217, 0xffff0000, v208
  v_lshlrev_b32 v218, 16, v209
  v_and_b32 v219, 0xffff0000, v209
  v_lshlrev_b32 v220, 16, v210
  v_and_b32 v221, 0xffff0000, v210
  v_lshlrev_b32 v222, 16, v211
  v_and_b32 v223, 0xffff0000, v211
  v_add_f32 v234, 1.0, v234
  v_add_f32 v235, 1.0, v235
  v_rcp_f32 v234, v234
  v_rcp_f32 v235, v235
  v_lshlrev_b32 v224, 16, v212
  v_and_b32 v225, 0xffff0000, v212
  v_lshlrev_b32 v226, 16, v213
  v_and_b32 v227, 0xffff0000, v213
  v_lshlrev_b32 v228, 16, v214
  v_and_b32 v229, 0xffff0000, v214
  v_lshlrev_b32 v230, 16, v215
  v_and_b32 v231, 0xffff0000, v215
  v_mul_f32 v232, v232, v234
  v_mul_f32 v233, v233, v235
  v_cvt_pk_bf16_f32 v234, v232, v233
  v_lshlrev_b32 v232, 16, v234
  v_and_b32 v233, 0xffff0000, v234
  v_mul_f32 v216, v232, v216
  v_mul_f32 v217, v232, v217
  v_mul_f32 v218, v232, v218
  v_mul_f32 v219, v232, v219
  v_mul_f32 v220, v232, v220
  v_mul_f32 v221, v232, v221
  v_mul_f32 v222, v232, v222
  v_mul_f32 v223, v232, v223
  v_fmac_f32 v216, v233, v224
  v_fmac_f32 v217, v233, v225
  v_fmac_f32 v218, v233, v226
  v_fmac_f32 v219, v233, v227
  v_fmac_f32 v220, v233, v228
  v_fmac_f32 v221, v233, v229
  v_fmac_f32 v222, v233, v230
  v_fmac_f32 v223, v233, v231
  v_and_b32 v234, 7, v1
  v_lshrrev_b32 v235, 4, v1
  v_lshlrev_b32 v234, 5, v234
  s_lshl_b32 s66, s3, 8
  v_lshl_add_u32 v234, v235, 3, v234
  s_add_u32 s66, s66, 65536
  v_permlane32_swap_b32 v216, v220
  v_permlane32_swap_b32 v217, v221
  v_permlane32_swap_b32 v218, v222
  v_permlane32_swap_b32 v219, v223
  v_add_f32 v216, v216, v220
  v_add_f32 v217, v217, v221
  v_add_f32 v218, v218, v222
  v_add_f32 v219, v219, v223
  v_add_u32 v234, s66, v234
  v_permlane16_swap_b32 v216, v218
  v_permlane16_swap_b32 v217, v219
  v_add_f32 v216, v216, v218
  v_add_f32 v217, v217, v219
  s_nop 0
  v_add_f32_dpp v216, v216, v216 row_ror:8 row_mask:0xf bank_mask:0xf
  v_add_f32_dpp v217, v217, v217 row_ror:8 row_mask:0xf bank_mask:0xf
  ds_write_b64 v234, v[216:217]
  s_waitcnt vmcnt(5)
  ds_read_b128 v[128:131], v6 offset:0
  ds_read_b128 v[132:135], v6 offset:2048
  ds_read_b128 v[136:139], v6 offset:64
  ds_read_b128 v[140:143], v6 offset:2112
  s_waitcnt lgkmcnt(4)
  s_waitcnt vmcnt(3)
  s_barrier
  ds_read_b64_tr_b16 v[16:17], v8 offset:16384
  ds_read_b64_tr_b16 v[18:19], v8 offset:16640
  ds_read_b64_tr_b16 v[20:21], v9 offset:16384
  ds_read_b64_tr_b16 v[22:23], v9 offset:16640
  ds_read_b64_tr_b16 v[24:25], v8 offset:16896
  ds_read_b64_tr_b16 v[26:27], v8 offset:17152
  ds_read_b64_tr_b16 v[28:29], v9 offset:16896
  ds_read_b64_tr_b16 v[30:31], v9 offset:17152
  s_waitcnt lgkmcnt(8)
  ds_read_b64_tr_b16 v[32:33], v8 offset:17408
  ds_read_b64_tr_b16 v[34:35], v8 offset:17664
  ds_read_b64_tr_b16 v[36:37], v9 offset:17408
  ds_read_b64_tr_b16 v[38:39], v9 offset:17664
  ds_read_b64_tr_b16 v[40:41], v8 offset:17920
  ds_read_b64_tr_b16 v[42:43], v8 offset:18176
  ds_read_b64_tr_b16 v[44:45], v9 offset:17920
  ds_read_b64_tr_b16 v[46:47], v9 offset:18176
  s_cmp_ge_u32 s2, 192
  s_cselect_b32 s8, 1, s3
  s_cmp_lg_u32 s8, 0
  s_cbranch_scc1 g_1
  v_lshlrev_b32 v234, 2, v1
  v_add_u32 v232, 65536, v234
  ds_read_b32 v224, v232 offset:0
  ds_read_b32 v225, v232 offset:256
  ds_read_b32 v226, v232 offset:512
  ds_read_b32 v227, v232 offset:768
  ds_read_b32 v228, v232 offset:1024
  ds_read_b32 v229, v232 offset:1280
  ds_read_b32 v230, v232 offset:1536
  ds_read_b32 v231, v232 offset:1792
  s_mul_i32 s8, s5, 12288
  s_lshl_b32 s64, s4, 8
  s_add_u32 s8, s8, s64
  s_add_u32 s8, s8, 0x4000
  s_lshl_b32 s64, s5, 4
  s_add_u32 s64, s64, s4
  s_lshl_b32 s64, s64, 9
  s_add_u32 s64, s64, 0x10000
  v_lshrrev_b32 v232, 4, v1
  v_and_b32 v233, 15, v1
  v_lshlrev_b32 v232, 7, v232
  v_lshl_add_u32 v232, v233, 2, v232
  v_mov_b32 v233, 0
  s_cmp_lt_u32 s4, 16
  s_cselect_b32 s64, s64, s54
  s_waitcnt lgkmcnt(0)
  v_add_f32 v224, v224, v225
  v_add_f32 v224, v224, v226
  v_add_f32 v224, v224, v227
  v_add_f32 v224, v224, v228
  v_add_f32 v224, v224, v229
  v_add_f32 v224, v224, v230
  v_add_f32 v224, v224, v231
  buffer_store_dword v224, v234, s[36:39], s8 offen sc1
  s_mov_b64 exec, -1
  buffer_store_dword v233, v232, s[36:39], s64 offen sc1
  s_mov_b64 exec, -1
g_1:
  s_waitcnt lgkmcnt(12)
  v_mfma_f32_16x16x32_bf16 v[64:67], v[16:19], v[128:131], 0
  s_add_u32 m0, s60, 32768
  s_add_u32 s64, s57, 0
  buffer_load_dwordx4 v5, s[32:35], s64 offen offset:0 lds
  v_mfma_f32_16x16x32_bf16 v[68:71], v[16:19], v[132:135], 0
  ds_read_b64_tr_b16 v[16:17], v8 offset:24576
  ds_read_b64_tr_b16 v[18:19], v8 offset:24832
  s_add_u32 m0, s60, 32768
  s_add_u32 s64, s57, 7168
  buffer_load_dwordx4 v5, s[32:35], s64 offen offset:1024 lds
  v_mfma_f32_16x16x32_bf16 v[72:75], v[20:23], v[128:131], 0
  s_add_u32 m0, s60, 32768
  s_add_u32 s64, s57, 14336
  buffer_load_dwordx4 v5, s[32:35], s64 offen offset:2048 lds
  v_mfma_f32_16x16x32_bf16 v[76:79], v[20:23], v[132:135], 0
  ds_read_b64_tr_b16 v[20:21], v9 offset:24576
  ds_read_b64_tr_b16 v[22:23], v9 offset:24832
  s_add_u32 m0, s60, 32768
  s_add_u32 s64, s57, 21504
  buffer_load_dwordx4 v5, s[32:35], s64 offen offset:3072 lds
  s_waitcnt lgkmcnt(12)
  v_mfma_f32_16x16x32_bf16 v[80:83], v[24:27], v[128:131], 0
  s_add_u32 s57, s57, 128
  s_and_b32 s57, s57, 0x3ff
  v_mfma_f32_16x16x32_bf16 v[84:87], v[24:27], v[132:135], 0
  ds_read_b64_tr_b16 v[24:25], v8 offset:25088
  ds_read_b64_tr_b16 v[26:27], v8 offset:25344
  s_add_u32 m0, s59, 49152
  s_nop 0
  buffer_load_dwordx4 v4, s[12:15], s56 offen lds
  v_mfma_f32_16x16x32_bf16 v[88:91], v[28:31], v[128:131], 0
  s_add_u32 m0, s59, 50048
  s_add_u32 s65, s56, 0x80000
  buffer_load_dwordx4 v4, s[12:15], s56 offen offset:128 lds
  s_and_b32 s56, s65, 0x3fffff
  v_mfma_f32_16x16x32_bf16 v[92:95], v[28:31], v[132:135], 0
  ds_read_b64_tr_b16 v[28:29], v9 offset:25088
  ds_read_b64_tr_b16 v[30:31], v9 offset:25344
  s_add_u32 m0, s60, 0
  s_add_u32 s64, s57, 0
  buffer_load_dwordx4 v5, s[32:35], s64 offen offset:0 lds
  s_waitcnt lgkmcnt(12)
  v_mfma_f32_16x16x32_bf16 v[96:99], v[32:35], v[128:131], 0
  s_add_u32 m0, s60, 0
  s_add_u32 s64, s57, 7168
  buffer_load_dwordx4 v5, s[32:35], s64 offen offset:1024 lds
  v_mfma_f32_16x16x32_bf16 v[100:103], v[32:35], v[132:135], 0
  ds_read_b64_tr_b16 v[32:33], v8 offset:25600
  ds_read_b64_tr_b16 v[34:35], v8 offset:25856
  s_add_u32 m0, s60, 0
  s_add_u32 s64, s57, 14336
  buffer_load_dwordx4 v5, s[32:35], s64 offen offset:2048 lds
  v_mfma_f32_16x16x32_bf16 v[104:107], v[36:39], v[128:131], 0
  s_add_u32 m0, s60, 0
  s_add_u32 s64, s57, 21504
  buffer_load_dwordx4 v5, s[32:35], s64 offen offset:3072 lds
  v_mfma_f32_16x16x32_bf16 v[108:111], v[36:39], v[132:135], 0
  ds_read_b64_tr_b16 v[36:37], v9 offset:25600
  ds_read_b64_tr_b16 v[38:39], v9 offset:25856
  s_add_u32 s57, s57, 128
  s_and_b32 s57, s57, 0x3ff
  s_waitcnt lgkmcnt(12)
  v_mfma_f32_16x16x32_bf16 v[112:115], v[40:43], v[128:131], 0
  s_add_u32 m0, s59, 65536
  s_nop 0
  buffer_load_dwordx4 v4, s[12:15], s56 offen lds
  v_mfma_f32_16x16x32_bf16 v[116:119], v[40:43], v[132:135], 0
  ds_read_b64_tr_b16 v[40:41], v8 offset:26112
  ds_read_b64_tr_b16 v[42:43], v8 offset:26368
  s_add_u32 m0, s59, 66432
  s_add_u32 s65, s56, 0x80000
  buffer_load_dwordx4 v4, s[12:15], s56 offen offset:128 lds
  s_and_b32 s56, s65, 0x3fffff
  v_mfma_f32_16x16x32_bf16 v[120:123], v[44:47], v[128:131], 0
  s_waitcnt vmcnt(8)
  ds_read_b128 v[144:147], v6 offset:32768
  v_mfma_f32_16x16x32_bf16 v[124:127], v[44:47], v[132:135], 0
  ds_read_b64_tr_b16 v[44:45], v9 offset:26112
  ds_read_b64_tr_b16 v[46:47], v9 offset:26368
  ds_read_b128 v[148:151], v6 offset:34816
  ds_read_b128 v[152:155], v6 offset:32832
  s_waitcnt lgkmcnt(15)
  v_mfma_f32_16x16x32_bf16 v[64:67], v[16:19], v[136:139], v[64:67]
  s_barrier
  ds_read_b128 v[156:159], v6 offset:34880
  s_waitcnt lgkmcnt(0)
  v_mfma_f32_16x16x32_bf16 v[68:71], v[16:19], v[140:143], v[68:71]
  ds_read_b64_tr_b16 v[16:17], v8 offset:32768
  ds_read_b64_tr_b16 v[18:19], v8 offset:33024
  s_add_u32 m0, s60, 32768
  s_add_u32 s64, s57, 0
  buffer_load_dwordx4 v5, s[32:35], s64 offen offset:0 lds
  v_mfma_f32_16x16x32_bf16 v[72:75], v[20:23], v[136:139], v[72:75]
  s_add_u32 m0, s60, 32768
  s_add_u32 s64, s57, 7168
  buffer_load_dwordx4 v5, s[32:35], s64 offen offset:1024 lds
  v_mfma_f32_16x16x32_bf16 v[76:79], v[20:23], v[140:143], v[76:79]
  ds_read_b64_tr_b16 v[20:21], v9 offset:32768
  ds_read_b64_tr_b16 v[22:23], v9 offset:33024
  s_add_u32 m0, s60, 32768
  s_add_u32 s64, s57, 14336
  buffer_load_dwordx4 v5, s[32:35], s64 offen offset:2048 lds
  v_mfma_f32_16x16x32_bf16 v[80:83], v[24:27], v[136:139], v[80:83]
  s_add_u32 m0, s60, 32768
  s_add_u32 s64, s57, 21504
  buffer_load_dwordx4 v5, s[32:35], s64 offen offset:3072 lds
  v_mfma_f32_16x16x32_bf16 v[84:87], v[24:27], v[140:143], v[84:87]
  ds_read_b64_tr_b16 v[24:25], v8 offset:33280
  ds_read_b64_tr_b16 v[26:27], v8 offset:33536
  s_add_u32 s57, s57, 128
  s_and_b32 s57, s57, 0x3ff
  v_mfma_f32_16x16x32_bf16 v[88:91], v[28:31], v[136:139], v[88:91]
  s_cmp_ge_u32 s2, 192
  s_cselect_b32 s8, 1, s3
  s_cmp_lg_u32 s8, 0
  s_cbranch_scc1 g_2
  s_waitcnt vmcnt(16)
  s_cmp_lt_u32 s4, 16
  s_cselect_b32 s55, 0, 128
  v_mov_b32 v0, 0
  v_mov_b32 v3, 1
  s_mov_b64 exec, 1
  buffer_atomic_add v3, v0, s[68:71], s55 offen
  s_mov_b64 exec, -1
g_2:
  v_mfma_f32_16x16x32_bf16 v[92:95], v[28:31], v[140:143], v[92:95]
  ds_read_b64_tr_b16 v[28:29], v9 offset:33280
  ds_read_b64_tr_b16 v[30:31], v9 offset:33536
  s_add_u32 m0, s59, 0
  s_nop 0
  buffer_load_dwordx4 v4, s[12:15], s56 offen lds
  v_mfma_f32_16x16x32_bf16 v[96:99], v[32:35], v[136:139], v[96:99]
  s_add_u32 m0, s59, 896
  s_add_u32 s65, s56, 0x80000
  buffer_load_dwordx4 v4, s[12:15], s56 offen offset:128 lds
  s_and_b32 s56, s65, 0x3fffff
  v_mfma_f32_16x16x32_bf16 v[100:103], v[32:35], v[140:143], v[100:103]
  ds_read_b64_tr_b16 v[32:33], v8 offset:33792
  ds_read_b64_tr_b16 v[34:35], v8 offset:34048
  v_lshlrev_b32 v248, 16, v12
  v_mfma_f32_16x16x32_bf16 v[104:107], v[36:39], v[136:139], v[104:107]
  v_and_b32 v249, 0xffff0000, v12
  v_lshlrev_b32 v250, 16, v13
  v_mfma_f32_16x16x32_bf16 v[108:111], v[36:39], v[140:143], v[108:111]
  ds_read_b64_tr_b16 v[36:37], v9 offset:33792
  ds_read_b64_tr_b16 v[38:39], v9 offset:34048
  v_and_b32 v251, 0xffff0000, v13
  v_lshlrev_b32 v252, 16, v14
  v_mfma_f32_16x16x32_bf16 v[112:115], v[40:43], v[136:139], v[112:115]
  v_and_b32 v253, 0xffff0000, v14
  v_lshlrev_b32 v254, 16, v15
  v_mfma_f32_16x16x32_bf16 v[116:119], v[40:43], v[140:143], v[116:119]
  ds_read_b64_tr_b16 v[40:41], v8 offset:34304
  ds_read_b64_tr_b16 v[42:43], v8 offset:34560
  v_and_b32 v255, 0xffff0000, v15
  v_add_f32 v238, v248, v249
  v_mfma_f32_16x16x32_bf16 v[120:123], v[44:47], v[136:139], v[120:123]
  v_add_f32 v239, v250, v251
  v_add_f32 v240, v252, v253
  v_mfma_f32_16x16x32_bf16 v[124:127], v[44:47], v[140:143], v[124:127]
  ds_read_b64_tr_b16 v[44:45], v9 offset:34304
  ds_read_b64_tr_b16 v[46:47], v9 offset:34560
  v_add_f32 v241, v254, v255
  v_add_f32 v238, v238, v239
  s_waitcnt lgkmcnt(12)
  v_mfma_f32_16x16x32_bf16 v[64:67], v[16:19], v[144:147], v[64:67]
  s_waitcnt vmcnt(8)
  ds_read_b128 v[160:163], v6 offset:0
  v_mfma_f32_16x16x32_bf16 v[68:71], v[16:19], v[148:151], v[68:71]
  ds_read_b64_tr_b16 v[16:17], v8 offset:40960
  ds_read_b64_tr_b16 v[18:19], v8 offset:41216
  ds_read_b128 v[164:167], v6 offset:2048
  ds_read_b128 v[168:171], v6 offset:64
  v_mfma_f32_16x16x32_bf16 v[72:75], v[20:23], v[144:147], v[72:75]
  ds_read_b128 v[172:175], v6 offset:2112
  v_add_f32 v240, v240, v241
  v_mfma_f32_16x16x32_bf16 v[76:79], v[20:23], v[148:151], v[76:79]
  ds_read_b64_tr_b16 v[20:21], v9 offset:40960
  ds_read_b64_tr_b16 v[22:23], v9 offset:41216
  v_add_f32 v238, v238, v240
  s_nop 1
  v_add_f32_dpp v238, v238, v238 row_shr:1 row_mask:0xf bank_mask:0xf
  s_waitcnt lgkmcnt(15)
  v_mfma_f32_16x16x32_bf16 v[80:83], v[24:27], v[144:147], v[80:83]
  v_add_f32_dpp v238, v238, v238 row_shr:2 row_mask:0xf bank_mask:0xf
  s_nop 1
  v_add_f32_dpp v238, v238, v238 row_shr:4 row_mask:0xf bank_mask:0xf
  v_mfma_f32_16x16x32_bf16 v[84:87], v[24:27], v[148:151], v[84:87]
  ds_read_b64_tr_b16 v[24:25], v8 offset:41472
  ds_read_b64_tr_b16 v[26:27], v8 offset:41728
  v_add_f32_dpp v238, v238, v238 row_shr:8 row_mask:0xf bank_mask:0xf
  s_nop 1
  v_add_f32_dpp v238, v238, v238 row_bcast:15 row_mask:0xa bank_mask:0xf
  v_mfma_f32_16x16x32_bf16 v[88:91], v[28:31], v[144:147], v[88:91]
  s_nop 0
  v_add_f32_dpp v238, v238, v238 row_bcast:31 row_mask:0xc bank_mask:0xf
  s_nop 0
  v_readlane_b32 s66, v238, 63
  v_mfma_f32_16x16x32_bf16 v[92:95], v[28:31], v[148:151], v[92:95]
  ds_read_b64_tr_b16 v[28:29], v9 offset:41472
  ds_read_b64_tr_b16 v[30:31], v9 offset:41728
  v_mov_b32 v239, 0x3b000000
  v_mul_f32 v239, s66, v239
  s_waitcnt lgkmcnt(15)
  v_mfma_f32_16x16x32_bf16 v[96:99], v[32:35], v[144:147], v[96:99]
  s_waitcnt lgkmcnt(6)
  s_add_u32 m0, s60, 0
  s_add_u32 s64, s57, 0
  buffer_load_dwordx4 v5, s[32:35], s64 offen offset:0 lds
  v_mfma_f32_16x16x32_bf16 v[100:103], v[32:35], v[148:151], v[100:103]
  ds_read_b64_tr_b16 v[32:33], v8 offset:41984
  ds_read_b64_tr_b16 v[34:35], v8 offset:42240
  s_add_u32 m0, s60, 0
  s_add_u32 s64, s57, 7168
  buffer_load_dwordx4 v5, s[32:35], s64 offen offset:1024 lds
  v_mfma_f32_16x16x32_bf16 v[104:107], v[36:39], v[144:147], v[104:107]
  s_add_u32 m0, s60, 0
  s_add_u32 s64, s57, 14336
  buffer_load_dwordx4 v5, s[32:35], s64 offen offset:2048 lds
  v_mfma_f32_16x16x32_bf16 v[108:111], v[36:39], v[148:151], v[108:111]
  ds_read_b64_tr_b16 v[36:37], v9 offset:41984
  ds_read_b64_tr_b16 v[38:39], v9 offset:42240
  s_add_u32 m0, s60, 0
  s_add_u32 s64, s57, 21504
  buffer_load_dwordx4 v5, s[32:35], s64 offen offset:3072 lds
  v_mfma_f32_16x16x32_bf16 v[112:115], v[40:43], v[144:147], v[112:115]
  s_add_u32 s57, s57, 128
  s_and_b32 s57, s57, 0x3ff
  v_mfma_f32_16x16x32_bf16 v[116:119], v[40:43], v[148:151], v[116:119]
  ds_read_b64_tr_b16 v[40:41], v8 offset:42496
  ds_read_b64_tr_b16 v[42:43], v8 offset:42752
  v_sub_f32 v240, v248, v239
  v_sub_f32 v241, v249, v239
  v_mfma_f32_16x16x32_bf16 v[120:123], v[44:47], v[144:147], v[120:123]
  v_sub_f32 v242, v250, v239
  v_sub_f32 v243, v251, v239
  v_mfma_f32_16x16x32_bf16 v[124:127], v[44:47], v[148:151], v[124:127]
  ds_read_b64_tr_b16 v[44:45], v9 offset:42496
  ds_read_b64_tr_b16 v[46:47], v9 offset:42752
  v_sub_f32 v244, v252, v239
  v_sub_f32 v245, v253, v239
  s_waitcnt lgkmcnt(12)
  v_mfma_f32_16x16x32_bf16 v[64:67], v[16:19], v[152:155], v[64:67]
  s_barrier
  s_add_u32 m0, s59, 16384
  s_nop 0
  buffer_load_dwordx4 v4, s[12:15], s56 offen lds
  v_mfma_f32_16x16x32_bf16 v[68:71], v[16:19], v[156:159], v[68:71]
  ds_read_b64_tr_b16 v[16:17], v8 offset:49152
  ds_read_b64_tr_b16 v[18:19], v8 offset:49408
  s_add_u32 m0, s59, 17280
  s_add_u32 s65, s56, 0x80000
  buffer_load_dwordx4 v4, s[12:15], s56 offen offset:128 lds
  s_and_b32 s56, s65, 0x3fffff
  v_mfma_f32_16x16x32_bf16 v[72:75], v[20:23], v[152:155], v[72:75]
  v_sub_f32 v246, v254, v239
  v_sub_f32 v247, v255, v239
  v_mfma_f32_16x16x32_bf16 v[76:79], v[20:23], v[156:159], v[76:79]
  ds_read_b64_tr_b16 v[20:21], v9 offset:49152
  ds_read_b64_tr_b16 v[22:23], v9 offset:49408
  v_mul_f32 v238, v240, v240
  v_fmac_f32 v238, v241, v241
  s_waitcnt lgkmcnt(12)
  v_mfma_f32_16x16x32_bf16 v[80:83], v[24:27], v[152:155], v[80:83]
  v_fmac_f32 v238, v242, v242
  v_fmac_f32 v238, v243, v243
  v_mfma_f32_16x16x32_bf16 v[84:87], v[24:27], v[156:159], v[84:87]
  ds_read_b64_tr_b16 v[24:25], v8 offset:49664
  ds_read_b64_tr_b16 v[26:27], v8 offset:49920
  v_fmac_f32 v238, v244, v244
  v_fmac_f32 v238, v245, v245
  v_mfma_f32_16x16x32_bf16 v[88:91], v[28:31], v[152:155], v[88:91]
  v_fmac_f32 v238, v246, v246
  v_fmac_f32 v238, v247, v247
  v_mfma_f32_16x16x32_bf16 v[92:95], v[28:31], v[156:159], v[92:95]
  ds_read_b64_tr_b16 v[28:29], v9 offset:49664
  ds_read_b64_tr_b16 v[30:31], v9 offset:49920
  v_add_f32_dpp v238, v238, v238 row_shr:1 row_mask:0xf bank_mask:0xf
  s_nop 1
  v_add_f32_dpp v238, v238, v238 row_shr:2 row_mask:0xf bank_mask:0xf
  s_waitcnt lgkmcnt(12)
  v_mfma_f32_16x16x32_bf16 v[96:99], v[32:35], v[152:155], v[96:99]
  v_add_f32_dpp v238, v238, v238 row_shr:4 row_mask:0xf bank_mask:0xf
  s_nop 1
  v_add_f32_dpp v238, v238, v238 row_shr:8 row_mask:0xf bank_mask:0xf
  v_mfma_f32_16x16x32_bf16 v[100:103], v[32:35], v[156:159], v[100:103]
  ds_read_b64_tr_b16 v[32:33], v8 offset:50176
  ds_read_b64_tr_b16 v[34:35], v8 offset:50432
  v_add_f32_dpp v238, v238, v238 row_bcast:15 row_mask:0xa bank_mask:0xf
  s_nop 1
  v_add_f32_dpp v238, v238, v238 row_bcast:31 row_mask:0xc bank_mask:0xf
  v_mfma_f32_16x16x32_bf16 v[104:107], v[36:39], v[152:155], v[104:107]
  v_readlane_b32 s67, v238, 63
  v_mov_b32 v240, 0x3b000000
  v_mfma_f32_16x16x32_bf16 v[108:111], v[36:39], v[156:159], v[108:111]
  ds_read_b64_tr_b16 v[36:37], v9 offset:50176
  ds_read_b64_tr_b16 v[38:39], v9 offset:50432
  v_mul_f32 v240, s67, v240
  v_cvt_pk_bf16_f32 v238, v239, v240
  s_waitcnt lgkmcnt(12)
  v_mfma_f32_16x16x32_bf16 v[112:115], v[40:43], v[152:155], v[112:115]
  v_lshlrev_b32 v239, 16, v238
  v_and_b32 v240, 0xffff0000, v238
  v_mfma_f32_16x16x32_bf16 v[116:119], v[40:43], v[156:159], v[116:119]
  ds_read_b64_tr_b16 v[40:41], v8 offset:50688
  ds_read_b64_tr_b16 v[42:43], v8 offset:50944
  v_add_f32 v240, 0x3727c5ac, v240
  v_cvt_pk_bf16_f32 v238, v240, v241
  v_mfma_f32_16x16x32_bf16 v[120:123], v[44:47], v[152:155], v[120:123]
  v_lshlrev_b32 v240, 16, v238
  v_and_b32 v241, 0xffff0000, v238
  v_mfma_f32_16x16x32_bf16 v[124:127], v[44:47], v[156:159], v[124:127]
  ds_read_b64_tr_b16 v[44:45], v9 offset:50688
  ds_read_b64_tr_b16 v[46:47], v9 offset:50944
  v_sqrt_f32 v240, v240
  s_nop 0
  v_cvt_pk_bf16_f32 v238, v240, v241
  s_waitcnt lgkmcnt(12)
  v_mfma_f32_16x16x32_bf16 v[64:67], v[16:19], v[160:163], v[64:67]
  s_waitcnt vmcnt(8)
  ds_read_b128 v[176:179], v6 offset:32768
  v_mfma_f32_16x16x32_bf16 v[68:71], v[16:19], v[164:167], v[68:71]
  ds_read_b64_tr_b16 v[16:17], v8 offset:57344
  ds_read_b64_tr_b16 v[18:19], v8 offset:57600
  ds_read_b128 v[180:183], v6 offset:34816
  ds_read_b128 v[184:187], v6 offset:32832
  v_mfma_f32_16x16x32_bf16 v[72:75], v[20:23], v[160:163], v[72:75]
  ds_read_b128 v[188:191], v6 offset:34880
  v_lshlrev_b32 v240, 16, v238
  v_mfma_f32_16x16x32_bf16 v[76:79], v[20:23], v[164:167], v[76:79]
  ds_read_b64_tr_b16 v[20:21], v9 offset:57344
  ds_read_b64_tr_b16 v[22:23], v9 offset:57600
  v_and_b32 v241, 0xffff0000, v238
  v_rcp_f32 v240, v240
  s_waitcnt lgkmcnt(15)
  v_mfma_f32_16x16x32_bf16 v[80:83], v[24:27], v[160:163], v[80:83]
  v_sub_f32 v248, v248, v239
  v_sub_f32 v249, v249, v239
  v_mfma_f32_16x16x32_bf16 v[84:87], v[24:27], v[164:167], v[84:87]
  ds_read_b64_tr_b16 v[24:25], v8 offset:57856
  ds_read_b64_tr_b16 v[26:27], v8 offset:58112
  v_sub_f32 v250, v250, v239
  v_sub_f32 v251, v251, v239
  v_mfma_f32_16x16x32_bf16 v[88:91], v[28:31], v[160:163], v[88:91]
  v_sub_f32 v252, v252, v239
  v_sub_f32 v253, v253, v239
  v_mfma_f32_16x16x32_bf16 v[92:95], v[28:31], v[164:167], v[92:95]
  ds_read_b64_tr_b16 v[28:29], v9 offset:57856
  ds_read_b64_tr_b16 v[30:31], v9 offset:58112
  v_sub_f32 v254, v254, v239
  v_sub_f32 v255, v255, v239
  s_waitcnt lgkmcnt(15)
  v_mfma_f32_16x16x32_bf16 v[96:99], v[32:35], v[160:163], v[96:99]
  s_waitcnt lgkmcnt(6)
  s_add_u32 m0, s60, 32768
  s_add_u32 s64, s57, 0
  buffer_load_dwordx4 v5, s[32:35], s64 offen offset:0 lds
  v_mfma_f32_16x16x32_bf16 v[100:103], v[32:35], v[164:167], v[100:103]
  ds_read_b64_tr_b16 v[32:33], v8 offset:58368
  ds_read_b64_tr_b16 v[34:35], v8 offset:58624
  s_add_u32 m0, s60, 32768
  s_add_u32 s64, s57, 7168
  buffer_load_dwordx4 v5, s[32:35], s64 offen offset:1024 lds
  v_mfma_f32_16x16x32_bf16 v[104:107], v[36:39], v[160:163], v[104:107]
  s_add_u32 m0, s60, 32768
  s_add_u32 s64, s57, 14336
  buffer_load_dwordx4 v5, s[32:35], s64 offen offset:2048 lds
  v_mfma_f32_16x16x32_bf16 v[108:111], v[36:39], v[164:167], v[108:111]
  ds_read_b64_tr_b16 v[36:37], v9 offset:58368
  ds_read_b64_tr_b16 v[38:39], v9 offset:58624
  s_add_u32 m0, s60, 32768
  s_add_u32 s64, s57, 21504
  buffer_load_dwordx4 v5, s[32:35], s64 offen offset:3072 lds
  v_mfma_f32_16x16x32_bf16 v[112:115], v[40:43], v[160:163], v[112:115]
  s_add_u32 s57, s57, 128
  s_and_b32 s57, s57, 0x3ff
  v_mfma_f32_16x16x32_bf16 v[116:119], v[40:43], v[164:167], v[116:119]
  ds_read_b64_tr_b16 v[40:41], v8 offset:58880
  ds_read_b64_tr_b16 v[42:43], v8 offset:59136
  v_cvt_pk_bf16_f32 v241, v248, v249
  v_cvt_pk_bf16_f32 v242, v250, v251
  v_mfma_f32_16x16x32_bf16 v[120:123], v[44:47], v[160:163], v[120:123]
  v_cvt_pk_bf16_f32 v243, v252, v253
  v_cvt_pk_bf16_f32 v244, v254, v255
  v_mfma_f32_16x16x32_bf16 v[124:127], v[44:47], v[164:167], v[124:127]
  ds_read_b64_tr_b16 v[44:45], v9 offset:58880
  ds_read_b64_tr_b16 v[46:47], v9 offset:59136
  v_lshlrev_b32 v248, 16, v241
  v_and_b32 v249, 0xffff0000, v241
  s_waitcnt lgkmcnt(12)
  v_mfma_f32_16x16x32_bf16 v[64:67], v[16:19], v[168:171], v[64:67]
  s_barrier
  s_add_u32 m0, s59, 32768
  s_nop 0
  buffer_load_dwordx4 v4, s[12:15], s56 offen lds
  v_mfma_f32_16x16x32_bf16 v[68:71], v[16:19], v[172:175], v[68:71]
  v_add_u32 v8, 0x10000, v8
  v_add_u32 v9, 0x10000, v9
  ds_read_b64_tr_b16 v[16:17], v8 offset:0
  ds_read_b64_tr_b16 v[18:19], v8 offset:256
  s_add_u32 m0, s59, 33664
  s_add_u32 s65, s56, 0x80000
  buffer_load_dwordx4 v4, s[12:15], s56 offen offset:128 lds
  s_and_b32 s56, s65, 0x3fffff
  v_mfma_f32_16x16x32_bf16 v[72:75], v[20:23], v[168:171], v[72:75]
  v_lshlrev_b32 v250, 16, v242
  v_and_b32 v251, 0xffff0000, v242
  v_mfma_f32_16x16x32_bf16 v[76:79], v[20:23], v[172:175], v[76:79]
  ds_read_b64_tr_b16 v[20:21], v9 offset:0
  ds_read_b64_tr_b16 v[22:23], v9 offset:256
  v_lshlrev_b32 v252, 16, v243
  v_and_b32 v253, 0xffff0000, v243
  s_waitcnt lgkmcnt(12)
  v_mfma_f32_16x16x32_bf16 v[80:83], v[24:27], v[168:171], v[80:83]
  v_lshlrev_b32 v254, 16, v244
  v_and_b32 v255, 0xffff0000, v244
  v_mfma_f32_16x16x32_bf16 v[84:87], v[24:27], v[172:175], v[84:87]
  ds_read_b64_tr_b16 v[24:25], v8 offset:512
  ds_read_b64_tr_b16 v[26:27], v8 offset:768
  v_mul_f32 v248, v248, v240
  v_mul_f32 v249, v249, v240
  v_mfma_f32_16x16x32_bf16 v[88:91], v[28:31], v[168:171], v[88:91]
  v_mul_f32 v250, v250, v240
  v_mul_f32 v251, v251, v240
  v_mfma_f32_16x16x32_bf16 v[92:95], v[28:31], v[172:175], v[92:95]
  ds_read_b64_tr_b16 v[28:29], v9 offset:512
  ds_read_b64_tr_b16 v[30:31], v9 offset:768
  v_mul_f32 v252, v252, v240
  v_mul_f32 v253, v253, v240
  s_waitcnt lgkmcnt(12)
  v_mfma_f32_16x16x32_bf16 v[96:99], v[32:35], v[168:171], v[96:99]
  v_mul_f32 v254, v254, v240
  v_mul_f32 v255, v255, v240
  v_mfma_f32_16x16x32_bf16 v[100:103], v[32:35], v[172:175], v[100:103]
  ds_read_b64_tr_b16 v[32:33], v8 offset:1024
  ds_read_b64_tr_b16 v[34:35], v8 offset:1280
  v_cvt_pk_bf16_f32 v12, v248, v249
  v_cvt_pk_bf16_f32 v13, v250, v251
  v_mfma_f32_16x16x32_bf16 v[104:107], v[36:39], v[168:171], v[104:107]
  v_cvt_pk_bf16_f32 v14, v252, v253
  v_cvt_pk_bf16_f32 v15, v254, v255
  v_mfma_f32_16x16x32_bf16 v[108:111], v[36:39], v[172:175], v[108:111]
  ds_read_b64_tr_b16 v[36:37], v9 offset:1024
  ds_read_b64_tr_b16 v[38:39], v9 offset:1280
  s_waitcnt lgkmcnt(12)
  v_mfma_f32_16x16x32_bf16 v[112:115], v[40:43], v[168:171], v[112:115]
  v_mfma_f32_16x16x32_bf16 v[116:119], v[40:43], v[172:175], v[116:119]
  ds_read_b64_tr_b16 v[40:41], v8 offset:1536
  ds_read_b64_tr_b16 v[42:43], v8 offset:1792
  v_mfma_f32_16x16x32_bf16 v[120:123], v[44:47], v[168:171], v[120:123]
  v_mfma_f32_16x16x32_bf16 v[124:127], v[44:47], v[172:175], v[124:127]
  ds_read_b64_tr_b16 v[44:45], v9 offset:1536
  ds_read_b64_tr_b16 v[46:47], v9 offset:1792
  s_waitcnt lgkmcnt(12)
  v_mfma_f32_16x16x32_bf16 v[64:67], v[16:19], v[176:179], v[64:67]
  s_waitcnt vmcnt(8)
  ds_read_b128 v[192:195], v6 offset:0
  v_mfma_f32_16x16x32_bf16 v[68:71], v[16:19], v[180:183], v[68:71]
  ds_read_b64_tr_b16 v[16:17], v8 offset:8192
  ds_read_b64_tr_b16 v[18:19], v8 offset:8448
  ds_read_b128 v[196:199], v6 offset:2048
  ds_read_b128 v[200:203], v6 offset:64
  v_mfma_f32_16x16x32_bf16 v[72:75], v[20:23], v[176:179], v[72:75]
  ds_read_b128 v[204:207], v6 offset:2112
  v_mfma_f32_16x16x32_bf16 v[76:79], v[20:23], v[180:183], v[76:79]
  ds_read_b64_tr_b16 v[20:21], v9 offset:8192
  ds_read_b64_tr_b16 v[22:23], v9 offset:8448
  s_waitcnt lgkmcnt(15)
  v_mfma_f32_16x16x32_bf16 v[80:83], v[24:27], v[176:179], v[80:83]
  v_mfma_f32_16x16x32_bf16 v[84:87], v[24:27], v[180:183], v[84:87]
  ds_read_b64_tr_b16 v[24:25], v8 offset:8704
  ds_read_b64_tr_b16 v[26:27], v8 offset:8960
  v_mfma_f32_16x16x32_bf16 v[88:91], v[28:31], v[176:179], v[88:91]
  v_mfma_f32_16x16x32_bf16 v[92:95], v[28:31], v[180:183], v[92:95]
  ds_read_b64_tr_b16 v[28:29], v9 offset:8704
  ds_read_b64_tr_b16 v[30:31], v9 offset:8960
  s_waitcnt lgkmcnt(15)
  v_mfma_f32_16x16x32_bf16 v[96:99], v[32:35], v[176:179], v[96:99]
  s_waitcnt lgkmcnt(6)
  s_add_u32 m0, s60, 0
  s_add_u32 s64, s57, 0
  buffer_load_dwordx4 v5, s[32:35], s64 offen offset:0 lds
  v_mfma_f32_16x16x32_bf16 v[100:103], v[32:35], v[180:183], v[100:103]
  ds_read_b64_tr_b16 v[32:33], v8 offset:9216
  ds_read_b64_tr_b16 v[34:35], v8 offset:9472
  s_add_u32 m0, s60, 0
  s_add_u32 s64, s57, 7168
  buffer_load_dwordx4 v5, s[32:35], s64 offen offset:1024 lds
  v_mfma_f32_16x16x32_bf16 v[104:107], v[36:39], v[176:179], v[104:107]
  s_add_u32 m0, s60, 0
  s_add_u32 s64, s57, 14336
  buffer_load_dwordx4 v5, s[32:35], s64 offen offset:2048 lds
  v_mfma_f32_16x16x32_bf16 v[108:111], v[36:39], v[180:183], v[108:111]
  ds_read_b64_tr_b16 v[36:37], v9 offset:9216
  ds_read_b64_tr_b16 v[38:39], v9 offset:9472
  s_add_u32 m0, s60, 0
  s_add_u32 s64, s57, 21504
  buffer_load_dwordx4 v5, s[32:35], s64 offen offset:3072 lds
  v_mfma_f32_16x16x32_bf16 v[112:115], v[40:43], v[176:179], v[112:115]
  s_add_u32 s57, s57, 128
  s_and_b32 s57, s57, 0x3ff
  v_mfma_f32_16x16x32_bf16 v[116:119], v[40:43], v[180:183], v[116:119]
  ds_read_b64_tr_b16 v[40:41], v8 offset:9728
  ds_read_b64_tr_b16 v[42:43], v8 offset:9984
  v_mfma_f32_16x16x32_bf16 v[120:123], v[44:47], v[176:179], v[120:123]
  v_mfma_f32_16x16x32_bf16 v[124:127], v[44:47], v[180:183], v[124:127]
  ds_read_b64_tr_b16 v[44:45], v9 offset:9728
  ds_read_b64_tr_b16 v[46:47], v9 offset:9984
  v_subrev_u32 v8, 0x10000, v8
  v_subrev_u32 v9, 0x10000, v9
  s_waitcnt lgkmcnt(12)
  v_mfma_f32_16x16x32_bf16 v[64:67], v[16:19], v[184:187], v[64:67]
  s_barrier
  s_cmp_eq_u32 s3, 0
  s_cselect_b32 s6, 0, s54
  v_mov_b32 v0, 0
  buffer_load_dword v3, v0, s[68:71], s6 offen sc1
  v_mfma_f32_16x16x32_bf16 v[68:71], v[16:19], v[188:191], v[68:71]
  ds_read_b64_tr_b16 v[16:17], v8 offset:0
  ds_read_b64_tr_b16 v[18:19], v8 offset:256
  s_add_u32 m0, s59, 49152
  s_nop 0
  buffer_load_dwordx4 v4, s[12:15], s56 offen lds
  v_mfma_f32_16x16x32_bf16 v[72:75], v[20:23], v[184:187], v[72:75]
  s_add_u32 m0, s59, 50048
  s_add_u32 s65, s56, 0x80000
  buffer_load_dwordx4 v4, s[12:15], s56 offen offset:128 lds
  s_and_b32 s56, s65, 0x3fffff
  v_mfma_f32_16x16x32_bf16 v[76:79], v[20:23], v[188:191], v[76:79]
  ds_read_b64_tr_b16 v[20:21], v9 offset:0
  ds_read_b64_tr_b16 v[22:23], v9 offset:256
  s_waitcnt lgkmcnt(12)
  v_mfma_f32_16x16x32_bf16 v[80:83], v[24:27], v[184:187], v[80:83]
  v_mfma_f32_16x16x32_bf16 v[84:87], v[24:27], v[188:191], v[84:87]
  ds_read_b64_tr_b16 v[24:25], v8 offset:512
  ds_read_b64_tr_b16 v[26:27], v8 offset:768
  v_mfma_f32_16x16x32_bf16 v[88:91], v[28:31], v[184:187], v[88:91]
  v_mfma_f32_16x16x32_bf16 v[92:95], v[28:31], v[188:191], v[92:95]
  ds_read_b64_tr_b16 v[28:29], v9 offset:512
  ds_read_b64_tr_b16 v[30:31], v9 offset:768
  s_waitcnt lgkmcnt(12)
  v_mfma_f32_16x16x32_bf16 v[96:99], v[32:35], v[184:187], v[96:99]
  v_mfma_f32_16x16x32_bf16 v[100:103], v[32:35], v[188:191], v[100:103]
  ds_read_b64_tr_b16 v[32:33], v8 offset:1024
  ds_read_b64_tr_b16 v[34:35], v8 offset:1280
  v_mfma_f32_16x16x32_bf16 v[104:107], v[36:39], v[184:187], v[104:107]
  v_mfma_f32_16x16x32_bf16 v[108:111], v[36:39], v[188:191], v[108:111]
  ds_read_b64_tr_b16 v[36:37], v9 offset:1024
  ds_read_b64_tr_b16 v[38:39], v9 offset:1280
  s_waitcnt lgkmcnt(12)
  v_mfma_f32_16x16x32_bf16 v[112:115], v[40:43], v[184:187], v[112:115]
  v_mfma_f32_16x16x32_bf16 v[116:119], v[40:43], v[188:191], v[116:119]
  ds_read_b64_tr_b16 v[40:41], v8 offset:1536
  ds_read_b64_tr_b16 v[42:43], v8 offset:1792
  v_mfma_f32_16x16x32_bf16 v[120:123], v[44:47], v[184:187], v[120:123]
  v_mfma_f32_16x16x32_bf16 v[124:127], v[44:47], v[188:191], v[124:127]
  ds_read_b64_tr_b16 v[44:45], v9 offset:1536
  ds_read_b64_tr_b16 v[46:47], v9 offset:1792
  s_waitcnt lgkmcnt(12)
  v_mfma_f32_16x16x32_bf16 v[64:67], v[16:19], v[192:195], v[64:67]
  s_waitcnt vmcnt(9)
  ds_read_b128 v[208:211], v6 offset:32768
  v_mfma_f32_16x16x32_bf16 v[68:71], v[16:19], v[196:199], v[68:71]
  ds_read_b64_tr_b16 v[16:17], v8 offset:8192
  ds_read_b64_tr_b16 v[18:19], v8 offset:8448
  ds_read_b128 v[212:215], v6 offset:34816
  ds_read_b128 v[216:219], v6 offset:32832
  v_mfma_f32_16x16x32_bf16 v[72:75], v[20:23], v[192:195], v[72:75]
  ds_read_b128 v[220:223], v6 offset:34880
  v_mfma_f32_16x16x32_bf16 v[76:79], v[20:23], v[196:199], v[76:79]
  ds_read_b64_tr_b16 v[20:21], v9 offset:8192
  ds_read_b64_tr_b16 v[22:23], v9 offset:8448
  s_waitcnt lgkmcnt(15)
  v_mfma_f32_16x16x32_bf16 v[80:83], v[24:27], v[192:195], v[80:83]
  v_mfma_f32_16x16x32_bf16 v[84:87], v[24:27], v[196:199], v[84:87]
  ds_read_b64_tr_b16 v[24:25], v8 offset:8704
  ds_read_b64_tr_b16 v[26:27], v8 offset:8960
  v_mfma_f32_16x16x32_bf16 v[88:91], v[28:31], v[192:195], v[88:91]
  v_mfma_f32_16x16x32_bf16 v[92:95], v[28:31], v[196:199], v[92:95]
  ds_read_b64_tr_b16 v[28:29], v9 offset:8704
  ds_read_b64_tr_b16 v[30:31], v9 offset:8960
  s_waitcnt lgkmcnt(15)
  v_mfma_f32_16x16x32_bf16 v[96:99], v[32:35], v[192:195], v[96:99]
  s_waitcnt lgkmcnt(6)
  s_add_u32 m0, s60, 32768
  s_add_u32 s64, s57, 0
  buffer_load_dwordx4 v5, s[32:35], s64 offen offset:0 lds
  v_mfma_f32_16x16x32_bf16 v[100:103], v[32:35], v[196:199], v[100:103]
  ds_read_b64_tr_b16 v[32:33], v8 offset:9216
  ds_read_b64_tr_b16 v[34:35], v8 offset:9472
  s_add_u32 m0, s60, 32768
  s_add_u32 s64, s57, 7168
  buffer_load_dwordx4 v5, s[32:35], s64 offen offset:1024 lds
  v_mfma_f32_16x16x32_bf16 v[104:107], v[36:39], v[192:195], v[104:107]
  s_add_u32 m0, s60, 32768
  s_add_u32 s64, s57, 14336
  buffer_load_dwordx4 v5, s[32:35], s64 offen offset:2048 lds
  v_mfma_f32_16x16x32_bf16 v[108:111], v[36:39], v[196:199], v[108:111]
  ds_read_b64_tr_b16 v[36:37], v9 offset:9216
  ds_read_b64_tr_b16 v[38:39], v9 offset:9472
  s_add_u32 m0, s60, 32768
  s_add_u32 s64, s57, 21504
  buffer_load_dwordx4 v5, s[32:35], s64 offen offset:3072 lds
  v_mfma_f32_16x16x32_bf16 v[112:115], v[40:43], v[192:195], v[112:115]
  s_add_u32 s57, s57, 128
  s_and_b32 s57, s57, 0x3ff
  v_mfma_f32_16x16x32_bf16 v[116:119], v[40:43], v[196:199], v[116:119]
  ds_read_b64_tr_b16 v[40:41], v8 offset:9728
  ds_read_b64_tr_b16 v[42:43], v8 offset:9984
  v_mfma_f32_16x16x32_bf16 v[120:123], v[44:47], v[192:195], v[120:123]
  v_mfma_f32_16x16x32_bf16 v[124:127], v[44:47], v[196:199], v[124:127]
  ds_read_b64_tr_b16 v[44:45], v9 offset:9728
  ds_read_b64_tr_b16 v[46:47], v9 offset:9984
  s_waitcnt lgkmcnt(12)
  v_mfma_f32_16x16x32_bf16 v[64:67], v[16:19], v[200:203], v[64:67]
  s_waitcnt vmcnt(6)
  s_cmp_lg_u32 s3, 0
  s_cbranch_scc1 pw_3
  v_readfirstlane_b32 s9, v3
  s_nop 0
  s_cmp_ge_u32 s9, 64
  s_cbranch_scc0 spin_4
pw_3:
  s_barrier
  s_add_u32 m0, s59, 65536
  s_nop 0
  buffer_load_dwordx4 v4, s[16:19], s56 offen lds
  v_mfma_f32_16x16x32_bf16 v[68:71], v[16:19], v[204:207], v[68:71]
  ds_read_b64_tr_b16 v[16:17], v8 offset:16384
  ds_read_b64_tr_b16 v[18:19], v8 offset:16640
  s_add_u32 m0, s59, 66432
  s_add_u32 s65, s56, 0x80000
  buffer_load_dwordx4 v4, s[16:19], s56 offen offset:128 lds
  s_and_b32 s56, s65, 0x3fffff
  v_mfma_f32_16x16x32_bf16 v[72:75], v[20:23], v[200:203], v[72:75]
  v_lshlrev_b32 v0, 3, v1
  s_lshl_b32 s66, s3, 9
  v_mfma_f32_16x16x32_bf16 v[76:79], v[20:23], v[204:207], v[76:79]
  ds_read_b64_tr_b16 v[20:21], v9 offset:16384
  ds_read_b64_tr_b16 v[22:23], v9 offset:16640
  s_add_u32 s66, s66, 0x4000
  buffer_load_dwordx2 v[48:49], v0, s[36:39], s66 offen sc1
  s_add_u32 s66, s66, 12288
  s_waitcnt lgkmcnt(12)
  v_mfma_f32_16x16x32_bf16 v[80:83], v[24:27], v[200:203], v[80:83]
  buffer_load_dwordx2 v[50:51], v0, s[36:39], s66 offen sc1
  s_add_u32 s66, s66, 12288
  v_mfma_f32_16x16x32_bf16 v[84:87], v[24:27], v[204:207], v[84:87]
  ds_read_b64_tr_b16 v[24:25], v8 offset:16896
  ds_read_b64_tr_b16 v[26:27], v8 offset:17152
  buffer_load_dwordx2 v[52:53], v0, s[36:39], s66 offen sc1
  s_add_u32 s66, s66, 12288
  v_mfma_f32_16x16x32_bf16 v[88:91], v[28:31], v[200:203], v[88:91]
  buffer_load_dwordx2 v[54:55], v0, s[36:39], s66 offen sc1
  v_mfma_f32_16x16x32_bf16 v[92:95], v[28:31], v[204:207], v[92:95]
  ds_read_b64_tr_b16 v[28:29], v9 offset:16896
  ds_read_b64_tr_b16 v[30:31], v9 offset:17152
  s_waitcnt lgkmcnt(12)
  v_mfma_f32_16x16x32_bf16 v[96:99], v[32:35], v[200:203], v[96:99]
  v_mfma_f32_16x16x32_bf16 v[100:103], v[32:35], v[204:207], v[100:103]
  ds_read_b64_tr_b16 v[32:33], v8 offset:17408
  ds_read_b64_tr_b16 v[34:35], v8 offset:17664
  v_mfma_f32_16x16x32_bf16 v[104:107], v[36:39], v[200:203], v[104:107]
  v_mfma_f32_16x16x32_bf16 v[108:111], v[36:39], v[204:207], v[108:111]
  ds_read_b64_tr_b16 v[36:37], v9 offset:17408
  ds_read_b64_tr_b16 v[38:39], v9 offset:17664
  s_waitcnt lgkmcnt(12)
  v_mfma_f32_16x16x32_bf16 v[112:115], v[40:43], v[200:203], v[112:115]
  v_mfma_f32_16x16x32_bf16 v[116:119], v[40:43], v[204:207], v[116:119]
  ds_read_b64_tr_b16 v[40:41], v8 offset:17920
  ds_read_b64_tr_b16 v[42:43], v8 offset:18176
  v_mfma_f32_16x16x32_bf16 v[120:123], v[44:47], v[200:203], v[120:123]
  v_mfma_f32_16x16x32_bf16 v[124:127], v[44:47], v[204:207], v[124:127]
  ds_read_b64_tr_b16 v[44:45], v9 offset:17920
  ds_read_b64_tr_b16 v[46:47], v9 offset:18176
  s_waitcnt lgkmcnt(12)
  v_mfma_f32_16x16x32_bf16 v[64:67], v[16:19], v[208:211], v[64:67]
  ds_read_b128 v[224:227], v6 offset:0
  v_mfma_f32_16x16x32_bf16 v[68:71], v[16:19], v[212:215], v[68:71]
  ds_read_b64_tr_b16 v[16:17], v8 offset:24576
  ds_read_b64_tr_b16 v[18:19], v8 offset:24832
  ds_read_b128 v[228:231], v6 offset:2048
  ds_read_b128 v[232:235], v6 offset:64
  v_mfma_f32_16x16x32_bf16 v[72:75], v[20:23], v[208:211], v[72:75]
  ds_read_b128 v[236:239], v6 offset:2112
  v_mfma_f32_16x16x32_bf16 v[76:79], v[20:23], v[212:215], v[76:79]
  ds_read_b64_tr_b16 v[20:21], v9 offset:24576
  ds_read_b64_tr_b16 v[22:23], v9 offset:24832
  s_waitcnt lgkmcnt(15)
  v_mfma_f32_16x16x32_bf16 v[80:83], v[24:27], v[208:211], v[80:83]
  v_mfma_f32_16x16x32_bf16 v[84:87], v[24:27], v[212:215], v[84:87]
  ds_read_b64_tr_b16 v[24:25], v8 offset:25088
  ds_read_b64_tr_b16 v[26:27], v8 offset:25344
  v_mfma_f32_16x16x32_bf16 v[88:91], v[28:31], v[208:211], v[88:91]
  v_mfma_f32_16x16x32_bf16 v[92:95], v[28:31], v[212:215], v[92:95]
  ds_read_b64_tr_b16 v[28:29], v9 offset:25088
  ds_read_b64_tr_b16 v[30:31], v9 offset:25344
  s_waitcnt lgkmcnt(15)
  v_mfma_f32_16x16x32_bf16 v[96:99], v[32:35], v[208:211], v[96:99]
  v_mfma_f32_16x16x32_bf16 v[100:103], v[32:35], v[212:215], v[100:103]
  ds_read_b64_tr_b16 v[32:33], v8 offset:25600
  ds_read_b64_tr_b16 v[34:35], v8 offset:25856
  v_mfma_f32_16x16x32_bf16 v[104:107], v[36:39], v[208:211], v[104:107]
  v_mfma_f32_16x16x32_bf16 v[108:111], v[36:39], v[212:215], v[108:111]
  ds_read_b64_tr_b16 v[36:37], v9 offset:25600
  ds_read_b64_tr_b16 v[38:39], v9 offset:25856
  s_waitcnt lgkmcnt(15)
  v_mfma_f32_16x16x32_bf16 v[112:115], v[40:43], v[208:211], v[112:115]
  v_mfma_f32_16x16x32_bf16 v[116:119], v[40:43], v[212:215], v[116:119]
  ds_read_b64_tr_b16 v[40:41], v8 offset:26112
  ds_read_b64_tr_b16 v[42:43], v8 offset:26368
  v_mfma_f32_16x16x32_bf16 v[120:123], v[44:47], v[208:211], v[120:123]
  v_mfma_f32_16x16x32_bf16 v[124:127], v[44:47], v[212:215], v[124:127]
  ds_read_b64_tr_b16 v[44:45], v9 offset:26112
  ds_read_b64_tr_b16 v[46:47], v9 offset:26368
  s_waitcnt lgkmcnt(12)
  v_mfma_f32_16x16x32_bf16 v[64:67], v[16:19], v[216:219], v[64:67]
  s_barrier
  s_add_u32 m0, s59, 0
  s_nop 0
  buffer_load_dwordx4 v4, s[16:19], s56 offen lds
  v_mfma_f32_16x16x32_bf16 v[68:71], v[16:19], v[220:223], v[68:71]
  ds_read_b64_tr_b16 v[16:17], v8 offset:32768
  ds_read_b64_tr_b16 v[18:19], v8 offset:33024
  s_add_u32 m0, s59, 896
  s_add_u32 s65, s56, 0x80000
  buffer_load_dwordx4 v4, s[16:19], s56 offen offset:128 lds
  s_and_b32 s56, s65, 0x3fffff
  v_mfma_f32_16x16x32_bf16 v[72:75], v[20:23], v[216:219], v[72:75]
  v_mfma_f32_16x16x32_bf16 v[76:79], v[20:23], v[220:223], v[76:79]
  ds_read_b64_tr_b16 v[20:21], v9 offset:32768
  ds_read_b64_tr_b16 v[22:23], v9 offset:33024
  s_waitcnt lgkmcnt(12)
  v_mfma_f32_16x16x32_bf16 v[80:83], v[24:27], v[216:219], v[80:83]
  v_mfma_f32_16x16x32_bf16 v[84:87], v[24:27], v[220:223], v[84:87]
  ds_read_b64_tr_b16 v[24:25], v8 offset:33280
  ds_read_b64_tr_b16 v[26:27], v8 offset:33536
  v_mfma_f32_16x16x32_bf16 v[88:91], v[28:31], v[216:219], v[88:91]
  v_mfma_f32_16x16x32_bf16 v[92:95], v[28:31], v[220:223], v[92:95]
  ds_read_b64_tr_b16 v[28:29], v9 offset:33280
  ds_read_b64_tr_b16 v[30:31], v9 offset:33536
  s_waitcnt lgkmcnt(12)
  v_mfma_f32_16x16x32_bf16 v[96:99], v[32:35], v[216:219], v[96:99]
  v_mfma_f32_16x16x32_bf16 v[100:103], v[32:35], v[220:223], v[100:103]
  ds_read_b64_tr_b16 v[32:33], v8 offset:33792
  ds_read_b64_tr_b16 v[34:35], v8 offset:34048
  v_mfma_f32_16x16x32_bf16 v[104:107], v[36:39], v[216:219], v[104:107]
  v_mfma_f32_16x16x32_bf16 v[108:111], v[36:39], v[220:223], v[108:111]
  ds_read_b64_tr_b16 v[36:37], v9 offset:33792
  ds_read_b64_tr_b16 v[38:39], v9 offset:34048
  s_waitcnt lgkmcnt(12)
  v_mfma_f32_16x16x32_bf16 v[112:115], v[40:43], v[216:219], v[112:115]
  v_mfma_f32_16x16x32_bf16 v[116:119], v[40:43], v[220:223], v[116:119]
  ds_read_b64_tr_b16 v[40:41], v8 offset:34304
  ds_read_b64_tr_b16 v[42:43], v8 offset:34560
  v_mfma_f32_16x16x32_bf16 v[120:123], v[44:47], v[216:219], v[120:123]
  v_mfma_f32_16x16x32_bf16 v[124:127], v[44:47], v[220:223], v[124:127]
  ds_read_b64_tr_b16 v[44:45], v9 offset:34304
  ds_read_b64_tr_b16 v[46:47], v9 offset:34560
  s_waitcnt lgkmcnt(12)
  v_mfma_f32_16x16x32_bf16 v[64:67], v[16:19], v[224:227], v[64:67]
  s_waitcnt vmcnt(8)
  ds_read_b128 v[240:243], v6 offset:32768
  v_mfma_f32_16x16x32_bf16 v[68:71], v[16:19], v[228:231], v[68:71]
  ds_read_b64_tr_b16 v[16:17], v8 offset:40960
  ds_read_b64_tr_b16 v[18:19], v8 offset:41216
  ds_read_b128 v[244:247], v6 offset:34816
  ds_read_b128 v[248:251], v6 offset:32832
  v_mfma_f32_16x16x32_bf16 v[72:75], v[20:23], v[224:227], v[72:75]
  ds_read_b128 v[252:255], v6 offset:34880
  s_waitcnt vmcnt(2)
  v_mfma_f32_16x16x32_bf16 v[76:79], v[20:23], v[228:231], v[76:79]
  ds_read_b64_tr_b16 v[20:21], v9 offset:40960
  ds_read_b64_tr_b16 v[22:23], v9 offset:41216
  v_add_f32 v48, v48, v50
  v_add_f32 v52, v52, v54
  s_waitcnt lgkmcnt(15)
  v_mfma_f32_16x16x32_bf16 v[80:83], v[24:27], v[224:227], v[80:83]
  v_add_f32 v49, v49, v51
  v_add_f32 v53, v53, v55
  v_mfma_f32_16x16x32_bf16 v[84:87], v[24:27], v[228:231], v[84:87]
  ds_read_b64_tr_b16 v[24:25], v8 offset:41472
  ds_read_b64_tr_b16 v[26:27], v8 offset:41728
  v_add_f32 v48, v48, v52
  v_add_f32 v49, v49, v53
  v_mfma_f32_16x16x32_bf16 v[88:91], v[28:31], v[224:227], v[88:91]
  v_cvt_pk_bf16_f32 v50, v48, v49
  v_lshlrev_b32 v48, 16, v50
  v_mfma_f32_16x16x32_bf16 v[92:95], v[28:31], v[228:231], v[92:95]
  ds_read_b64_tr_b16 v[28:29], v9 offset:41472
  ds_read_b64_tr_b16 v[30:31], v9 offset:41728
  v_and_b32 v49, 0xffff0000, v50
  s_cmp_ge_u32 s3, 4
  s_cselect_b32 s67, 1.0, 0
  s_lshl_b32 s66, s3, 9
  s_add_u32 s66, s66, 67584
  s_waitcnt lgkmcnt(15)
  v_mfma_f32_16x16x32_bf16 v[96:99], v[32:35], v[224:227], v[96:99]
  v_lshlrev_b32 v5, 12, v1
  v_and_b32 v5, 0xe000, v5
  v_lshl_or_b32 v5, v1, 7, v5
  v_and_b32 v5, 0xe080, v5
  v_mfma_f32_16x16x32_bf16 v[100:103], v[32:35], v[228:231], v[100:103]
  ds_read_b64_tr_b16 v[32:33], v8 offset:41984
  ds_read_b64_tr_b16 v[34:35], v8 offset:42240
  s_lshr_b32 s64, s2, 5
  s_lshl_b32 s64, s64, 3
  s_add_u32 s64, s64, s3
  s_lshl_b32 s64, s64, 16
  s_lshl_b32 s65, s41, 8
  s_add_u32 s64, s64, s65
  s_mov_b32 m0, 71680
  s_mov_b64 exec, 0xffff
  buffer_load_dword v5, s[28:31], s64 offen lds
  s_mov_b64 exec, -1
  v_mfma_f32_16x16x32_bf16 v[104:107], v[36:39], v[224:227], v[104:107]
  v_add_f32 v48, s67, v48
  v_add_f32 v49, s67, v49
  v_mfma_f32_16x16x32_bf16 v[108:111], v[36:39], v[228:231], v[108:111]
  ds_read_b64_tr_b16 v[36:37], v9 offset:41984
  ds_read_b64_tr_b16 v[38:39], v9 offset:42240
  v_add_u32 v0, s66, v0
  v_cvt_pk_bf16_f32 v50, v48, v49
  s_waitcnt lgkmcnt(15)
  v_mfma_f32_16x16x32_bf16 v[112:115], v[40:43], v[224:227], v[112:115]
  v_lshlrev_b32 v48, 16, v50
  v_and_b32 v49, 0xffff0000, v50
  v_mfma_f32_16x16x32_bf16 v[116:119], v[40:43], v[228:231], v[116:119]
  ds_read_b64_tr_b16 v[40:41], v8 offset:42496
  ds_read_b64_tr_b16 v[42:43], v8 offset:42752
  ds_write_b64 v0, v[48:49]
  v_mfma_f32_16x16x32_bf16 v[120:123], v[44:47], v[224:227], v[120:123]
  v_mfma_f32_16x16x32_bf16 v[124:127], v[44:47], v[228:231], v[124:127]
  ds_read_b64_tr_b16 v[44:45], v9 offset:42496
  ds_read_b64_tr_b16 v[46:47], v9 offset:42752
  s_waitcnt lgkmcnt(13)
  v_mfma_f32_16x16x32_bf16 v[64:67], v[16:19], v[232:235], v[64:67]
  s_waitcnt lgkmcnt(2)
  s_barrier
  s_add_u32 m0, s59, 16384
  s_nop 0
  buffer_load_dwordx4 v4, s[16:19], s56 offen lds
  v_mfma_f32_16x16x32_bf16 v[68:71], v[16:19], v[236:239], v[68:71]
  ds_read_b64_tr_b16 v[16:17], v8 offset:49152
  ds_read_b64_tr_b16 v[18:19], v8 offset:49408
  s_add_u32 m0, s59, 17280
  s_add_u32 s65, s56, 0x80000
  buffer_load_dwordx4 v4, s[16:19], s56 offen offset:128 lds
  s_and_b32 s56, s65, 0x3fffff
  v_mfma_f32_16x16x32_bf16 v[72:75], v[20:23], v[232:235], v[72:75]
  v_lshlrev_b32 v0, 5, v1
  v_add_u32 v0, 0x10000, v0
  v_mfma_f32_16x16x32_bf16 v[76:79], v[20:23], v[236:239], v[76:79]
  ds_read_b64_tr_b16 v[20:21], v9 offset:49152
  ds_read_b64_tr_b16 v[22:23], v9 offset:49408
  ds_read_b128 v[48:51], v0 offset:4096
  ds_read_b128 v[52:55], v0 offset:4112
  v_mfma_f32_16x16x32_bf16 v[80:83], v[24:27], v[232:235], v[80:83]
  ds_read_b128 v[56:59], v0 offset:2048
  ds_read_b128 v[60:63], v0 offset:2064
  v_mfma_f32_16x16x32_bf16 v[84:87], v[24:27], v[236:239], v[84:87]
  ds_read_b64_tr_b16 v[24:25], v8 offset:49664
  ds_read_b64_tr_b16 v[26:27], v8 offset:49920
  s_waitcnt lgkmcnt(2)
  v_lshlrev_b32 v0, 16, v12
  v_mfma_f32_16x16x32_bf16 v[88:91], v[28:31], v[232:235], v[88:91]
  v_and_b32 v3, 0xffff0000, v12
  v_mul_f32 v48, v0, v48
  v_mfma_f32_16x16x32_bf16 v[92:95], v[28:31], v[236:239], v[92:95]
  ds_read_b64_tr_b16 v[28:29], v9 offset:49664
  ds_read_b64_tr_b16 v[30:31], v9 offset:49920
  v_mul_f32 v49, v3, v49
  v_lshlrev_b32 v0, 16, v13
  v_mfma_f32_16x16x32_bf16 v[96:99], v[32:35], v[232:235], v[96:99]
  v_and_b32 v3, 0xffff0000, v13
  v_mul_f32 v50, v0, v50
  v_mfma_f32_16x16x32_bf16 v[100:103], v[32:35], v[236:239], v[100:103]
  ds_read_b64_tr_b16 v[32:33], v8 offset:50176
  ds_read_b64_tr_b16 v[34:35], v8 offset:50432
  v_mul_f32 v51, v3, v51
  v_lshlrev_b32 v0, 16, v14
  v_mfma_f32_16x16x32_bf16 v[104:107], v[36:39], v[232:235], v[104:107]
  v_and_b32 v3, 0xffff0000, v14
  v_mul_f32 v52, v0, v52
  v_mfma_f32_16x16x32_bf16 v[108:111], v[36:39], v[236:239], v[108:111]
  ds_read_b64_tr_b16 v[36:37], v9 offset:50176
  ds_read_b64_tr_b16 v[38:39], v9 offset:50432
  v_mul_f32 v53, v3, v53
  v_lshlrev_b32 v0, 16, v15
  v_mfma_f32_16x16x32_bf16 v[112:115], v[40:43], v[232:235], v[112:115]
  v_and_b32 v3, 0xffff0000, v15
  v_mul_f32 v54, v0, v54
  v_mfma_f32_16x16x32_bf16 v[116:119], v[40:43], v[236:239], v[116:119]
  ds_read_b64_tr_b16 v[40:41], v8 offset:50688
  ds_read_b64_tr_b16 v[42:43], v8 offset:50944
  v_mul_f32 v55, v3, v55
  v_cvt_pk_bf16_f32 v12, v48, v49
  v_mfma_f32_16x16x32_bf16 v[120:123], v[44:47], v[232:235], v[120:123]
  v_cvt_pk_bf16_f32 v13, v50, v51
  v_cvt_pk_bf16_f32 v14, v52, v53
  v_mfma_f32_16x16x32_bf16 v[124:127], v[44:47], v[236:239], v[124:127]
  ds_read_b64_tr_b16 v[44:45], v9 offset:50688
  ds_read_b64_tr_b16 v[46:47], v9 offset:50944
  v_cvt_pk_bf16_f32 v15, v54, v55
  v_lshlrev_b32 v48, 16, v12
  v_mfma_f32_16x16x32_bf16 v[64:67], v[16:19], v[240:243], v[64:67]
  v_and_b32 v49, 0xffff0000, v12
  v_lshlrev_b32 v50, 16, v13
  v_mfma_f32_16x16x32_bf16 v[68:71], v[16:19], v[244:247], v[68:71]
  ds_read_b64_tr_b16 v[16:17], v8 offset:57344
  ds_read_b64_tr_b16 v[18:19], v8 offset:57600
  v_and_b32 v51, 0xffff0000, v13
  v_lshlrev_b32 v52, 16, v14
  v_mfma_f32_16x16x32_bf16 v[72:75], v[20:23], v[240:243], v[72:75]
  v_and_b32 v53, 0xffff0000, v14
  v_lshlrev_b32 v54, 16, v15
  v_mfma_f32_16x16x32_bf16 v[76:79], v[20:23], v[244:247], v[76:79]
  ds_read_b64_tr_b16 v[20:21], v9 offset:57344
  ds_read_b64_tr_b16 v[22:23], v9 offset:57600
  v_and_b32 v55, 0xffff0000, v15
  v_add_f32 v48, v48, v56
  s_waitcnt lgkmcnt(12)
  v_mfma_f32_16x16x32_bf16 v[80:83], v[24:27], v[240:243], v[80:83]
  v_add_f32 v49, v49, v57
  v_add_f32 v50, v50, v58
  v_mfma_f32_16x16x32_bf16 v[84:87], v[24:27], v[244:247], v[84:87]
  ds_read_b64_tr_b16 v[24:25], v8 offset:57856
  ds_read_b64_tr_b16 v[26:27], v8 offset:58112
  v_add_f32 v51, v51, v59
  v_add_f32 v52, v52, v60
  v_mfma_f32_16x16x32_bf16 v[88:91], v[28:31], v[240:243], v[88:91]
  v_add_f32 v53, v53, v61
  v_add_f32 v54, v54, v62
  v_mfma_f32_16x16x32_bf16 v[92:95], v[28:31], v[244:247], v[92:95]
  ds_read_b64_tr_b16 v[28:29], v9 offset:57856
  ds_read_b64_tr_b16 v[30:31], v9 offset:58112
  v_add_f32 v55, v55, v63
  v_cvt_pk_bf16_f32 v12, v48, v49
  s_waitcnt lgkmcnt(12)
  v_mfma_f32_16x16x32_bf16 v[96:99], v[32:35], v[240:243], v[96:99]
  v_cvt_pk_bf16_f32 v13, v50, v51
  v_cvt_pk_bf16_f32 v14, v52, v53
  v_mfma_f32_16x16x32_bf16 v[100:103], v[32:35], v[244:247], v[100:103]
  ds_read_b64_tr_b16 v[32:33], v8 offset:58368
  ds_read_b64_tr_b16 v[34:35], v8 offset:58624
  v_cvt_pk_bf16_f32 v15, v54, v55
  s_lshl_b32 s66, s3, 4
  v_mfma_f32_16x16x32_bf16 v[104:107], v[36:39], v[240:243], v[104:107]
  s_add_u32 s66, s66, 73728
  v_lshlrev_b32 v0, 7, v1
  v_mfma_f32_16x16x32_bf16 v[108:111], v[36:39], v[244:247], v[108:111]
  ds_read_b64_tr_b16 v[36:37], v9 offset:58368
  ds_read_b64_tr_b16 v[38:39], v9 offset:58624
  v_add_u32 v0, s66, v0
  ds_write_b128 v0, v[12:15]
  s_waitcnt lgkmcnt(13)
  v_mfma_f32_16x16x32_bf16 v[112:115], v[40:43], v[240:243], v[112:115]
  v_mfma_f32_16x16x32_bf16 v[116:119], v[40:43], v[244:247], v[116:119]
  ds_read_b64_tr_b16 v[40:41], v8 offset:58880
  ds_read_b64_tr_b16 v[42:43], v8 offset:59136
  v_mfma_f32_16x16x32_bf16 v[120:123], v[44:47], v[240:243], v[120:123]
  v_mfma_f32_16x16x32_bf16 v[124:127], v[44:47], v[244:247], v[124:127]
  ds_read_b64_tr_b16 v[44:45], v9 offset:58880
  ds_read_b64_tr_b16 v[46:47], v9 offset:59136
  s_waitcnt lgkmcnt(13)
  v_mfma_f32_16x16x32_bf16 v[64:67], v[16:19], v[248:251], v[64:67]
  s_waitcnt lgkmcnt(4)
  s_barrier
  s_add_u32 m0, s59, 32768
  s_nop 0
  buffer_load_dwordx4 v4, s[16:19], s56 offen lds
  v_mfma_f32_16x16x32_bf16 v[68:71], v[16:19], v[252:255], v[68:71]
  v_add_u32 v8, 0x10000, v8
  v_add_u32 v9, 0x10000, v9
  ds_read_b64_tr_b16 v[16:17], v8 offset:0
  ds_read_b64_tr_b16 v[18:19], v8 offset:256
  s_add_u32 m0, s59, 33664
  s_add_u32 s65, s56, 0x80000
  buffer_load_dwordx4 v4, s[16:19], s56 offen offset:128 lds
  s_and_b32 s56, s65, 0x3fffff
  v_mfma_f32_16x16x32_bf16 v[72:75], v[20:23], v[248:251], v[72:75]
  s_lshl_b32 s66, s3, 10
  s_add_u32 s66, s66, 73728
  v_mfma_f32_16x16x32_bf16 v[76:79], v[20:23], v[252:255], v[76:79]
  ds_read_b64_tr_b16 v[20:21], v9 offset:0
  ds_read_b64_tr_b16 v[22:23], v9 offset:256
  v_add_u32 v0, s66, v2
  ds_read_b128 v[12:15], v0
  v_mfma_f32_16x16x32_bf16 v[80:83], v[24:27], v[248:251], v[80:83]
  v_lshrrev_b32 v3, 3, v1
  v_lshlrev_b32 v3, 9, v3
  v_mfma_f32_16x16x32_bf16 v[84:87], v[24:27], v[252:255], v[84:87]
  ds_read_b64_tr_b16 v[24:25], v8 offset:512
  ds_read_b64_tr_b16 v[26:27], v8 offset:768
  v_and_b32 v0, 7, v1
  v_lshl_add_u32 v0, v0, 4, v3
  v_mfma_f32_16x16x32_bf16 v[88:91], v[28:31], v[248:251], v[88:91]
  s_lshr_b32 s66, s2, 2
  s_lshl_b32 s66, s66, 15
  v_mfma_f32_16x16x32_bf16 v[92:95], v[28:31], v[252:255], v[92:95]
  ds_read_b64_tr_b16 v[28:29], v9 offset:512
  ds_read_b64_tr_b16 v[30:31], v9 offset:768
  s_and_b32 s67, s2, 3
  s_lshl_b32 s67, s67, 7
  v_mfma_f32_16x16x32_bf16 v[96:99], v[32:35], v[248:251], v[96:99]
  s_add_u32 s66, s66, s67
  s_lshl_b32 s67, s3, 12
  v_mfma_f32_16x16x32_bf16 v[100:103], v[32:35], v[252:255], v[100:103]
  ds_read_b64_tr_b16 v[32:33], v8 offset:1024
  ds_read_b64_tr_b16 v[34:35], v8 offset:1280
  s_add_u32 s66, s66, s67
  s_add_u32 s66, s66, 0x300000
  v_mfma_f32_16x16x32_bf16 v[104:107], v[36:39], v[248:251], v[104:107]
  s_waitcnt lgkmcnt(6)
  buffer_store_dwordx4 v[12:15], v0, s[36:39], s66 offen sc1
  v_mfma_f32_16x16x32_bf16 v[108:111], v[36:39], v[252:255], v[108:111]
  ds_read_b64_tr_b16 v[36:37], v9 offset:1024
  ds_read_b64_tr_b16 v[38:39], v9 offset:1280
  v_mfma_f32_16x16x32_bf16 v[112:115], v[40:43], v[248:251], v[112:115]
  v_mfma_f32_16x16x32_bf16 v[116:119], v[40:43], v[252:255], v[116:119]
  ds_read_b64_tr_b16 v[40:41], v8 offset:1536
  ds_read_b64_tr_b16 v[42:43], v8 offset:1792
  v_mfma_f32_16x16x32_bf16 v[120:123], v[44:47], v[248:251], v[120:123]
  v_mfma_f32_16x16x32_bf16 v[124:127], v[44:47], v[252:255], v[124:127]
  ds_read_b64_tr_b16 v[44:45], v9 offset:1536
  ds_read_b64_tr_b16 v[46:47], v9 offset:1792
  v_cvt_pk_bf16_f32 v224, v64, v65
  v_cvt_pk_bf16_f32 v225, v66, v67
  v_cvt_pk_bf16_f32 v226, v72, v73
  v_cvt_pk_bf16_f32 v227, v74, v75
  v_cvt_pk_bf16_f32 v228, v68, v69
  v_cvt_pk_bf16_f32 v229, v70, v71
  v_cvt_pk_bf16_f32 v230, v76, v77
  v_cvt_pk_bf16_f32 v231, v78, v79
  v_mfma_f32_16x16x32_bf16 v[64:67], v[128:131], v[16:19], 0
  s_add_u32 s7, s61, 0
  buffer_store_dwordx4 v[224:227], v2, s[20:23], s7 offen offset:0 sc1
  v_mfma_f32_16x16x32_bf16 v[68:71], v[132:135], v[16:19], 0
  ds_read_b64_tr_b16 v[16:17], v8 offset:8192
  ds_read_b64_tr_b16 v[18:19], v8 offset:8448
  v_mfma_f32_16x16x32_bf16 v[72:75], v[128:131], v[20:23], 0
  v_mfma_f32_16x16x32_bf16 v[76:79], v[132:135], v[20:23], 0
  ds_read_b64_tr_b16 v[20:21], v9 offset:8192
  ds_read_b64_tr_b16 v[22:23], v9 offset:8448
  v_cvt_pk_bf16_f32 v232, v80, v81
  v_cvt_pk_bf16_f32 v233, v82, v83
  v_cvt_pk_bf16_f32 v234, v88, v89
  v_cvt_pk_bf16_f32 v235, v90, v91
  v_cvt_pk_bf16_f32 v236, v84, v85
  v_cvt_pk_bf16_f32 v237, v86, v87
  v_cvt_pk_bf16_f32 v238, v92, v93
  v_cvt_pk_bf16_f32 v239, v94, v95
  s_waitcnt lgkmcnt(12)
  v_mfma_f32_16x16x32_bf16 v[80:83], v[128:131], v[24:27], 0
  v_mfma_f32_16x16x32_bf16 v[84:87], v[132:135], v[24:27], 0
  ds_read_b64_tr_b16 v[24:25], v8 offset:8704
  ds_read_b64_tr_b16 v[26:27], v8 offset:8960
  v_mfma_f32_16x16x32_bf16 v[88:91], v[128:131], v[28:31], 0
  v_mfma_f32_16x16x32_bf16 v[92:95], v[132:135], v[28:31], 0
  ds_read_b64_tr_b16 v[28:29], v9 offset:8704
  ds_read_b64_tr_b16 v[30:31], v9 offset:8960
  v_cvt_pk_bf16_f32 v240, v96, v97
  v_cvt_pk_bf16_f32 v241, v98, v99
  v_cvt_pk_bf16_f32 v242, v104, v105
  v_cvt_pk_bf16_f32 v243, v106, v107
  v_cvt_pk_bf16_f32 v244, v100, v101
  v_cvt_pk_bf16_f32 v245, v102, v103
  v_cvt_pk_bf16_f32 v246, v108, v109
  v_cvt_pk_bf16_f32 v247, v110, v111
  s_waitcnt lgkmcnt(12)
  v_mfma_f32_16x16x32_bf16 v[96:99], v[128:131], v[32:35], 0
  v_mfma_f32_16x16x32_bf16 v[100:103], v[132:135], v[32:35], 0
  ds_read_b64_tr_b16 v[32:33], v8 offset:9216
  ds_read_b64_tr_b16 v[34:35], v8 offset:9472
  v_mfma_f32_16x16x32_bf16 v[104:107], v[128:131], v[36:39], 0
  v_mfma_f32_16x16x32_bf16 v[108:111], v[132:135], v[36:39], 0
  ds_read_b64_tr_b16 v[36:37], v9 offset:9216
  ds_read_b64_tr_b16 v[38:39], v9 offset:9472
  v_cvt_pk_bf16_f32 v248, v112, v113
  v_cvt_pk_bf16_f32 v249, v114, v115
  v_cvt_pk_bf16_f32 v250, v120, v121
  v_cvt_pk_bf16_f32 v251, v122, v123
  v_cvt_pk_bf16_f32 v252, v116, v117
  v_cvt_pk_bf16_f32 v253, v118, v119
  v_cvt_pk_bf16_f32 v254, v124, v125
  v_cvt_pk_bf16_f32 v255, v126, v127
  s_waitcnt lgkmcnt(12)
  v_mfma_f32_16x16x32_bf16 v[112:115], v[128:131], v[40:43], 0
  v_mfma_f32_16x16x32_bf16 v[116:119], v[132:135], v[40:43], 0
  ds_read_b64_tr_b16 v[40:41], v8 offset:9728
  ds_read_b64_tr_b16 v[42:43], v8 offset:9984
  v_mfma_f32_16x16x32_bf16 v[120:123], v[128:131], v[44:47], 0
  v_mfma_f32_16x16x32_bf16 v[124:127], v[132:135], v[44:47], 0
  ds_read_b64_tr_b16 v[44:45], v9 offset:9728
  ds_read_b64_tr_b16 v[46:47], v9 offset:9984
  v_subrev_u32 v8, 0x10000, v8
  v_subrev_u32 v9, 0x10000, v9
  s_waitcnt lgkmcnt(12)
  v_mfma_f32_16x16x32_bf16 v[64:67], v[136:139], v[16:19], v[64:67]
  s_waitcnt vmcnt(7)
  s_barrier
  s_add_u32 m0, s59, 49152
  s_nop 0
  buffer_load_dwordx4 v4, s[16:19], s56 offen lds
  v_mfma_f32_16x16x32_bf16 v[68:71], v[140:143], v[16:19], v[68:71]
  ds_read_b64_tr_b16 v[16:17], v8 offset:0
  ds_read_b64_tr_b16 v[18:19], v8 offset:256
  s_add_u32 m0, s59, 50048
  s_add_u32 s65, s56, 0x80000
  buffer_load_dwordx4 v4, s[16:19], s56 offen offset:128 lds
  s_and_b32 s56, s65, 0x3fffff
  v_mfma_f32_16x16x32_bf16 v[72:75], v[136:139], v[20:23], v[72:75]
  v_mfma_f32_16x16x32_bf16 v[76:79], v[140:143], v[20:23], v[76:79]
  ds_read_b64_tr_b16 v[20:21], v9 offset:0
  ds_read_b64_tr_b16 v[22:23], v9 offset:256
  s_waitcnt lgkmcnt(12)
  v_mfma_f32_16x16x32_bf16 v[80:83], v[136:139], v[24:27], v[80:83]
  v_mfma_f32_16x16x32_bf16 v[84:87], v[140:143], v[24:27], v[84:87]
  ds_read_b64_tr_b16 v[24:25], v8 offset:512
  ds_read_b64_tr_b16 v[26:27], v8 offset:768
  v_mfma_f32_16x16x32_bf16 v[88:91], v[136:139], v[28:31], v[88:91]
  v_mfma_f32_16x16x32_bf16 v[92:95], v[140:143], v[28:31], v[92:95]
  ds_read_b64_tr_b16 v[28:29], v9 offset:512
  ds_read_b64_tr_b16 v[30:31], v9 offset:768
  s_waitcnt lgkmcnt(12)
  v_mfma_f32_16x16x32_bf16 v[96:99], v[136:139], v[32:35], v[96:99]
  s_add_u32 s7, s61, 0
  buffer_store_dwordx4 v[228:231], v2, s[20:23], s7 offen offset:1024 sc1
  v_mfma_f32_16x16x32_bf16 v[100:103], v[140:143], v[32:35], v[100:103]
  ds_read_b64_tr_b16 v[32:33], v8 offset:1024
  ds_read_b64_tr_b16 v[34:35], v8 offset:1280
  v_mfma_f32_16x16x32_bf16 v[104:107], v[136:139], v[36:39], v[104:107]
  v_mfma_f32_16x16x32_bf16 v[108:111], v[140:143], v[36:39], v[108:111]
  ds_read_b64_tr_b16 v[36:37], v9 offset:1024
  ds_read_b64_tr_b16 v[38:39], v9 offset:1280
  s_waitcnt lgkmcnt(12)
  v_mfma_f32_16x16x32_bf16 v[112:115], v[136:139], v[40:43], v[112:115]
  v_mfma_f32_16x16x32_bf16 v[116:119], v[140:143], v[40:43], v[116:119]
  ds_read_b64_tr_b16 v[40:41], v8 offset:1536
  ds_read_b64_tr_b16 v[42:43], v8 offset:1792
  v_mfma_f32_16x16x32_bf16 v[120:123], v[136:139], v[44:47], v[120:123]
  v_mfma_f32_16x16x32_bf16 v[124:127], v[140:143], v[44:47], v[124:127]
  ds_read_b64_tr_b16 v[44:45], v9 offset:1536
  ds_read_b64_tr_b16 v[46:47], v9 offset:1792
  s_waitcnt lgkmcnt(12)
  v_mfma_f32_16x16x32_bf16 v[64:67], v[144:147], v[16:19], v[64:67]
  v_mfma_f32_16x16x32_bf16 v[68:71], v[148:151], v[16:19], v[68:71]
  ds_read_b64_tr_b16 v[16:17], v8 offset:8192
  ds_read_b64_tr_b16 v[18:19], v8 offset:8448
  v_mfma_f32_16x16x32_bf16 v[72:75], v[144:147], v[20:23], v[72:75]
  v_mfma_f32_16x16x32_bf16 v[76:79], v[148:151], v[20:23], v[76:79]
  ds_read_b64_tr_b16 v[20:21], v9 offset:8192
  ds_read_b64_tr_b16 v[22:23], v9 offset:8448
  s_waitcnt lgkmcnt(12)
  v_mfma_f32_16x16x32_bf16 v[80:83], v[144:147], v[24:27], v[80:83]
  v_mfma_f32_16x16x32_bf16 v[84:87], v[148:151], v[24:27], v[84:87]
  ds_read_b64_tr_b16 v[24:25], v8 offset:8704
  ds_read_b64_tr_b16 v[26:27], v8 offset:8960
  v_mfma_f32_16x16x32_bf16 v[88:91], v[144:147], v[28:31], v[88:91]
  v_mfma_f32_16x16x32_bf16 v[92:95], v[148:151], v[28:31], v[92:95]
  ds_read_b64_tr_b16 v[28:29], v9 offset:8704
  ds_read_b64_tr_b16 v[30:31], v9 offset:8960
  s_waitcnt lgkmcnt(12)
  v_mfma_f32_16x16x32_bf16 v[96:99], v[144:147], v[32:35], v[96:99]
  v_mfma_f32_16x16x32_bf16 v[100:103], v[148:151], v[32:35], v[100:103]
  ds_read_b64_tr_b16 v[32:33], v8 offset:9216
  ds_read_b64_tr_b16 v[34:35], v8 offset:9472
  v_mfma_f32_16x16x32_bf16 v[104:107], v[144:147], v[36:39], v[104:107]
  v_mfma_f32_16x16x32_bf16 v[108:111], v[148:151], v[36:39], v[108:111]
  ds_read_b64_tr_b16 v[36:37], v9 offset:9216
  ds_read_b64_tr_b16 v[38:39], v9 offset:9472
  s_waitcnt lgkmcnt(12)
  v_mfma_f32_16x16x32_bf16 v[112:115], v[144:147], v[40:43], v[112:115]
  v_mfma_f32_16x16x32_bf16 v[116:119], v[148:151], v[40:43], v[116:119]
  ds_read_b64_tr_b16 v[40:41], v8 offset:9728
  ds_read_b64_tr_b16 v[42:43], v8 offset:9984
  v_mfma_f32_16x16x32_bf16 v[120:123], v[144:147], v[44:47], v[120:123]
  v_mfma_f32_16x16x32_bf16 v[124:127], v[148:151], v[44:47], v[124:127]
  ds_read_b64_tr_b16 v[44:45], v9 offset:9728
  ds_read_b64_tr_b16 v[46:47], v9 offset:9984
  s_waitcnt lgkmcnt(12)
  v_mfma_f32_16x16x32_bf16 v[64:67], v[152:155], v[16:19], v[64:67]
  s_waitcnt vmcnt(4)
  s_barrier
  s_add_u32 m0, s59, 65536
  s_nop 0
  buffer_load_dwordx4 v4, s[16:19], s56 offen lds
  v_mfma_f32_16x16x32_bf16 v[68:71], v[156:159], v[16:19], v[68:71]
  ds_read_b64_tr_b16 v[16:17], v8 offset:16384
  ds_read_b64_tr_b16 v[18:19], v8 offset:16640
  s_add_u32 m0, s59, 66432
  s_add_u32 s65, s56, 0x80000
  buffer_load_dwordx4 v4, s[16:19], s56 offen offset:128 lds
  s_and_b32 s56, s65, 0x3fffff
  v_mfma_f32_16x16x32_bf16 v[72:75], v[152:155], v[20:23], v[72:75]
  s_add_u32 s7, s61, 0
  buffer_store_dwordx4 v[232:235], v2, s[20:23], s7 offen offset:2048 sc1
  v_mfma_f32_16x16x32_bf16 v[76:79], v[156:159], v[20:23], v[76:79]
  ds_read_b64_tr_b16 v[20:21], v9 offset:16384
  ds_read_b64_tr_b16 v[22:23], v9 offset:16640
  s_cmp_lg_u32 s3, 0
  s_cbranch_scc1 g_5
  s_lshr_b32 s55, s2, 2
  s_lshl_b32 s55, s55, 7
  s_add_u32 s55, s55, 0x10000
  v_mov_b32 v0, 0
  v_mov_b32 v3, 1
  s_mov_b64 exec, 1
  buffer_atomic_add v3, v0, s[36:39], s55 offen
  s_mov_b64 exec, -1
g_5:
  s_waitcnt lgkmcnt(12)
  v_mfma_f32_16x16x32_bf16 v[80:83], v[152:155], v[24:27], v[80:83]
  v_mfma_f32_16x16x32_bf16 v[84:87], v[156:159], v[24:27], v[84:87]
  ds_read_b64_tr_b16 v[24:25], v8 offset:16896
  ds_read_b64_tr_b16 v[26:27], v8 offset:17152
  v_mfma_f32_16x16x32_bf16 v[88:91], v[152:155], v[28:31], v[88:91]
  v_mfma_f32_16x16x32_bf16 v[92:95], v[156:159], v[28:31], v[92:95]
  ds_read_b64_tr_b16 v[28:29], v9 offset:16896
  ds_read_b64_tr_b16 v[30:31], v9 offset:17152
  s_waitcnt lgkmcnt(12)
  v_mfma_f32_16x16x32_bf16 v[96:99], v[152:155], v[32:35], v[96:99]
  v_mfma_f32_16x16x32_bf16 v[100:103], v[156:159], v[32:35], v[100:103]
  ds_read_b64_tr_b16 v[32:33], v8 offset:17408
  ds_read_b64_tr_b16 v[34:35], v8 offset:17664
  v_mfma_f32_16x16x32_bf16 v[104:107], v[152:155], v[36:39], v[104:107]
  v_mfma_f32_16x16x32_bf16 v[108:111], v[156:159], v[36:39], v[108:111]
  ds_read_b64_tr_b16 v[36:37], v9 offset:17408
  ds_read_b64_tr_b16 v[38:39], v9 offset:17664
  s_waitcnt lgkmcnt(12)
  v_mfma_f32_16x16x32_bf16 v[112:115], v[152:155], v[40:43], v[112:115]
  v_mfma_f32_16x16x32_bf16 v[116:119], v[156:159], v[40:43], v[116:119]
  ds_read_b64_tr_b16 v[40:41], v8 offset:17920
  ds_read_b64_tr_b16 v[42:43], v8 offset:18176
  v_mfma_f32_16x16x32_bf16 v[120:123], v[152:155], v[44:47], v[120:123]
  v_mfma_f32_16x16x32_bf16 v[124:127], v[156:159], v[44:47], v[124:127]
  ds_read_b64_tr_b16 v[44:45], v9 offset:17920
  ds_read_b64_tr_b16 v[46:47], v9 offset:18176
  s_waitcnt lgkmcnt(12)
  v_mfma_f32_16x16x32_bf16 v[64:67], v[160:163], v[16:19], v[64:67]
  v_mfma_f32_16x16x32_bf16 v[68:71], v[164:167], v[16:19], v[68:71]
  ds_read_b64_tr_b16 v[16:17], v8 offset:24576
  ds_read_b64_tr_b16 v[18:19], v8 offset:24832
  v_mfma_f32_16x16x32_bf16 v[72:75], v[160:163], v[20:23], v[72:75]
  v_mfma_f32_16x16x32_bf16 v[76:79], v[164:167], v[20:23], v[76:79]
  ds_read_b64_tr_b16 v[20:21], v9 offset:24576
  ds_read_b64_tr_b16 v[22:23], v9 offset:24832
  s_waitcnt lgkmcnt(12)
  v_mfma_f32_16x16x32_bf16 v[80:83], v[160:163], v[24:27], v[80:83]
  v_mfma_f32_16x16x32_bf16 v[84:87], v[164:167], v[24:27], v[84:87]
  ds_read_b64_tr_b16 v[24:25], v8 offset:25088
  ds_read_b64_tr_b16 v[26:27], v8 offset:25344
  v_mfma_f32_16x16x32_bf16 v[88:91], v[160:163], v[28:31], v[88:91]
  v_mfma_f32_16x16x32_bf16 v[92:95], v[164:167], v[28:31], v[92:95]
  ds_read_b64_tr_b16 v[28:29], v9 offset:25088
  ds_read_b64_tr_b16 v[30:31], v9 offset:25344
  s_waitcnt lgkmcnt(12)
  v_mfma_f32_16x16x32_bf16 v[96:99], v[160:163], v[32:35], v[96:99]
  s_add_u32 s7, s61, 0
  buffer_store_dwordx4 v[236:239], v2, s[20:23], s7 offen offset:3072 sc1
  v_mfma_f32_16x16x32_bf16 v[100:103], v[164:167], v[32:35], v[100:103]
  ds_read_b64_tr_b16 v[32:33], v8 offset:25600
  ds_read_b64_tr_b16 v[34:35], v8 offset:25856
  v_mfma_f32_16x16x32_bf16 v[104:107], v[160:163], v[36:39], v[104:107]
  v_mfma_f32_16x16x32_bf16 v[108:111], v[164:167], v[36:39], v[108:111]
  ds_read_b64_tr_b16 v[36:37], v9 offset:25600
  ds_read_b64_tr_b16 v[38:39], v9 offset:25856
  s_waitcnt lgkmcnt(12)
  v_mfma_f32_16x16x32_bf16 v[112:115], v[160:163], v[40:43], v[112:115]
  v_mfma_f32_16x16x32_bf16 v[116:119], v[164:167], v[40:43], v[116:119]
  ds_read_b64_tr_b16 v[40:41], v8 offset:26112
  ds_read_b64_tr_b16 v[42:43], v8 offset:26368
  v_mfma_f32_16x16x32_bf16 v[120:123], v[160:163], v[44:47], v[120:123]
  v_mfma_f32_16x16x32_bf16 v[124:127], v[164:167], v[44:47], v[124:127]
  ds_read_b64_tr_b16 v[44:45], v9 offset:26112
  ds_read_b64_tr_b16 v[46:47], v9 offset:26368
  s_waitcnt lgkmcnt(12)
  v_mfma_f32_16x16x32_bf16 v[64:67], v[168:171], v[16:19], v[64:67]
  s_barrier
  s_add_u32 m0, s59, 0
  s_nop 0
  buffer_load_dwordx4 v4, s[16:19], s56 offen lds
  v_mfma_f32_16x16x32_bf16 v[68:71], v[172:175], v[16:19], v[68:71]
  ds_read_b64_tr_b16 v[16:17], v8 offset:32768
  ds_read_b64_tr_b16 v[18:19], v8 offset:33024
  s_add_u32 m0, s59, 896
  s_add_u32 s65, s56, 0x80000
  buffer_load_dwordx4 v4, s[16:19], s56 offen offset:128 lds
  s_and_b32 s56, s65, 0x3fffff
  v_mfma_f32_16x16x32_bf16 v[72:75], v[168:171], v[20:23], v[72:75]
  v_mfma_f32_16x16x32_bf16 v[76:79], v[172:175], v[20:23], v[76:79]
  ds_read_b64_tr_b16 v[20:21], v9 offset:32768
  ds_read_b64_tr_b16 v[22:23], v9 offset:33024
  s_waitcnt lgkmcnt(12)
  v_mfma_f32_16x16x32_bf16 v[80:83], v[168:171], v[24:27], v[80:83]
  v_mfma_f32_16x16x32_bf16 v[84:87], v[172:175], v[24:27], v[84:87]
  ds_read_b64_tr_b16 v[24:25], v8 offset:33280
  ds_read_b64_tr_b16 v[26:27], v8 offset:33536
  v_mfma_f32_16x16x32_bf16 v[88:91], v[168:171], v[28:31], v[88:91]
  v_mfma_f32_16x16x32_bf16 v[92:95], v[172:175], v[28:31], v[92:95]
  ds_read_b64_tr_b16 v[28:29], v9 offset:33280
  ds_read_b64_tr_b16 v[30:31], v9 offset:33536
  s_waitcnt lgkmcnt(12)
  v_mfma_f32_16x16x32_bf16 v[96:99], v[168:171], v[32:35], v[96:99]
  v_mfma_f32_16x16x32_bf16 v[100:103], v[172:175], v[32:35], v[100:103]
  ds_read_b64_tr_b16 v[32:33], v8 offset:33792
  ds_read_b64_tr_b16 v[34:35], v8 offset:34048
  v_mfma_f32_16x16x32_bf16 v[104:107], v[168:171], v[36:39], v[104:107]
  v_mfma_f32_16x16x32_bf16 v[108:111], v[172:175], v[36:39], v[108:111]
  ds_read_b64_tr_b16 v[36:37], v9 offset:33792
  ds_read_b64_tr_b16 v[38:39], v9 offset:34048
  s_waitcnt lgkmcnt(12)
  v_mfma_f32_16x16x32_bf16 v[112:115], v[168:171], v[40:43], v[112:115]
  v_mfma_f32_16x16x32_bf16 v[116:119], v[172:175], v[40:43], v[116:119]
  ds_read_b64_tr_b16 v[40:41], v8 offset:34304
  ds_read_b64_tr_b16 v[42:43], v8 offset:34560
  v_mfma_f32_16x16x32_bf16 v[120:123], v[168:171], v[44:47], v[120:123]
  v_mfma_f32_16x16x32_bf16 v[124:127], v[172:175], v[44:47], v[124:127]
  ds_read_b64_tr_b16 v[44:45], v9 offset:34304
  ds_read_b64_tr_b16 v[46:47], v9 offset:34560
  s_waitcnt lgkmcnt(12)
  v_mfma_f32_16x16x32_bf16 v[64:67], v[176:179], v[16:19], v[64:67]
  s_add_u32 s7, s61, 4096
  buffer_store_dwordx4 v[240:243], v2, s[20:23], s7 offen offset:0 sc1
  v_mfma_f32_16x16x32_bf16 v[68:71], v[180:183], v[16:19], v[68:71]
  ds_read_b64_tr_b16 v[16:17], v8 offset:40960
  ds_read_b64_tr_b16 v[18:19], v8 offset:41216
  s_lshl_b32 s6, s42, 7
  s_add_u32 s6, s6, 0x10000
  v_mfma_f32_16x16x32_bf16 v[72:75], v[176:179], v[20:23], v[72:75]
  s_load_dword s9, s[36:37], s6 glc
  v_mfma_f32_16x16x32_bf16 v[76:79], v[180:183], v[20:23], v[76:79]
  ds_read_b64_tr_b16 v[20:21], v9 offset:40960
  ds_read_b64_tr_b16 v[22:23], v9 offset:41216
  s_waitcnt lgkmcnt(12)
  v_mfma_f32_16x16x32_bf16 v[80:83], v[176:179], v[24:27], v[80:83]
  v_mfma_f32_16x16x32_bf16 v[84:87], v[180:183], v[24:27], v[84:87]
  ds_read_b64_tr_b16 v[24:25], v8 offset:41472
  ds_read_b64_tr_b16 v[26:27], v8 offset:41728
  v_mfma_f32_16x16x32_bf16 v[88:91], v[176:179], v[28:31], v[88:91]
  v_mfma_f32_16x16x32_bf16 v[92:95], v[180:183], v[28:31], v[92:95]
  ds_read_b64_tr_b16 v[28:29], v9 offset:41472
  ds_read_b64_tr_b16 v[30:31], v9 offset:41728
  s_waitcnt lgkmcnt(12)
  v_mfma_f32_16x16x32_bf16 v[96:99], v[176:179], v[32:35], v[96:99]
  v_mfma_f32_16x16x32_bf16 v[100:103], v[180:183], v[32:35], v[100:103]
  ds_read_b64_tr_b16 v[32:33], v8 offset:41984
  ds_read_b64_tr_b16 v[34:35], v8 offset:42240
  v_mfma_f32_16x16x32_bf16 v[104:107], v[176:179], v[36:39], v[104:107]
  v_mfma_f32_16x16x32_bf16 v[108:111], v[180:183], v[36:39], v[108:111]
  ds_read_b64_tr_b16 v[36:37], v9 offset:41984
  ds_read_b64_tr_b16 v[38:39], v9 offset:42240
  s_waitcnt lgkmcnt(12)
  v_mfma_f32_16x16x32_bf16 v[112:115], v[176:179], v[40:43], v[112:115]
  v_mfma_f32_16x16x32_bf16 v[116:119], v[180:183], v[40:43], v[116:119]
  ds_read_b64_tr_b16 v[40:41], v8 offset:42496
  ds_read_b64_tr_b16 v[42:43], v8 offset:42752
  v_mfma_f32_16x16x32_bf16 v[120:123], v[176:179], v[44:47], v[120:123]
  v_mfma_f32_16x16x32_bf16 v[124:127], v[180:183], v[44:47], v[124:127]
  ds_read_b64_tr_b16 v[44:45], v9 offset:42496
  ds_read_b64_tr_b16 v[46:47], v9 offset:42752
  s_waitcnt lgkmcnt(12)
  v_mfma_f32_16x16x32_bf16 v[64:67], v[184:187], v[16:19], v[64:67]
  s_waitcnt vmcnt(8)
  s_barrier
  s_add_u32 m0, s59, 16384
  s_nop 0
  buffer_load_dwordx4 v4, s[16:19], s56 offen lds
  v_mfma_f32_16x16x32_bf16 v[68:71], v[188:191], v[16:19], v[68:71]
  ds_read_b64_tr_b16 v[16:17], v8 offset:49152
  ds_read_b64_tr_b16 v[18:19], v8 offset:49408
  s_add_u32 m0, s59, 17280
  s_add_u32 s65, s56, 0x80000
  buffer_load_dwordx4 v4, s[16:19], s56 offen offset:128 lds
  s_and_b32 s56, s65, 0x3fffff
  v_mfma_f32_16x16x32_bf16 v[72:75], v[184:187], v[20:23], v[72:75]
  v_mfma_f32_16x16x32_bf16 v[76:79], v[188:191], v[20:23], v[76:79]
  ds_read_b64_tr_b16 v[20:21], v9 offset:49152
  ds_read_b64_tr_b16 v[22:23], v9 offset:49408
  s_waitcnt lgkmcnt(12)
  v_mfma_f32_16x16x32_bf16 v[80:83], v[184:187], v[24:27], v[80:83]
  v_mfma_f32_16x16x32_bf16 v[84:87], v[188:191], v[24:27], v[84:87]
  ds_read_b64_tr_b16 v[24:25], v8 offset:49664
  ds_read_b64_tr_b16 v[26:27], v8 offset:49920
  v_mfma_f32_16x16x32_bf16 v[88:91], v[184:187], v[28:31], v[88:91]
  v_mfma_f32_16x16x32_bf16 v[92:95], v[188:191], v[28:31], v[92:95]
  ds_read_b64_tr_b16 v[28:29], v9 offset:49664
  ds_read_b64_tr_b16 v[30:31], v9 offset:49920
  s_waitcnt lgkmcnt(12)
  v_mfma_f32_16x16x32_bf16 v[96:99], v[184:187], v[32:35], v[96:99]
  s_add_u32 s7, s61, 4096
  buffer_store_dwordx4 v[244:247], v2, s[20:23], s7 offen offset:1024 sc1
  v_mfma_f32_16x16x32_bf16 v[100:103], v[188:191], v[32:35], v[100:103]
  ds_read_b64_tr_b16 v[32:33], v8 offset:50176
  ds_read_b64_tr_b16 v[34:35], v8 offset:50432
  v_mfma_f32_16x16x32_bf16 v[104:107], v[184:187], v[36:39], v[104:107]
  v_mfma_f32_16x16x32_bf16 v[108:111], v[188:191], v[36:39], v[108:111]
  ds_read_b64_tr_b16 v[36:37], v9 offset:50176
  ds_read_b64_tr_b16 v[38:39], v9 offset:50432
  s_waitcnt lgkmcnt(12)
  v_mfma_f32_16x16x32_bf16 v[112:115], v[184:187], v[40:43], v[112:115]
  v_mfma_f32_16x16x32_bf16 v[116:119], v[188:191], v[40:43], v[116:119]
  ds_read_b64_tr_b16 v[40:41], v8 offset:50688
  ds_read_b64_tr_b16 v[42:43], v8 offset:50944
  v_mfma_f32_16x16x32_bf16 v[120:123], v[184:187], v[44:47], v[120:123]
  v_mfma_f32_16x16x32_bf16 v[124:127], v[188:191], v[44:47], v[124:127]
  ds_read_b64_tr_b16 v[44:45], v9 offset:50688
  ds_read_b64_tr_b16 v[46:47], v9 offset:50944
  s_waitcnt lgkmcnt(12)
  v_mfma_f32_16x16x32_bf16 v[64:67], v[192:195], v[16:19], v[64:67]
  s_waitcnt lgkmcnt(0)
  s_cmp_ge_u32 s9, 4
  s_cbranch_scc0 spin_7
spc_8:
pw_6:
  v_mfma_f32_16x16x32_bf16 v[68:71], v[196:199], v[16:19], v[68:71]
  ds_read_b64_tr_b16 v[16:17], v8 offset:57344
  ds_read_b64_tr_b16 v[18:19], v8 offset:57600
  buffer_load_dwordx4 v[128:131], v7, s[36:39], s58 offen offset:0 sc1
  v_mfma_f32_16x16x32_bf16 v[72:75], v[192:195], v[20:23], v[72:75]
  buffer_load_dwordx4 v[132:135], v7, s[36:39], s58 offen offset:256 sc1
  v_mfma_f32_16x16x32_bf16 v[76:79], v[196:199], v[20:23], v[76:79]
  ds_read_b64_tr_b16 v[20:21], v9 offset:57344
  ds_read_b64_tr_b16 v[22:23], v9 offset:57600
  buffer_load_dwordx4 v[136:139], v7, s[36:39], s58 offen offset:2048 sc1
  s_waitcnt lgkmcnt(12)
  v_mfma_f32_16x16x32_bf16 v[80:83], v[192:195], v[24:27], v[80:83]
  buffer_load_dwordx4 v[140:143], v7, s[36:39], s58 offen offset:2304 sc1
  v_mfma_f32_16x16x32_bf16 v[84:87], v[196:199], v[24:27], v[84:87]
  ds_read_b64_tr_b16 v[24:25], v8 offset:57856
  ds_read_b64_tr_b16 v[26:27], v8 offset:58112
  s_add_u32 s58, s58, 0x1000
  s_and_b32 s58, s58, 0x7fff
  v_mfma_f32_16x16x32_bf16 v[88:91], v[192:195], v[28:31], v[88:91]
  buffer_load_dwordx4 v[144:147], v7, s[36:39], s58 offen offset:0 sc1
  v_mfma_f32_16x16x32_bf16 v[92:95], v[196:199], v[28:31], v[92:95]
  ds_read_b64_tr_b16 v[28:29], v9 offset:57856
  ds_read_b64_tr_b16 v[30:31], v9 offset:58112
  buffer_load_dwordx4 v[148:151], v7, s[36:39], s58 offen offset:256 sc1
  s_waitcnt lgkmcnt(12)
  v_mfma_f32_16x16x32_bf16 v[96:99], v[192:195], v[32:35], v[96:99]
  buffer_load_dwordx4 v[152:155], v7, s[36:39], s58 offen offset:2048 sc1
  v_mfma_f32_16x16x32_bf16 v[100:103], v[196:199], v[32:35], v[100:103]
  ds_read_b64_tr_b16 v[32:33], v8 offset:58368
  ds_read_b64_tr_b16 v[34:35], v8 offset:58624
  buffer_load_dwordx4 v[156:159], v7, s[36:39], s58 offen offset:2304 sc1
  v_mfma_f32_16x16x32_bf16 v[104:107], v[192:195], v[36:39], v[104:107]
  s_add_u32 s58, s58, 0x1000
  s_and_b32 s58, s58, 0x7fff
  v_mfma_f32_16x16x32_bf16 v[108:111], v[196:199], v[36:39], v[108:111]
  ds_read_b64_tr_b16 v[36:37], v9 offset:58368
  ds_read_b64_tr_b16 v[38:39], v9 offset:58624
  s_waitcnt lgkmcnt(12)
  v_mfma_f32_16x16x32_bf16 v[112:115], v[192:195], v[40:43], v[112:115]
  v_mfma_f32_16x16x32_bf16 v[116:119], v[196:199], v[40:43], v[116:119]
  ds_read_b64_tr_b16 v[40:41], v8 offset:58880
  ds_read_b64_tr_b16 v[42:43], v8 offset:59136
  v_mfma_f32_16x16x32_bf16 v[120:123], v[192:195], v[44:47], v[120:123]
  v_mfma_f32_16x16x32_bf16 v[124:127], v[196:199], v[44:47], v[124:127]
  ds_read_b64_tr_b16 v[44:45], v9 offset:58880
  ds_read_b64_tr_b16 v[46:47], v9 offset:59136
  s_waitcnt lgkmcnt(12)
  v_mfma_f32_16x16x32_bf16 v[64:67], v[200:203], v[16:19], v[64:67]
  s_waitcnt vmcnt(16)
  s_barrier
  s_add_u32 m0, s59, 32768
  s_nop 0
  buffer_load_dwordx4 v4, s[28:31], s56 offen lds
  v_mfma_f32_16x16x32_bf16 v[68:71], v[204:207], v[16:19], v[68:71]
  v_add_u32 v8, 0x10000, v8
  v_add_u32 v9, 0x10000, v9
  ds_read_b64_tr_b16 v[16:17], v8 offset:0
  ds_read_b64_tr_b16 v[18:19], v8 offset:256
  s_add_u32 m0, s59, 33664
  s_add_u32 s65, s56, 0x80000
  buffer_load_dwordx4 v4, s[28:31], s56 offen offset:128 lds
  s_and_b32 s56, s65, 0x3fffff
  v_mfma_f32_16x16x32_bf16 v[72:75], v[200:203], v[20:23], v[72:75]
  s_add_u32 s7, s61, 4096
  buffer_store_dwordx4 v[248:251], v2, s[20:23], s7 offen offset:2048 sc1
  v_mfma_f32_16x16x32_bf16 v[76:79], v[204:207], v[20:23], v[76:79]
  ds_read_b64_tr_b16 v[20:21], v9 offset:0
  ds_read_b64_tr_b16 v[22:23], v9 offset:256
  s_waitcnt lgkmcnt(12)
  v_mfma_f32_16x16x32_bf16 v[80:83], v[200:203], v[24:27], v[80:83]
  v_mfma_f32_16x16x32_bf16 v[84:87], v[204:207], v[24:27], v[84:87]
  ds_read_b64_tr_b16 v[24:25], v8 offset:512
  ds_read_b64_tr_b16 v[26:27], v8 offset:768
  v_mfma_f32_16x16x32_bf16 v[88:91], v[200:203], v[28:31], v[88:91]
  v_mfma_f32_16x16x32_bf16 v[92:95], v[204:207], v[28:31], v[92:95]
  ds_read_b64_tr_b16 v[28:29], v9 offset:512
  ds_read_b64_tr_b16 v[30:31], v9 offset:768
  s_waitcnt lgkmcnt(12)
  v_mfma_f32_16x16x32_bf16 v[96:99], v[200:203], v[32:35], v[96:99]
  v_mfma_f32_16x16x32_bf16 v[100:103], v[204:207], v[32:35], v[100:103]
  ds_read_b64_tr_b16 v[32:33], v8 offset:1024
  ds_read_b64_tr_b16 v[34:35], v8 offset:1280
  v_mfma_f32_16x16x32_bf16 v[104:107], v[200:203], v[36:39], v[104:107]
  v_mfma_f32_16x16x32_bf16 v[108:111], v[204:207], v[36:39], v[108:111]
  ds_read_b64_tr_b16 v[36:37], v9 offset:1024
  ds_read_b64_tr_b16 v[38:39], v9 offset:1280
  s_waitcnt lgkmcnt(12)
  v_mfma_f32_16x16x32_bf16 v[112:115], v[200:203], v[40:43], v[112:115]
  v_mfma_f32_16x16x32_bf16 v[116:119], v[204:207], v[40:43], v[116:119]
  ds_read_b64_tr_b16 v[40:41], v8 offset:1536
  ds_read_b64_tr_b16 v[42:43], v8 offset:1792
  v_mfma_f32_16x16x32_bf16 v[120:123], v[200:203], v[44:47], v[120:123]
  v_mfma_f32_16x16x32_bf16 v[124:127], v[204:207], v[44:47], v[124:127]
  ds_read_b64_tr_b16 v[44:45], v9 offset:1536
  ds_read_b64_tr_b16 v[46:47], v9 offset:1792
  s_waitcnt lgkmcnt(12)
  v_mfma_f32_16x16x32_bf16 v[64:67], v[208:211], v[16:19], v[64:67]
  ds_read_b128 v[224:227], v6 offset:0
  ds_read_b128 v[228:231], v6 offset:2048
  v_mfma_f32_16x16x32_bf16 v[68:71], v[212:215], v[16:19], v[68:71]
  ds_read_b64_tr_b16 v[16:17], v8 offset:8192
  ds_read_b64_tr_b16 v[18:19], v8 offset:8448
  ds_read_b128 v[232:235], v6 offset:64
  ds_read_b128 v[236:239], v6 offset:2112
  v_mfma_f32_16x16x32_bf16 v[72:75], v[208:211], v[20:23], v[72:75]
  buffer_load_dwordx4 v[160:163], v7, s[36:39], s58 offen offset:0 sc1
  v_mfma_f32_16x16x32_bf16 v[76:79], v[212:215], v[20:23], v[76:79]
  ds_read_b64_tr_b16 v[20:21], v9 offset:8192
  ds_read_b64_tr_b16 v[22:23], v9 offset:8448
  buffer_load_dwordx4 v[164:167], v7, s[36:39], s58 offen offset:256 sc1
  s_waitcnt lgkmcnt(15)
  v_mfma_f32_16x16x32_bf16 v[80:83], v[208:211], v[24:27], v[80:83]
  buffer_load_dwordx4 v[168:171], v7, s[36:39], s58 offen offset:2048 sc1
  v_mfma_f32_16x16x32_bf16 v[84:87], v[212:215], v[24:27], v[84:87]
  ds_read_b64_tr_b16 v[24:25], v8 offset:8704
  ds_read_b64_tr_b16 v[26:27], v8 offset:8960
  buffer_load_dwordx4 v[172:175], v7, s[36:39], s58 offen offset:2304 sc1
  v_mfma_f32_16x16x32_bf16 v[88:91], v[208:211], v[28:31], v[88:91]
  s_add_u32 s58, s58, 0x1000
  s_and_b32 s58, s58, 0x7fff
  v_mfma_f32_16x16x32_bf16 v[92:95], v[212:215], v[28:31], v[92:95]
  ds_read_b64_tr_b16 v[28:29], v9 offset:8704
  ds_read_b64_tr_b16 v[30:31], v9 offset:8960
  s_waitcnt lgkmcnt(15)
  v_mfma_f32_16x16x32_bf16 v[96:99], v[208:211], v[32:35], v[96:99]
  s_add_u32 s7, s61, 4096
  buffer_store_dwordx4 v[252:255], v2, s[20:23], s7 offen offset:3072 sc1
  v_mfma_f32_16x16x32_bf16 v[100:103], v[212:215], v[32:35], v[100:103]
  ds_read_b64_tr_b16 v[32:33], v8 offset:9216
  ds_read_b64_tr_b16 v[34:35], v8 offset:9472
  v_mfma_f32_16x16x32_bf16 v[104:107], v[208:211], v[36:39], v[104:107]
  v_mfma_f32_16x16x32_bf16 v[108:111], v[212:215], v[36:39], v[108:111]
  ds_read_b64_tr_b16 v[36:37], v9 offset:9216
  ds_read_b64_tr_b16 v[38:39], v9 offset:9472
  s_waitcnt lgkmcnt(15)
  v_mfma_f32_16x16x32_bf16 v[112:115], v[208:211], v[40:43], v[112:115]
  v_mfma_f32_16x16x32_bf16 v[116:119], v[212:215], v[40:43], v[116:119]
  ds_read_b64_tr_b16 v[40:41], v8 offset:9728
  ds_read_b64_tr_b16 v[42:43], v8 offset:9984
  v_mfma_f32_16x16x32_bf16 v[120:123], v[208:211], v[44:47], v[120:123]
  v_mfma_f32_16x16x32_bf16 v[124:127], v[212:215], v[44:47], v[124:127]
  ds_read_b64_tr_b16 v[44:45], v9 offset:9728
  ds_read_b64_tr_b16 v[46:47], v9 offset:9984
  v_subrev_u32 v8, 0x10000, v8
  v_subrev_u32 v9, 0x10000, v9
  s_waitcnt lgkmcnt(12)
  v_mfma_f32_16x16x32_bf16 v[64:67], v[216:219], v[16:19], v[64:67]
  s_waitcnt vmcnt(20)
  s_barrier
  s_add_u32 m0, s59, 49152
  s_nop 0
  buffer_load_dwordx4 v4, s[28:31], s56 offen lds
  v_mfma_f32_16x16x32_bf16 v[68:71], v[220:223], v[16:19], v[68:71]
  ds_read_b64_tr_b16 v[16:17], v8 offset:0
  ds_read_b64_tr_b16 v[18:19], v8 offset:256
  s_add_u32 m0, s59, 50048
  s_add_u32 s65, s56, 0x80000
  buffer_load_dwordx4 v4, s[28:31], s56 offen offset:128 lds
  s_and_b32 s56, s65, 0x3fffff
  v_mfma_f32_16x16x32_bf16 v[72:75], v[216:219], v[20:23], v[72:75]
  v_mfma_f32_16x16x32_bf16 v[76:79], v[220:223], v[20:23], v[76:79]
  ds_read_b64_tr_b16 v[20:21], v9 offset:0
  ds_read_b64_tr_b16 v[22:23], v9 offset:256
  s_waitcnt lgkmcnt(12)
  v_mfma_f32_16x16x32_bf16 v[80:83], v[216:219], v[24:27], v[80:83]
  v_mfma_f32_16x16x32_bf16 v[84:87], v[220:223], v[24:27], v[84:87]
  ds_read_b64_tr_b16 v[24:25], v8 offset:512
  ds_read_b64_tr_b16 v[26:27], v8 offset:768
  v_mfma_f32_16x16x32_bf16 v[88:91], v[216:219], v[28:31], v[88:91]
  v_mfma_f32_16x16x32_bf16 v[92:95], v[220:223], v[28:31], v[92:95]
  ds_read_b64_tr_b16 v[28:29], v9 offset:512
  ds_read_b64_tr_b16 v[30:31], v9 offset:768
  s_waitcnt lgkmcnt(12)
  v_mfma_f32_16x16x32_bf16 v[96:99], v[216:219], v[32:35], v[96:99]
  v_mfma_f32_16x16x32_bf16 v[100:103], v[220:223], v[32:35], v[100:103]
  ds_read_b64_tr_b16 v[32:33], v8 offset:1024
  ds_read_b64_tr_b16 v[34:35], v8 offset:1280
  v_mfma_f32_16x16x32_bf16 v[104:107], v[216:219], v[36:39], v[104:107]
  v_mfma_f32_16x16x32_bf16 v[108:111], v[220:223], v[36:39], v[108:111]
  ds_read_b64_tr_b16 v[36:37], v9 offset:1024
  ds_read_b64_tr_b16 v[38:39], v9 offset:1280
  s_waitcnt lgkmcnt(12)
  v_mfma_f32_16x16x32_bf16 v[112:115], v[216:219], v[40:43], v[112:115]
  v_mfma_f32_16x16x32_bf16 v[116:119], v[220:223], v[40:43], v[116:119]
  ds_read_b64_tr_b16 v[40:41], v8 offset:1536
  ds_read_b64_tr_b16 v[42:43], v8 offset:1792
  v_mfma_f32_16x16x32_bf16 v[120:123], v[216:219], v[44:47], v[120:123]
  v_mfma_f32_16x16x32_bf16 v[124:127], v[220:223], v[44:47], v[124:127]
  ds_read_b64_tr_b16 v[44:45], v9 offset:1536
  ds_read_b64_tr_b16 v[46:47], v9 offset:1792
  s_waitcnt lgkmcnt(12)
  v_mfma_f32_16x16x32_bf16 v[64:67], v[224:227], v[16:19], v[64:67]
  ds_read_b128 v[240:243], v6 offset:32768
  ds_read_b128 v[244:247], v6 offset:34816
  v_mfma_f32_16x16x32_bf16 v[68:71], v[228:231], v[16:19], v[68:71]
  ds_read_b64_tr_b16 v[16:17], v8 offset:8192
  ds_read_b64_tr_b16 v[18:19], v8 offset:8448
  ds_read_b128 v[248:251], v6 offset:32832
  ds_read_b128 v[252:255], v6 offset:34880
  v_mfma_f32_16x16x32_bf16 v[72:75], v[224:227], v[20:23], v[72:75]
  buffer_load_dwordx4 v[176:179], v7, s[36:39], s58 offen offset:0 sc1
  v_mfma_f32_16x16x32_bf16 v[76:79], v[228:231], v[20:23], v[76:79]
  ds_read_b64_tr_b16 v[20:21], v9 offset:8192
  ds_read_b64_tr_b16 v[22:23], v9 offset:8448
  buffer_load_dwordx4 v[180:183], v7, s[36:39], s58 offen offset:256 sc1
  s_waitcnt lgkmcnt(15)
  v_mfma_f32_16x16x32_bf16 v[80:83], v[224:227], v[24:27], v[80:83]
  buffer_load_dwordx4 v[184:187], v7, s[36:39], s58 offen offset:2048 sc1
  v_mfma_f32_16x16x32_bf16 v[84:87], v[228:231], v[24:27], v[84:87]
  ds_read_b64_tr_b16 v[24:25], v8 offset:8704
  ds_read_b64_tr_b16 v[26:27], v8 offset:8960
  buffer_load_dwordx4 v[188:191], v7, s[36:39], s58 offen offset:2304 sc1
  v_mfma_f32_16x16x32_bf16 v[88:91], v[224:227], v[28:31], v[88:91]
  s_add_u32 s58, s58, 0x1000
  s_and_b32 s58, s58, 0x7fff
  v_mfma_f32_16x16x32_bf16 v[92:95], v[228:231], v[28:31], v[92:95]
  ds_read_b64_tr_b16 v[28:29], v9 offset:8704
  ds_read_b64_tr_b16 v[30:31], v9 offset:8960
  s_waitcnt lgkmcnt(15)
  v_mfma_f32_16x16x32_bf16 v[96:99], v[224:227], v[32:35], v[96:99]
  v_mfma_f32_16x16x32_bf16 v[100:103], v[228:231], v[32:35], v[100:103]
  ds_read_b64_tr_b16 v[32:33], v8 offset:9216
  ds_read_b64_tr_b16 v[34:35], v8 offset:9472
  v_mfma_f32_16x16x32_bf16 v[104:107], v[224:227], v[36:39], v[104:107]
  v_mfma_f32_16x16x32_bf16 v[108:111], v[228:231], v[36:39], v[108:111]
  ds_read_b64_tr_b16 v[36:37], v9 offset:9216
  ds_read_b64_tr_b16 v[38:39], v9 offset:9472
  s_waitcnt lgkmcnt(15)
  v_mfma_f32_16x16x32_bf16 v[112:115], v[224:227], v[40:43], v[112:115]
  v_mfma_f32_16x16x32_bf16 v[116:119], v[228:231], v[40:43], v[116:119]
  ds_read_b64_tr_b16 v[40:41], v8 offset:9728
  ds_read_b64_tr_b16 v[42:43], v8 offset:9984
  v_mfma_f32_16x16x32_bf16 v[120:123], v[224:227], v[44:47], v[120:123]
  v_mfma_f32_16x16x32_bf16 v[124:127], v[228:231], v[44:47], v[124:127]
  ds_read_b64_tr_b16 v[44:45], v9 offset:9728
  ds_read_b64_tr_b16 v[46:47], v9 offset:9984
  s_waitcnt lgkmcnt(12)
  v_mfma_f32_16x16x32_bf16 v[64:67], v[232:235], v[16:19], v[64:67]
  s_waitcnt vmcnt(23)
  s_barrier
  s_add_u32 m0, s59, 65536
  s_nop 0
  buffer_load_dwordx4 v4, s[28:31], s56 offen lds
  v_mfma_f32_16x16x32_bf16 v[68:71], v[236:239], v[16:19], v[68:71]
  ds_read_b64_tr_b16 v[16:17], v8 offset:16384
  ds_read_b64_tr_b16 v[18:19], v8 offset:16640
  s_add_u32 m0, s59, 66432
  s_add_u32 s65, s56, 0x80000
  buffer_load_dwordx4 v4, s[28:31], s56 offen offset:128 lds
  s_and_b32 s56, s65, 0x3fffff
  v_mfma_f32_16x16x32_bf16 v[72:75], v[232:235], v[20:23], v[72:75]
  v_mfma_f32_16x16x32_bf16 v[76:79], v[236:239], v[20:23], v[76:79]
  ds_read_b64_tr_b16 v[20:21], v9 offset:16384
  ds_read_b64_tr_b16 v[22:23], v9 offset:16640
  s_waitcnt lgkmcnt(12)
  v_mfma_f32_16x16x32_bf16 v[80:83], v[232:235], v[24:27], v[80:83]
  v_mfma_f32_16x16x32_bf16 v[84:87], v[236:239], v[24:27], v[84:87]
  ds_read_b64_tr_b16 v[24:25], v8 offset:16896
  ds_read_b64_tr_b16 v[26:27], v8 offset:17152
  v_mfma_f32_16x16x32_bf16 v[88:91], v[232:235], v[28:31], v[88:91]
  v_mfma_f32_16x16x32_bf16 v[92:95], v[236:239], v[28:31], v[92:95]
  ds_read_b64_tr_b16 v[28:29], v9 offset:16896
  ds_read_b64_tr_b16 v[30:31], v9 offset:17152
  s_waitcnt lgkmcnt(12)
  v_mfma_f32_16x16x32_bf16 v[96:99], v[232:235], v[32:35], v[96:99]
  v_mfma_f32_16x16x32_bf16 v[100:103], v[236:239], v[32:35], v[100:103]
  ds_read_b64_tr_b16 v[32:33], v8 offset:17408
  ds_read_b64_tr_b16 v[34:35], v8 offset:17664
  v_mfma_f32_16x16x32_bf16 v[104:107], v[232:235], v[36:39], v[104:107]
  v_mfma_f32_16x16x32_bf16 v[108:111], v[236:239], v[36:39], v[108:111]
  ds_read_b64_tr_b16 v[36:37], v9 offset:17408
  ds_read_b64_tr_b16 v[38:39], v9 offset:17664
  s_waitcnt lgkmcnt(12)
  v_mfma_f32_16x16x32_bf16 v[112:115], v[232:235], v[40:43], v[112:115]
  v_mfma_f32_16x16x32_bf16 v[116:119], v[236:239], v[40:43], v[116:119]
  ds_read_b64_tr_b16 v[40:41], v8 offset:17920
  ds_read_b64_tr_b16 v[42:43], v8 offset:18176
  v_mfma_f32_16x16x32_bf16 v[120:123], v[232:235], v[44:47], v[120:123]
  v_mfma_f32_16x16x32_bf16 v[124:127], v[236:239], v[44:47], v[124:127]
  ds_read_b64_tr_b16 v[44:45], v9 offset:17920
  ds_read_b64_tr_b16 v[46:47], v9 offset:18176
  s_waitcnt lgkmcnt(12)
  v_mfma_f32_16x16x32_bf16 v[64:67], v[240:243], v[16:19], v[64:67]
  buffer_load_dwordx4 v[192:195], v7, s[36:39], s58 offen offset:0 sc1
  v_mfma_f32_16x16x32_bf16 v[68:71], v[244:247], v[16:19], v[68:71]
  ds_read_b64_tr_b16 v[16:17], v8 offset:24576
  ds_read_b64_tr_b16 v[18:19], v8 offset:24832
  buffer_load_dwordx4 v[196:199], v7, s[36:39], s58 offen offset:256 sc1
  v_mfma_f32_16x16x32_bf16 v[72:75], v[240:243], v[20:23], v[72:75]
  buffer_load_dwordx4 v[200:203], v7, s[36:39], s58 offen offset:2048 sc1
  v_mfma_f32_16x16x32_bf16 v[76:79], v[244:247], v[20:23], v[76:79]
  ds_read_b64_tr_b16 v[20:21], v9 offset:24576
  ds_read_b64_tr_b16 v[22:23], v9 offset:24832
  buffer_load_dwordx4 v[204:207], v7, s[36:39], s58 offen offset:2304 sc1
  s_waitcnt lgkmcnt(12)
  v_mfma_f32_16x16x32_bf16 v[80:83], v[240:243], v[24:27], v[80:83]
  s_add_u32 s58, s58, 0x1000
  s_and_b32 s58, s58, 0x7fff
  v_mfma_f32_16x16x32_bf16 v[84:87], v[244:247], v[24:27], v[84:87]
  ds_read_b64_tr_b16 v[24:25], v8 offset:25088
  ds_read_b64_tr_b16 v[26:27], v8 offset:25344
  buffer_load_dwordx4 v[208:211], v7, s[36:39], s58 offen offset:0 sc1
  v_mfma_f32_16x16x32_bf16 v[88:91], v[240:243], v[28:31], v[88:91]
  buffer_load_dwordx4 v[212:215], v7, s[36:39], s58 offen offset:256 sc1
  v_mfma_f32_16x16x32_bf16 v[92:95], v[244:247], v[28:31], v[92:95]
  ds_read_b64_tr_b16 v[28:29], v9 offset:25088
  ds_read_b64_tr_b16 v[30:31], v9 offset:25344
  buffer_load_dwordx4 v[216:219], v7, s[36:39], s58 offen offset:2048 sc1
  s_waitcnt lgkmcnt(12)
  v_mfma_f32_16x16x32_bf16 v[96:99], v[240:243], v[32:35], v[96:99]
  buffer_load_dwordx4 v[220:223], v7, s[36:39], s58 offen offset:2304 sc1
  v_mfma_f32_16x16x32_bf16 v[100:103], v[244:247], v[32:35], v[100:103]
  ds_read_b64_tr_b16 v[32:33], v8 offset:25600
  ds_read_b64_tr_b16 v[34:35], v8 offset:25856
  s_add_u32 s58, s58, 0x1000
  s_and_b32 s58, s58, 0x7fff
  v_mfma_f32_16x16x32_bf16 v[104:107], v[240:243], v[36:39], v[104:107]
  v_mfma_f32_16x16x32_bf16 v[108:111], v[244:247], v[36:39], v[108:111]
  ds_read_b64_tr_b16 v[36:37], v9 offset:25600
  ds_read_b64_tr_b16 v[38:39], v9 offset:25856
  s_waitcnt lgkmcnt(12)
  v_mfma_f32_16x16x32_bf16 v[112:115], v[240:243], v[40:43], v[112:115]
  v_mfma_f32_16x16x32_bf16 v[116:119], v[244:247], v[40:43], v[116:119]
  ds_read_b64_tr_b16 v[40:41], v8 offset:26112
  ds_read_b64_tr_b16 v[42:43], v8 offset:26368
  v_mfma_f32_16x16x32_bf16 v[120:123], v[240:243], v[44:47], v[120:123]
  v_mfma_f32_16x16x32_bf16 v[124:127], v[244:247], v[44:47], v[124:127]
  ds_read_b64_tr_b16 v[44:45], v9 offset:26112
  ds_read_b64_tr_b16 v[46:47], v9 offset:26368
  s_waitcnt lgkmcnt(12)
  v_mfma_f32_16x16x32_bf16 v[64:67], v[248:251], v[16:19], v[64:67]
  s_waitcnt vmcnt(22)
  s_barrier
  s_add_u32 m0, s59, 0
  s_nop 0
  buffer_load_dwordx4 v4, s[28:31], s56 offen lds
  v_mfma_f32_16x16x32_bf16 v[68:71], v[252:255], v[16:19], v[68:71]
  ds_read_b64_tr_b16 v[16:17], v8 offset:32768
  ds_read_b64_tr_b16 v[18:19], v8 offset:33024
  s_add_u32 m0, s59, 896
  s_add_u32 s65, s56, 0x80000
  buffer_load_dwordx4 v4, s[28:31], s56 offen offset:128 lds
  s_and_b32 s56, s65, 0x3fffff
  v_mfma_f32_16x16x32_bf16 v[72:75], v[248:251], v[20:23], v[72:75]
  v_mfma_f32_16x16x32_bf16 v[76:79], v[252:255], v[20:23], v[76:79]
  ds_read_b64_tr_b16 v[20:21], v9 offset:32768
  ds_read_b64_tr_b16 v[22:23], v9 offset:33024
  s_waitcnt lgkmcnt(12)
  v_mfma_f32_16x16x32_bf16 v[80:83], v[248:251], v[24:27], v[80:83]
  v_mfma_f32_16x16x32_bf16 v[84:87], v[252:255], v[24:27], v[84:87]
  ds_read_b64_tr_b16 v[24:25], v8 offset:33280
  ds_read_b64_tr_b16 v[26:27], v8 offset:33536
  v_mfma_f32_16x16x32_bf16 v[88:91], v[248:251], v[28:31], v[88:91]
  v_mfma_f32_16x16x32_bf16 v[92:95], v[252:255], v[28:31], v[92:95]
  ds_read_b64_tr_b16 v[28:29], v9 offset:33280
  ds_read_b64_tr_b16 v[30:31], v9 offset:33536
  s_waitcnt lgkmcnt(12)
  v_mfma_f32_16x16x32_bf16 v[96:99], v[248:251], v[32:35], v[96:99]
  v_mfma_f32_16x16x32_bf16 v[100:103], v[252:255], v[32:35], v[100:103]
  ds_read_b64_tr_b16 v[32:33], v8 offset:33792
  ds_read_b64_tr_b16 v[34:35], v8 offset:34048
  v_mfma_f32_16x16x32_bf16 v[104:107], v[248:251], v[36:39], v[104:107]
  v_mfma_f32_16x16x32_bf16 v[108:111], v[252:255], v[36:39], v[108:111]
  ds_read_b64_tr_b16 v[36:37], v9 offset:33792
  ds_read_b64_tr_b16 v[38:39], v9 offset:34048
  s_waitcnt lgkmcnt(12)
  v_mfma_f32_16x16x32_bf16 v[112:115], v[248:251], v[40:43], v[112:115]
  v_mfma_f32_16x16x32_bf16 v[116:119], v[252:255], v[40:43], v[116:119]
  ds_read_b64_tr_b16 v[40:41], v8 offset:34304
  ds_read_b64_tr_b16 v[42:43], v8 offset:34560
  v_mfma_f32_16x16x32_bf16 v[120:123], v[248:251], v[44:47], v[120:123]
  v_mfma_f32_16x16x32_bf16 v[124:127], v[252:255], v[44:47], v[124:127]
  ds_read_b64_tr_b16 v[44:45], v9 offset:34304
  ds_read_b64_tr_b16 v[46:47], v9 offset:34560
  v_cvt_pk_bf16_f32 v224, v64, v65
  v_cvt_pk_bf16_f32 v225, v66, v67
  v_cvt_pk_bf16_f32 v226, v68, v69
  v_cvt_pk_bf16_f32 v227, v70, v71
  v_cvt_pk_bf16_f32 v228, v72, v73
  v_cvt_pk_bf16_f32 v229, v74, v75
  v_cvt_pk_bf16_f32 v230, v76, v77
  v_cvt_pk_bf16_f32 v231, v78, v79
  s_waitcnt lgkmcnt(12)
  v_mfma_f32_16x16x32_bf16 v[64:67], v[16:19], v[128:131], 0
  v_mfma_f32_16x16x32_bf16 v[68:71], v[16:19], v[132:135], 0
  ds_read_b64_tr_b16 v[16:17], v8 offset:40960
  ds_read_b64_tr_b16 v[18:19], v8 offset:41216
  v_mfma_f32_16x16x32_bf16 v[72:75], v[20:23], v[128:131], 0
  v_mfma_f32_16x16x32_bf16 v[76:79], v[20:23], v[132:135], 0
  ds_read_b64_tr_b16 v[20:21], v9 offset:40960
  ds_read_b64_tr_b16 v[22:23], v9 offset:41216
  v_cvt_pk_bf16_f32 v232, v80, v81
  v_cvt_pk_bf16_f32 v233, v82, v83
  v_cvt_pk_bf16_f32 v234, v84, v85
  v_cvt_pk_bf16_f32 v235, v86, v87
  v_cvt_pk_bf16_f32 v236, v88, v89
  v_cvt_pk_bf16_f32 v237, v90, v91
  v_cvt_pk_bf16_f32 v238, v92, v93
  v_cvt_pk_bf16_f32 v239, v94, v95
  s_waitcnt lgkmcnt(12)
  v_mfma_f32_16x16x32_bf16 v[80:83], v[24:27], v[128:131], 0
  v_mfma_f32_16x16x32_bf16 v[84:87], v[24:27], v[132:135], 0
  ds_read_b64_tr_b16 v[24:25], v8 offset:41472
  ds_read_b64_tr_b16 v[26:27], v8 offset:41728
  v_mfma_f32_16x16x32_bf16 v[88:91], v[28:31], v[128:131], 0
  v_mfma_f32_16x16x32_bf16 v[92:95], v[28:31], v[132:135], 0
  ds_read_b64_tr_b16 v[28:29], v9 offset:41472
  ds_read_b64_tr_b16 v[30:31], v9 offset:41728
  v_cvt_pk_bf16_f32 v240, v96, v97
  v_cvt_pk_bf16_f32 v241, v98, v99
  v_cvt_pk_bf16_f32 v242, v100, v101
  v_cvt_pk_bf16_f32 v243, v102, v103
  v_cvt_pk_bf16_f32 v244, v104, v105
  v_cvt_pk_bf16_f32 v245, v106, v107
  v_cvt_pk_bf16_f32 v246, v108, v109
  v_cvt_pk_bf16_f32 v247, v110, v111
  s_cmp_lg_u32 s3, 0
  s_cbranch_scc1 g_9
  s_add_u32 s7, s61, 16384
  buffer_store_dwordx4 v[224:227], v2, s[20:23], s7 offen offset:0 sc1
  s_add_u32 s7, s61, 16384
  buffer_store_dwordx4 v[228:231], v2, s[20:23], s7 offen offset:1024 sc1
g_9:
  s_waitcnt lgkmcnt(12)
  v_mfma_f32_16x16x32_bf16 v[96:99], v[32:35], v[128:131], 0
  s_add_u32 s7, s73, 16384
  buffer_store_dwordx4 v[224:227], v2, s[20:23], s7 offen offset:0 sc1
  v_mfma_f32_16x16x32_bf16 v[100:103], v[32:35], v[132:135], 0
  ds_read_b64_tr_b16 v[32:33], v8 offset:41984
  ds_read_b64_tr_b16 v[34:35], v8 offset:42240
  s_cmp_lg_u32 s3, 0
  s_cbranch_scc1 g_10
  s_add_u32 s7, s61, 16384
  buffer_store_dwordx4 v[232:235], v2, s[20:23], s7 offen offset:2048 sc1
  s_add_u32 s7, s61, 16384
  buffer_store_dwordx4 v[236:239], v2, s[20:23], s7 offen offset:3072 sc1
g_10:
  v_mfma_f32_16x16x32_bf16 v[104:107], v[36:39], v[128:131], 0
  v_mfma_f32_16x16x32_bf16 v[108:111], v[36:39], v[132:135], 0
  ds_read_b64_tr_b16 v[36:37], v9 offset:41984
  ds_read_b64_tr_b16 v[38:39], v9 offset:42240
  v_cvt_pk_bf16_f32 v248, v112, v113
  v_cvt_pk_bf16_f32 v249, v114, v115
  v_cvt_pk_bf16_f32 v250, v116, v117
  v_cvt_pk_bf16_f32 v251, v118, v119
  v_cvt_pk_bf16_f32 v252, v120, v121
  v_cvt_pk_bf16_f32 v253, v122, v123
  v_cvt_pk_bf16_f32 v254, v124, v125
  v_cvt_pk_bf16_f32 v255, v126, v127
  s_cmp_lg_u32 s3, 0
  s_cbranch_scc1 g_11
  s_add_u32 s7, s61, 20480
  buffer_store_dwordx4 v[240:243], v2, s[20:23], s7 offen offset:0 sc1
  s_add_u32 s7, s61, 20480
  buffer_store_dwordx4 v[244:247], v2, s[20:23], s7 offen offset:1024 sc1
g_11:
  s_waitcnt lgkmcnt(12)
  v_mfma_f32_16x16x32_bf16 v[112:115], v[40:43], v[128:131], 0
  v_mfma_f32_16x16x32_bf16 v[116:119], v[40:43], v[132:135], 0
  ds_read_b64_tr_b16 v[40:41], v8 offset:42496
  ds_read_b64_tr_b16 v[42:43], v8 offset:42752
  s_cmp_lg_u32 s3, 0
  s_cbranch_scc1 g_12
  s_add_u32 s7, s61, 20480
  buffer_store_dwordx4 v[248:251], v2, s[20:23], s7 offen offset:2048 sc1
  s_add_u32 s7, s61, 20480
  buffer_store_dwordx4 v[252:255], v2, s[20:23], s7 offen offset:3072 sc1
g_12:
  v_mfma_f32_16x16x32_bf16 v[120:123], v[44:47], v[128:131], 0
  v_mfma_f32_16x16x32_bf16 v[124:127], v[44:47], v[132:135], 0
  ds_read_b64_tr_b16 v[44:45], v9 offset:42496
  ds_read_b64_tr_b16 v[46:47], v9 offset:42752
  s_waitcnt lgkmcnt(12)
  v_mfma_f32_16x16x32_bf16 v[64:67], v[16:19], v[136:139], v[64:67]
  s_waitcnt vmcnt(17)
  s_barrier
  s_add_u32 m0, s59, 16384
  s_nop 0
  buffer_load_dwordx4 v4, s[28:31], s56 offen lds
  v_mfma_f32_16x16x32_bf16 v[68:71], v[16:19], v[140:143], v[68:71]
  ds_read_b64_tr_b16 v[16:17], v8 offset:49152
  ds_read_b64_tr_b16 v[18:19], v8 offset:49408
  s_add_u32 m0, s59, 17280
  s_add_u32 s65, s56, 0x80000
  buffer_load_dwordx4 v4, s[28:31], s56 offen offset:128 lds
  s_and_b32 s56, s65, 0x3fffff
  v_mfma_f32_16x16x32_bf16 v[72:75], v[20:23], v[136:139], v[72:75]
  v_mfma_f32_16x16x32_bf16 v[76:79], v[20:23], v[140:143], v[76:79]
  ds_read_b64_tr_b16 v[20:21], v9 offset:49152
  ds_read_b64_tr_b16 v[22:23], v9 offset:49408
  s_waitcnt lgkmcnt(12)
  v_mfma_f32_16x16x32_bf16 v[80:83], v[24:27], v[136:139], v[80:83]
  v_mfma_f32_16x16x32_bf16 v[84:87], v[24:27], v[140:143], v[84:87]
  ds_read_b64_tr_b16 v[24:25], v8 offset:49664
  ds_read_b64_tr_b16 v[26:27], v8 offset:49920
  v_mfma_f32_16x16x32_bf16 v[88:91], v[28:31], v[136:139], v[88:91]
  v_mfma_f32_16x16x32_bf16 v[92:95], v[28:31], v[140:143], v[92:95]
  ds_read_b64_tr_b16 v[28:29], v9 offset:49664
  ds_read_b64_tr_b16 v[30:31], v9 offset:49920
  s_waitcnt lgkmcnt(12)
  v_mfma_f32_16x16x32_bf16 v[96:99], v[32:35], v[136:139], v[96:99]
  s_add_u32 s7, s73, 16384
  buffer_store_dwordx4 v[228:231], v2, s[20:23], s7 offen offset:1024 sc1
  v_mfma_f32_16x16x32_bf16 v[100:103], v[32:35], v[140:143], v[100:103]
  ds_read_b64_tr_b16 v[32:33], v8 offset:50176
  ds_read_b64_tr_b16 v[34:35], v8 offset:50432
  v_mfma_f32_16x16x32_bf16 v[104:107], v[36:39], v[136:139], v[104:107]
  v_mfma_f32_16x16x32_bf16 v[108:111], v[36:39], v[140:143], v[108:111]
  ds_read_b64_tr_b16 v[36:37], v9 offset:50176
  ds_read_b64_tr_b16 v[38:39], v9 offset:50432
  s_waitcnt lgkmcnt(12)
  v_mfma_f32_16x16x32_bf16 v[112:115], v[40:43], v[136:139], v[112:115]
  v_mfma_f32_16x16x32_bf16 v[116:119], v[40:43], v[140:143], v[116:119]
  ds_read_b64_tr_b16 v[40:41], v8 offset:50688
  ds_read_b64_tr_b16 v[42:43], v8 offset:50944
  v_mfma_f32_16x16x32_bf16 v[120:123], v[44:47], v[136:139], v[120:123]
  v_mfma_f32_16x16x32_bf16 v[124:127], v[44:47], v[140:143], v[124:127]
  ds_read_b64_tr_b16 v[44:45], v9 offset:50688
  ds_read_b64_tr_b16 v[46:47], v9 offset:50944
  s_waitcnt lgkmcnt(12)
  v_mfma_f32_16x16x32_bf16 v[64:67], v[16:19], v[144:147], v[64:67]
  v_mfma_f32_16x16x32_bf16 v[68:71], v[16:19], v[148:151], v[68:71]
  ds_read_b64_tr_b16 v[16:17], v8 offset:57344
  ds_read_b64_tr_b16 v[18:19], v8 offset:57600
  v_mfma_f32_16x16x32_bf16 v[72:75], v[20:23], v[144:147], v[72:75]
  v_mfma_f32_16x16x32_bf16 v[76:79], v[20:23], v[148:151], v[76:79]
  ds_read_b64_tr_b16 v[20:21], v9 offset:57344
  ds_read_b64_tr_b16 v[22:23], v9 offset:57600
  s_waitcnt lgkmcnt(12)
  v_mfma_f32_16x16x32_bf16 v[80:83], v[24:27], v[144:147], v[80:83]
  v_mfma_f32_16x16x32_bf16 v[84:87], v[24:27], v[148:151], v[84:87]
  ds_read_b64_tr_b16 v[24:25], v8 offset:57856
  ds_read_b64_tr_b16 v[26:27], v8 offset:58112
  v_mfma_f32_16x16x32_bf16 v[88:91], v[28:31], v[144:147], v[88:91]
  v_mfma_f32_16x16x32_bf16 v[92:95], v[28:31], v[148:151], v[92:95]
  ds_read_b64_tr_b16 v[28:29], v9 offset:57856
  ds_read_b64_tr_b16 v[30:31], v9 offset:58112
  s_waitcnt lgkmcnt(12)
  v_mfma_f32_16x16x32_bf16 v[96:99], v[32:35], v[144:147], v[96:99]
  s_add_u32 s7, s73, 16384
  buffer_store_dwordx4 v[232:235], v2, s[20:23], s7 offen offset:2048 sc1
  v_mfma_f32_16x16x32_bf16 v[100:103], v[32:35], v[148:151], v[100:103]
  ds_read_b64_tr_b16 v[32:33], v8 offset:58368
  ds_read_b64_tr_b16 v[34:35], v8 offset:58624
  v_mfma_f32_16x16x32_bf16 v[104:107], v[36:39], v[144:147], v[104:107]
  v_mfma_f32_16x16x32_bf16 v[108:111], v[36:39], v[148:151], v[108:111]
  ds_read_b64_tr_b16 v[36:37], v9 offset:58368
  ds_read_b64_tr_b16 v[38:39], v9 offset:58624
  s_waitcnt lgkmcnt(12)
  v_mfma_f32_16x16x32_bf16 v[112:115], v[40:43], v[144:147], v[112:115]
  v_mfma_f32_16x16x32_bf16 v[116:119], v[40:43], v[148:151], v[116:119]
  ds_read_b64_tr_b16 v[40:41], v8 offset:58880
  ds_read_b64_tr_b16 v[42:43], v8 offset:59136
  v_mfma_f32_16x16x32_bf16 v[120:123], v[44:47], v[144:147], v[120:123]
  v_mfma_f32_16x16x32_bf16 v[124:127], v[44:47], v[148:151], v[124:127]
  ds_read_b64_tr_b16 v[44:45], v9 offset:58880
  ds_read_b64_tr_b16 v[46:47], v9 offset:59136
  s_waitcnt lgkmcnt(12)
  v_mfma_f32_16x16x32_bf16 v[64:67], v[16:19], v[152:155], v[64:67]
  s_waitcnt vmcnt(15)
  s_barrier
  s_cmp_lg_u32 s3, 0
  s_cbranch_scc1 g_13
  s_waitcnt vmcnt(4)
  s_add_u32 s55, s75, 4
  v_mov_b32 v0, 0
  v_mov_b32 v3, 1
  s_mov_b64 exec, 1
  buffer_atomic_add v3, v0, s[36:39], s55 offen
  s_mov_b64 exec, -1
g_13:
  s_add_u32 m0, s59, 32768
  s_nop 0
  buffer_load_dwordx4 v4, s[28:31], s56 offen lds
  v_mfma_f32_16x16x32_bf16 v[68:71], v[16:19], v[156:159], v[68:71]
  v_add_u32 v8, 0x10000, v8
  v_add_u32 v9, 0x10000, v9
  ds_read_b64_tr_b16 v[16:17], v8 offset:0
  ds_read_b64_tr_b16 v[18:19], v8 offset:256
  s_add_u32 m0, s59, 33664
  s_add_u32 s65, s56, 0x80000
  buffer_load_dwordx4 v4, s[28:31], s56 offen offset:128 lds
  s_and_b32 s56, s65, 0x3fffff
  v_mfma_f32_16x16x32_bf16 v[72:75], v[20:23], v[152:155], v[72:75]
  v_mfma_f32_16x16x32_bf16 v[76:79], v[20:23], v[156:159], v[76:79]
  ds_read_b64_tr_b16 v[20:21], v9 offset:0
  ds_read_b64_tr_b16 v[22:23], v9 offset:256
  s_waitcnt lgkmcnt(12)
  v_mfma_f32_16x16x32_bf16 v[80:83], v[24:27], v[152:155], v[80:83]
  v_mfma_f32_16x16x32_bf16 v[84:87], v[24:27], v[156:159], v[84:87]
  ds_read_b64_tr_b16 v[24:25], v8 offset:512
  ds_read_b64_tr_b16 v[26:27], v8 offset:768
  v_mfma_f32_16x16x32_bf16 v[88:91], v[28:31], v[152:155], v[88:91]
  v_mfma_f32_16x16x32_bf16 v[92:95], v[28:31], v[156:159], v[92:95]
  ds_read_b64_tr_b16 v[28:29], v9 offset:512
  ds_read_b64_tr_b16 v[30:31], v9 offset:768
  s_waitcnt lgkmcnt(12)
  v_mfma_f32_16x16x32_bf16 v[96:99], v[32:35], v[152:155], v[96:99]
  s_add_u32 s7, s73, 16384
  buffer_store_dwordx4 v[236:239], v2, s[20:23], s7 offen offset:3072 sc1
  v_mfma_f32_16x16x32_bf16 v[100:103], v[32:35], v[156:159], v[100:103]
  ds_read_b64_tr_b16 v[32:33], v8 offset:1024
  ds_read_b64_tr_b16 v[34:35], v8 offset:1280
  v_mfma_f32_16x16x32_bf16 v[104:107], v[36:39], v[152:155], v[104:107]
  v_mfma_f32_16x16x32_bf16 v[108:111], v[36:39], v[156:159], v[108:111]
  ds_read_b64_tr_b16 v[36:37], v9 offset:1024
  ds_read_b64_tr_b16 v[38:39], v9 offset:1280
  s_waitcnt lgkmcnt(12)
  v_mfma_f32_16x16x32_bf16 v[112:115], v[40:43], v[152:155], v[112:115]
  v_mfma_f32_16x16x32_bf16 v[116:119], v[40:43], v[156:159], v[116:119]
  ds_read_b64_tr_b16 v[40:41], v8 offset:1536
  ds_read_b64_tr_b16 v[42:43], v8 offset:1792
  v_mfma_f32_16x16x32_bf16 v[120:123], v[44:47], v[152:155], v[120:123]
  v_mfma_f32_16x16x32_bf16 v[124:127], v[44:47], v[156:159], v[124:127]
  ds_read_b64_tr_b16 v[44:45], v9 offset:1536
  ds_read_b64_tr_b16 v[46:47], v9 offset:1792
  s_waitcnt lgkmcnt(12)
  v_mfma_f32_16x16x32_bf16 v[64:67], v[16:19], v[160:163], v[64:67]
  v_mfma_f32_16x16x32_bf16 v[68:71], v[16:19], v[164:167], v[68:71]
  ds_read_b64_tr_b16 v[16:17], v8 offset:8192
  ds_read_b64_tr_b16 v[18:19], v8 offset:8448
  v_mfma_f32_16x16x32_bf16 v[72:75], v[20:23], v[160:163], v[72:75]
  v_mfma_f32_16x16x32_bf16 v[76:79], v[20:23], v[164:167], v[76:79]
  ds_read_b64_tr_b16 v[20:21], v9 offset:8192
  ds_read_b64_tr_b16 v[22:23], v9 offset:8448
  s_waitcnt lgkmcnt(12)
  v_mfma_f32_16x16x32_bf16 v[80:83], v[24:27], v[160:163], v[80:83]
  v_mfma_f32_16x16x32_bf16 v[84:87], v[24:27], v[164:167], v[84:87]
  ds_read_b64_tr_b16 v[24:25], v8 offset:8704
  ds_read_b64_tr_b16 v[26:27], v8 offset:8960
  v_mfma_f32_16x16x32_bf16 v[88:91], v[28:31], v[160:163], v[88:91]
  v_mfma_f32_16x16x32_bf16 v[92:95], v[28:31], v[164:167], v[92:95]
  ds_read_b64_tr_b16 v[28:29], v9 offset:8704
  ds_read_b64_tr_b16 v[30:31], v9 offset:8960
  s_waitcnt lgkmcnt(12)
  v_mfma_f32_16x16x32_bf16 v[96:99], v[32:35], v[160:163], v[96:99]
  s_add_u32 s7, s73, 20480
  buffer_store_dwordx4 v[240:243], v2, s[20:23], s7 offen offset:0 sc1
  v_mfma_f32_16x16x32_bf16 v[100:103], v[32:35], v[164:167], v[100:103]
  ds_read_b64_tr_b16 v[32:33], v8 offset:9216
  ds_read_b64_tr_b16 v[34:35], v8 offset:9472
  v_mfma_f32_16x16x32_bf16 v[104:107], v[36:39], v[160:163], v[104:107]
  v_mfma_f32_16x16x32_bf16 v[108:111], v[36:39], v[164:167], v[108:111]
  ds_read_b64_tr_b16 v[36:37], v9 offset:9216
  ds_read_b64_tr_b16 v[38:39], v9 offset:9472
  s_waitcnt lgkmcnt(12)
  v_mfma_f32_16x16x32_bf16 v[112:115], v[40:43], v[160:163], v[112:115]
  v_mfma_f32_16x16x32_bf16 v[116:119], v[40:43], v[164:167], v[116:119]
  ds_read_b64_tr_b16 v[40:41], v8 offset:9728
  ds_read_b64_tr_b16 v[42:43], v8 offset:9984
  v_mfma_f32_16x16x32_bf16 v[120:123], v[44:47], v[160:163], v[120:123]
  v_mfma_f32_16x16x32_bf16 v[124:127], v[44:47], v[164:167], v[124:127]
  ds_read_b64_tr_b16 v[44:45], v9 offset:9728
  ds_read_b64_tr_b16 v[46:47], v9 offset:9984
  v_subrev_u32 v8, 0x10000, v8
  v_subrev_u32 v9, 0x10000, v9
  s_waitcnt lgkmcnt(12)
  v_mfma_f32_16x16x32_bf16 v[64:67], v[16:19], v[168:171], v[64:67]
  s_waitcnt vmcnt(9)
  s_barrier
  s_add_u32 m0, s59, 49152
  s_nop 0
  buffer_load_dwordx4 v4, s[28:31], s56 offen lds
  v_mfma_f32_16x16x32_bf16 v[68:71], v[16:19], v[172:175], v[68:71]
  ds_read_b64_tr_b16 v[16:17], v8 offset:0
  ds_read_b64_tr_b16 v[18:19], v8 offset:256
  s_add_u32 m0, s59, 50048
  s_add_u32 s65, s56, 0x80000
  buffer_load_dwordx4 v4, s[28:31], s56 offen offset:128 lds
  s_and_b32 s56, s65, 0x3fffff
  v_mfma_f32_16x16x32_bf16 v[72:75], v[20:23], v[168:171], v[72:75]
  v_mfma_f32_16x16x32_bf16 v[76:79], v[20:23], v[172:175], v[76:79]
  ds_read_b64_tr_b16 v[20:21], v9 offset:0
  ds_read_b64_tr_b16 v[22:23], v9 offset:256
  s_waitcnt lgkmcnt(12)
  v_mfma_f32_16x16x32_bf16 v[80:83], v[24:27], v[168:171], v[80:83]
  v_mfma_f32_16x16x32_bf16 v[84:87], v[24:27], v[172:175], v[84:87]
  ds_read_b64_tr_b16 v[24:25], v8 offset:512
  ds_read_b64_tr_b16 v[26:27], v8 offset:768
  v_mfma_f32_16x16x32_bf16 v[88:91], v[28:31], v[168:171], v[88:91]
  v_mfma_f32_16x16x32_bf16 v[92:95], v[28:31], v[172:175], v[92:95]
  ds_read_b64_tr_b16 v[28:29], v9 offset:512
  ds_read_b64_tr_b16 v[30:31], v9 offset:768
  s_waitcnt lgkmcnt(12)
  v_mfma_f32_16x16x32_bf16 v[96:99], v[32:35], v[168:171], v[96:99]
  s_add_u32 s7, s73, 20480
  buffer_store_dwordx4 v[244:247], v2, s[20:23], s7 offen offset:1024 sc1
  v_mfma_f32_16x16x32_bf16 v[100:103], v[32:35], v[172:175], v[100:103]
  ds_read_b64_tr_b16 v[32:33], v8 offset:1024
  ds_read_b64_tr_b16 v[34:35], v8 offset:1280
  v_mfma_f32_16x16x32_bf16 v[104:107], v[36:39], v[168:171], v[104:107]
  v_mfma_f32_16x16x32_bf16 v[108:111], v[36:39], v[172:175], v[108:111]
  ds_read_b64_tr_b16 v[36:37], v9 offset:1024
  ds_read_b64_tr_b16 v[38:39], v9 offset:1280
  s_waitcnt lgkmcnt(12)
  v_mfma_f32_16x16x32_bf16 v[112:115], v[40:43], v[168:171], v[112:115]
  v_mfma_f32_16x16x32_bf16 v[116:119], v[40:43], v[172:175], v[116:119]
  ds_read_b64_tr_b16 v[40:41], v8 offset:1536
  ds_read_b64_tr_b16 v[42:43], v8 offset:1792
  v_mfma_f32_16x16x32_bf16 v[120:123], v[44:47], v[168:171], v[120:123]
  v_mfma_f32_16x16x32_bf16 v[124:127], v[44:47], v[172:175], v[124:127]
  ds_read_b64_tr_b16 v[44:45], v9 offset:1536
  ds_read_b64_tr_b16 v[46:47], v9 offset:1792
  s_waitcnt lgkmcnt(12)
  v_mfma_f32_16x16x32_bf16 v[64:67], v[16:19], v[176:179], v[64:67]
  v_mfma_f32_16x16x32_bf16 v[68:71], v[16:19], v[180:183], v[68:71]
  ds_read_b64_tr_b16 v[16:17], v8 offset:8192
  ds_read_b64_tr_b16 v[18:19], v8 offset:8448
  v_mfma_f32_16x16x32_bf16 v[72:75], v[20:23], v[176:179], v[72:75]
  v_mfma_f32_16x16x32_bf16 v[76:79], v[20:23], v[180:183], v[76:79]
  ds_read_b64_tr_b16 v[20:21], v9 offset:8192
  ds_read_b64_tr_b16 v[22:23], v9 offset:8448
  s_waitcnt lgkmcnt(12)
  v_mfma_f32_16x16x32_bf16 v[80:83], v[24:27], v[176:179], v[80:83]
  v_mfma_f32_16x16x32_bf16 v[84:87], v[24:27], v[180:183], v[84:87]
  ds_read_b64_tr_b16 v[24:25], v8 offset:8704
  ds_read_b64_tr_b16 v[26:27], v8 offset:8960
  v_mfma_f32_16x16x32_bf16 v[88:91], v[28:31], v[176:179], v[88:91]
  v_mfma_f32_16x16x32_bf16 v[92:95], v[28:31], v[180:183], v[92:95]
  ds_read_b64_tr_b16 v[28:29], v9 offset:8704
  ds_read_b64_tr_b16 v[30:31], v9 offset:8960
  s_waitcnt lgkmcnt(12)
  v_mfma_f32_16x16x32_bf16 v[96:99], v[32:35], v[176:179], v[96:99]
  s_add_u32 s7, s73, 20480
  buffer_store_dwordx4 v[248:251], v2, s[20:23], s7 offen offset:2048 sc1
  v_mfma_f32_16x16x32_bf16 v[100:103], v[32:35], v[180:183], v[100:103]
  ds_read_b64_tr_b16 v[32:33], v8 offset:9216
  ds_read_b64_tr_b16 v[34:35], v8 offset:9472
  v_mfma_f32_16x16x32_bf16 v[104:107], v[36:39], v[176:179], v[104:107]
  v_mfma_f32_16x16x32_bf16 v[108:111], v[36:39], v[180:183], v[108:111]
  ds_read_b64_tr_b16 v[36:37], v9 offset:9216
  ds_read_b64_tr_b16 v[38:39], v9 offset:9472
  s_waitcnt lgkmcnt(12)
  v_mfma_f32_16x16x32_bf16 v[112:115], v[40:43], v[176:179], v[112:115]
  v_mfma_f32_16x16x32_bf16 v[116:119], v[40:43], v[180:183], v[116:119]
  ds_read_b64_tr_b16 v[40:41], v8 offset:9728
  ds_read_b64_tr_b16 v[42:43], v8 offset:9984
  v_mfma_f32_16x16x32_bf16 v[120:123], v[44:47], v[176:179], v[120:123]
  v_mfma_f32_16x16x32_bf16 v[124:127], v[44:47], v[180:183], v[124:127]
  ds_read_b64_tr_b16 v[44:45], v9 offset:9728
  ds_read_b64_tr_b16 v[46:47], v9 offset:9984
  s_waitcnt lgkmcnt(12)
  v_mfma_f32_16x16x32_bf16 v[64:67], v[16:19], v[184:187], v[64:67]
  s_waitcnt vmcnt(10)
  s_barrier
  s_add_u32 m0, s59, 65536
  s_nop 0
  buffer_load_dwordx4 v4, s[28:31], s56 offen lds
  v_mfma_f32_16x16x32_bf16 v[68:71], v[16:19], v[188:191], v[68:71]
  ds_read_b64_tr_b16 v[16:17], v8 offset:16384
  ds_read_b64_tr_b16 v[18:19], v8 offset:16640
  s_add_u32 m0, s59, 66432
  s_add_u32 s65, s56, 0x80000
  buffer_load_dwordx4 v4, s[28:31], s56 offen offset:128 lds
  s_and_b32 s56, s65, 0x3fffff
  v_mfma_f32_16x16x32_bf16 v[72:75], v[20:23], v[184:187], v[72:75]
  v_mfma_f32_16x16x32_bf16 v[76:79], v[20:23], v[188:191], v[76:79]
  ds_read_b64_tr_b16 v[20:21], v9 offset:16384
  ds_read_b64_tr_b16 v[22:23], v9 offset:16640
  s_waitcnt lgkmcnt(12)
  v_mfma_f32_16x16x32_bf16 v[80:83], v[24:27], v[184:187], v[80:83]
  v_mfma_f32_16x16x32_bf16 v[84:87], v[24:27], v[188:191], v[84:87]
  ds_read_b64_tr_b16 v[24:25], v8 offset:16896
  ds_read_b64_tr_b16 v[26:27], v8 offset:17152
  v_mfma_f32_16x16x32_bf16 v[88:91], v[28:31], v[184:187], v[88:91]
  v_mfma_f32_16x16x32_bf16 v[92:95], v[28:31], v[188:191], v[92:95]
  ds_read_b64_tr_b16 v[28:29], v9 offset:16896
  ds_read_b64_tr_b16 v[30:31], v9 offset:17152
  s_waitcnt lgkmcnt(12)
  v_mfma_f32_16x16x32_bf16 v[96:99], v[32:35], v[184:187], v[96:99]
  s_add_u32 s7, s73, 20480
  buffer_store_dwordx4 v[252:255], v2, s[20:23], s7 offen offset:3072 sc1
  v_mfma_f32_16x16x32_bf16 v[100:103], v[32:35], v[188:191], v[100:103]
  ds_read_b64_tr_b16 v[32:33], v8 offset:17408
  ds_read_b64_tr_b16 v[34:35], v8 offset:17664
  v_mfma_f32_16x16x32_bf16 v[104:107], v[36:39], v[184:187], v[104:107]
  v_mfma_f32_16x16x32_bf16 v[108:111], v[36:39], v[188:191], v[108:111]
  ds_read_b64_tr_b16 v[36:37], v9 offset:17408
  ds_read_b64_tr_b16 v[38:39], v9 offset:17664
  s_waitcnt lgkmcnt(12)
  v_mfma_f32_16x16x32_bf16 v[112:115], v[40:43], v[184:187], v[112:115]
  v_mfma_f32_16x16x32_bf16 v[116:119], v[40:43], v[188:191], v[116:119]
  ds_read_b64_tr_b16 v[40:41], v8 offset:17920
  ds_read_b64_tr_b16 v[42:43], v8 offset:18176
  v_mfma_f32_16x16x32_bf16 v[120:123], v[44:47], v[184:187], v[120:123]
  v_mfma_f32_16x16x32_bf16 v[124:127], v[44:47], v[188:191], v[124:127]
  ds_read_b64_tr_b16 v[44:45], v9 offset:17920
  ds_read_b64_tr_b16 v[46:47], v9 offset:18176
  s_waitcnt lgkmcnt(12)
  v_mfma_f32_16x16x32_bf16 v[64:67], v[16:19], v[192:195], v[64:67]
  buffer_load_dwordx4 v[224:227], v7, s[36:39], s58 offen offset:0 sc1
  v_mfma_f32_16x16x32_bf16 v[68:71], v[16:19], v[196:199], v[68:71]
  ds_read_b64_tr_b16 v[16:17], v8 offset:24576
  ds_read_b64_tr_b16 v[18:19], v8 offset:24832
  buffer_load_dwordx4 v[228:231], v7, s[36:39], s58 offen offset:256 sc1
  v_mfma_f32_16x16x32_bf16 v[72:75], v[20:23], v[192:195], v[72:75]
  buffer_load_dwordx4 v[232:235], v7, s[36:39], s58 offen offset:2048 sc1
  v_mfma_f32_16x16x32_bf16 v[76:79], v[20:23], v[196:199], v[76:79]
  ds_read_b64_tr_b16 v[20:21], v9 offset:24576
  ds_read_b64_tr_b16 v[22:23], v9 offset:24832
  buffer_load_dwordx4 v[236:239], v7, s[36:39], s58 offen offset:2304 sc1
  s_waitcnt lgkmcnt(12)
  v_mfma_f32_16x16x32_bf16 v[80:83], v[24:27], v[192:195], v[80:83]
  s_add_u32 s58, s58, 0x1000
  s_and_b32 s58, s58, 0x7fff
  v_mfma_f32_16x16x32_bf16 v[84:87], v[24:27], v[196:199], v[84:87]
  ds_read_b64_tr_b16 v[24:25], v8 offset:25088
  ds_read_b64_tr_b16 v[26:27], v8 offset:25344
  buffer_load_dwordx4 v[240:243], v7, s[36:39], s58 offen offset:0 sc1
  v_mfma_f32_16x16x32_bf16 v[88:91], v[28:31], v[192:195], v[88:91]
  buffer_load_dwordx4 v[244:247], v7, s[36:39], s58 offen offset:256 sc1
  v_mfma_f32_16x16x32_bf16 v[92:95], v[28:31], v[196:199], v[92:95]
  ds_read_b64_tr_b16 v[28:29], v9 offset:25088
  ds_read_b64_tr_b16 v[30:31], v9 offset:25344
  buffer_load_dwordx4 v[248:251], v7, s[36:39], s58 offen offset:2048 sc1
  s_waitcnt lgkmcnt(12)
  v_mfma_f32_16x16x32_bf16 v[96:99], v[32:35], v[192:195], v[96:99]
  buffer_load_dwordx4 v[252:255], v7, s[36:39], s58 offen offset:2304 sc1
  v_mfma_f32_16x16x32_bf16 v[100:103], v[32:35], v[196:199], v[100:103]
  ds_read_b64_tr_b16 v[32:33], v8 offset:25600
  ds_read_b64_tr_b16 v[34:35], v8 offset:25856
  s_add_u32 s58, s58, 0x1000
  s_and_b32 s58, s58, 0x7fff
  v_mfma_f32_16x16x32_bf16 v[104:107], v[36:39], v[192:195], v[104:107]
  s_lshl_b32 s6, s41, 7
  s_add_u32 s6, s6, 0x12004
  v_mfma_f32_16x16x32_bf16 v[108:111], v[36:39], v[196:199], v[108:111]
  ds_read_b64_tr_b16 v[36:37], v9 offset:25600
  ds_read_b64_tr_b16 v[38:39], v9 offset:25856
  s_cmp_lg_u32 s3, 0
  s_cbranch_scc1 g_14
  s_load_dword s9, s[36:37], s6 glc
g_14:
  s_waitcnt lgkmcnt(12)
  v_mfma_f32_16x16x32_bf16 v[112:115], v[40:43], v[192:195], v[112:115]
  v_mfma_f32_16x16x32_bf16 v[116:119], v[40:43], v[196:199], v[116:119]
  ds_read_b64_tr_b16 v[40:41], v8 offset:26112
  ds_read_b64_tr_b16 v[42:43], v8 offset:26368
  v_mfma_f32_16x16x32_bf16 v[120:123], v[44:47], v[192:195], v[120:123]
  v_mfma_f32_16x16x32_bf16 v[124:127], v[44:47], v[196:199], v[124:127]
  ds_read_b64_tr_b16 v[44:45], v9 offset:26112
  ds_read_b64_tr_b16 v[46:47], v9 offset:26368
  s_waitcnt lgkmcnt(12)
  v_mfma_f32_16x16x32_bf16 v[64:67], v[16:19], v[200:203], v[64:67]
  s_cmp_lg_u32 s3, 0
  s_cbranch_scc1 pw_15
  s_waitcnt lgkmcnt(0)
  s_cmp_ge_u32 s9, 8
  s_cbranch_scc0 spin_16
spc_17:
pw_15:
  s_waitcnt vmcnt(17)
  s_barrier
  v_mfma_f32_16x16x32_bf16 v[68:71], v[16:19], v[204:207], v[68:71]
  ds_read_b64_tr_b16 v[16:17], v8 offset:32768
  ds_read_b64_tr_b16 v[18:19], v8 offset:33024
  v_mfma_f32_16x16x32_bf16 v[72:75], v[20:23], v[200:203], v[72:75]
  v_mfma_f32_16x16x32_bf16 v[76:79], v[20:23], v[204:207], v[76:79]
  ds_read_b64_tr_b16 v[20:21], v9 offset:32768
  ds_read_b64_tr_b16 v[22:23], v9 offset:33024
  s_waitcnt lgkmcnt(12)
  v_mfma_f32_16x16x32_bf16 v[80:83], v[24:27], v[200:203], v[80:83]
  v_mfma_f32_16x16x32_bf16 v[84:87], v[24:27], v[204:207], v[84:87]
  ds_read_b64_tr_b16 v[24:25], v8 offset:33280
  ds_read_b64_tr_b16 v[26:27], v8 offset:33536
  v_mfma_f32_16x16x32_bf16 v[88:91], v[28:31], v[200:203], v[88:91]
  v_mfma_f32_16x16x32_bf16 v[92:95], v[28:31], v[204:207], v[92:95]
  ds_read_b64_tr_b16 v[28:29], v9 offset:33280
  ds_read_b64_tr_b16 v[30:31], v9 offset:33536
  s_waitcnt lgkmcnt(12)
  v_mfma_f32_16x16x32_bf16 v[96:99], v[32:35], v[200:203], v[96:99]
  s_cmp_lt_u32 s47, s48
  s_cselect_b32 s49, s47, s54
  s_add_u32 m0, s46, s52
  s_add_u32 s47, s47, s62
  buffer_load_dwordx4 v2, s[20:23], s49 offen offset:0 sc1 lds
  v_mfma_f32_16x16x32_bf16 v[100:103], v[32:35], v[204:207], v[100:103]
  ds_read_b64_tr_b16 v[32:33], v8 offset:33792
  ds_read_b64_tr_b16 v[34:35], v8 offset:34048
  buffer_load_dwordx4 v2, s[20:23], s49 offen offset:1024 sc1 lds
  v_mfma_f32_16x16x32_bf16 v[104:107], v[36:39], v[200:203], v[104:107]
  v_mfma_f32_16x16x32_bf16 v[108:111], v[36:39], v[204:207], v[108:111]
  ds_read_b64_tr_b16 v[36:37], v9 offset:33792
  ds_read_b64_tr_b16 v[38:39], v9 offset:34048
  s_waitcnt lgkmcnt(12)
  v_mfma_f32_16x16x32_bf16 v[112:115], v[40:43], v[200:203], v[112:115]
  v_mfma_f32_16x16x32_bf16 v[116:119], v[40:43], v[204:207], v[116:119]
  ds_read_b64_tr_b16 v[40:41], v8 offset:34304
  ds_read_b64_tr_b16 v[42:43], v8 offset:34560
  v_mfma_f32_16x16x32_bf16 v[120:123], v[44:47], v[200:203], v[120:123]
  v_mfma_f32_16x16x32_bf16 v[124:127], v[44:47], v[204:207], v[124:127]
  ds_read_b64_tr_b16 v[44:45], v9 offset:34304
  ds_read_b64_tr_b16 v[46:47], v9 offset:34560
  s_waitcnt lgkmcnt(12)
  v_mfma_f32_16x16x32_bf16 v[64:67], v[16:19], v[208:211], v[64:67]
  buffer_load_dwordx4 v2, s[20:23], s49 offen offset:2048 sc1 lds
  v_mfma_f32_16x16x32_bf16 v[68:71], v[16:19], v[212:215], v[68:71]
  ds_read_b64_tr_b16 v[16:17], v8 offset:40960
  ds_read_b64_tr_b16 v[18:19], v8 offset:41216
  v_mfma_f32_16x16x32_bf16 v[72:75], v[20:23], v[208:211], v[72:75]
  v_mfma_f32_16x16x32_bf16 v[76:79], v[20:23], v[212:215], v[76:79]
  ds_read_b64_tr_b16 v[20:21], v9 offset:40960
  ds_read_b64_tr_b16 v[22:23], v9 offset:41216
  s_waitcnt lgkmcnt(12)
  v_mfma_f32_16x16x32_bf16 v[80:83], v[24:27], v[208:211], v[80:83]
  v_mfma_f32_16x16x32_bf16 v[84:87], v[24:27], v[212:215], v[84:87]
  ds_read_b64_tr_b16 v[24:25], v8 offset:41472
  ds_read_b64_tr_b16 v[26:27], v8 offset:41728
  v_mfma_f32_16x16x32_bf16 v[88:91], v[28:31], v[208:211], v[88:91]
  v_mfma_f32_16x16x32_bf16 v[92:95], v[28:31], v[212:215], v[92:95]
  ds_read_b64_tr_b16 v[28:29], v9 offset:41472
  ds_read_b64_tr_b16 v[30:31], v9 offset:41728
  s_waitcnt lgkmcnt(12)
  v_mfma_f32_16x16x32_bf16 v[96:99], v[32:35], v[208:211], v[96:99]
  buffer_load_dwordx4 v2, s[20:23], s49 offen offset:3072 sc1 lds
  v_mfma_f32_16x16x32_bf16 v[100:103], v[32:35], v[212:215], v[100:103]
  ds_read_b64_tr_b16 v[32:33], v8 offset:41984
  ds_read_b64_tr_b16 v[34:35], v8 offset:42240
  v_mfma_f32_16x16x32_bf16 v[104:107], v[36:39], v[208:211], v[104:107]
  v_mfma_f32_16x16x32_bf16 v[108:111], v[36:39], v[212:215], v[108:111]
  ds_read_b64_tr_b16 v[36:37], v9 offset:41984
  ds_read_b64_tr_b16 v[38:39], v9 offset:42240
  s_waitcnt lgkmcnt(12)
  v_mfma_f32_16x16x32_bf16 v[112:115], v[40:43], v[208:211], v[112:115]
  v_mfma_f32_16x16x32_bf16 v[116:119], v[40:43], v[212:215], v[116:119]
  ds_read_b64_tr_b16 v[40:41], v8 offset:42496
  ds_read_b64_tr_b16 v[42:43], v8 offset:42752
  v_mfma_f32_16x16x32_bf16 v[120:123], v[44:47], v[208:211], v[120:123]
  v_mfma_f32_16x16x32_bf16 v[124:127], v[44:47], v[212:215], v[124:127]
  ds_read_b64_tr_b16 v[44:45], v9 offset:42496
  ds_read_b64_tr_b16 v[46:47], v9 offset:42752
  s_waitcnt lgkmcnt(12)
  v_mfma_f32_16x16x32_bf16 v[64:67], v[16:19], v[216:219], v[64:67]
  s_waitcnt vmcnt(12)
  s_barrier
  s_add_u32 m0, m0, 0x4000
  s_sub_u32 s49, s49, 0x4000
  buffer_load_dwordx4 v2, s[20:23], s49 offen offset:0 sc1 lds
  v_mfma_f32_16x16x32_bf16 v[68:71], v[16:19], v[220:223], v[68:71]
  ds_read_b64_tr_b16 v[16:17], v8 offset:49152
  ds_read_b64_tr_b16 v[18:19], v8 offset:49408
  buffer_load_dwordx4 v2, s[20:23], s49 offen offset:1024 sc1 lds
  v_mfma_f32_16x16x32_bf16 v[72:75], v[20:23], v[216:219], v[72:75]
  s_cmp_lg_u32 s3, 0
  s_cbranch_scc1 g_18
  s_lshl_b32 s55, s41, 7
  s_add_u32 s55, s55, 0x12000
  v_mov_b32 v0, 0
  v_mov_b32 v3, 1
  s_mov_b64 exec, 1
  buffer_atomic_add v3, v0, s[36:39], s55 offen
  s_mov_b64 exec, -1
g_18:
  v_mfma_f32_16x16x32_bf16 v[76:79], v[20:23], v[220:223], v[76:79]
  ds_read_b64_tr_b16 v[20:21], v9 offset:49152
  ds_read_b64_tr_b16 v[22:23], v9 offset:49408
  s_waitcnt lgkmcnt(12)
  v_mfma_f32_16x16x32_bf16 v[80:83], v[24:27], v[216:219], v[80:83]
  v_mfma_f32_16x16x32_bf16 v[84:87], v[24:27], v[220:223], v[84:87]
  ds_read_b64_tr_b16 v[24:25], v8 offset:49664
  ds_read_b64_tr_b16 v[26:27], v8 offset:49920
  v_mfma_f32_16x16x32_bf16 v[88:91], v[28:31], v[216:219], v[88:91]
  v_mfma_f32_16x16x32_bf16 v[92:95], v[28:31], v[220:223], v[92:95]
  ds_read_b64_tr_b16 v[28:29], v9 offset:49664
  ds_read_b64_tr_b16 v[30:31], v9 offset:49920
  s_waitcnt lgkmcnt(12)
  v_mfma_f32_16x16x32_bf16 v[96:99], v[32:35], v[216:219], v[96:99]
  buffer_load_dwordx4 v2, s[20:23], s49 offen offset:2048 sc1 lds
  v_mfma_f32_16x16x32_bf16 v[100:103], v[32:35], v[220:223], v[100:103]
  ds_read_b64_tr_b16 v[32:33], v8 offset:50176
  ds_read_b64_tr_b16 v[34:35], v8 offset:50432
  v_mfma_f32_16x16x32_bf16 v[104:107], v[36:39], v[216:219], v[104:107]
  v_mfma_f32_16x16x32_bf16 v[108:111], v[36:39], v[220:223], v[108:111]
  ds_read_b64_tr_b16 v[36:37], v9 offset:50176
  ds_read_b64_tr_b16 v[38:39], v9 offset:50432
  s_waitcnt lgkmcnt(12)
  v_mfma_f32_16x16x32_bf16 v[112:115], v[40:43], v[216:219], v[112:115]
  v_mfma_f32_16x16x32_bf16 v[116:119], v[40:43], v[220:223], v[116:119]
  ds_read_b64_tr_b16 v[40:41], v8 offset:50688
  ds_read_b64_tr_b16 v[42:43], v8 offset:50944
  v_mfma_f32_16x16x32_bf16 v[120:123], v[44:47], v[216:219], v[120:123]
  v_mfma_f32_16x16x32_bf16 v[124:127], v[44:47], v[220:223], v[124:127]
  ds_read_b64_tr_b16 v[44:45], v9 offset:50688
  ds_read_b64_tr_b16 v[46:47], v9 offset:50944
  s_waitcnt vmcnt(11)
  s_waitcnt lgkmcnt(12)
  v_mfma_f32_16x16x32_bf16 v[64:67], v[16:19], v[224:227], v[64:67]
  buffer_load_dwordx4 v2, s[20:23], s49 offen offset:3072 sc1 lds
  s_add_u32 s46, s46, s62
  s_cmp_eq_u32 s46, s63
  s_cselect_b32 s46, 0, s46
  v_mfma_f32_16x16x32_bf16 v[68:71], v[16:19], v[228:231], v[68:71]
  ds_read_b64_tr_b16 v[16:17], v8 offset:57344
  ds_read_b64_tr_b16 v[18:19], v8 offset:57600
  v_mfma_f32_16x16x32_bf16 v[72:75], v[20:23], v[224:227], v[72:75]
  v_mfma_f32_16x16x32_bf16 v[76:79], v[20:23], v[228:231], v[76:79]
  ds_read_b64_tr_b16 v[20:21], v9 offset:57344
  ds_read_b64_tr_b16 v[22:23], v9 offset:57600
  s_waitcnt lgkmcnt(12)
  v_mfma_f32_16x16x32_bf16 v[80:83], v[24:27], v[224:227], v[80:83]
  v_mfma_f32_16x16x32_bf16 v[84:87], v[24:27], v[228:231], v[84:87]
  ds_read_b64_tr_b16 v[24:25], v8 offset:57856
  ds_read_b64_tr_b16 v[26:27], v8 offset:58112
  v_mfma_f32_16x16x32_bf16 v[88:91], v[28:31], v[224:227], v[88:91]
  v_mfma_f32_16x16x32_bf16 v[92:95], v[28:31], v[228:231], v[92:95]
  ds_read_b64_tr_b16 v[28:29], v9 offset:57856
  ds_read_b64_tr_b16 v[30:31], v9 offset:58112
  s_waitcnt lgkmcnt(12)
  v_mfma_f32_16x16x32_bf16 v[96:99], v[32:35], v[224:227], v[96:99]
  v_mfma_f32_16x16x32_bf16 v[100:103], v[32:35], v[228:231], v[100:103]
  ds_read_b64_tr_b16 v[32:33], v8 offset:58368
  ds_read_b64_tr_b16 v[34:35], v8 offset:58624
  v_mfma_f32_16x16x32_bf16 v[104:107], v[36:39], v[224:227], v[104:107]
  v_mfma_f32_16x16x32_bf16 v[108:111], v[36:39], v[228:231], v[108:111]
  ds_read_b64_tr_b16 v[36:37], v9 offset:58368
  ds_read_b64_tr_b16 v[38:39], v9 offset:58624
  s_waitcnt lgkmcnt(12)
  v_mfma_f32_16x16x32_bf16 v[112:115], v[40:43], v[224:227], v[112:115]
  v_mfma_f32_16x16x32_bf16 v[116:119], v[40:43], v[228:231], v[116:119]
  ds_read_b64_tr_b16 v[40:41], v8 offset:58880
  ds_read_b64_tr_b16 v[42:43], v8 offset:59136
  v_mfma_f32_16x16x32_bf16 v[120:123], v[44:47], v[224:227], v[120:123]
  v_mfma_f32_16x16x32_bf16 v[124:127], v[44:47], v[228:231], v[124:127]
  ds_read_b64_tr_b16 v[44:45], v9 offset:58880
  ds_read_b64_tr_b16 v[46:47], v9 offset:59136
  s_waitcnt lgkmcnt(12)
  v_mfma_f32_16x16x32_bf16 v[64:67], v[16:19], v[232:235], v[64:67]
  s_barrier
  v_mfma_f32_16x16x32_bf16 v[68:71], v[16:19], v[236:239], v[68:71]
  v_add_u32 v8, 0x10000, v8
  v_add_u32 v9, 0x10000, v9
  ds_read_b64_tr_b16 v[16:17], v8 offset:0
  ds_read_b64_tr_b16 v[18:19], v8 offset:256
  v_mfma_f32_16x16x32_bf16 v[72:75], v[20:23], v[232:235], v[72:75]
  v_mfma_f32_16x16x32_bf16 v[76:79], v[20:23], v[236:239], v[76:79]
  ds_read_b64_tr_b16 v[20:21], v9 offset:0
  ds_read_b64_tr_b16 v[22:23], v9 offset:256
  s_waitcnt lgkmcnt(12)
  v_mfma_f32_16x16x32_bf16 v[80:83], v[24:27], v[232:235], v[80:83]
  v_mfma_f32_16x16x32_bf16 v[84:87], v[24:27], v[236:239], v[84:87]
  ds_read_b64_tr_b16 v[24:25], v8 offset:512
  ds_read_b64_tr_b16 v[26:27], v8 offset:768
  v_mfma_f32_16x16x32_bf16 v[88:91], v[28:31], v[232:235], v[88:91]
  v_mfma_f32_16x16x32_bf16 v[92:95], v[28:31], v[236:239], v[92:95]
  ds_read_b64_tr_b16 v[28:29], v9 offset:512
  ds_read_b64_tr_b16 v[30:31], v9 offset:768
  s_waitcnt lgkmcnt(12)
  v_mfma_f32_16x16x32_bf16 v[96:99], v[32:35], v[232:235], v[96:99]
  s_cmp_lt_u32 s47, s48
  s_cselect_b32 s49, s47, s54
  s_add_u32 m0, s46, s52
  s_add_u32 s47, s47, s62
  buffer_load_dwordx4 v2, s[20:23], s49 offen offset:0 sc1 lds
  v_mfma_f32_16x16x32_bf16 v[100:103], v[32:35], v[236:239], v[100:103]
  ds_read_b64_tr_b16 v[32:33], v8 offset:1024
  ds_read_b64_tr_b16 v[34:35], v8 offset:1280
  buffer_load_dwordx4 v2, s[20:23], s49 offen offset:1024 sc1 lds
  v_mfma_f32_16x16x32_bf16 v[104:107], v[36:39], v[232:235], v[104:107]
  v_mfma_f32_16x16x32_bf16 v[108:111], v[36:39], v[236:239], v[108:111]
  ds_read_b64_tr_b16 v[36:37], v9 offset:1024
  ds_read_b64_tr_b16 v[38:39], v9 offset:1280
  s_waitcnt lgkmcnt(12)
  v_mfma_f32_16x16x32_bf16 v[112:115], v[40:43], v[232:235], v[112:115]
  v_mfma_f32_16x16x32_bf16 v[116:119], v[40:43], v[236:239], v[116:119]
  ds_read_b64_tr_b16 v[40:41], v8 offset:1536
  ds_read_b64_tr_b16 v[42:43], v8 offset:1792
  v_mfma_f32_16x16x32_bf16 v[120:123], v[44:47], v[232:235], v[120:123]
  v_mfma_f32_16x16x32_bf16 v[124:127], v[44:47], v[236:239], v[124:127]
  ds_read_b64_tr_b16 v[44:45], v9 offset:1536
  ds_read_b64_tr_b16 v[46:47], v9 offset:1792
  s_waitcnt vmcnt(10)
  s_waitcnt lgkmcnt(12)
  v_mfma_f32_16x16x32_bf16 v[64:67], v[16:19], v[240:243], v[64:67]
  buffer_load_dwordx4 v2, s[20:23], s49 offen offset:2048 sc1 lds
  v_mfma_f32_16x16x32_bf16 v[68:71], v[16:19], v[244:247], v[68:71]
  ds_read_b64_tr_b16 v[16:17], v8 offset:8192
  ds_read_b64_tr_b16 v[18:19], v8 offset:8448
  buffer_load_dwordx4 v2, s[20:23], s49 offen offset:3072 sc1 lds
  v_mfma_f32_16x16x32_bf16 v[72:75], v[20:23], v[240:243], v[72:75]
  v_mfma_f32_16x16x32_bf16 v[76:79], v[20:23], v[244:247], v[76:79]
  ds_read_b64_tr_b16 v[20:21], v9 offset:8192
  ds_read_b64_tr_b16 v[22:23], v9 offset:8448
  s_waitcnt lgkmcnt(12)
  v_mfma_f32_16x16x32_bf16 v[80:83], v[24:27], v[240:243], v[80:83]
  v_mfma_f32_16x16x32_bf16 v[84:87], v[24:27], v[244:247], v[84:87]
  ds_read_b64_tr_b16 v[24:25], v8 offset:8704
  ds_read_b64_tr_b16 v[26:27], v8 offset:8960
  v_mfma_f32_16x16x32_bf16 v[88:91], v[28:31], v[240:243], v[88:91]
  v_mfma_f32_16x16x32_bf16 v[92:95], v[28:31], v[244:247], v[92:95]
  ds_read_b64_tr_b16 v[28:29], v9 offset:8704
  ds_read_b64_tr_b16 v[30:31], v9 offset:8960
  s_waitcnt lgkmcnt(12)
  v_mfma_f32_16x16x32_bf16 v[96:99], v[32:35], v[240:243], v[96:99]
  s_add_u32 m0, m0, 0x4000
  s_sub_u32 s49, s49, 0x4000
  buffer_load_dwordx4 v2, s[20:23], s49 offen offset:0 sc1 lds
  v_mfma_f32_16x16x32_bf16 v[100:103], v[32:35], v[244:247], v[100:103]
  ds_read_b64_tr_b16 v[32:33], v8 offset:9216
  ds_read_b64_tr_b16 v[34:35], v8 offset:9472
  v_mfma_f32_16x16x32_bf16 v[104:107], v[36:39], v[240:243], v[104:107]
  v_mfma_f32_16x16x32_bf16 v[108:111], v[36:39], v[244:247], v[108:111]
  ds_read_b64_tr_b16 v[36:37], v9 offset:9216
  ds_read_b64_tr_b16 v[38:39], v9 offset:9472
  s_waitcnt lgkmcnt(12)
  v_mfma_f32_16x16x32_bf16 v[112:115], v[40:43], v[240:243], v[112:115]
  v_mfma_f32_16x16x32_bf16 v[116:119], v[40:43], v[244:247], v[116:119]
  ds_read_b64_tr_b16 v[40:41], v8 offset:9728
  ds_read_b64_tr_b16 v[42:43], v8 offset:9984
  v_mfma_f32_16x16x32_bf16 v[120:123], v[44:47], v[240:243], v[120:123]
  v_mfma_f32_16x16x32_bf16 v[124:127], v[44:47], v[244:247], v[124:127]
  ds_read_b64_tr_b16 v[44:45], v9 offset:9728
  ds_read_b64_tr_b16 v[46:47], v9 offset:9984
  v_subrev_u32 v8, 0x10000, v8
  v_subrev_u32 v9, 0x10000, v9
  s_waitcnt lgkmcnt(12)
  v_mfma_f32_16x16x32_bf16 v[64:67], v[16:19], v[248:251], v[64:67]
  s_waitcnt vmcnt(5)
  s_barrier
  buffer_load_dwordx4 v2, s[20:23], s49 offen offset:1024 sc1 lds
  v_mfma_f32_16x16x32_bf16 v[68:71], v[16:19], v[252:255], v[68:71]
  buffer_load_dwordx4 v2, s[20:23], s49 offen offset:2048 sc1 lds
  v_mfma_f32_16x16x32_bf16 v[72:75], v[20:23], v[248:251], v[72:75]
  v_mfma_f32_16x16x32_bf16 v[76:79], v[20:23], v[252:255], v[76:79]
  s_waitcnt lgkmcnt(8)
  v_mfma_f32_16x16x32_bf16 v[80:83], v[24:27], v[248:251], v[80:83]
  v_mfma_f32_16x16x32_bf16 v[84:87], v[24:27], v[252:255], v[84:87]
  v_mfma_f32_16x16x32_bf16 v[88:91], v[28:31], v[248:251], v[88:91]
  v_mfma_f32_16x16x32_bf16 v[92:95], v[28:31], v[252:255], v[92:95]
  s_waitcnt lgkmcnt(4)
  v_mfma_f32_16x16x32_bf16 v[96:99], v[32:35], v[248:251], v[96:99]
  buffer_load_dwordx4 v2, s[20:23], s49 offen offset:3072 sc1 lds
  s_add_u32 s46, s46, s62
  s_cmp_eq_u32 s46, s63
  s_cselect_b32 s46, 0, s46
  v_mfma_f32_16x16x32_bf16 v[100:103], v[32:35], v[252:255], v[100:103]
  v_mfma_f32_16x16x32_bf16 v[104:107], v[36:39], v[248:251], v[104:107]
  v_mfma_f32_16x16x32_bf16 v[108:111], v[36:39], v[252:255], v[108:111]
  s_waitcnt lgkmcnt(0)
  v_mfma_f32_16x16x32_bf16 v[112:115], v[40:43], v[248:251], v[112:115]
  v_mfma_f32_16x16x32_bf16 v[116:119], v[40:43], v[252:255], v[116:119]
  v_mfma_f32_16x16x32_bf16 v[120:123], v[44:47], v[248:251], v[120:123]
  v_mfma_f32_16x16x32_bf16 v[124:127], v[44:47], v[252:255], v[124:127]
  s_load_dwordx2 s[4:5], s[0:1], 40
  s_mov_b32 s9, 8
  s_cmp_lg_u32 s3, 0
  s_cbranch_scc1 vp_19
  s_load_dword s9, s[36:37], s75 glc
vp_19:
  s_add_u32 s24, s10, 0x4000000
  s_addc_u32 s25, s11, 0
  s_mov_b32 s26, 0x1000000
  s_mov_b32 s27, 0x20000
  s_mov_b32 s55, 0x3e0293ee
  v_and_b32 v62, 31, v1
  v_lshrrev_b32 v5, 5, v1
  v_lshlrev_b32 v5, 3, v5
  v_sub_u32 v62, v62, v5
  s_and_b32 s66, s42, 1
  s_lshl_b32 s66, s66, 5
  v_add_u32 v62, s66, v62
  s_cmp_eq_u32 s43, 0
  s_cselect_b32 s66, 0, 1000
  v_add_u32 v58, s66, v62
  v_mov_b32 v63, 0xf149f2ca
  v_and_b32 v4, 3, v1
  v_lshlrev_b32 v4, 4, v4
  v_bfe_u32 v5, v1, 2, 1
  v_lshl_add_u32 v4, v5, 7, v4
  v_bfe_u32 v5, v1, 3, 1
  v_lshl_add_u32 v4, v5, 6, v4
  v_bfe_u32 v5, v1, 4, 1
  v_lshl_add_u32 v4, v5, 10, v4
  v_lshrrev_b32 v5, 5, v1
  v_lshl_add_u32 v4, v5, 9, v4
  v_mov_b32 v3, v2
  v_mul_f32 v64, s55, v64
  v_mul_f32 v65, s55, v65
  v_mul_f32 v66, s55, v66
  v_mul_f32 v67, s55, v67
  v_mul_f32 v68, s55, v68
  v_mul_f32 v69, s55, v69
  v_mul_f32 v70, s55, v70
  v_mul_f32 v71, s55, v71
  v_mul_f32 v72, s55, v72
  v_mul_f32 v73, s55, v73
  v_mul_f32 v74, s55, v74
  v_mul_f32 v75, s55, v75
  v_mul_f32 v76, s55, v76
  v_mul_f32 v77, s55, v77
  v_mul_f32 v78, s55, v78
  v_mul_f32 v79, s55, v79
  v_cvt_pk_bf16_f32 v128, v64, v65
  v_cvt_pk_bf16_f32 v129, v66, v67
  v_cvt_pk_bf16_f32 v130, v72, v73
  v_cvt_pk_bf16_f32 v131, v74, v75
  v_cvt_pk_bf16_f32 v132, v68, v69
  v_cvt_pk_bf16_f32 v133, v70, v71
  v_cvt_pk_bf16_f32 v134, v76, v77
  v_cvt_pk_bf16_f32 v135, v78, v79
  v_mul_f32 v80, s55, v80
  v_mul_f32 v81, s55, v81
  v_mul_f32 v82, s55, v82
  v_mul_f32 v83, s55, v83
  v_mul_f32 v84, s55, v84
  v_mul_f32 v85, s55, v85
  v_mul_f32 v86, s55, v86
  v_mul_f32 v87, s55, v87
  v_mul_f32 v88, s55, v88
  v_mul_f32 v89, s55, v89
  v_mul_f32 v90, s55, v90
  v_mul_f32 v91, s55, v91
  v_mul_f32 v92, s55, v92
  v_mul_f32 v93, s55, v93
  v_mul_f32 v94, s55, v94
  v_mul_f32 v95, s55, v95
  v_cvt_pk_bf16_f32 v136, v80, v81
  v_cvt_pk_bf16_f32 v137, v82, v83
  v_cvt_pk_bf16_f32 v138, v88, v89
  v_cvt_pk_bf16_f32 v139, v90, v91
  v_cvt_pk_bf16_f32 v140, v84, v85
  v_cvt_pk_bf16_f32 v141, v86, v87
  v_cvt_pk_bf16_f32 v142, v92, v93
  v_cvt_pk_bf16_f32 v143, v94, v95
  v_mul_f32 v96, s55, v96
  v_mul_f32 v97, s55, v97
  v_mul_f32 v98, s55, v98
  v_mul_f32 v99, s55, v99
  v_mul_f32 v100, s55, v100
  v_mul_f32 v101, s55, v101
  v_mul_f32 v102, s55, v102
  v_mul_f32 v103, s55, v103
  v_mul_f32 v104, s55, v104
  v_mul_f32 v105, s55, v105
  v_mul_f32 v106, s55, v106
  v_mul_f32 v107, s55, v107
  v_mul_f32 v108, s55, v108
  v_mul_f32 v109, s55, v109
  v_mul_f32 v110, s55, v110
  v_mul_f32 v111, s55, v111
  v_cvt_pk_bf16_f32 v144, v96, v97
  v_cvt_pk_bf16_f32 v145, v98, v99
  v_cvt_pk_bf16_f32 v146, v104, v105
  v_cvt_pk_bf16_f32 v147, v106, v107
  v_cvt_pk_bf16_f32 v148, v100, v101
  v_cvt_pk_bf16_f32 v149, v102, v103
  v_cvt_pk_bf16_f32 v150, v108, v109
  v_cvt_pk_bf16_f32 v151, v110, v111
  v_mul_f32 v112, s55, v112
  v_mul_f32 v113, s55, v113
  v_mul_f32 v114, s55, v114
  v_mul_f32 v115, s55, v115
  v_mul_f32 v116, s55, v116
  v_mul_f32 v117, s55, v117
  v_mul_f32 v118, s55, v118
  v_mul_f32 v119, s55, v119
  v_mul_f32 v120, s55, v120
  v_mul_f32 v121, s55, v121
  v_mul_f32 v122, s55, v122
  v_mul_f32 v123, s55, v123
  v_mul_f32 v124, s55, v124
  v_mul_f32 v125, s55, v125
  v_mul_f32 v126, s55, v126
  v_mul_f32 v127, s55, v127
  v_cvt_pk_bf16_f32 v152, v112, v113
  v_cvt_pk_bf16_f32 v153, v114, v115
  v_cvt_pk_bf16_f32 v154, v120, v121
  v_cvt_pk_bf16_f32 v155, v122, v123
  v_cvt_pk_bf16_f32 v156, v116, v117
  v_cvt_pk_bf16_f32 v157, v118, v119
  v_cvt_pk_bf16_f32 v158, v124, v125
  v_cvt_pk_bf16_f32 v159, v126, v127
  s_add_u32 s32, s44, 1
  s_mul_i32 s65, s32, 52
  s_lshr_b32 s65, s65, 8
  s_mul_i32 s65, s65, 5
  s_sub_u32 s32, s32, s65
  s_lshl_b32 s32, s32, 15
  s_add_u32 s16, s10, 0x10000
  s_addc_u32 s17, s11, 0
  s_mov_b32 s18, 0x8000
  s_mov_b32 s19, 0x20000
  s_and_b32 s34, s2, 7
  s_lshl_b32 s34, s34, 3
  s_lshr_b32 s65, s2, 5
  s_add_u32 s34, s34, s65
  s_lshl_b32 s34, s34, 7
  s_lshl_b32 s65, s3, 2
  s_add_u32 s34, s34, s65
  s_add_u32 s34, s34, 16384
  s_waitcnt lgkmcnt(0)
  s_mov_b32 s12, s4
  s_mov_b32 s13, s5
  s_mov_b32 s14, 0x400000
  s_mov_b32 s15, 0x20000
  s_and_b32 s35, s41, 3
  s_sub_u32 s72, s32, s62
  s_cmp_eq_u32 s32, 0
  s_cselect_b32 s72, 0x20000, s72
  s_movk_i32 s73, 12800
  s_cmp_eq_u32 s40, 0
  s_cbranch_scc0 fused_kernel_lo
fused_kernel_hi:
  s_cmp_lt_u32 s2, 32
  s_cbranch_scc1 fused_kernel_hi_p32
  s_cmp_ge_u32 s2, 224
  s_cbranch_scc1 fused_kernel_hi_p32
  ds_read_b128 v[160:163], v3 offset:0
  ds_read_b128 v[168:171], v3 offset:2048
  ds_read_b128 v[176:179], v3 offset:4096
  ds_read_b128 v[184:187], v3 offset:6144
  ds_read_b128 v[164:167], v3 offset:1024
  ds_read_b128 v[172:175], v3 offset:3072
  ds_read_b128 v[180:183], v3 offset:5120
  ds_read_b128 v[188:191], v3 offset:7168
  ds_read_b128 v[192:195], v3 offset:8192
  ds_read_b128 v[200:203], v3 offset:10240
  ds_read_b128 v[208:211], v3 offset:12288
  ds_read_b128 v[216:219], v3 offset:14336
  ds_read_b128 v[196:199], v3 offset:9216
  ds_read_b128 v[204:207], v3 offset:11264
  ds_read_b128 v[212:215], v3 offset:13312
  ds_read_b128 v[220:223], v3 offset:15360
  v_mov_b32 v24, 0
  v_mov_b32 v25, 0
  v_mov_b32 v26, 0
  v_mov_b32 v27, 0
  s_waitcnt lgkmcnt(12)
  v_mfma_f32_16x16x32_bf16 v[224:227], v[160:163], v[128:131], 0
  v_mfma_f32_16x16x32_bf16 v[224:227], v[168:171], v[136:139], v[224:227]
  v_mfma_f32_16x16x32_bf16 v[224:227], v[176:179], v[144:147], v[224:227]
  v_mfma_f32_16x16x32_bf16 v[224:227], v[184:187], v[152:155], v[224:227]
  v_mfma_f32_16x16x32_bf16 v[228:231], v[160:163], v[132:135], 0
  v_mfma_f32_16x16x32_bf16 v[228:231], v[168:171], v[140:143], v[228:231]
  v_mfma_f32_16x16x32_bf16 v[228:231], v[176:179], v[148:151], v[228:231]
  v_mfma_f32_16x16x32_bf16 v[228:231], v[184:187], v[156:159], v[228:231]
  s_waitcnt lgkmcnt(8)
  v_mfma_f32_16x16x32_bf16 v[232:235], v[164:167], v[128:131], 0
  v_mfma_f32_16x16x32_bf16 v[232:235], v[172:175], v[136:139], v[232:235]
  v_mfma_f32_16x16x32_bf16 v[232:235], v[180:183], v[144:147], v[232:235]
  v_mfma_f32_16x16x32_bf16 v[232:235], v[188:191], v[152:155], v[232:235]
  v_mfma_f32_16x16x32_bf16 v[236:239], v[164:167], v[132:135], 0
  v_mfma_f32_16x16x32_bf16 v[236:239], v[172:175], v[140:143], v[236:239]
  v_mfma_f32_16x16x32_bf16 v[236:239], v[180:183], v[148:151], v[236:239]
  v_mfma_f32_16x16x32_bf16 v[236:239], v[188:191], v[156:159], v[236:239]
  v_mfma_f32_32x32x16_bf16 v[64:79], v[24:27], v[24:27], 0
  v_mfma_f32_32x32x16_bf16 v[80:95], v[24:27], v[24:27], 0
  v_mfma_f32_32x32x16_bf16 v[96:111], v[24:27], v[24:27], 0
  v_mfma_f32_32x32x16_bf16 v[112:127], v[24:27], v[24:27], 0
  s_add_u32 s45, s45, s62
  s_cmp_eq_u32 s45, s63
  s_cselect_b32 s45, 0, s45
  v_max3_f32 v56, v224, v225, v226
  v_max3_f32 v57, v228, v229, v230
  v_max3_f32 v56, v56, v227, v232
  v_max3_f32 v57, v57, v231, v236
  v_max3_f32 v56, v56, v233, v234
  v_max3_f32 v57, v57, v237, v238
  v_max_f32 v56, v56, v235
  v_max_f32 v57, v57, v239
  s_nop 1
  v_permlane16_swap_b32 v56, v57
  v_max_f32 v56, v56, v57
  v_mov_b32 v57, v56
  s_nop 1
  v_permlane32_swap_b32 v57, v56
  v_max_f32 v56, v56, v57
  v_mov_b32 v57, v56
  s_nop 1
  v_permlane16_swap_b32 v56, v57
  v_sub_f32 v32, 0, v56
  v_sub_f32 v33, 0, v56
  v_sub_f32 v34, 0, v56
  v_sub_f32 v35, 0, v56
  v_sub_f32 v36, 0, v57
  v_sub_f32 v37, 0, v57
  v_sub_f32 v38, 0, v57
  v_sub_f32 v39, 0, v57
  s_waitcnt lgkmcnt(0)
  v_mfma_f32_16x16x32_bf16 v[240:243], v[192:195], v[128:131], v[32:35]
  v_add_u32 v3, s45, v2
  s_waitcnt vmcnt(0)
  s_waitcnt lgkmcnt(0)
  s_cmp_ge_u32 s9, 8
  s_cbranch_scc0 spin_20
spc_21:
  s_barrier
  ds_read_b128 v[160:163], v3 offset:0
  ds_read_b128 v[168:171], v3 offset:2048
  ds_read_b128 v[176:179], v3 offset:4096
  ds_read_b128 v[184:187], v3 offset:6144
  ds_read_b128 v[164:167], v3 offset:1024
  ds_read_b128 v[172:175], v3 offset:3072
  ds_read_b128 v[180:183], v3 offset:5120
  ds_read_b128 v[188:191], v3 offset:7168
  v_sub_f32 v224, v224, v56
  v_sub_f32 v225, v225, v56
  v_sub_f32 v226, v226, v56
  v_sub_f32 v227, v227, v56
  v_mfma_f32_16x16x32_bf16 v[240:243], v[200:203], v[136:139], v[240:243]
  v_exp_f32 v48, v224
  v_sub_f32 v228, v228, v57
  v_exp_f32 v49, v225
  v_sub_f32 v229, v229, v57
  v_mfma_f32_16x16x32_bf16 v[240:243], v[208:211], v[144:147], v[240:243]
  v_exp_f32 v50, v226
  v_sub_f32 v230, v230, v57
  v_add_f32 v40, v48, v49
  v_cvt_pk_bf16_f32 v16, v48, v49
  v_mfma_f32_16x16x32_bf16 v[240:243], v[216:219], v[152:155], v[240:243]
  v_exp_f32 v51, v227
  v_sub_f32 v231, v231, v57
  v_add_f32 v40, v40, v50
  v_exp_f32 v52, v228
  v_mfma_f32_16x16x32_bf16 v[244:247], v[192:195], v[132:135], v[36:39]
  v_sub_f32 v232, v232, v56
  v_add_f32 v40, v40, v51
  v_cvt_pk_bf16_f32 v17, v50, v51
  v_exp_f32 v53, v229
  v_mfma_f32_16x16x32_bf16 v[244:247], v[200:203], v[140:143], v[244:247]
  v_sub_f32 v233, v233, v56
  v_exp_f32 v54, v230
  v_sub_f32 v234, v234, v56
  v_add_f32 v41, v52, v53
  v_mfma_f32_16x16x32_bf16 v[244:247], v[208:211], v[148:151], v[244:247]
  v_cvt_pk_bf16_f32 v20, v52, v53
  v_exp_f32 v55, v231
  v_sub_f32 v235, v235, v56
  v_add_f32 v41, v41, v54
  v_mfma_f32_16x16x32_bf16 v[244:247], v[216:219], v[156:159], v[244:247]
  v_exp_f32 v48, v232
  v_sub_f32 v236, v236, v57
  v_add_f32 v41, v41, v55
  v_cvt_pk_bf16_f32 v21, v54, v55
  v_mfma_f32_16x16x32_bf16 v[248:251], v[196:199], v[128:131], v[32:35]
  v_exp_f32 v49, v233
  v_sub_f32 v237, v237, v57
  v_add_f32 v40, v40, v48
  v_exp_f32 v50, v234
  v_mfma_f32_16x16x32_bf16 v[248:251], v[204:207], v[136:139], v[248:251]
  v_sub_f32 v238, v238, v57
  v_add_f32 v40, v40, v49
  v_cvt_pk_bf16_f32 v18, v48, v49
  v_exp_f32 v51, v235
  v_mfma_f32_16x16x32_bf16 v[248:251], v[212:215], v[144:147], v[248:251]
  v_sub_f32 v239, v239, v57
  v_add_f32 v40, v40, v50
  v_exp_f32 v52, v236
  v_add_f32 v40, v40, v51
  v_mfma_f32_16x16x32_bf16 v[248:251], v[220:223], v[152:155], v[248:251]
  v_cvt_pk_bf16_f32 v19, v50, v51
  v_exp_f32 v53, v237
  v_add_f32 v41, v41, v52
  v_exp_f32 v54, v238
  v_mfma_f32_16x16x32_bf16 v[252:255], v[196:199], v[132:135], v[36:39]
  v_add_f32 v41, v41, v53
  v_cvt_pk_bf16_f32 v22, v52, v53
  v_exp_f32 v55, v239
  v_add_f32 v41, v41, v54
  v_mfma_f32_16x16x32_bf16 v[252:255], v[204:207], v[140:143], v[252:255]
  v_add_f32 v41, v41, v55
  v_cvt_pk_bf16_f32 v23, v54, v55
  v_mfma_f32_16x16x32_bf16 v[252:255], v[212:215], v[148:151], v[252:255]
  v_mfma_f32_16x16x32_bf16 v[252:255], v[220:223], v[156:159], v[252:255]
  v_mov_b32 v60, v40
  v_mov_b32 v61, v41
  s_nop 3
  s_waitcnt lgkmcnt(0)
  s_lshr_b32 s50, s2, 5
  s_lshl_b32 s50, s50, 2
  s_add_u32 s50, s50, 5
  s_sub_u32 s50, s50, s3
  s_lshr_b32 s50, s50, 1
  s_sub_u32 s53, s43, 1
  s_min_u32 s50, s50, s53
  s_sub_u32 s53, s53, s50
.p2align 6
fused_kernel_hi_l16:
  v_mfma_f32_16x16x32_bf16 v[224:227], v[160:163], v[128:131], v[32:35]
  v_exp_f32_e64 v48, v240
  ds_read_b128 v[192:195], v3 offset:16384
  v_mfma_f32_16x16x32_bf16 v[224:227], v[168:171], v[136:139], v[224:227]
  ds_read_b128 v[196:199], v3 offset:17408
  v_mfma_f32_16x16x32_bf16 v[224:227], v[176:179], v[144:147], v[224:227]
  v_exp_f32_e64 v49, v241
  ds_read_b128 v[200:203], v3 offset:18432
  v_mfma_f32_16x16x32_bf16 v[224:227], v[184:187], v[152:155], v[224:227]
  v_add_f32_e64 v40, v48, v49
  v_cvt_pk_bf16_f32 v24, v48, v49
  ds_read_b128 v[204:207], v3 offset:19456
  v_mfma_f32_16x16x32_bf16 v[228:231], v[160:163], v[132:135], v[36:39]
  v_exp_f32_e64 v50, v242
  ds_read_b128 v[208:211], v3 offset:20480
  v_mfma_f32_16x16x32_bf16 v[228:231], v[168:171], v[140:143], v[228:231]
  v_add_f32_e64 v40, v40, v50
  ds_read_b128 v[212:215], v3 offset:21504
  v_mfma_f32_16x16x32_bf16 v[228:231], v[176:179], v[148:151], v[228:231]
  v_exp_f32_e64 v51, v243
  ds_read_b128 v[216:219], v3 offset:22528
  v_mfma_f32_16x16x32_bf16 v[228:231], v[184:187], v[156:159], v[228:231]
  v_add_f32_e64 v40, v40, v51
  v_cvt_pk_bf16_f32 v25, v50, v51
  ds_read_b128 v[220:223], v3 offset:23552
  v_mfma_f32_16x16x32_bf16 v[232:235], v[164:167], v[128:131], v[32:35]
  v_exp_f32_e64 v52, v244
  v_mfma_f32_16x16x32_bf16 v[232:235], v[172:175], v[136:139], v[232:235]
  v_mfma_f32_16x16x32_bf16 v[232:235], v[180:183], v[144:147], v[232:235]
  v_exp_f32_e64 v53, v245
  v_mfma_f32_16x16x32_bf16 v[232:235], v[188:191], v[152:155], v[232:235]
  v_add_f32_e64 v41, v52, v53
  v_cvt_pk_bf16_f32 v28, v52, v53
  v_mfma_f32_16x16x32_bf16 v[236:239], v[164:167], v[132:135], v[36:39]
  v_exp_f32_e64 v54, v246
  v_mfma_f32_16x16x32_bf16 v[236:239], v[172:175], v[140:143], v[236:239]
  v_add_f32_e64 v41, v41, v54
  v_mfma_f32_16x16x32_bf16 v[236:239], v[180:183], v[148:151], v[236:239]
  v_exp_f32_e64 v55, v247
  v_mfma_f32_16x16x32_bf16 v[236:239], v[188:191], v[156:159], v[236:239]
  v_add_f32_e64 v41, v41, v55
  v_cvt_pk_bf16_f32 v29, v54, v55
  s_waitcnt lgkmcnt(0)
  v_mfma_f32_16x16x32_bf16 v[64:67], v[192:195], v[16:19], v[64:67]
  v_exp_f32_e64 v48, v248
  s_nop 0
  v_add_f32 v40, v40, v48
  ds_read_b128 v[160:163], v3 offset:8192
  v_mfma_f32_16x16x32_bf16 v[68:71], v[192:195], v[20:23], v[68:71]
  v_exp_f32_e64 v49, v249
  ds_read_b128 v[168:171], v3 offset:10240
  v_mfma_f32_16x16x32_bf16 v[72:75], v[196:199], v[16:19], v[72:75]
  v_add_f32_e64 v40, v40, v49
  v_cvt_pk_bf16_f32 v26, v48, v49
  ds_read_b128 v[176:179], v3 offset:12288
  v_mfma_f32_16x16x32_bf16 v[76:79], v[196:199], v[20:23], v[76:79]
  v_exp_f32_e64 v50, v250
  ds_read_b128 v[184:187], v3 offset:14336
  v_mfma_f32_16x16x32_bf16 v[80:83], v[200:203], v[16:19], v[80:83]
  v_add_f32_e64 v40, v40, v50
  ds_read_b128 v[164:167], v3 offset:9216
  v_mfma_f32_16x16x32_bf16 v[84:87], v[200:203], v[20:23], v[84:87]
  v_exp_f32_e64 v51, v251
  ds_read_b128 v[172:175], v3 offset:11264
  v_mfma_f32_16x16x32_bf16 v[88:91], v[204:207], v[16:19], v[88:91]
  v_add_f32_e64 v40, v40, v51
  v_cvt_pk_bf16_f32 v27, v50, v51
  ds_read_b128 v[180:183], v3 offset:13312
  v_mfma_f32_16x16x32_bf16 v[92:95], v[204:207], v[20:23], v[92:95]
  v_exp_f32_e64 v52, v252
  ds_read_b128 v[188:191], v3 offset:15360
  v_mfma_f32_16x16x32_bf16 v[96:99], v[208:211], v[16:19], v[96:99]
  v_add_f32_e64 v41, v41, v52
  v_mfma_f32_16x16x32_bf16 v[100:103], v[208:211], v[20:23], v[100:103]
  v_exp_f32_e64 v53, v253
  v_mfma_f32_16x16x32_bf16 v[104:107], v[212:215], v[16:19], v[104:107]
  v_add_f32_e64 v41, v41, v53
  v_cvt_pk_bf16_f32 v30, v52, v53
  v_mfma_f32_16x16x32_bf16 v[108:111], v[212:215], v[20:23], v[108:111]
  v_exp_f32 v54, v254
  s_add_u32 s45, s45, s62
  v_mfma_f32_16x16x32_bf16 v[112:115], v[216:219], v[16:19], v[112:115]
  v_add_f32_e64 v41, v41, v54
  v_mfma_f32_16x16x32_bf16 v[116:119], v[216:219], v[20:23], v[116:119]
  v_exp_f32_e64 v55, v255
  s_cmp_eq_u32 s45, s63
  s_cselect_b32 s45, 0, s45
  v_mfma_f32_16x16x32_bf16 v[120:123], v[220:223], v[16:19], v[120:123]
  v_add_f32_e64 v41, v41, v55
  v_cvt_pk_bf16_f32 v31, v54, v55
  v_mfma_f32_16x16x32_bf16 v[124:127], v[220:223], v[20:23], v[124:127]
  v_max_f32 v59, v40, v41
  v_cmp_lt_f32 vcc, s51, v59
  s_cbranch_vccnz fix_22
cont_23:
  v_add_f32 v60, v60, v40
  v_add_f32 v61, v61, v41
  s_waitcnt lgkmcnt(0)
  v_mfma_f32_16x16x32_bf16 v[240:243], v[160:163], v[128:131], v[32:35]
  v_exp_f32_e64 v48, v224
  ds_read_b128 v[192:195], v3 offset:24576
  v_mfma_f32_16x16x32_bf16 v[240:243], v[168:171], v[136:139], v[240:243]
  ds_read_b128 v[196:199], v3 offset:25600
  v_mfma_f32_16x16x32_bf16 v[240:243], v[176:179], v[144:147], v[240:243]
  v_exp_f32_e64 v49, v225
  ds_read_b128 v[200:203], v3 offset:26624
  v_mfma_f32_16x16x32_bf16 v[240:243], v[184:187], v[152:155], v[240:243]
  v_add_f32_e64 v40, v48, v49
  v_cvt_pk_bf16_f32 v16, v48, v49
  ds_read_b128 v[204:207], v3 offset:27648
  v_mfma_f32_16x16x32_bf16 v[244:247], v[160:163], v[132:135], v[36:39]
  v_exp_f32_e64 v50, v226
  ds_read_b128 v[208:211], v3 offset:28672
  v_mfma_f32_16x16x32_bf16 v[244:247], v[168:171], v[140:143], v[244:247]
  v_add_f32_e64 v40, v40, v50
  ds_read_b128 v[212:215], v3 offset:29696
  v_mfma_f32_16x16x32_bf16 v[244:247], v[176:179], v[148:151], v[244:247]
  v_exp_f32_e64 v51, v227
  ds_read_b128 v[216:219], v3 offset:30720
  v_mfma_f32_16x16x32_bf16 v[244:247], v[184:187], v[156:159], v[244:247]
  v_add_f32_e64 v40, v40, v51
  v_cvt_pk_bf16_f32 v17, v50, v51
  ds_read_b128 v[220:223], v3 offset:31744
  v_mfma_f32_16x16x32_bf16 v[248:251], v[164:167], v[128:131], v[32:35]
  v_exp_f32_e64 v52, v228
  v_mfma_f32_16x16x32_bf16 v[248:251], v[172:175], v[136:139], v[248:251]
  v_add_u32_e64 v3, s45, v2
  v_mfma_f32_16x16x32_bf16 v[248:251], v[180:183], v[144:147], v[248:251]
  v_exp_f32_e64 v53, v229
  v_mfma_f32_16x16x32_bf16 v[248:251], v[188:191], v[152:155], v[248:251]
  v_add_f32_e64 v41, v52, v53
  v_cvt_pk_bf16_f32 v20, v52, v53
  v_mfma_f32_16x16x32_bf16 v[252:255], v[164:167], v[132:135], v[36:39]
  v_exp_f32_e64 v54, v230
  v_mfma_f32_16x16x32_bf16 v[252:255], v[172:175], v[140:143], v[252:255]
  v_add_f32_e64 v41, v41, v54
  v_mfma_f32_16x16x32_bf16 v[252:255], v[180:183], v[148:151], v[252:255]
  v_exp_f32_e64 v55, v231
  v_mfma_f32_16x16x32_bf16 v[252:255], v[188:191], v[156:159], v[252:255]
  v_add_f32_e64 v41, v41, v55
  v_cvt_pk_bf16_f32 v21, v54, v55
  s_waitcnt lgkmcnt(0)
  v_mfma_f32_16x16x32_bf16 v[64:67], v[192:195], v[24:27], v[64:67]
  s_barrier
  v_exp_f32 v48, v232
  s_nop 0
  v_add_f32 v40, v40, v48
  ds_read_b128 v[160:163], v3 offset:0
  v_mfma_f32_16x16x32_bf16 v[68:71], v[192:195], v[28:31], v[68:71]
  v_exp_f32_e64 v49, v233
  ds_read_b128 v[168:171], v3 offset:2048
  v_mfma_f32_16x16x32_bf16 v[72:75], v[196:199], v[24:27], v[72:75]
  v_add_f32_e64 v40, v40, v49
  v_cvt_pk_bf16_f32 v18, v48, v49
  ds_read_b128 v[176:179], v3 offset:4096
  v_mfma_f32_16x16x32_bf16 v[76:79], v[196:199], v[28:31], v[76:79]
  v_exp_f32_e64 v50, v234
  ds_read_b128 v[184:187], v3 offset:6144
  v_mfma_f32_16x16x32_bf16 v[80:83], v[200:203], v[24:27], v[80:83]
  v_add_f32_e64 v40, v40, v50
  ds_read_b128 v[164:167], v3 offset:1024
  v_mfma_f32_16x16x32_bf16 v[84:87], v[200:203], v[28:31], v[84:87]
  v_exp_f32_e64 v51, v235
  ds_read_b128 v[172:175], v3 offset:3072
  v_mfma_f32_16x16x32_bf16 v[88:91], v[204:207], v[24:27], v[88:91]
  v_add_f32_e64 v40, v40, v51
  v_cvt_pk_bf16_f32 v19, v50, v51
  ds_read_b128 v[180:183], v3 offset:5120
  v_mfma_f32_16x16x32_bf16 v[92:95], v[204:207], v[28:31], v[92:95]
  v_exp_f32_e64 v52, v236
  ds_read_b128 v[188:191], v3 offset:7168
  v_mfma_f32_16x16x32_bf16 v[96:99], v[208:211], v[24:27], v[96:99]
  v_add_f32_e64 v41, v41, v52
  v_mfma_f32_16x16x32_bf16 v[100:103], v[208:211], v[28:31], v[100:103]
  v_exp_f32_e64 v53, v237
  v_mfma_f32_16x16x32_bf16 v[104:107], v[212:215], v[24:27], v[104:107]
  v_add_f32_e64 v41, v41, v53
  v_cvt_pk_bf16_f32 v22, v52, v53
  v_mfma_f32_16x16x32_bf16 v[108:111], v[212:215], v[28:31], v[108:111]
  v_exp_f32_e64 v54, v238
  v_mfma_f32_16x16x32_bf16 v[112:115], v[216:219], v[24:27], v[112:115]
  v_add_f32_e64 v41, v41, v54
  v_mfma_f32_16x16x32_bf16 v[116:119], v[216:219], v[28:31], v[116:119]
  v_exp_f32_e64 v55, v239
  v_mfma_f32_16x16x32_bf16 v[120:123], v[220:223], v[24:27], v[120:123]
  v_add_f32_e64 v41, v41, v55
  v_cvt_pk_bf16_f32 v23, v54, v55
  v_mfma_f32_16x16x32_bf16 v[124:127], v[220:223], v[28:31], v[124:127]
  v_max_f32 v59, v40, v41
  v_cmp_lt_f32 vcc, s51, v59
  s_sub_u32 s50, s50, 1
  s_cmp_lg_u32 s50, 0
  s_cbranch_vccnz fix_24
cont_25:
  v_add_f32 v60, v60, v40
  v_add_f32 v61, v61, v41
  s_waitcnt lgkmcnt(0)
  s_cbranch_scc1 fused_kernel_hi_l16
  v_add_u32 v3, s45, v4
  v_permlane16_swap_b32 v128, v132
  v_permlane16_swap_b32 v129, v133
  v_permlane16_swap_b32 v130, v134
  v_permlane16_swap_b32 v131, v135
  ds_read_b128 v[160:163], v3 offset:0
  ds_read_b128 v[164:167], v3 offset:256
  ds_read_b128 v[168:171], v3 offset:2048
  ds_read_b128 v[172:175], v3 offset:2304
  ds_read_b128 v[176:179], v3 offset:4096
  ds_read_b128 v[180:183], v3 offset:4352
  ds_read_b128 v[184:187], v3 offset:6144
  ds_read_b128 v[188:191], v3 offset:6400
  v_permlane16_swap_b32 v136, v140
  v_permlane16_swap_b32 v137, v141
  v_permlane16_swap_b32 v138, v142
  v_permlane16_swap_b32 v139, v143
  v_permlane16_swap_b32 v144, v148
  v_permlane16_swap_b32 v145, v149
  v_permlane16_swap_b32 v146, v150
  v_permlane16_swap_b32 v147, v151
  v_permlane16_swap_b32 v152, v156
  v_permlane16_swap_b32 v153, v157
  v_permlane16_swap_b32 v154, v158
  v_permlane16_swap_b32 v155, v159
  v_permlane16_swap_b32 v240, v244
  v_permlane16_swap_b32 v241, v245
  v_permlane16_swap_b32 v242, v246
  v_permlane16_swap_b32 v243, v247
  v_permlane16_swap_b32 v248, v252
  v_permlane16_swap_b32 v249, v253
  v_permlane16_swap_b32 v250, v254
  v_permlane16_swap_b32 v251, v255
  v_permlane16_swap_b32 v32, v36
  v_permlane16_swap_b32 v60, v61
  v_permlane16_swap_b32 v16, v20
  v_permlane16_swap_b32 v17, v21
  v_permlane16_swap_b32 v18, v22
  v_permlane16_swap_b32 v19, v23
  v_add_f32 v60, v60, v61
  v_mov_b32 v33, v32
  v_mov_b32 v34, v32
  v_mov_b32 v35, v32
  v_mov_b32 v36, v32
  v_mov_b32 v37, v32
  v_mov_b32 v38, v32
  v_mov_b32 v39, v32
  v_mov_b32 v40, v32
  v_mov_b32 v41, v32
  v_mov_b32 v42, v32
  v_mov_b32 v43, v32
  v_mov_b32 v44, v32
  v_mov_b32 v45, v32
  v_mov_b32 v46, v32
  v_mov_b32 v47, v32
  v_permlane16_swap_b32 v64, v68
  v_permlane16_swap_b32 v65, v69
  v_permlane16_swap_b32 v66, v70
  v_permlane16_swap_b32 v67, v71
  v_permlane16_swap_b32 v72, v76
  v_permlane16_swap_b32 v73, v77
  v_permlane16_swap_b32 v74, v78
  v_permlane16_swap_b32 v75, v79
  v_permlane16_swap_b32 v80, v84
  v_permlane16_swap_b32 v81, v85
  v_permlane16_swap_b32 v82, v86
  v_permlane16_swap_b32 v83, v87
  v_permlane16_swap_b32 v88, v92
  v_permlane16_swap_b32 v89, v93
  v_permlane16_swap_b32 v90, v94
  v_permlane16_swap_b32 v91, v95
  v_permlane16_swap_b32 v96, v100
  v_permlane16_swap_b32 v97, v101
  v_permlane16_swap_b32 v98, v102
  v_permlane16_swap_b32 v99, v103
  v_permlane16_swap_b32 v104, v108
  v_permlane16_swap_b32 v105, v109
  v_permlane16_swap_b32 v106, v110
  v_permlane16_swap_b32 v107, v111
  v_permlane16_swap_b32 v112, v116
  v_permlane16_swap_b32 v113, v117
  v_permlane16_swap_b32 v114, v118
  v_permlane16_swap_b32 v115, v119
  v_permlane16_swap_b32 v120, v124
  v_permlane16_swap_b32 v121, v125
  v_permlane16_swap_b32 v122, v126
  v_permlane16_swap_b32 v123, v127
  s_waitcnt lgkmcnt(0)
  s_mov_b32 s50, s53
  s_cmp_lg_u32 s53, 0
  s_cbranch_scc1 fused_kernel_hi_loop
  s_branch fused_kernel_hi_last
fused_kernel_hi_p32:
  v_mov_b32 v3, v4
  v_permlane16_swap_b32 v128, v132
  v_permlane16_swap_b32 v129, v133
  v_permlane16_swap_b32 v130, v134
  v_permlane16_swap_b32 v131, v135
  v_permlane16_swap_b32 v136, v140
  v_permlane16_swap_b32 v137, v141
  v_permlane16_swap_b32 v138, v142
  v_permlane16_swap_b32 v139, v143
  v_permlane16_swap_b32 v144, v148
  v_permlane16_swap_b32 v145, v149
  v_permlane16_swap_b32 v146, v150
  v_permlane16_swap_b32 v147, v151
  v_permlane16_swap_b32 v152, v156
  v_permlane16_swap_b32 v153, v157
  v_permlane16_swap_b32 v154, v158
  v_permlane16_swap_b32 v155, v159
  ds_read_b128 v[160:163], v3 offset:0
  ds_read_b128 v[164:167], v3 offset:256
  ds_read_b128 v[168:171], v3 offset:2048
  ds_read_b128 v[172:175], v3 offset:2304
  ds_read_b128 v[176:179], v3 offset:4096
  ds_read_b128 v[180:183], v3 offset:4352
  ds_read_b128 v[184:187], v3 offset:6144
  ds_read_b128 v[188:191], v3 offset:6400
  ds_read_b128 v[192:195], v3 offset:8192
  ds_read_b128 v[196:199], v3 offset:8448
  ds_read_b128 v[200:203], v3 offset:10240
  ds_read_b128 v[204:207], v3 offset:10496
  ds_read_b128 v[208:211], v3 offset:12288
  ds_read_b128 v[212:215], v3 offset:12544
  ds_read_b128 v[216:219], v3 offset:14336
  ds_read_b128 v[220:223], v3 offset:14592
  v_mov_b32 v24, 0
  v_mov_b32 v25, 0
  v_mov_b32 v26, 0
  v_mov_b32 v27, 0
  s_waitcnt lgkmcnt(12)
  v_mfma_f32_32x32x16_bf16 v[224:239], v[160:163], v[128:131], 0
  v_mfma_f32_32x32x16_bf16 v[224:239], v[164:167], v[132:135], v[224:239]
  v_mfma_f32_32x32x16_bf16 v[224:239], v[168:171], v[136:139], v[224:239]
  v_mfma_f32_32x32x16_bf16 v[224:239], v[172:175], v[140:143], v[224:239]
  s_waitcnt lgkmcnt(8)
  v_mfma_f32_32x32x16_bf16 v[224:239], v[176:179], v[144:147], v[224:239]
  v_mfma_f32_32x32x16_bf16 v[224:239], v[180:183], v[148:151], v[224:239]
  v_mfma_f32_32x32x16_bf16 v[224:239], v[184:187], v[152:155], v[224:239]
  v_mfma_f32_32x32x16_bf16 v[224:239], v[188:191], v[156:159], v[224:239]
  v_mfma_f32_32x32x16_bf16 v[64:79], v[24:27], v[24:27], 0
  v_mfma_f32_32x32x16_bf16 v[80:95], v[24:27], v[24:27], 0
  v_mfma_f32_32x32x16_bf16 v[96:111], v[24:27], v[24:27], 0
  v_mfma_f32_32x32x16_bf16 v[112:127], v[24:27], v[24:27], 0
  s_add_u32 s45, s45, s62
  s_cmp_eq_u32 s45, s63
  s_cselect_b32 s45, 0, s45
  s_nop 2
  s_cmp_lg_u32 s43, 0
  s_cbranch_scc1 mk_26
  v_cmp_gt_i32 s[56:57], 0, v62
  v_cmp_gt_i32 s[58:59], 1, v62
  v_cmp_gt_i32 s[60:61], 2, v62
  v_cmp_gt_i32 s[38:39], 3, v62
  v_cndmask_b32 v224, v224, v63, s[56:57]
  v_cndmask_b32 v225, v225, v63, s[58:59]
  v_cndmask_b32 v226, v226, v63, s[60:61]
  v_cndmask_b32 v227, v227, v63, s[38:39]
  v_cmp_gt_i32 s[56:57], 4, v62
  v_cmp_gt_i32 s[58:59], 5, v62
  v_cmp_gt_i32 s[60:61], 6, v62
  v_cmp_gt_i32 s[38:39], 7, v62
  v_cndmask_b32 v228, v228, v63, s[56:57]
  v_cndmask_b32 v229, v229, v63, s[58:59]
  v_cndmask_b32 v230, v230, v63, s[60:61]
  v_cndmask_b32 v231, v231, v63, s[38:39]
  v_cmp_gt_i32 s[56:57], 16, v62
  v_cmp_gt_i32 s[58:59], 17, v62
  v_cmp_gt_i32 s[60:61], 18, v62
  v_cmp_gt_i32 s[38:39], 19, v62
  v_cndmask_b32 v232, v232, v63, s[56:57]
  v_cndmask_b32 v233, v233, v63, s[58:59]
  v_cndmask_b32 v234, v234, v63, s[60:61]
  v_cndmask_b32 v235, v235, v63, s[38:39]
  v_cmp_gt_i32 s[56:57], 20, v62
  v_cmp_gt_i32 s[58:59], 21, v62
  v_cmp_gt_i32 s[60:61], 22, v62
  v_cmp_gt_i32 s[38:39], 23, v62
  v_cndmask_b32 v236, v236, v63, s[56:57]
  v_cndmask_b32 v237, v237, v63, s[58:59]
  v_cndmask_b32 v238, v238, v63, s[60:61]
  v_cndmask_b32 v239, v239, v63, s[38:39]
mk_26:
  v_max3_f32 v56, v224, v225, v226
  v_max3_f32 v57, v227, v228, v229
  v_max3_f32 v56, v56, v230, v231
  v_max3_f32 v57, v57, v232, v233
  v_max3_f32 v56, v56, v234, v235
  v_max3_f32 v57, v57, v236, v237
  v_max3_f32 v56, v56, v238, v239
  v_max_f32 v56, v56, v57
  v_mov_b32 v57, v56
  s_nop 1
  v_permlane32_swap_b32 v57, v56
  v_max_f32 v56, v56, v57
  v_sub_f32 v32, 0, v56
  v_sub_f32 v33, 0, v56
  v_sub_f32 v34, 0, v56
  v_sub_f32 v35, 0, v56
  v_sub_f32 v36, 0, v56
  v_sub_f32 v37, 0, v56
  v_sub_f32 v38, 0, v56
  v_sub_f32 v39, 0, v56
  v_sub_f32 v40, 0, v56
  v_sub_f32 v41, 0, v56
  v_sub_f32 v42, 0, v56
  v_sub_f32 v43, 0, v56
  v_sub_f32 v44, 0, v56
  v_sub_f32 v45, 0, v56
  v_sub_f32 v46, 0, v56
  v_sub_f32 v47, 0, v56
  s_waitcnt lgkmcnt(0)
  s_nop 0
  v_mfma_f32_32x32x16_bf16 v[240:255], v[192:195], v[128:131], v[32:47]
  v_add_u32 v3, s45, v4
  s_waitcnt vmcnt(0)
  s_waitcnt lgkmcnt(0)
  s_cmp_ge_u32 s9, 8
  s_cbranch_scc0 spin_29
spc_30:
  s_barrier
  s_cmp_eq_u32 s43, 0
  s_cselect_b32 s53, 0x4000, 0
  v_add_u32 v57, s53, v3
  ds_read_b128 v[160:163], v57 offset:0
  ds_read_b128 v[164:167], v57 offset:256
  ds_read_b128 v[168:171], v57 offset:2048
  ds_read_b128 v[172:175], v57 offset:2304
  ds_read_b128 v[176:179], v57 offset:4096
  ds_read_b128 v[180:183], v57 offset:4352
  ds_read_b128 v[184:187], v57 offset:6144
  ds_read_b128 v[188:191], v57 offset:6400
  v_sub_f32 v224, v224, v56
  v_sub_f32 v225, v225, v56
  v_sub_f32 v226, v226, v56
  v_sub_f32 v227, v227, v56
  v_exp_f32 v48, v224
  v_sub_f32 v228, v228, v56
  v_exp_f32 v49, v225
  v_mfma_f32_32x32x16_bf16 v[240:255], v[196:199], v[132:135], v[240:255]
  v_sub_f32 v229, v229, v56
  v_exp_f32 v50, v226
  v_sub_f32 v230, v230, v56
  v_add_f32 v61, v48, v49
  v_cvt_pk_bf16_f32 v16, v48, v49
  v_exp_f32 v51, v227
  v_sub_f32 v231, v231, v56
  v_mfma_f32_32x32x16_bf16 v[240:255], v[200:203], v[136:139], v[240:255]
  v_add_f32 v61, v61, v50
  v_exp_f32 v52, v228
  v_sub_f32 v232, v232, v56
  v_add_f32 v61, v61, v51
  v_cvt_pk_bf16_f32 v17, v50, v51
  v_exp_f32 v53, v229
  v_sub_f32 v233, v233, v56
  v_mfma_f32_32x32x16_bf16 v[240:255], v[204:207], v[140:143], v[240:255]
  v_add_f32 v61, v61, v52
  v_exp_f32 v54, v230
  v_sub_f32 v234, v234, v56
  v_add_f32 v61, v61, v53
  v_cvt_pk_bf16_f32 v20, v52, v53
  v_exp_f32 v55, v231
  v_sub_f32 v235, v235, v56
  v_mfma_f32_32x32x16_bf16 v[240:255], v[208:211], v[144:147], v[240:255]
  v_add_f32 v61, v61, v54
  v_exp_f32 v48, v232
  v_sub_f32 v236, v236, v56
  v_add_f32 v61, v61, v55
  v_cvt_pk_bf16_f32 v21, v54, v55
  v_exp_f32 v49, v233
  v_sub_f32 v237, v237, v56
  v_mfma_f32_32x32x16_bf16 v[240:255], v[212:215], v[148:151], v[240:255]
  v_add_f32 v61, v61, v48
  v_exp_f32 v50, v234
  v_sub_f32 v238, v238, v56
  v_add_f32 v61, v61, v49
  v_cvt_pk_bf16_f32 v18, v48, v49
  v_exp_f32 v51, v235
  v_sub_f32 v239, v239, v56
  v_mfma_f32_32x32x16_bf16 v[240:255], v[216:219], v[152:155], v[240:255]
  v_add_f32 v61, v61, v50
  v_exp_f32 v52, v236
  v_add_f32 v61, v61, v51
  v_cvt_pk_bf16_f32 v19, v50, v51
  v_exp_f32 v53, v237
  v_add_f32 v61, v61, v52
  v_exp_f32 v54, v238
  v_mfma_f32_32x32x16_bf16 v[240:255], v[220:223], v[156:159], v[240:255]
  v_add_f32 v61, v61, v53
  v_cvt_pk_bf16_f32 v22, v52, v53
  v_exp_f32 v55, v239
  v_add_f32 v61, v61, v54
  v_add_f32 v61, v61, v55
  v_cvt_pk_bf16_f32 v23, v54, v55
  v_mov_b32 v60, v61
  s_nop 3
  s_waitcnt lgkmcnt(0)
  s_cmp_eq_u32 s43, 0
  s_cbranch_scc1 fused_kernel_hi_tail
  s_cmp_eq_u32 s43, 1
  s_cbranch_scc1 fused_kernel_hi_last
  s_sub_u32 s50, s43, 1
.p2align 6
fused_kernel_hi_loop:
  v_mfma_f32_32x32x16_bf16 v[224:239], v[160:163], v[128:131], v[32:47]
  v_exp_f32_e64 v48, v240
  ds_read_b128 v[192:195], v3 offset:16384
  ds_read_b128 v[200:203], v3 offset:18432
  v_mfma_f32_32x32x16_bf16 v[224:239], v[164:167], v[132:135], v[224:239]
  v_exp_f32_e64 v49, v241
  ds_read_b128 v[208:211], v3 offset:20480
  ds_read_b128 v[216:219], v3 offset:22528
  v_mfma_f32_32x32x16_bf16 v[224:239], v[168:171], v[136:139], v[224:239]
  v_exp_f32 v50, v242
  v_add_f32 v61, v48, v49
  ds_read_b128 v[196:199], v3 offset:16640
  ds_read_b128 v[204:207], v3 offset:18688
  v_mfma_f32_32x32x16_bf16 v[224:239], v[172:175], v[140:143], v[224:239]
  v_exp_f32 v51, v243
  v_add_f32 v61, v61, v50
  ds_read_b128 v[212:215], v3 offset:20736
  ds_read_b128 v[220:223], v3 offset:22784
  v_mfma_f32_32x32x16_bf16 v[224:239], v[176:179], v[144:147], v[224:239]
  v_exp_f32_e64 v52, v244
  v_add_f32 v61, v61, v51
  v_exp_f32 v53, v245
  v_cvt_pk_bf16_f32 v24, v48, v49
  v_mfma_f32_32x32x16_bf16 v[224:239], v[180:183], v[148:151], v[224:239]
  v_exp_f32_e64 v54, v246
  v_add_f32 v61, v61, v52
  v_add_f32 v61, v61, v53
  v_cvt_pk_bf16_f32 v25, v50, v51
  v_mfma_f32_32x32x16_bf16 v[224:239], v[184:187], v[152:155], v[224:239]
  v_exp_f32_e64 v55, v247
  v_add_f32 v61, v61, v54
  v_exp_f32 v48, v248
  v_cvt_pk_bf16_f32 v28, v52, v53
  v_mfma_f32_32x32x16_bf16 v[224:239], v[188:191], v[156:159], v[224:239]
  v_exp_f32 v49, v249
  v_add_f32 v61, v61, v55
  v_cvt_pk_bf16_f32 v29, v54, v55
  v_add_f32 v61, v61, v48
  s_waitcnt lgkmcnt(0)
  v_mfma_f32_32x32x16_bf16 v[64:79], v[192:195], v[16:19], v[64:79]
  v_exp_f32 v50, v250
  v_add_f32 v61, v61, v49
  ds_read_b128 v[160:163], v3 offset:8192
  ds_read_b128 v[164:167], v3 offset:8448
  v_mfma_f32_32x32x16_bf16 v[80:95], v[200:203], v[16:19], v[80:95]
  v_exp_f32 v51, v251
  v_add_f32 v61, v61, v50
  ds_read_b128 v[168:171], v3 offset:10240
  ds_read_b128 v[172:175], v3 offset:10496
  v_mfma_f32_32x32x16_bf16 v[96:111], v[208:211], v[16:19], v[96:111]
  v_exp_f32 v52, v252
  v_add_f32 v61, v61, v51
  ds_read_b128 v[176:179], v3 offset:12288
  ds_read_b128 v[180:183], v3 offset:12544
  v_mfma_f32_32x32x16_bf16 v[112:127], v[216:219], v[16:19], v[112:127]
  v_exp_f32 v53, v253
  v_add_f32 v61, v61, v52
  ds_read_b128 v[184:187], v3 offset:14336
  ds_read_b128 v[188:191], v3 offset:14592
  v_mfma_f32_32x32x16_bf16 v[64:79], v[196:199], v[20:23], v[64:79]
  v_exp_f32_e64 v54, v254
  v_add_f32 v61, v61, v53
  v_exp_f32 v55, v255
  v_cvt_pk_bf16_f32 v26, v48, v49
  v_mfma_f32_32x32x16_bf16 v[80:95], v[204:207], v[20:23], v[80:95]
  v_add_f32_e64 v61, v61, v54
  v_cvt_pk_bf16_f32 v27, v50, v51
  v_add_f32_e64 v61, v61, v55
  v_cvt_pk_bf16_f32 v30, v52, v53
  s_add_u32 s45, s45, s62
  v_mfma_f32_32x32x16_bf16 v[96:111], v[212:215], v[20:23], v[96:111]
  v_cmp_lt_f32 vcc, s51, v61
  v_cvt_pk_bf16_f32 v31, v54, v55
  s_cmp_eq_u32 s45, s63
  s_cselect_b32 s45, 0, s45
  v_mfma_f32_32x32x16_bf16 v[112:127], v[220:223], v[20:23], v[112:127]
  s_cbranch_vccnz fix_31
cont_32:
  v_add_f32_e64 v60, v60, v61
  s_waitcnt lgkmcnt(0)
  v_mfma_f32_32x32x16_bf16 v[240:255], v[160:163], v[128:131], v[32:47]
  v_exp_f32_e64 v48, v224
  ds_read_b128 v[192:195], v3 offset:24576
  ds_read_b128 v[200:203], v3 offset:26624
  v_mfma_f32_32x32x16_bf16 v[240:255], v[164:167], v[132:135], v[240:255]
  v_exp_f32_e64 v49, v225
  ds_read_b128 v[208:211], v3 offset:28672
  ds_read_b128 v[216:219], v3 offset:30720
  v_mfma_f32_32x32x16_bf16 v[240:255], v[168:171], v[136:139], v[240:255]
  v_exp_f32 v50, v226
  v_add_f32 v61, v48, v49
  ds_read_b128 v[196:199], v3 offset:24832
  ds_read_b128 v[204:207], v3 offset:26880
  v_mfma_f32_32x32x16_bf16 v[240:255], v[172:175], v[140:143], v[240:255]
  v_exp_f32 v51, v227
  v_add_f32 v61, v61, v50
  ds_read_b128 v[212:215], v3 offset:28928
  ds_read_b128 v[220:223], v3 offset:30976
  v_mfma_f32_32x32x16_bf16 v[240:255], v[176:179], v[144:147], v[240:255]
  v_exp_f32_e64 v52, v228
  v_add_f32 v61, v61, v51
  v_exp_f32 v53, v229
  v_cvt_pk_bf16_f32 v16, v48, v49
  v_mfma_f32_32x32x16_bf16 v[240:255], v[180:183], v[148:151], v[240:255]
  v_exp_f32_e64 v54, v230
  v_add_f32 v61, v61, v52
  v_add_f32 v61, v61, v53
  v_cvt_pk_bf16_f32 v17, v50, v51
  v_add_u32_e64 v3, s45, v4
  v_mfma_f32_32x32x16_bf16 v[240:255], v[184:187], v[152:155], v[240:255]
  v_exp_f32_e64 v55, v231
  v_add_f32 v61, v61, v54
  v_exp_f32 v48, v232
  v_cvt_pk_bf16_f32 v20, v52, v53
  v_mfma_f32_32x32x16_bf16 v[240:255], v[188:191], v[156:159], v[240:255]
  v_exp_f32 v49, v233
  v_add_f32 v61, v61, v55
  v_cvt_pk_bf16_f32 v21, v54, v55
  v_add_f32 v61, v61, v48
  s_waitcnt lgkmcnt(0)
  v_mfma_f32_32x32x16_bf16 v[64:79], v[192:195], v[24:27], v[64:79]
  s_barrier
  v_exp_f32 v50, v234
  v_add_f32_e64 v61, v61, v49
  ds_read_b128 v[160:163], v3 offset:0
  ds_read_b128 v[164:167], v3 offset:256
  v_mfma_f32_32x32x16_bf16 v[80:95], v[200:203], v[24:27], v[80:95]
  v_exp_f32 v51, v235
  v_add_f32 v61, v61, v50
  ds_read_b128 v[168:171], v3 offset:2048
  ds_read_b128 v[172:175], v3 offset:2304
  v_mfma_f32_32x32x16_bf16 v[96:111], v[208:211], v[24:27], v[96:111]
  v_exp_f32 v52, v236
  v_add_f32 v61, v61, v51
  ds_read_b128 v[176:179], v3 offset:4096
  ds_read_b128 v[180:183], v3 offset:4352
  v_mfma_f32_32x32x16_bf16 v[112:127], v[216:219], v[24:27], v[112:127]
  v_exp_f32 v53, v237
  v_add_f32 v61, v61, v52
  ds_read_b128 v[184:187], v3 offset:6144
  ds_read_b128 v[188:191], v3 offset:6400
  v_mfma_f32_32x32x16_bf16 v[64:79], v[196:199], v[28:31], v[64:79]
  v_exp_f32_e64 v54, v238
  v_add_f32 v61, v61, v53
  v_exp_f32 v55, v239
  v_cvt_pk_bf16_f32 v18, v48, v49
  v_mfma_f32_32x32x16_bf16 v[80:95], v[204:207], v[28:31], v[80:95]
  v_add_f32_e64 v61, v61, v54
  v_cvt_pk_bf16_f32 v19, v50, v51
  v_add_f32_e64 v61, v61, v55
  v_cvt_pk_bf16_f32 v22, v52, v53
  v_mfma_f32_32x32x16_bf16 v[96:111], v[212:215], v[28:31], v[96:111]
  v_cmp_lt_f32_e64 vcc, s51, v61
  v_cvt_pk_bf16_f32 v23, v54, v55
  s_sub_u32 s50, s50, 1
  s_cmp_lg_u32 s50, 0
  v_mfma_f32_32x32x16_bf16 v[112:127], v[220:223], v[28:31], v[112:127]
  s_cbranch_vccnz fix_33
cont_34:
  v_add_f32 v60, v60, v61
  s_waitcnt lgkmcnt(0)
  s_cbranch_scc1 fused_kernel_hi_loop
.p2align 3
fused_kernel_hi_last:
  v_mfma_f32_32x32x16_bf16 v[224:239], v[160:163], v[128:131], v[32:47]
  v_exp_f32_e64 v48, v240
  ds_read_b128 v[192:195], v3 offset:16384
  ds_read_b128 v[200:203], v3 offset:18432
  v_mfma_f32_32x32x16_bf16 v[224:239], v[164:167], v[132:135], v[224:239]
  v_exp_f32_e64 v49, v241
  ds_read_b128 v[208:211], v3 offset:20480
  ds_read_b128 v[216:219], v3 offset:22528
  v_mfma_f32_32x32x16_bf16 v[224:239], v[168:171], v[136:139], v[224:239]
  v_exp_f32 v50, v242
  v_add_f32 v61, v48, v49
  ds_read_b128 v[196:199], v3 offset:16640
  ds_read_b128 v[204:207], v3 offset:18688
  v_mfma_f32_32x32x16_bf16 v[224:239], v[172:175], v[140:143], v[224:239]
  v_exp_f32 v51, v243
  v_add_f32 v61, v61, v50
  ds_read_b128 v[212:215], v3 offset:20736
  ds_read_b128 v[220:223], v3 offset:22784
  v_mfma_f32_32x32x16_bf16 v[224:239], v[176:179], v[144:147], v[224:239]
  v_exp_f32_e64 v52, v244
  v_add_f32 v61, v61, v51
  v_exp_f32 v53, v245
  v_cvt_pk_bf16_f32 v24, v48, v49
  v_mfma_f32_32x32x16_bf16 v[224:239], v[180:183], v[148:151], v[224:239]
  v_exp_f32_e64 v54, v246
  v_add_f32 v61, v61, v52
  v_add_f32 v61, v61, v53
  v_cvt_pk_bf16_f32 v25, v50, v51
  v_mfma_f32_32x32x16_bf16 v[224:239], v[184:187], v[152:155], v[224:239]
  v_exp_f32_e64 v55, v247
  v_add_f32 v61, v61, v54
  v_exp_f32 v48, v248
  v_cvt_pk_bf16_f32 v28, v52, v53
  v_mfma_f32_32x32x16_bf16 v[224:239], v[188:191], v[156:159], v[224:239]
  v_exp_f32 v49, v249
  v_add_f32 v61, v61, v55
  v_cvt_pk_bf16_f32 v29, v54, v55
  v_add_f32 v61, v61, v48
  s_waitcnt lgkmcnt(0)
  v_mfma_f32_32x32x16_bf16 v[64:79], v[192:195], v[16:19], v[64:79]
  v_exp_f32 v50, v250
  v_add_f32 v61, v61, v49
  ds_read_b128 v[160:163], v3 offset:8192
  ds_read_b128 v[164:167], v3 offset:8448
  v_mfma_f32_32x32x16_bf16 v[80:95], v[200:203], v[16:19], v[80:95]
  v_exp_f32 v51, v251
  v_add_f32 v61, v61, v50
  ds_read_b128 v[168:171], v3 offset:10240
  ds_read_b128 v[172:175], v3 offset:10496
  v_mfma_f32_32x32x16_bf16 v[96:111], v[208:211], v[16:19], v[96:111]
  v_exp_f32 v52, v252
  v_add_f32 v61, v61, v51
  ds_read_b128 v[176:179], v3 offset:12288
  ds_read_b128 v[180:183], v3 offset:12544
  v_mfma_f32_32x32x16_bf16 v[112:127], v[216:219], v[16:19], v[112:127]
  v_exp_f32 v53, v253
  v_add_f32 v61, v61, v52
  ds_read_b128 v[184:187], v3 offset:14336
  ds_read_b128 v[188:191], v3 offset:14592
  v_mfma_f32_32x32x16_bf16 v[64:79], v[196:199], v[20:23], v[64:79]
  v_exp_f32_e64 v54, v254
  v_add_f32 v61, v61, v53
  v_exp_f32 v55, v255
  v_cvt_pk_bf16_f32 v26, v48, v49
  v_mfma_f32_32x32x16_bf16 v[80:95], v[204:207], v[20:23], v[80:95]
  v_add_f32_e64 v61, v61, v54
  v_cvt_pk_bf16_f32 v27, v50, v51
  v_add_f32_e64 v61, v61, v55
  v_cvt_pk_bf16_f32 v30, v52, v53
  s_add_u32 s45, s45, s62
  v_mfma_f32_32x32x16_bf16 v[96:111], v[212:215], v[20:23], v[96:111]
  v_cmp_lt_f32 vcc, s51, v61
  v_cvt_pk_bf16_f32 v31, v54, v55
  s_cmp_eq_u32 s45, s63
  s_cselect_b32 s45, 0, s45
  v_mfma_f32_32x32x16_bf16 v[112:127], v[220:223], v[20:23], v[112:127]
  s_cbranch_vccnz fix_35
cont_36:
  v_add_f32_e64 v60, v60, v61
  s_waitcnt lgkmcnt(0)
  v_mfma_f32_32x32x16_bf16 v[240:255], v[160:163], v[128:131], v[32:47]
  v_cmp_gt_i32 s[56:57], 0, v62
  v_cmp_gt_i32 s[58:59], 1, v62
  v_cmp_gt_i32 s[60:61], 2, v62
  v_cmp_gt_i32 s[38:39], 3, v62
  v_cndmask_b32 v224, v224, v63, s[56:57]
  v_cndmask_b32 v225, v225, v63, s[58:59]
  v_cndmask_b32 v226, v226, v63, s[60:61]
  v_cndmask_b32 v227, v227, v63, s[38:39]
  v_exp_f32_e64 v48, v224
  ds_read_b128 v[192:195], v3 offset:24576
  ds_read_b128 v[200:203], v3 offset:26624
  v_mfma_f32_32x32x16_bf16 v[240:255], v[164:167], v[132:135], v[240:255]
  v_exp_f32_e64 v49, v225
  ds_read_b128 v[208:211], v3 offset:28672
  ds_read_b128 v[216:219], v3 offset:30720
  v_mfma_f32_32x32x16_bf16 v[240:255], v[168:171], v[136:139], v[240:255]
  v_exp_f32 v50, v226
  v_add_f32 v61, v48, v49
  ds_read_b128 v[196:199], v3 offset:24832
  ds_read_b128 v[204:207], v3 offset:26880
  v_mfma_f32_32x32x16_bf16 v[240:255], v[172:175], v[140:143], v[240:255]
  v_exp_f32 v51, v227
  v_add_f32 v61, v61, v50
  ds_read_b128 v[212:215], v3 offset:28928
  ds_read_b128 v[220:223], v3 offset:30976
  v_cmp_gt_i32 s[56:57], 4, v62
  v_cmp_gt_i32 s[58:59], 5, v62
  v_cmp_gt_i32 s[60:61], 6, v62
  v_cmp_gt_i32 s[38:39], 7, v62
  v_cndmask_b32 v228, v228, v63, s[56:57]
  v_cndmask_b32 v229, v229, v63, s[58:59]
  v_cndmask_b32 v230, v230, v63, s[60:61]
  v_cndmask_b32 v231, v231, v63, s[38:39]
  v_mfma_f32_32x32x16_bf16 v[240:255], v[176:179], v[144:147], v[240:255]
  v_exp_f32_e64 v52, v228
  v_add_f32 v61, v61, v51
  v_exp_f32 v53, v229
  v_cvt_pk_bf16_f32 v16, v48, v49
  v_mfma_f32_32x32x16_bf16 v[240:255], v[180:183], v[148:151], v[240:255]
  v_exp_f32_e64 v54, v230
  v_add_f32 v61, v61, v52
  v_add_f32 v61, v61, v53
  v_cvt_pk_bf16_f32 v17, v50, v51
  v_cmp_gt_i32 s[56:57], 16, v62
  v_cmp_gt_i32 s[58:59], 17, v62
  v_cmp_gt_i32 s[60:61], 18, v62
  v_cmp_gt_i32 s[38:39], 19, v62
  v_cndmask_b32 v232, v232, v63, s[56:57]
  v_cndmask_b32 v233, v233, v63, s[58:59]
  v_cndmask_b32 v234, v234, v63, s[60:61]
  v_cndmask_b32 v235, v235, v63, s[38:39]
  v_add_u32_e64 v3, s45, v4
  v_mfma_f32_32x32x16_bf16 v[240:255], v[184:187], v[152:155], v[240:255]
  v_exp_f32_e64 v55, v231
  v_add_f32 v61, v61, v54
  v_exp_f32 v48, v232
  v_cvt_pk_bf16_f32 v20, v52, v53
  v_mfma_f32_32x32x16_bf16 v[240:255], v[188:191], v[156:159], v[240:255]
  v_exp_f32 v49, v233
  v_add_f32 v61, v61, v55
  v_cvt_pk_bf16_f32 v21, v54, v55
  v_add_f32 v61, v61, v48
  s_waitcnt lgkmcnt(0)
  v_mfma_f32_32x32x16_bf16 v[64:79], v[192:195], v[24:27], v[64:79]
  s_barrier
  v_exp_f32 v50, v234
  v_add_f32_e64 v61, v61, v49
  ds_read_b128 v[160:163], v3 offset:16384
  ds_read_b128 v[168:171], v3 offset:18432
  v_mfma_f32_32x32x16_bf16 v[80:95], v[200:203], v[24:27], v[80:95]
  v_exp_f32 v51, v235
  v_add_f32 v61, v61, v50
  ds_read_b128 v[176:179], v3 offset:20480
  ds_read_b128 v[184:187], v3 offset:22528
  v_cmp_gt_i32 s[56:57], 20, v62
  v_cmp_gt_i32 s[58:59], 21, v62
  v_cmp_gt_i32 s[60:61], 22, v62
  v_cmp_gt_i32 s[38:39], 23, v62
  v_cndmask_b32 v236, v236, v63, s[56:57]
  v_cndmask_b32 v237, v237, v63, s[58:59]
  v_cndmask_b32 v238, v238, v63, s[60:61]
  v_cndmask_b32 v239, v239, v63, s[38:39]
  v_mfma_f32_32x32x16_bf16 v[96:111], v[208:211], v[24:27], v[96:111]
  v_exp_f32 v52, v236
  v_add_f32 v61, v61, v51
  ds_read_b128 v[164:167], v3 offset:16640
  ds_read_b128 v[172:175], v3 offset:18688
  v_mfma_f32_32x32x16_bf16 v[112:127], v[216:219], v[24:27], v[112:127]
  v_exp_f32 v53, v237
  v_add_f32 v61, v61, v52
  ds_read_b128 v[180:183], v3 offset:20736
  ds_read_b128 v[188:191], v3 offset:22784
  v_mfma_f32_32x32x16_bf16 v[64:79], v[196:199], v[28:31], v[64:79]
  v_exp_f32_e64 v54, v238
  v_add_f32 v61, v61, v53
  v_exp_f32 v55, v239
  v_cvt_pk_bf16_f32 v18, v48, v49
  v_mfma_f32_32x32x16_bf16 v[80:95], v[204:207], v[28:31], v[80:95]
  v_add_f32_e64 v61, v61, v54
  v_cvt_pk_bf16_f32 v19, v50, v51
  v_add_f32_e64 v61, v61, v55
  v_cvt_pk_bf16_f32 v22, v52, v53
  v_mfma_f32_32x32x16_bf16 v[96:111], v[212:215], v[28:31], v[96:111]
  v_cmp_lt_f32_e64 vcc, s51, v61
  v_cvt_pk_bf16_f32 v23, v54, v55
  v_mfma_f32_32x32x16_bf16 v[112:127], v[220:223], v[28:31], v[112:127]
  s_cbranch_vccnz fix_37
cont_38:
  v_add_f32 v60, v60, v61
  s_waitcnt lgkmcnt(0)
fused_kernel_hi_tail:
  v_mfma_f32_32x32x16_bf16 v[64:79], v[160:163], v[16:19], v[64:79]
  ds_read_b128 v[192:195], v3 offset:24576
  ds_read_b128 v[200:203], v3 offset:26624
  v_cmp_gt_i32 s[56:57], 32, v62
  v_cmp_gt_i32 s[58:59], 33, v62
  v_cmp_gt_i32 s[60:61], 34, v62
  v_cmp_gt_i32 s[38:39], 35, v62
  v_cndmask_b32 v240, v240, v63, s[56:57]
  v_cndmask_b32 v241, v241, v63, s[58:59]
  v_cndmask_b32 v242, v242, v63, s[60:61]
  v_cndmask_b32 v243, v243, v63, s[38:39]
  v_exp_f32 v48, v240
  v_mfma_f32_32x32x16_bf16 v[80:95], v[168:171], v[16:19], v[80:95]
  ds_read_b128 v[208:211], v3 offset:28672
  ds_read_b128 v[216:219], v3 offset:30720
  v_exp_f32 v49, v241
  v_exp_f32 v50, v242
  v_add_f32 v61, v48, v49
  v_cvt_pk_bf16_f32 v24, v48, v49
  v_exp_f32 v51, v243
  v_add_f32 v61, v61, v50
  v_cmp_gt_i32 s[56:57], 36, v62
  v_cmp_gt_i32 s[58:59], 37, v62
  v_cmp_gt_i32 s[60:61], 38, v62
  v_mfma_f32_32x32x16_bf16 v[96:111], v[176:179], v[16:19], v[96:111]
  ds_read_b128 v[196:199], v3 offset:24832
  ds_read_b128 v[204:207], v3 offset:26880
  v_cmp_gt_i32 s[38:39], 39, v62
  v_cndmask_b32 v244, v244, v63, s[56:57]
  v_cndmask_b32 v245, v245, v63, s[58:59]
  v_cndmask_b32 v246, v246, v63, s[60:61]
  v_cndmask_b32 v247, v247, v63, s[38:39]
  v_exp_f32 v52, v244
  v_add_f32 v61, v61, v51
  v_cvt_pk_bf16_f32 v25, v50, v51
  v_exp_f32 v53, v245
  v_mfma_f32_32x32x16_bf16 v[112:127], v[184:187], v[16:19], v[112:127]
  ds_read_b128 v[212:215], v3 offset:28928
  ds_read_b128 v[220:223], v3 offset:30976
  v_add_f32 v61, v61, v52
  v_exp_f32 v54, v246
  v_add_f32 v61, v61, v53
  v_cvt_pk_bf16_f32 v28, v52, v53
  v_exp_f32 v55, v247
  v_add_f32 v61, v61, v54
  v_cmp_gt_i32 s[56:57], 48, v62
  v_cmp_gt_i32 s[58:59], 49, v62
  v_cmp_gt_i32 s[60:61], 50, v62
  v_mfma_f32_32x32x16_bf16 v[64:79], v[164:167], v[20:23], v[64:79]
  v_cmp_gt_i32 s[38:39], 51, v62
  v_cndmask_b32 v248, v248, v63, s[56:57]
  v_cndmask_b32 v249, v249, v63, s[58:59]
  v_cndmask_b32 v250, v250, v63, s[60:61]
  v_cndmask_b32 v251, v251, v63, s[38:39]
  v_exp_f32 v48, v248
  v_add_f32 v61, v61, v55
  v_cvt_pk_bf16_f32 v29, v54, v55
  v_exp_f32 v49, v249
  v_mfma_f32_32x32x16_bf16 v[80:95], v[172:175], v[20:23], v[80:95]
  v_add_f32 v61, v61, v48
  v_exp_f32 v50, v250
  v_add_f32 v61, v61, v49
  v_cvt_pk_bf16_f32 v26, v48, v49
  v_exp_f32 v51, v251
  v_add_f32 v61, v61, v50
  v_cmp_gt_i32 s[56:57], 52, v62
  v_cmp_gt_i32 s[58:59], 53, v62
  v_cmp_gt_i32 s[60:61], 54, v62
  v_mfma_f32_32x32x16_bf16 v[96:111], v[180:183], v[20:23], v[96:111]
  v_cmp_gt_i32 s[38:39], 55, v62
  v_cndmask_b32 v252, v252, v63, s[56:57]
  v_cndmask_b32 v253, v253, v63, s[58:59]
  v_cndmask_b32 v254, v254, v63, s[60:61]
  v_cndmask_b32 v255, v255, v63, s[38:39]
  v_exp_f32 v52, v252
  v_add_f32 v61, v61, v51
  v_cvt_pk_bf16_f32 v27, v50, v51
  v_exp_f32 v53, v253
  v_mfma_f32_32x32x16_bf16 v[112:127], v[188:191], v[20:23], v[112:127]
  v_add_f32 v61, v61, v52
  v_exp_f32 v54, v254
  v_add_f32 v61, v61, v53
  v_cvt_pk_bf16_f32 v30, v52, v53
  v_exp_f32 v55, v255
  v_add_f32 v61, v61, v54
  v_add_f32 v61, v61, v55
  v_cvt_pk_bf16_f32 v31, v54, v55
  v_cmp_lt_f32 vcc, s51, v61
  s_nop 0
  s_cbranch_vccnz fix_39
cont_40:
  v_add_f32 v60, v60, v61
  s_waitcnt lgkmcnt(0)
  s_add_u32 s53, s43, 2
  s_cmp_gt_u32 s53, s44
  s_cbranch_scc1 xb_41
  s_barrier
xb_41:
  v_mfma_f32_32x32x16_bf16 v[64:79], v[192:195], v[24:27], v[64:79]
  v_mov_b32 v56, v60
  s_nop 0
  s_nop 0
  v_permlane32_swap_b32 v56, v60
  v_add_f32 v60, v60, v56
  v_mfma_f32_32x32x16_bf16 v[64:79], v[196:199], v[28:31], v[64:79]
  v_rcp_f32 v60, v60
  s_lshl_b32 s55, s42, 18
  s_lshl_b32 s49, s41, 13
  s_add_u32 s55, s55, s49
  v_mfma_f32_32x32x16_bf16 v[80:95], v[200:203], v[24:27], v[80:95]
  v_mfma_f32_32x32x16_bf16 v[80:95], v[204:207], v[28:31], v[80:95]
  s_nop 5
  v_mul_f32 v64, v64, v60
  v_mul_f32 v65, v65, v60
  v_mul_f32 v66, v66, v60
  v_mul_f32 v67, v67, v60
  v_mul_f32 v68, v68, v60
  v_mul_f32 v69, v69, v60
  v_mul_f32 v70, v70, v60
  v_mfma_f32_32x32x16_bf16 v[96:111], v[208:211], v[24:27], v[96:111]
  v_mul_f32 v71, v71, v60
  v_cvt_pk_bf16_f32 v224, v64, v65
  v_cvt_pk_bf16_f32 v225, v66, v67
  v_cvt_pk_bf16_f32 v226, v68, v69
  v_cvt_pk_bf16_f32 v227, v70, v71
  v_mul_f32 v72, v72, v60
  v_mul_f32 v73, v73, v60
  v_mfma_f32_32x32x16_bf16 v[96:111], v[212:215], v[28:31], v[96:111]
  v_mul_f32 v74, v74, v60
  v_mul_f32 v75, v75, v60
  v_mul_f32 v76, v76, v60
  v_mul_f32 v77, v77, v60
  v_mul_f32 v78, v78, v60
  v_mul_f32 v79, v79, v60
  v_cvt_pk_bf16_f32 v228, v72, v73
  v_mfma_f32_32x32x16_bf16 v[112:127], v[216:219], v[24:27], v[112:127]
  v_cvt_pk_bf16_f32 v229, v74, v75
  v_cvt_pk_bf16_f32 v230, v76, v77
  v_cvt_pk_bf16_f32 v231, v78, v79
  v_permlane16_swap_b32 v224, v228
  v_permlane16_swap_b32 v225, v229
  v_permlane16_swap_b32 v226, v230
  v_permlane16_swap_b32 v227, v231
  v_mfma_f32_32x32x16_bf16 v[112:127], v[220:223], v[28:31], v[112:127]
  buffer_store_dwordx4 v[224:227], v2, s[24:27], s55 offen offset:0 sc1
  buffer_store_dwordx4 v[228:231], v2, s[24:27], s55 offen offset:1024 sc1
  v_mul_f32 v80, v80, v60
  v_mul_f32 v81, v81, v60
  v_mul_f32 v82, v82, v60
  v_mul_f32 v83, v83, v60
  v_mul_f32 v84, v84, v60
  v_mul_f32 v85, v85, v60
  v_mul_f32 v86, v86, v60
  v_mul_f32 v87, v87, v60
  v_cvt_pk_bf16_f32 v232, v80, v81
  v_cvt_pk_bf16_f32 v233, v82, v83
  v_cvt_pk_bf16_f32 v234, v84, v85
  v_cvt_pk_bf16_f32 v235, v86, v87
  v_mul_f32 v88, v88, v60
  v_mul_f32 v89, v89, v60
  v_mul_f32 v90, v90, v60
  v_mul_f32 v91, v91, v60
  v_mul_f32 v92, v92, v60
  v_mul_f32 v93, v93, v60
  v_mul_f32 v94, v94, v60
  v_mul_f32 v95, v95, v60
  v_cvt_pk_bf16_f32 v236, v88, v89
  v_cvt_pk_bf16_f32 v237, v90, v91
  v_cvt_pk_bf16_f32 v238, v92, v93
  v_cvt_pk_bf16_f32 v239, v94, v95
  v_permlane16_swap_b32 v232, v236
  v_permlane16_swap_b32 v233, v237
  v_permlane16_swap_b32 v234, v238
  v_permlane16_swap_b32 v235, v239
  buffer_store_dwordx4 v[232:235], v2, s[24:27], s55 offen offset:2048 sc1
  buffer_store_dwordx4 v[236:239], v2, s[24:27], s55 offen offset:3072 sc1
  v_mul_f32 v96, v96, v60
  v_mul_f32 v97, v97, v60
  v_mul_f32 v98, v98, v60
  v_mul_f32 v99, v99, v60
  v_mul_f32 v100, v100, v60
  v_mul_f32 v101, v101, v60
  v_mul_f32 v102, v102, v60
  v_mul_f32 v103, v103, v60
  v_cvt_pk_bf16_f32 v240, v96, v97
  v_cvt_pk_bf16_f32 v241, v98, v99
  v_cvt_pk_bf16_f32 v242, v100, v101
  v_cvt_pk_bf16_f32 v243, v102, v103
  s_add_u32 s55, s55, 4096
  v_mul_f32 v104, v104, v60
  v_mul_f32 v105, v105, v60
  v_mul_f32 v106, v106, v60
  v_mul_f32 v107, v107, v60
  v_mul_f32 v108, v108, v60
  v_mul_f32 v109, v109, v60
  v_mul_f32 v110, v110, v60
  v_mul_f32 v111, v111, v60
  v_cvt_pk_bf16_f32 v244, v104, v105
  v_cvt_pk_bf16_f32 v245, v106, v107
  v_cvt_pk_bf16_f32 v246, v108, v109
  v_cvt_pk_bf16_f32 v247, v110, v111
  v_permlane16_swap_b32 v240, v244
  v_permlane16_swap_b32 v241, v245
  v_permlane16_swap_b32 v242, v246
  v_permlane16_swap_b32 v243, v247
  buffer_store_dwordx4 v[240:243], v2, s[24:27], s55 offen offset:0 sc1
  buffer_store_dwordx4 v[244:247], v2, s[24:27], s55 offen offset:1024 sc1
  v_mul_f32 v112, v112, v60
  v_mul_f32 v113, v113, v60
  v_mul_f32 v114, v114, v60
  v_mul_f32 v115, v115, v60
  v_mul_f32 v116, v116, v60
  v_mul_f32 v117, v117, v60
  v_mul_f32 v118, v118, v60
  v_mul_f32 v119, v119, v60
  v_cvt_pk_bf16_f32 v248, v112, v113
  v_cvt_pk_bf16_f32 v249, v114, v115
  v_cvt_pk_bf16_f32 v250, v116, v117
  v_cvt_pk_bf16_f32 v251, v118, v119
  v_mul_f32 v120, v120, v60
  v_mul_f32 v121, v121, v60
  v_mul_f32 v122, v122, v60
  v_mul_f32 v123, v123, v60
  v_mul_f32 v124, v124, v60
  v_mul_f32 v125, v125, v60
  v_mul_f32 v126, v126, v60
  v_mul_f32 v127, v127, v60
  v_cvt_pk_bf16_f32 v252, v120, v121
  v_cvt_pk_bf16_f32 v253, v122, v123
  v_cvt_pk_bf16_f32 v254, v124, v125
  v_cvt_pk_bf16_f32 v255, v126, v127
  v_permlane16_swap_b32 v248, v252
  v_permlane16_swap_b32 v249, v253
  v_permlane16_swap_b32 v250, v254
  v_permlane16_swap_b32 v251, v255
  buffer_store_dwordx4 v[248:251], v2, s[24:27], s55 offen offset:2048 sc1
  buffer_store_dwordx4 v[252:255], v2, s[24:27], s55 offen offset:3072 sc1
  s_lshl_b32 s36, s42, 18
  s_andn2_b32 s65, s41, 3
  s_lshl_b32 s65, s65, 13
  s_add_u32 s36, s36, s65
  v_and_b32 v6, 3, v1
  v_lshlrev_b32 v12, 3, v6
  v_bfe_u32 v6, v1, 2, 2
  v_lshl_add_u32 v12, v6, 6, v12
  v_bfe_u32 v7, v1, 4, 1
  v_mul_u32_u24 v7, 4128, v7
  v_add_u32 v12, v12, v7
  v_lshrrev_b32 v7, 5, v1
  v_lshl_add_u32 v12, v7, 11, v12
  s_add_u32 s65, s72, 31744
  v_mov_b32 v14, s65
  v_mov_b32 v15, 1
  s_lshl_b32 s67, s3, 2
  s_add_u32 s75, s65, s67
  v_add_u32 v8, s32, v12
  v_xor_b32 v9, 32, v8
  ds_read_b64_tr_b16 v[16:17], v8 offset:0
  ds_read_b64_tr_b16 v[18:19], v9 offset:256
  ds_read_b64_tr_b16 v[20:21], v8 offset:512
  ds_read_b64_tr_b16 v[22:23], v9 offset:768
  ds_read_b64_tr_b16 v[24:25], v8 offset:1024
  ds_read_b64_tr_b16 v[26:27], v9 offset:1280
  ds_read_b64_tr_b16 v[28:29], v8 offset:1536
  ds_read_b64_tr_b16 v[30:31], v9 offset:1792
  ds_read_b64_tr_b16 v[32:33], v9 offset:0
  ds_read_b64_tr_b16 v[34:35], v8 offset:256
  ds_read_b64_tr_b16 v[36:37], v9 offset:512
  ds_read_b64_tr_b16 v[38:39], v8 offset:768
  ds_read_b64_tr_b16 v[40:41], v9 offset:1024
  ds_read_b64_tr_b16 v[42:43], v8 offset:1280
  ds_read_b64_tr_b16 v[44:45], v9 offset:1536
  ds_read_b64_tr_b16 v[46:47], v8 offset:1792
  s_waitcnt lgkmcnt(12)
  v_mfma_f32_16x16x32_bf16 v[64:67], v[16:19], v[224:227], 0
  v_mfma_f32_16x16x32_bf16 v[68:71], v[16:19], v[228:231], 0
  ds_read_b64_tr_b16 v[16:17], v8 offset:8192
  v_mfma_f32_16x16x32_bf16 v[80:83], v[20:23], v[224:227], 0
  ds_read_b64_tr_b16 v[18:19], v9 offset:8448
  v_mfma_f32_16x16x32_bf16 v[84:87], v[20:23], v[228:231], 0
  ds_read_b64_tr_b16 v[20:21], v8 offset:8704
  s_waitcnt lgkmcnt(11)
  v_mfma_f32_16x16x32_bf16 v[96:99], v[24:27], v[224:227], 0
  ds_read_b64_tr_b16 v[22:23], v9 offset:8960
  v_mfma_f32_16x16x32_bf16 v[100:103], v[24:27], v[228:231], 0
  ds_read_b64_tr_b16 v[24:25], v8 offset:9216
  v_mfma_f32_16x16x32_bf16 v[112:115], v[28:31], v[224:227], 0
  ds_read_b64_tr_b16 v[26:27], v9 offset:9472
  v_mfma_f32_16x16x32_bf16 v[116:119], v[28:31], v[228:231], 0
  ds_read_b64_tr_b16 v[28:29], v8 offset:9728
  s_waitcnt lgkmcnt(11)
  v_mfma_f32_16x16x32_bf16 v[72:75], v[32:35], v[224:227], 0
  ds_read_b64_tr_b16 v[30:31], v9 offset:9984
  v_mfma_f32_16x16x32_bf16 v[76:79], v[32:35], v[228:231], 0
  ds_read_b64_tr_b16 v[32:33], v9 offset:8192
  v_mfma_f32_16x16x32_bf16 v[88:91], v[36:39], v[224:227], 0
  ds_read_b64_tr_b16 v[34:35], v8 offset:8448
  v_mfma_f32_16x16x32_bf16 v[92:95], v[36:39], v[228:231], 0
  ds_read_b64_tr_b16 v[36:37], v9 offset:8704
  s_waitcnt lgkmcnt(11)
  v_mfma_f32_16x16x32_bf16 v[104:107], v[40:43], v[224:227], 0
  ds_read_b64_tr_b16 v[38:39], v8 offset:8960
  v_mfma_f32_16x16x32_bf16 v[108:111], v[40:43], v[228:231], 0
  ds_read_b64_tr_b16 v[40:41], v9 offset:9216
  v_mfma_f32_16x16x32_bf16 v[120:123], v[44:47], v[224:227], 0
  ds_read_b64_tr_b16 v[42:43], v8 offset:9472
  v_mfma_f32_16x16x32_bf16 v[124:127], v[44:47], v[228:231], 0
  ds_read_b64_tr_b16 v[44:45], v9 offset:9728
  s_waitcnt lgkmcnt(11)
  v_mfma_f32_16x16x32_bf16 v[64:67], v[16:19], v[232:235], v[64:67]
  ds_read_b64_tr_b16 v[46:47], v8 offset:9984
  v_mfma_f32_16x16x32_bf16 v[68:71], v[16:19], v[236:239], v[68:71]
  ds_read_b64_tr_b16 v[16:17], v8 offset:16384
  v_mfma_f32_16x16x32_bf16 v[80:83], v[20:23], v[232:235], v[80:83]
  ds_read_b64_tr_b16 v[18:19], v9 offset:16640
  v_mfma_f32_16x16x32_bf16 v[84:87], v[20:23], v[236:239], v[84:87]
  ds_read_b64_tr_b16 v[20:21], v8 offset:16896
  s_waitcnt lgkmcnt(11)
  v_mfma_f32_16x16x32_bf16 v[96:99], v[24:27], v[232:235], v[96:99]
  ds_read_b64_tr_b16 v[22:23], v9 offset:17152
  v_mfma_f32_16x16x32_bf16 v[100:103], v[24:27], v[236:239], v[100:103]
  ds_read_b64_tr_b16 v[24:25], v8 offset:17408
  v_mfma_f32_16x16x32_bf16 v[112:115], v[28:31], v[232:235], v[112:115]
  ds_read_b64_tr_b16 v[26:27], v9 offset:17664
  v_mfma_f32_16x16x32_bf16 v[116:119], v[28:31], v[236:239], v[116:119]
  ds_read_b64_tr_b16 v[28:29], v8 offset:17920
  s_waitcnt lgkmcnt(11)
  v_mfma_f32_16x16x32_bf16 v[72:75], v[32:35], v[232:235], v[72:75]
  ds_read_b64_tr_b16 v[30:31], v9 offset:18176
  v_mfma_f32_16x16x32_bf16 v[76:79], v[32:35], v[236:239], v[76:79]
  ds_read_b64_tr_b16 v[32:33], v9 offset:16384
  v_mfma_f32_16x16x32_bf16 v[88:91], v[36:39], v[232:235], v[88:91]
  ds_read_b64_tr_b16 v[34:35], v8 offset:16640
  v_mfma_f32_16x16x32_bf16 v[92:95], v[36:39], v[236:239], v[92:95]
  ds_read_b64_tr_b16 v[36:37], v9 offset:16896
  s_waitcnt lgkmcnt(11)
  v_mfma_f32_16x16x32_bf16 v[104:107], v[40:43], v[232:235], v[104:107]
  ds_read_b64_tr_b16 v[38:39], v8 offset:17152
  v_mfma_f32_16x16x32_bf16 v[108:111], v[40:43], v[236:239], v[108:111]
  ds_read_b64_tr_b16 v[40:41], v9 offset:17408
  v_mfma_f32_16x16x32_bf16 v[120:123], v[44:47], v[232:235], v[120:123]
  ds_read_b64_tr_b16 v[42:43], v8 offset:17664
  v_mfma_f32_16x16x32_bf16 v[124:127], v[44:47], v[236:239], v[124:127]
  ds_read_b64_tr_b16 v[44:45], v9 offset:17920
  s_waitcnt lgkmcnt(11)
  v_mfma_f32_16x16x32_bf16 v[64:67], v[16:19], v[240:243], v[64:67]
  ds_read_b64_tr_b16 v[46:47], v8 offset:18176
  v_mfma_f32_16x16x32_bf16 v[68:71], v[16:19], v[244:247], v[68:71]
  ds_read_b64_tr_b16 v[16:17], v8 offset:24576
  v_mfma_f32_16x16x32_bf16 v[80:83], v[20:23], v[240:243], v[80:83]
  ds_read_b64_tr_b16 v[18:19], v9 offset:24832
  v_mfma_f32_16x16x32_bf16 v[84:87], v[20:23], v[244:247], v[84:87]
  ds_read_b64_tr_b16 v[20:21], v8 offset:25088
  s_waitcnt lgkmcnt(11)
  v_mfma_f32_16x16x32_bf16 v[96:99], v[24:27], v[240:243], v[96:99]
  ds_read_b64_tr_b16 v[22:23], v9 offset:25344
  v_mfma_f32_16x16x32_bf16 v[100:103], v[24:27], v[244:247], v[100:103]
  ds_read_b64_tr_b16 v[24:25], v8 offset:25600
  v_mfma_f32_16x16x32_bf16 v[112:115], v[28:31], v[240:243], v[112:115]
  ds_read_b64_tr_b16 v[26:27], v9 offset:25856
  v_mfma_f32_16x16x32_bf16 v[116:119], v[28:31], v[244:247], v[116:119]
  ds_read_b64_tr_b16 v[28:29], v8 offset:26112
  s_waitcnt vmcnt(0)
  s_atomic_add s74, s[16:17], s34
  s_barrier
  v_mov_b32 v13, s75
  s_barrier
  s_load_dword s9, s[16:17], s34 glc
  s_waitcnt lgkmcnt(0)
  s_cmp_ge_u32 s9, 4
  s_cbranch_scc0 spin_42
spc_43:
  s_add_u32 s65, s35, 1
  s_and_b32 s65, s65, 3
  s_lshl_b32 s65, s65, 13
  s_add_u32 s65, s65, s36
  s_add_u32 s67, s65, 4096
  buffer_load_dwordx4 v[128:131], v2, s[24:27], s65 offen offset:0 sc1
  buffer_load_dwordx4 v[132:135], v2, s[24:27], s65 offen offset:1024 sc1
  buffer_load_dwordx4 v[136:139], v2, s[24:27], s65 offen offset:2048 sc1
  buffer_load_dwordx4 v[140:143], v2, s[24:27], s65 offen offset:3072 sc1
  buffer_load_dwordx4 v[144:147], v2, s[24:27], s67 offen offset:0 sc1
  buffer_load_dwordx4 v[148:151], v2, s[24:27], s67 offen offset:1024 sc1
  buffer_load_dwordx4 v[152:155], v2, s[24:27], s67 offen offset:2048 sc1
  buffer_load_dwordx4 v[156:159], v2, s[24:27], s67 offen offset:3072 sc1
  s_add_u32 s65, s35, 2
  s_and_b32 s65, s65, 3
  s_lshl_b32 s65, s65, 13
  s_add_u32 s65, s65, s36
  s_add_u32 s67, s65, 4096
  buffer_load_dwordx4 v[160:163], v2, s[24:27], s65 offen offset:0 sc1
  buffer_load_dwordx4 v[164:167], v2, s[24:27], s65 offen offset:1024 sc1
  buffer_load_dwordx4 v[168:171], v2, s[24:27], s65 offen offset:2048 sc1
  buffer_load_dwordx4 v[172:175], v2, s[24:27], s65 offen offset:3072 sc1
  buffer_load_dwordx4 v[176:179], v2, s[24:27], s67 offen offset:0 sc1
  buffer_load_dwordx4 v[180:183], v2, s[24:27], s67 offen offset:1024 sc1
  buffer_load_dwordx4 v[184:187], v2, s[24:27], s67 offen offset:2048 sc1
  buffer_load_dwordx4 v[188:191], v2, s[24:27], s67 offen offset:3072 sc1
  s_add_u32 s65, s35, 3
  s_and_b32 s65, s65, 3
  s_lshl_b32 s65, s65, 13
  s_add_u32 s65, s65, s36
  s_add_u32 s67, s65, 4096
  buffer_load_dwordx4 v[192:195], v2, s[24:27], s65 offen offset:0 sc1
  buffer_load_dwordx4 v[196:199], v2, s[24:27], s65 offen offset:1024 sc1
  buffer_load_dwordx4 v[200:203], v2, s[24:27], s65 offen offset:2048 sc1
  buffer_load_dwordx4 v[204:207], v2, s[24:27], s65 offen offset:3072 sc1
  buffer_load_dwordx4 v[208:211], v2, s[24:27], s67 offen offset:0 sc1
  buffer_load_dwordx4 v[212:215], v2, s[24:27], s67 offen offset:1024 sc1
  buffer_load_dwordx4 v[216:219], v2, s[24:27], s67 offen offset:2048 sc1
  buffer_load_dwordx4 v[220:223], v2, s[24:27], s67 offen offset:3072 sc1
  s_waitcnt lgkmcnt(11)
  v_mfma_f32_16x16x32_bf16 v[72:75], v[32:35], v[240:243], v[72:75]
  ds_read_b64_tr_b16 v[30:31], v9 offset:26368
  v_mfma_f32_16x16x32_bf16 v[76:79], v[32:35], v[244:247], v[76:79]
  ds_read_b64_tr_b16 v[32:33], v9 offset:24576
  v_mfma_f32_16x16x32_bf16 v[88:91], v[36:39], v[240:243], v[88:91]
  ds_read_b64_tr_b16 v[34:35], v8 offset:24832
  v_mfma_f32_16x16x32_bf16 v[92:95], v[36:39], v[244:247], v[92:95]
  ds_read_b64_tr_b16 v[36:37], v9 offset:25088
  s_waitcnt lgkmcnt(11)
  v_mfma_f32_16x16x32_bf16 v[104:107], v[40:43], v[240:243], v[104:107]
  ds_read_b64_tr_b16 v[38:39], v8 offset:25344
  v_mfma_f32_16x16x32_bf16 v[108:111], v[40:43], v[244:247], v[108:111]
  ds_read_b64_tr_b16 v[40:41], v9 offset:25600
  v_mfma_f32_16x16x32_bf16 v[120:123], v[44:47], v[240:243], v[120:123]
  ds_read_b64_tr_b16 v[42:43], v8 offset:25856
  v_mfma_f32_16x16x32_bf16 v[124:127], v[44:47], v[244:247], v[124:127]
  ds_read_b64_tr_b16 v[44:45], v9 offset:26112
  ds_read_b64_tr_b16 v[46:47], v8 offset:26368
  s_waitcnt lgkmcnt(12)
  v_mfma_f32_16x16x32_bf16 v[64:67], v[16:19], v[248:251], v[64:67]
  v_mfma_f32_16x16x32_bf16 v[68:71], v[16:19], v[252:255], v[68:71]
  s_add_u32 s32, s32, s62
  s_cmp_eq_u32 s32, s63
  s_cselect_b32 s32, 0, s32
  v_add_u32 v8, s32, v12
  v_xor_b32 v9, 32, v8
  ds_read_b64_tr_b16 v[16:17], v8 offset:0
  v_mfma_f32_16x16x32_bf16 v[80:83], v[20:23], v[248:251], v[80:83]
  ds_read_b64_tr_b16 v[18:19], v9 offset:256
  v_mfma_f32_16x16x32_bf16 v[84:87], v[20:23], v[252:255], v[84:87]
  ds_read_b64_tr_b16 v[20:21], v8 offset:512
  s_waitcnt lgkmcnt(11)
  v_mfma_f32_16x16x32_bf16 v[96:99], v[24:27], v[248:251], v[96:99]
  ds_read_b64_tr_b16 v[22:23], v9 offset:768
  v_mfma_f32_16x16x32_bf16 v[100:103], v[24:27], v[252:255], v[100:103]
  ds_read_b64_tr_b16 v[24:25], v8 offset:1024
  v_mfma_f32_16x16x32_bf16 v[112:115], v[28:31], v[248:251], v[112:115]
  ds_read_b64_tr_b16 v[26:27], v9 offset:1280
  v_mfma_f32_16x16x32_bf16 v[116:119], v[28:31], v[252:255], v[116:119]
  ds_read_b64_tr_b16 v[28:29], v8 offset:1536
  s_waitcnt lgkmcnt(11)
  v_mfma_f32_16x16x32_bf16 v[72:75], v[32:35], v[248:251], v[72:75]
  ds_read_b64_tr_b16 v[30:31], v9 offset:1792
  v_mfma_f32_16x16x32_bf16 v[76:79], v[32:35], v[252:255], v[76:79]
  ds_read_b64_tr_b16 v[32:33], v9 offset:0
  v_mfma_f32_16x16x32_bf16 v[88:91], v[36:39], v[248:251], v[88:91]
  ds_read_b64_tr_b16 v[34:35], v8 offset:256
  v_mfma_f32_16x16x32_bf16 v[92:95], v[36:39], v[252:255], v[92:95]
  ds_read_b64_tr_b16 v[36:37], v9 offset:512
  s_waitcnt lgkmcnt(11)
  v_mfma_f32_16x16x32_bf16 v[104:107], v[40:43], v[248:251], v[104:107]
  ds_read_b64_tr_b16 v[38:39], v8 offset:768
  v_mfma_f32_16x16x32_bf16 v[108:111], v[40:43], v[252:255], v[108:111]
  ds_read_b64_tr_b16 v[40:41], v9 offset:1024
  v_mfma_f32_16x16x32_bf16 v[120:123], v[44:47], v[248:251], v[120:123]
  ds_read_b64_tr_b16 v[42:43], v8 offset:1280
  v_mfma_f32_16x16x32_bf16 v[124:127], v[44:47], v[252:255], v[124:127]
  s_mov_b64 exec, 1
  ds_add_u32 v13, v15 offset:288
  s_mov_b64 exec, -1
  ds_read_b64_tr_b16 v[44:45], v9 offset:1536
  s_waitcnt vmcnt(20)
  s_waitcnt lgkmcnt(11)
  v_mfma_f32_16x16x32_bf16 v[64:67], v[16:19], v[128:131], v[64:67]
  ds_read_b64_tr_b16 v[46:47], v8 offset:1792
  v_mfma_f32_16x16x32_bf16 v[68:71], v[16:19], v[132:135], v[68:71]
  ds_read_b64_tr_b16 v[16:17], v8 offset:8192
  v_mfma_f32_16x16x32_bf16 v[80:83], v[20:23], v[128:131], v[80:83]
  ds_read_b64_tr_b16 v[18:19], v9 offset:8448
  v_mfma_f32_16x16x32_bf16 v[84:87], v[20:23], v[132:135], v[84:87]
  ds_read_b64_tr_b16 v[20:21], v8 offset:8704
  s_waitcnt lgkmcnt(11)
  v_mfma_f32_16x16x32_bf16 v[96:99], v[24:27], v[128:131], v[96:99]
  ds_read_b64_tr_b16 v[22:23], v9 offset:8960
  v_mfma_f32_16x16x32_bf16 v[100:103], v[24:27], v[132:135], v[100:103]
  ds_read_b64_tr_b16 v[24:25], v8 offset:9216
  v_mfma_f32_16x16x32_bf16 v[112:115], v[28:31], v[128:131], v[112:115]
  ds_read_b64_tr_b16 v[26:27], v9 offset:9472
  v_mfma_f32_16x16x32_bf16 v[116:119], v[28:31], v[132:135], v[116:119]
  ds_read_b64_tr_b16 v[28:29], v8 offset:9728
  s_waitcnt lgkmcnt(11)
  v_mfma_f32_16x16x32_bf16 v[72:75], v[32:35], v[128:131], v[72:75]
  ds_read_b64_tr_b16 v[30:31], v9 offset:9984
  v_mfma_f32_16x16x32_bf16 v[76:79], v[32:35], v[132:135], v[76:79]
  ds_read_b64_tr_b16 v[32:33], v9 offset:8192
  v_mfma_f32_16x16x32_bf16 v[88:91], v[36:39], v[128:131], v[88:91]
  ds_read_b64_tr_b16 v[34:35], v8 offset:8448
  v_mfma_f32_16x16x32_bf16 v[92:95], v[36:39], v[132:135], v[92:95]
  ds_read_b64_tr_b16 v[36:37], v9 offset:8704
  s_waitcnt lgkmcnt(11)
  v_mfma_f32_16x16x32_bf16 v[104:107], v[40:43], v[128:131], v[104:107]
  ds_read_b64_tr_b16 v[38:39], v8 offset:8960
  v_mfma_f32_16x16x32_bf16 v[108:111], v[40:43], v[132:135], v[108:111]
  ds_read_b64_tr_b16 v[40:41], v9 offset:9216
  v_mfma_f32_16x16x32_bf16 v[120:123], v[44:47], v[128:131], v[120:123]
  ds_read_b64_tr_b16 v[42:43], v8 offset:9472
  v_mfma_f32_16x16x32_bf16 v[124:127], v[44:47], v[132:135], v[124:127]
  ds_read_b64_tr_b16 v[44:45], v9 offset:9728
  s_waitcnt lgkmcnt(11)
  v_mfma_f32_16x16x32_bf16 v[64:67], v[16:19], v[136:139], v[64:67]
  ds_read_b64_tr_b16 v[46:47], v8 offset:9984
  v_mfma_f32_16x16x32_bf16 v[68:71], v[16:19], v[140:143], v[68:71]
  ds_read_b64_tr_b16 v[16:17], v8 offset:16384
  v_mfma_f32_16x16x32_bf16 v[80:83], v[20:23], v[136:139], v[80:83]
  ds_read_b64_tr_b16 v[18:19], v9 offset:16640
  v_mfma_f32_16x16x32_bf16 v[84:87], v[20:23], v[140:143], v[84:87]
  ds_read_b64_tr_b16 v[20:21], v8 offset:16896
  s_waitcnt lgkmcnt(11)
  v_mfma_f32_16x16x32_bf16 v[96:99], v[24:27], v[136:139], v[96:99]
  ds_read_b64_tr_b16 v[22:23], v9 offset:17152
  v_mfma_f32_16x16x32_bf16 v[100:103], v[24:27], v[140:143], v[100:103]
  ds_read_b64_tr_b16 v[24:25], v8 offset:17408
  v_mfma_f32_16x16x32_bf16 v[112:115], v[28:31], v[136:139], v[112:115]
  ds_read_b64_tr_b16 v[26:27], v9 offset:17664
  v_mfma_f32_16x16x32_bf16 v[116:119], v[28:31], v[140:143], v[116:119]
  ds_read_b64_tr_b16 v[28:29], v8 offset:17920
  s_waitcnt lgkmcnt(11)
  v_mfma_f32_16x16x32_bf16 v[72:75], v[32:35], v[136:139], v[72:75]
  ds_read_b64_tr_b16 v[30:31], v9 offset:18176
  v_mfma_f32_16x16x32_bf16 v[76:79], v[32:35], v[140:143], v[76:79]
  ds_read_b64_tr_b16 v[32:33], v9 offset:16384
  v_mfma_f32_16x16x32_bf16 v[88:91], v[36:39], v[136:139], v[88:91]
  ds_read_b64_tr_b16 v[34:35], v8 offset:16640
  v_mfma_f32_16x16x32_bf16 v[92:95], v[36:39], v[140:143], v[92:95]
  ds_read_b64_tr_b16 v[36:37], v9 offset:16896
  s_waitcnt lgkmcnt(11)
  v_mfma_f32_16x16x32_bf16 v[104:107], v[40:43], v[136:139], v[104:107]
  ds_read_b64_tr_b16 v[38:39], v8 offset:17152
  v_mfma_f32_16x16x32_bf16 v[108:111], v[40:43], v[140:143], v[108:111]
  ds_read_b64_tr_b16 v[40:41], v9 offset:17408
  v_mfma_f32_16x16x32_bf16 v[120:123], v[44:47], v[136:139], v[120:123]
  ds_read_b64_tr_b16 v[42:43], v8 offset:17664
  v_mfma_f32_16x16x32_bf16 v[124:127], v[44:47], v[140:143], v[124:127]
  ds_read_b64_tr_b16 v[44:45], v9 offset:17920
  s_waitcnt vmcnt(16)
  s_waitcnt lgkmcnt(11)
  v_mfma_f32_16x16x32_bf16 v[64:67], v[16:19], v[144:147], v[64:67]
  ds_read_b64_tr_b16 v[46:47], v8 offset:18176
  v_mfma_f32_16x16x32_bf16 v[68:71], v[16:19], v[148:151], v[68:71]
  ds_read_b64_tr_b16 v[16:17], v8 offset:24576
  v_mfma_f32_16x16x32_bf16 v[80:83], v[20:23], v[144:147], v[80:83]
  ds_read_b64_tr_b16 v[18:19], v9 offset:24832
  v_mfma_f32_16x16x32_bf16 v[84:87], v[20:23], v[148:151], v[84:87]
  ds_read_b64_tr_b16 v[20:21], v8 offset:25088
  s_waitcnt lgkmcnt(11)
  v_mfma_f32_16x16x32_bf16 v[96:99], v[24:27], v[144:147], v[96:99]
  ds_read_b64_tr_b16 v[22:23], v9 offset:25344
  v_mfma_f32_16x16x32_bf16 v[100:103], v[24:27], v[148:151], v[100:103]
  ds_read_b64_tr_b16 v[24:25], v8 offset:25600
  v_mfma_f32_16x16x32_bf16 v[112:115], v[28:31], v[144:147], v[112:115]
  ds_read_b64_tr_b16 v[26:27], v9 offset:25856
  v_mfma_f32_16x16x32_bf16 v[116:119], v[28:31], v[148:151], v[116:119]
  ds_read_b64_tr_b16 v[28:29], v8 offset:26112
  s_waitcnt lgkmcnt(11)
  v_mfma_f32_16x16x32_bf16 v[72:75], v[32:35], v[144:147], v[72:75]
  ds_read_b64_tr_b16 v[30:31], v9 offset:26368
  v_mfma_f32_16x16x32_bf16 v[76:79], v[32:35], v[148:151], v[76:79]
  ds_read_b64_tr_b16 v[32:33], v9 offset:24576
  v_mfma_f32_16x16x32_bf16 v[88:91], v[36:39], v[144:147], v[88:91]
  ds_read_b64_tr_b16 v[34:35], v8 offset:24832
  v_mfma_f32_16x16x32_bf16 v[92:95], v[36:39], v[148:151], v[92:95]
  ds_read_b64_tr_b16 v[36:37], v9 offset:25088
  s_waitcnt lgkmcnt(11)
  v_mfma_f32_16x16x32_bf16 v[104:107], v[40:43], v[144:147], v[104:107]
  ds_read_b64_tr_b16 v[38:39], v8 offset:25344
  v_mfma_f32_16x16x32_bf16 v[108:111], v[40:43], v[148:151], v[108:111]
  ds_read_b64_tr_b16 v[40:41], v9 offset:25600
  v_mfma_f32_16x16x32_bf16 v[120:123], v[44:47], v[144:147], v[120:123]
  ds_read_b64_tr_b16 v[42:43], v8 offset:25856
  v_mfma_f32_16x16x32_bf16 v[124:127], v[44:47], v[148:151], v[124:127]
  ds_read_b64_tr_b16 v[44:45], v9 offset:26112
  ds_read_b64_tr_b16 v[46:47], v8 offset:26368
  s_waitcnt lgkmcnt(12)
  v_mfma_f32_16x16x32_bf16 v[64:67], v[16:19], v[152:155], v[64:67]
  v_mfma_f32_16x16x32_bf16 v[68:71], v[16:19], v[156:159], v[68:71]
  s_add_u32 s32, s32, s62
  s_cmp_eq_u32 s32, s63
  s_cselect_b32 s32, 0, s32
  v_add_u32 v8, s32, v12
  v_xor_b32 v9, 32, v8
  ds_read_b64_tr_b16 v[16:17], v8 offset:0
  v_mfma_f32_16x16x32_bf16 v[80:83], v[20:23], v[152:155], v[80:83]
  ds_read_b64_tr_b16 v[18:19], v9 offset:256
  v_mfma_f32_16x16x32_bf16 v[84:87], v[20:23], v[156:159], v[84:87]
  ds_read_b64_tr_b16 v[20:21], v8 offset:512
  s_waitcnt lgkmcnt(11)
  v_mfma_f32_16x16x32_bf16 v[96:99], v[24:27], v[152:155], v[96:99]
  ds_read_b64_tr_b16 v[22:23], v9 offset:768
  v_mfma_f32_16x16x32_bf16 v[100:103], v[24:27], v[156:159], v[100:103]
  ds_read_b64_tr_b16 v[24:25], v8 offset:1024
  v_mfma_f32_16x16x32_bf16 v[112:115], v[28:31], v[152:155], v[112:115]
  ds_read_b64_tr_b16 v[26:27], v9 offset:1280
  v_mfma_f32_16x16x32_bf16 v[116:119], v[28:31], v[156:159], v[116:119]
  ds_read_b64_tr_b16 v[28:29], v8 offset:1536
  s_waitcnt lgkmcnt(11)
  v_mfma_f32_16x16x32_bf16 v[72:75], v[32:35], v[152:155], v[72:75]
  ds_read_b64_tr_b16 v[30:31], v9 offset:1792
  v_mfma_f32_16x16x32_bf16 v[76:79], v[32:35], v[156:159], v[76:79]
  ds_read_b64_tr_b16 v[32:33], v9 offset:0
  v_mfma_f32_16x16x32_bf16 v[88:91], v[36:39], v[152:155], v[88:91]
  ds_read_b64_tr_b16 v[34:35], v8 offset:256
  v_mfma_f32_16x16x32_bf16 v[92:95], v[36:39], v[156:159], v[92:95]
  ds_read_b64_tr_b16 v[36:37], v9 offset:512
  s_waitcnt lgkmcnt(11)
  v_mfma_f32_16x16x32_bf16 v[104:107], v[40:43], v[152:155], v[104:107]
  ds_read_b64_tr_b16 v[38:39], v8 offset:768
  v_mfma_f32_16x16x32_bf16 v[108:111], v[40:43], v[156:159], v[108:111]
  ds_read_b64_tr_b16 v[40:41], v9 offset:1024
  v_mfma_f32_16x16x32_bf16 v[120:123], v[44:47], v[152:155], v[120:123]
  ds_read_b64_tr_b16 v[42:43], v8 offset:1280
  v_mfma_f32_16x16x32_bf16 v[124:127], v[44:47], v[156:159], v[124:127]
  s_mov_b64 exec, 1
  ds_add_u32 v13, v15 offset:288
  s_mov_b64 exec, -1
  ds_read_b64_tr_b16 v[44:45], v9 offset:1536
  s_waitcnt vmcnt(12)
  s_waitcnt lgkmcnt(11)
  v_mfma_f32_16x16x32_bf16 v[64:67], v[16:19], v[160:163], v[64:67]
  ds_read_b64_tr_b16 v[46:47], v8 offset:1792
  v_mfma_f32_16x16x32_bf16 v[68:71], v[16:19], v[164:167], v[68:71]
  ds_read_b64_tr_b16 v[16:17], v8 offset:8192
  v_mfma_f32_16x16x32_bf16 v[80:83], v[20:23], v[160:163], v[80:83]
  ds_read_b64_tr_b16 v[18:19], v9 offset:8448
  v_mfma_f32_16x16x32_bf16 v[84:87], v[20:23], v[164:167], v[84:87]
  ds_read_b64_tr_b16 v[20:21], v8 offset:8704
  s_waitcnt lgkmcnt(11)
  v_mfma_f32_16x16x32_bf16 v[96:99], v[24:27], v[160:163], v[96:99]
  ds_read_b64_tr_b16 v[22:23], v9 offset:8960
  v_mfma_f32_16x16x32_bf16 v[100:103], v[24:27], v[164:167], v[100:103]
  ds_read_b64_tr_b16 v[24:25], v8 offset:9216
  v_mfma_f32_16x16x32_bf16 v[112:115], v[28:31], v[160:163], v[112:115]
  ds_read_b64_tr_b16 v[26:27], v9 offset:9472
  v_mfma_f32_16x16x32_bf16 v[116:119], v[28:31], v[164:167], v[116:119]
  ds_read_b64_tr_b16 v[28:29], v8 offset:9728
  s_waitcnt lgkmcnt(11)
  v_mfma_f32_16x16x32_bf16 v[72:75], v[32:35], v[160:163], v[72:75]
  ds_read_b64_tr_b16 v[30:31], v9 offset:9984
  v_mfma_f32_16x16x32_bf16 v[76:79], v[32:35], v[164:167], v[76:79]
  ds_read_b64_tr_b16 v[32:33], v9 offset:8192
  v_mfma_f32_16x16x32_bf16 v[88:91], v[36:39], v[160:163], v[88:91]
  ds_read_b64_tr_b16 v[34:35], v8 offset:8448
  v_mfma_f32_16x16x32_bf16 v[92:95], v[36:39], v[164:167], v[92:95]
  ds_read_b64_tr_b16 v[36:37], v9 offset:8704
  s_waitcnt lgkmcnt(11)
  v_mfma_f32_16x16x32_bf16 v[104:107], v[40:43], v[160:163], v[104:107]
  ds_read_b64_tr_b16 v[38:39], v8 offset:8960
  v_mfma_f32_16x16x32_bf16 v[108:111], v[40:43], v[164:167], v[108:111]
  ds_read_b64_tr_b16 v[40:41], v9 offset:9216
  v_mfma_f32_16x16x32_bf16 v[120:123], v[44:47], v[160:163], v[120:123]
  ds_read_b64_tr_b16 v[42:43], v8 offset:9472
  v_mfma_f32_16x16x32_bf16 v[124:127], v[44:47], v[164:167], v[124:127]
  ds_read_b64_tr_b16 v[44:45], v9 offset:9728
  s_waitcnt lgkmcnt(11)
  v_mfma_f32_16x16x32_bf16 v[64:67], v[16:19], v[168:171], v[64:67]
  ds_read_b64_tr_b16 v[46:47], v8 offset:9984
  v_mfma_f32_16x16x32_bf16 v[68:71], v[16:19], v[172:175], v[68:71]
  ds_read_b64_tr_b16 v[16:17], v8 offset:16384
  v_mfma_f32_16x16x32_bf16 v[80:83], v[20:23], v[168:171], v[80:83]
  ds_read_b64_tr_b16 v[18:19], v9 offset:16640
  v_mfma_f32_16x16x32_bf16 v[84:87], v[20:23], v[172:175], v[84:87]
  ds_read_b64_tr_b16 v[20:21], v8 offset:16896
  s_waitcnt lgkmcnt(11)
  v_mfma_f32_16x16x32_bf16 v[96:99], v[24:27], v[168:171], v[96:99]
  ds_read_b64_tr_b16 v[22:23], v9 offset:17152
  v_mfma_f32_16x16x32_bf16 v[100:103], v[24:27], v[172:175], v[100:103]
  ds_read_b64_tr_b16 v[24:25], v8 offset:17408
  v_mfma_f32_16x16x32_bf16 v[112:115], v[28:31], v[168:171], v[112:115]
  ds_read_b64_tr_b16 v[26:27], v9 offset:17664
  v_mfma_f32_16x16x32_bf16 v[116:119], v[28:31], v[172:175], v[116:119]
  ds_read_b64_tr_b16 v[28:29], v8 offset:17920
  s_waitcnt lgkmcnt(11)
  v_mfma_f32_16x16x32_bf16 v[72:75], v[32:35], v[168:171], v[72:75]
  ds_read_b64_tr_b16 v[30:31], v9 offset:18176
  v_mfma_f32_16x16x32_bf16 v[76:79], v[32:35], v[172:175], v[76:79]
  ds_read_b64_tr_b16 v[32:33], v9 offset:16384
  v_mfma_f32_16x16x32_bf16 v[88:91], v[36:39], v[168:171], v[88:91]
  ds_read_b64_tr_b16 v[34:35], v8 offset:16640
  v_mfma_f32_16x16x32_bf16 v[92:95], v[36:39], v[172:175], v[92:95]
  ds_read_b64_tr_b16 v[36:37], v9 offset:16896
  s_waitcnt lgkmcnt(11)
  v_mfma_f32_16x16x32_bf16 v[104:107], v[40:43], v[168:171], v[104:107]
  ds_read_b64_tr_b16 v[38:39], v8 offset:17152
  v_mfma_f32_16x16x32_bf16 v[108:111], v[40:43], v[172:175], v[108:111]
  ds_read_b64_tr_b16 v[40:41], v9 offset:17408
  v_mfma_f32_16x16x32_bf16 v[120:123], v[44:47], v[168:171], v[120:123]
  ds_read_b64_tr_b16 v[42:43], v8 offset:17664
  v_mfma_f32_16x16x32_bf16 v[124:127], v[44:47], v[172:175], v[124:127]
  ds_read_b64_tr_b16 v[44:45], v9 offset:17920
  s_waitcnt vmcnt(8)
  s_waitcnt lgkmcnt(11)
  v_mfma_f32_16x16x32_bf16 v[64:67], v[16:19], v[176:179], v[64:67]
  ds_read_b64_tr_b16 v[46:47], v8 offset:18176
  v_mfma_f32_16x16x32_bf16 v[68:71], v[16:19], v[180:183], v[68:71]
  ds_read_b64_tr_b16 v[16:17], v8 offset:24576
  v_mfma_f32_16x16x32_bf16 v[80:83], v[20:23], v[176:179], v[80:83]
  ds_read_b64_tr_b16 v[18:19], v9 offset:24832
  v_mfma_f32_16x16x32_bf16 v[84:87], v[20:23], v[180:183], v[84:87]
  ds_read_b64_tr_b16 v[20:21], v8 offset:25088
  s_waitcnt lgkmcnt(11)
  v_mfma_f32_16x16x32_bf16 v[96:99], v[24:27], v[176:179], v[96:99]
  ds_read_b64_tr_b16 v[22:23], v9 offset:25344
  v_mfma_f32_16x16x32_bf16 v[100:103], v[24:27], v[180:183], v[100:103]
  ds_read_b64_tr_b16 v[24:25], v8 offset:25600
  v_mfma_f32_16x16x32_bf16 v[112:115], v[28:31], v[176:179], v[112:115]
  ds_read_b64_tr_b16 v[26:27], v9 offset:25856
  v_mfma_f32_16x16x32_bf16 v[116:119], v[28:31], v[180:183], v[116:119]
  ds_read_b64_tr_b16 v[28:29], v8 offset:26112
  s_waitcnt lgkmcnt(11)
  v_mfma_f32_16x16x32_bf16 v[72:75], v[32:35], v[176:179], v[72:75]
  ds_read_b64_tr_b16 v[30:31], v9 offset:26368
  v_mfma_f32_16x16x32_bf16 v[76:79], v[32:35], v[180:183], v[76:79]
  ds_read_b64_tr_b16 v[32:33], v9 offset:24576
  v_mfma_f32_16x16x32_bf16 v[88:91], v[36:39], v[176:179], v[88:91]
  ds_read_b64_tr_b16 v[34:35], v8 offset:24832
  v_mfma_f32_16x16x32_bf16 v[92:95], v[36:39], v[180:183], v[92:95]
  ds_read_b64_tr_b16 v[36:37], v9 offset:25088
  s_waitcnt lgkmcnt(11)
  v_mfma_f32_16x16x32_bf16 v[104:107], v[40:43], v[176:179], v[104:107]
  ds_read_b64_tr_b16 v[38:39], v8 offset:25344
  v_mfma_f32_16x16x32_bf16 v[108:111], v[40:43], v[180:183], v[108:111]
  ds_read_b64_tr_b16 v[40:41], v9 offset:25600
  v_mfma_f32_16x16x32_bf16 v[120:123], v[44:47], v[176:179], v[120:123]
  ds_read_b64_tr_b16 v[42:43], v8 offset:25856
  v_mfma_f32_16x16x32_bf16 v[124:127], v[44:47], v[180:183], v[124:127]
  ds_read_b64_tr_b16 v[44:45], v9 offset:26112
  ds_read_b64_tr_b16 v[46:47], v8 offset:26368
  s_waitcnt lgkmcnt(12)
  v_mfma_f32_16x16x32_bf16 v[64:67], v[16:19], v[184:187], v[64:67]
  v_mfma_f32_16x16x32_bf16 v[68:71], v[16:19], v[188:191], v[68:71]
  s_add_u32 s32, s32, s62
  s_cmp_eq_u32 s32, s63
  s_cselect_b32 s32, 0, s32
  v_add_u32 v8, s32, v12
  v_xor_b32 v9, 32, v8
  ds_read_b64_tr_b16 v[16:17], v8 offset:0
  v_mfma_f32_16x16x32_bf16 v[80:83], v[20:23], v[184:187], v[80:83]
  ds_read_b64_tr_b16 v[18:19], v9 offset:256
  v_mfma_f32_16x16x32_bf16 v[84:87], v[20:23], v[188:191], v[84:87]
  ds_read_b64_tr_b16 v[20:21], v9 offset:0
  s_waitcnt lgkmcnt(11)
  v_mfma_f32_16x16x32_bf16 v[96:99], v[24:27], v[184:187], v[96:99]
  ds_read_b64_tr_b16 v[22:23], v8 offset:256
  v_mfma_f32_16x16x32_bf16 v[100:103], v[24:27], v[188:191], v[100:103]
  ds_read_b64_tr_b16 v[24:25], v8 offset:8192
  s_add_u32 s28, s10, 0x5000000
  s_addc_u32 s29, s11, 0
  s_mov_b32 s30, 0x1000000
  s_mov_b32 s31, 0x20000
  v_mfma_f32_16x16x32_bf16 v[112:115], v[28:31], v[184:187], v[112:115]
  ds_read_b64_tr_b16 v[26:27], v9 offset:8448
  v_mfma_f32_16x16x32_bf16 v[116:119], v[28:31], v[188:191], v[116:119]
  ds_read_b64_tr_b16 v[28:29], v9 offset:8192
  s_waitcnt lgkmcnt(11)
  v_mfma_f32_16x16x32_bf16 v[72:75], v[32:35], v[184:187], v[72:75]
  ds_read_b64_tr_b16 v[30:31], v8 offset:8448
  v_mfma_f32_16x16x32_bf16 v[76:79], v[32:35], v[188:191], v[76:79]
  ds_read_b64_tr_b16 v[32:33], v8 offset:16384
  s_lshr_b32 s65, s41, 2
  s_lshl_b32 s65, s65, 21
  s_lshl_b32 s36, s42, 15
  s_add_u32 s65, s65, s36
  s_lshl_b32 s36, s35, 13
  s_add_u32 s65, s65, s36
  s_add_u32 s36, s65, 4096
  v_lshrrev_b32 v10, 4, v1
  v_lshlrev_b32 v10, 9, v10
  v_and_b32 v11, 15, v1
  v_lshl_add_u32 v10, v11, 4, v10
  v_mfma_f32_16x16x32_bf16 v[88:91], v[36:39], v[184:187], v[88:91]
  ds_read_b64_tr_b16 v[34:35], v9 offset:16640
  v_mfma_f32_16x16x32_bf16 v[92:95], v[36:39], v[188:191], v[92:95]
  ds_read_b64_tr_b16 v[36:37], v9 offset:16384
  s_waitcnt lgkmcnt(11)
  v_mfma_f32_16x16x32_bf16 v[104:107], v[40:43], v[184:187], v[104:107]
  ds_read_b64_tr_b16 v[38:39], v8 offset:16640
  v_mfma_f32_16x16x32_bf16 v[108:111], v[40:43], v[188:191], v[108:111]
  ds_read_b64_tr_b16 v[40:41], v8 offset:24576
  v_mfma_f32_16x16x32_bf16 v[120:123], v[44:47], v[184:187], v[120:123]
  ds_read_b64_tr_b16 v[42:43], v9 offset:24832
  v_mfma_f32_16x16x32_bf16 v[124:127], v[44:47], v[188:191], v[124:127]
  s_mov_b64 exec, 1
  ds_add_u32 v13, v15 offset:288
  s_mov_b64 exec, -1
  ds_read_b64_tr_b16 v[44:45], v9 offset:24576
  s_waitcnt vmcnt(0)
  s_waitcnt lgkmcnt(11)
  v_mfma_f32_16x16x32_bf16 v[64:67], v[16:19], v[192:195], v[64:67]
  ds_read_b64_tr_b16 v[46:47], v8 offset:24832
  v_mfma_f32_16x16x32_bf16 v[68:71], v[16:19], v[196:199], v[68:71]
  ds_read_b64_tr_b16 v[16:17], v8 offset:512
  v_mfma_f32_16x16x32_bf16 v[72:75], v[20:23], v[192:195], v[72:75]
  ds_read_b64_tr_b16 v[18:19], v9 offset:768
  v_mfma_f32_16x16x32_bf16 v[76:79], v[20:23], v[196:199], v[76:79]
  ds_read_b64_tr_b16 v[20:21], v9 offset:512
  s_waitcnt lgkmcnt(11)
  v_mfma_f32_16x16x32_bf16 v[64:67], v[24:27], v[200:203], v[64:67]
  ds_read_b64_tr_b16 v[22:23], v8 offset:768
  v_mfma_f32_16x16x32_bf16 v[68:71], v[24:27], v[204:207], v[68:71]
  ds_read_b64_tr_b16 v[24:25], v8 offset:8704
  v_mfma_f32_16x16x32_bf16 v[72:75], v[28:31], v[200:203], v[72:75]
  ds_read_b64_tr_b16 v[26:27], v9 offset:8960
  v_mfma_f32_16x16x32_bf16 v[76:79], v[28:31], v[204:207], v[76:79]
  ds_read_b64_tr_b16 v[28:29], v9 offset:8704
  s_waitcnt lgkmcnt(11)
  v_mfma_f32_16x16x32_bf16 v[64:67], v[32:35], v[208:211], v[64:67]
  ds_read_b64_tr_b16 v[30:31], v8 offset:8960
  v_mfma_f32_16x16x32_bf16 v[68:71], v[32:35], v[212:215], v[68:71]
  ds_read_b64_tr_b16 v[32:33], v8 offset:16896
  v_mfma_f32_16x16x32_bf16 v[72:75], v[36:39], v[208:211], v[72:75]
  ds_read_b64_tr_b16 v[34:35], v9 offset:17152
  v_mfma_f32_16x16x32_bf16 v[76:79], v[36:39], v[212:215], v[76:79]
  ds_read_b64_tr_b16 v[36:37], v9 offset:16896
  s_waitcnt lgkmcnt(11)
  v_mfma_f32_16x16x32_bf16 v[64:67], v[40:43], v[216:219], v[64:67]
  ds_read_b64_tr_b16 v[38:39], v8 offset:17152
  v_mfma_f32_16x16x32_bf16 v[68:71], v[40:43], v[220:223], v[68:71]
  ds_read_b64_tr_b16 v[40:41], v8 offset:25088
  v_mfma_f32_16x16x32_bf16 v[72:75], v[44:47], v[216:219], v[72:75]
  ds_read_b64_tr_b16 v[42:43], v9 offset:25344
  v_mfma_f32_16x16x32_bf16 v[76:79], v[44:47], v[220:223], v[76:79]
  ds_read_b64_tr_b16 v[44:45], v9 offset:25088
  s_waitcnt lgkmcnt(11)
  v_mfma_f32_16x16x32_bf16 v[80:83], v[16:19], v[192:195], v[80:83]
  ds_read_b64_tr_b16 v[46:47], v8 offset:25344
  v_mfma_f32_16x16x32_bf16 v[84:87], v[16:19], v[196:199], v[84:87]
  ds_read_b64_tr_b16 v[16:17], v8 offset:1024
  v_mfma_f32_16x16x32_bf16 v[88:91], v[20:23], v[192:195], v[88:91]
  ds_read_b64_tr_b16 v[18:19], v9 offset:1280
  v_mfma_f32_16x16x32_bf16 v[92:95], v[20:23], v[196:199], v[92:95]
  ds_read_b64_tr_b16 v[20:21], v9 offset:1024
  v_cvt_pk_bf16_f32 v128, v64, v65
  s_waitcnt lgkmcnt(11)
  v_mfma_f32_16x16x32_bf16 v[80:83], v[24:27], v[200:203], v[80:83]
  ds_read_b64_tr_b16 v[22:23], v8 offset:1280
  v_cvt_pk_bf16_f32 v129, v66, v67
  v_mfma_f32_16x16x32_bf16 v[84:87], v[24:27], v[204:207], v[84:87]
  ds_read_b64_tr_b16 v[24:25], v8 offset:9216
  v_cvt_pk_bf16_f32 v130, v72, v73
  v_mfma_f32_16x16x32_bf16 v[88:91], v[28:31], v[200:203], v[88:91]
  ds_read_b64_tr_b16 v[26:27], v9 offset:9472
  v_cvt_pk_bf16_f32 v131, v74, v75
  v_mfma_f32_16x16x32_bf16 v[92:95], v[28:31], v[204:207], v[92:95]
  ds_read_b64_tr_b16 v[28:29], v9 offset:9216
  buffer_store_dwordx4 v[128:131], v10, s[28:31], s65 offen offset:0 sc1
  s_waitcnt lgkmcnt(11)
  v_mfma_f32_16x16x32_bf16 v[80:83], v[32:35], v[208:211], v[80:83]
  ds_read_b64_tr_b16 v[30:31], v8 offset:9472
  v_cvt_pk_bf16_f32 v132, v68, v69
  v_mfma_f32_16x16x32_bf16 v[84:87], v[32:35], v[212:215], v[84:87]
  ds_read_b64_tr_b16 v[32:33], v8 offset:17408
  v_cvt_pk_bf16_f32 v133, v70, v71
  v_mfma_f32_16x16x32_bf16 v[88:91], v[36:39], v[208:211], v[88:91]
  ds_read_b64_tr_b16 v[34:35], v9 offset:17664
  v_cvt_pk_bf16_f32 v134, v76, v77
  v_mfma_f32_16x16x32_bf16 v[92:95], v[36:39], v[212:215], v[92:95]
  ds_read_b64_tr_b16 v[36:37], v9 offset:17408
  v_cvt_pk_bf16_f32 v135, v78, v79
  s_waitcnt lgkmcnt(11)
  v_mfma_f32_16x16x32_bf16 v[80:83], v[40:43], v[216:219], v[80:83]
  ds_read_b64_tr_b16 v[38:39], v8 offset:17664
  buffer_store_dwordx4 v[132:135], v10, s[28:31], s65 offen offset:256 sc1
  v_mfma_f32_16x16x32_bf16 v[84:87], v[40:43], v[220:223], v[84:87]
  ds_read_b64_tr_b16 v[40:41], v8 offset:25600
  v_mfma_f32_16x16x32_bf16 v[88:91], v[44:47], v[216:219], v[88:91]
  ds_read_b64_tr_b16 v[42:43], v9 offset:25856
  v_mfma_f32_16x16x32_bf16 v[92:95], v[44:47], v[220:223], v[92:95]
  ds_read_b64_tr_b16 v[44:45], v9 offset:25600
  s_waitcnt lgkmcnt(11)
  v_mfma_f32_16x16x32_bf16 v[96:99], v[16:19], v[192:195], v[96:99]
  ds_read_b64_tr_b16 v[46:47], v8 offset:25856
  v_mfma_f32_16x16x32_bf16 v[100:103], v[16:19], v[196:199], v[100:103]
  ds_read_b64_tr_b16 v[16:17], v8 offset:1536
  v_mfma_f32_16x16x32_bf16 v[104:107], v[20:23], v[192:195], v[104:107]
  ds_read_b64_tr_b16 v[18:19], v9 offset:1792
  v_mfma_f32_16x16x32_bf16 v[108:111], v[20:23], v[196:199], v[108:111]
  ds_read_b64_tr_b16 v[20:21], v9 offset:1536
  v_cvt_pk_bf16_f32 v136, v80, v81
  s_waitcnt lgkmcnt(11)
  v_mfma_f32_16x16x32_bf16 v[96:99], v[24:27], v[200:203], v[96:99]
  ds_read_b64_tr_b16 v[22:23], v8 offset:1792
  v_cvt_pk_bf16_f32 v137, v82, v83
  v_mfma_f32_16x16x32_bf16 v[100:103], v[24:27], v[204:207], v[100:103]
  ds_read_b64_tr_b16 v[24:25], v8 offset:9728
  v_cvt_pk_bf16_f32 v138, v88, v89
  v_mfma_f32_16x16x32_bf16 v[104:107], v[28:31], v[200:203], v[104:107]
  ds_read_b64_tr_b16 v[26:27], v9 offset:9984
  v_cvt_pk_bf16_f32 v139, v90, v91
  v_mfma_f32_16x16x32_bf16 v[108:111], v[28:31], v[204:207], v[108:111]
  ds_read_b64_tr_b16 v[28:29], v9 offset:9728
  buffer_store_dwordx4 v[136:139], v10, s[28:31], s65 offen offset:2048 sc1
  s_waitcnt lgkmcnt(11)
  v_mfma_f32_16x16x32_bf16 v[96:99], v[32:35], v[208:211], v[96:99]
  ds_read_b64_tr_b16 v[30:31], v8 offset:9984
  v_cvt_pk_bf16_f32 v140, v84, v85
  v_mfma_f32_16x16x32_bf16 v[100:103], v[32:35], v[212:215], v[100:103]
  ds_read_b64_tr_b16 v[32:33], v8 offset:17920
  v_cvt_pk_bf16_f32 v141, v86, v87
  v_mfma_f32_16x16x32_bf16 v[104:107], v[36:39], v[208:211], v[104:107]
  ds_read_b64_tr_b16 v[34:35], v9 offset:18176
  v_cvt_pk_bf16_f32 v142, v92, v93
  v_mfma_f32_16x16x32_bf16 v[108:111], v[36:39], v[212:215], v[108:111]
  ds_read_b64_tr_b16 v[36:37], v9 offset:17920
  v_cvt_pk_bf16_f32 v143, v94, v95
  s_waitcnt lgkmcnt(11)
  v_mfma_f32_16x16x32_bf16 v[96:99], v[40:43], v[216:219], v[96:99]
  ds_read_b64_tr_b16 v[38:39], v8 offset:18176
  buffer_store_dwordx4 v[140:143], v10, s[28:31], s65 offen offset:2304 sc1
  v_mfma_f32_16x16x32_bf16 v[100:103], v[40:43], v[220:223], v[100:103]
  ds_read_b64_tr_b16 v[40:41], v8 offset:26112
  v_mfma_f32_16x16x32_bf16 v[104:107], v[44:47], v[216:219], v[104:107]
  ds_read_b64_tr_b16 v[42:43], v9 offset:26368
  v_mfma_f32_16x16x32_bf16 v[108:111], v[44:47], v[220:223], v[108:111]
  ds_read_b64_tr_b16 v[44:45], v9 offset:26112
  ds_read_b64_tr_b16 v[46:47], v8 offset:26368
  s_waitcnt lgkmcnt(12)
  v_mfma_f32_16x16x32_bf16 v[112:115], v[16:19], v[192:195], v[112:115]
  v_mfma_f32_16x16x32_bf16 v[116:119], v[16:19], v[196:199], v[116:119]
  v_mfma_f32_16x16x32_bf16 v[120:123], v[20:23], v[192:195], v[120:123]
  v_mfma_f32_16x16x32_bf16 v[124:127], v[20:23], v[196:199], v[124:127]
  v_cvt_pk_bf16_f32 v144, v96, v97
  s_waitcnt lgkmcnt(8)
  v_mfma_f32_16x16x32_bf16 v[112:115], v[24:27], v[200:203], v[112:115]
  v_cvt_pk_bf16_f32 v145, v98, v99
  v_mfma_f32_16x16x32_bf16 v[116:119], v[24:27], v[204:207], v[116:119]
  v_cvt_pk_bf16_f32 v146, v104, v105
  v_mfma_f32_16x16x32_bf16 v[120:123], v[28:31], v[200:203], v[120:123]
  v_cvt_pk_bf16_f32 v147, v106, v107
  v_mfma_f32_16x16x32_bf16 v[124:127], v[28:31], v[204:207], v[124:127]
  buffer_store_dwordx4 v[144:147], v10, s[28:31], s36 offen offset:0 sc1
  s_waitcnt lgkmcnt(4)
  v_mfma_f32_16x16x32_bf16 v[112:115], v[32:35], v[208:211], v[112:115]
  v_cvt_pk_bf16_f32 v148, v100, v101
  v_mfma_f32_16x16x32_bf16 v[116:119], v[32:35], v[212:215], v[116:119]
  v_cvt_pk_bf16_f32 v149, v102, v103
  v_mfma_f32_16x16x32_bf16 v[120:123], v[36:39], v[208:211], v[120:123]
  v_cvt_pk_bf16_f32 v150, v108, v109
  v_mfma_f32_16x16x32_bf16 v[124:127], v[36:39], v[212:215], v[124:127]
  v_cvt_pk_bf16_f32 v151, v110, v111
  s_waitcnt lgkmcnt(0)
  v_mfma_f32_16x16x32_bf16 v[112:115], v[40:43], v[216:219], v[112:115]
  buffer_store_dwordx4 v[148:151], v10, s[28:31], s36 offen offset:256 sc1
  v_mfma_f32_16x16x32_bf16 v[116:119], v[40:43], v[220:223], v[116:119]
  v_mfma_f32_16x16x32_bf16 v[120:123], v[44:47], v[216:219], v[120:123]
  v_mfma_f32_16x16x32_bf16 v[124:127], v[44:47], v[220:223], v[124:127]
  s_mov_b64 exec, 1
  ds_add_u32 v13, v15 offset:288
  s_mov_b64 exec, -1
  s_setprio 2
  s_load_dwordx2 s[44:45], s[0:1], 0
  s_load_dwordx2 s[46:47], s[0:1], 56
  s_load_dwordx2 s[48:49], s[0:1], 64
  s_load_dwordx2 s[50:51], s[0:1], 72
  s_load_dwordx2 s[52:53], s[0:1], 96
  v_cvt_pk_bf16_f32 v152, v112, v113
  v_cvt_pk_bf16_f32 v153, v114, v115
  v_cvt_pk_bf16_f32 v154, v120, v121
  v_cvt_pk_bf16_f32 v155, v122, v123
  buffer_store_dwordx4 v[152:155], v10, s[28:31], s36 offen offset:2048 sc1
  v_cvt_pk_bf16_f32 v156, v116, v117
  v_cvt_pk_bf16_f32 v157, v118, v119
  v_cvt_pk_bf16_f32 v158, v124, v125
  v_cvt_pk_bf16_f32 v159, v126, v127
  buffer_store_dwordx4 v[156:159], v10, s[28:31], s36 offen offset:2304 sc1
  s_branch fused_kernel_tail
fused_kernel_lo32:
fused_kernel_lo32_p32:
  v_mov_b32 v3, v4
  v_permlane16_swap_b32 v128, v132
  v_permlane16_swap_b32 v129, v133
  v_permlane16_swap_b32 v130, v134
  v_permlane16_swap_b32 v131, v135
  v_permlane16_swap_b32 v136, v140
  v_permlane16_swap_b32 v137, v141
  v_permlane16_swap_b32 v138, v142
  v_permlane16_swap_b32 v139, v143
  v_permlane16_swap_b32 v144, v148
  v_permlane16_swap_b32 v145, v149
  v_permlane16_swap_b32 v146, v150
  v_permlane16_swap_b32 v147, v151
  v_permlane16_swap_b32 v152, v156
  v_permlane16_swap_b32 v153, v157
  v_permlane16_swap_b32 v154, v158
  v_permlane16_swap_b32 v155, v159
  s_setprio 1
  s_waitcnt vmcnt(16)
  s_barrier
  ds_read_b128 v[160:163], v3 offset:0
  ds_read_b128 v[164:167], v3 offset:256
  ds_read_b128 v[168:171], v3 offset:2048
  ds_read_b128 v[172:175], v3 offset:2304
  ds_read_b128 v[176:179], v3 offset:4096
  ds_read_b128 v[180:183], v3 offset:4352
  ds_read_b128 v[184:187], v3 offset:6144
  ds_read_b128 v[188:191], v3 offset:6400
  ds_read_b128 v[192:195], v3 offset:8192
  ds_read_b128 v[196:199], v3 offset:8448
  ds_read_b128 v[200:203], v3 offset:10240
  ds_read_b128 v[204:207], v3 offset:10496
  ds_read_b128 v[208:211], v3 offset:12288
  ds_read_b128 v[212:215], v3 offset:12544
  ds_read_b128 v[216:219], v3 offset:14336
  ds_read_b128 v[220:223], v3 offset:14592
  v_mov_b32 v24, 0
  v_mov_b32 v25, 0
  v_mov_b32 v26, 0
  v_mov_b32 v27, 0
  s_waitcnt lgkmcnt(12)
  v_mfma_f32_32x32x16_bf16 v[224:239], v[160:163], v[128:131], 0
  v_mfma_f32_32x32x16_bf16 v[224:239], v[164:167], v[132:135], v[224:239]
  v_mfma_f32_32x32x16_bf16 v[224:239], v[168:171], v[136:139], v[224:239]
  v_mfma_f32_32x32x16_bf16 v[224:239], v[172:175], v[140:143], v[224:239]
  s_waitcnt lgkmcnt(8)
  v_mfma_f32_32x32x16_bf16 v[224:239], v[176:179], v[144:147], v[224:239]
  v_mfma_f32_32x32x16_bf16 v[224:239], v[180:183], v[148:151], v[224:239]
  v_mfma_f32_32x32x16_bf16 v[224:239], v[184:187], v[152:155], v[224:239]
  v_mfma_f32_32x32x16_bf16 v[224:239], v[188:191], v[156:159], v[224:239]
  v_mfma_f32_32x32x16_bf16 v[64:79], v[24:27], v[24:27], 0
  v_mfma_f32_32x32x16_bf16 v[80:95], v[24:27], v[24:27], 0
  v_mfma_f32_32x32x16_bf16 v[96:111], v[24:27], v[24:27], 0
  v_mfma_f32_32x32x16_bf16 v[112:127], v[24:27], v[24:27], 0
  s_add_u32 s45, s45, s62
  s_cmp_eq_u32 s45, s63
  s_cselect_b32 s45, 0, s45
  s_nop 2
  s_cmp_lg_u32 s43, 0
  s_cbranch_scc1 mk_44
  v_cmp_gt_i32 s[56:57], 0, v62
  v_cmp_gt_i32 s[58:59], 1, v62
  v_cmp_gt_i32 s[60:61], 2, v62
  v_cmp_gt_i32 s[38:39], 3, v62
  v_cndmask_b32 v224, v224, v63, s[56:57]
  v_cndmask_b32 v225, v225, v63, s[58:59]
  v_cndmask_b32 v226, v226, v63, s[60:61]
  v_cndmask_b32 v227, v227, v63, s[38:39]
  v_cmp_gt_i32 s[56:57], 4, v62
  v_cmp_gt_i32 s[58:59], 5, v62
  v_cmp_gt_i32 s[60:61], 6, v62
  v_cmp_gt_i32 s[38:39], 7, v62
  v_cndmask_b32 v228, v228, v63, s[56:57]
  v_cndmask_b32 v229, v229, v63, s[58:59]
  v_cndmask_b32 v230, v230, v63, s[60:61]
  v_cndmask_b32 v231, v231, v63, s[38:39]
  v_cmp_gt_i32 s[56:57], 16, v62
  v_cmp_gt_i32 s[58:59], 17, v62
  v_cmp_gt_i32 s[60:61], 18, v62
  v_cmp_gt_i32 s[38:39], 19, v62
  v_cndmask_b32 v232, v232, v63, s[56:57]
  v_cndmask_b32 v233, v233, v63, s[58:59]
  v_cndmask_b32 v234, v234, v63, s[60:61]
  v_cndmask_b32 v235, v235, v63, s[38:39]
  v_cmp_gt_i32 s[56:57], 20, v62
  v_cmp_gt_i32 s[58:59], 21, v62
  v_cmp_gt_i32 s[60:61], 22, v62
  v_cmp_gt_i32 s[38:39], 23, v62
  v_cndmask_b32 v236, v236, v63, s[56:57]
  v_cndmask_b32 v237, v237, v63, s[58:59]
  v_cndmask_b32 v238, v238, v63, s[60:61]
  v_cndmask_b32 v239, v239, v63, s[38:39]
mk_44:
  v_max3_f32 v56, v224, v225, v226
  v_max3_f32 v57, v227, v228, v229
  v_max3_f32 v56, v56, v230, v231
  v_max3_f32 v57, v57, v232, v233
  v_max3_f32 v56, v56, v234, v235
  v_max3_f32 v57, v57, v236, v237
  v_max3_f32 v56, v56, v238, v239
  v_max_f32 v56, v56, v57
  v_mov_b32 v57, v56
  s_nop 1
  v_permlane32_swap_b32 v57, v56
  v_max_f32 v56, v56, v57
  v_sub_f32 v32, 0, v56
  v_sub_f32 v33, 0, v56
  v_sub_f32 v34, 0, v56
  v_sub_f32 v35, 0, v56
  v_sub_f32 v36, 0, v56
  v_sub_f32 v37, 0, v56
  v_sub_f32 v38, 0, v56
  v_sub_f32 v39, 0, v56
  v_sub_f32 v40, 0, v56
  v_sub_f32 v41, 0, v56
  v_sub_f32 v42, 0, v56
  v_sub_f32 v43, 0, v56
  v_sub_f32 v44, 0, v56
  v_sub_f32 v45, 0, v56
  v_sub_f32 v46, 0, v56
  v_sub_f32 v47, 0, v56
  s_waitcnt lgkmcnt(0)
  s_nop 0
  v_mfma_f32_32x32x16_bf16 v[240:255], v[192:195], v[128:131], v[32:47]
  v_add_u32 v3, s45, v4
  s_cmp_eq_u32 s43, 0
  s_cselect_b32 s53, 0x4000, 0
  v_add_u32 v57, s53, v3
  ds_read_b128 v[160:163], v57 offset:0
  ds_read_b128 v[164:167], v57 offset:256
  ds_read_b128 v[168:171], v57 offset:2048
  ds_read_b128 v[172:175], v57 offset:2304
  ds_read_b128 v[176:179], v57 offset:4096
  ds_read_b128 v[180:183], v57 offset:4352
  ds_read_b128 v[184:187], v57 offset:6144
  ds_read_b128 v[188:191], v57 offset:6400
  v_sub_f32 v224, v224, v56
  v_sub_f32 v225, v225, v56
  v_sub_f32 v226, v226, v56
  v_sub_f32 v227, v227, v56
  v_exp_f32 v48, v224
  v_sub_f32 v228, v228, v56
  v_exp_f32 v49, v225
  v_mfma_f32_32x32x16_bf16 v[240:255], v[196:199], v[132:135], v[240:255]
  s_cmp_lt_u32 s47, s48
  s_cselect_b32 s49, s47, s54
  s_add_u32 m0, s46, s52
  s_add_u32 s47, s47, s62
  buffer_load_dwordx4 v2, s[20:23], s49 offen offset:0 sc1 lds
  v_sub_f32 v229, v229, v56
  v_exp_f32 v50, v226
  v_sub_f32 v230, v230, v56
  v_add_f32 v61, v48, v49
  v_cvt_pk_bf16_f32 v16, v48, v49
  v_exp_f32 v51, v227
  v_sub_f32 v231, v231, v56
  v_mfma_f32_32x32x16_bf16 v[240:255], v[200:203], v[136:139], v[240:255]
  buffer_load_dwordx4 v2, s[20:23], s49 offen offset:1024 sc1 lds
  v_add_f32 v61, v61, v50
  v_exp_f32 v52, v228
  v_sub_f32 v232, v232, v56
  v_add_f32 v61, v61, v51
  v_cvt_pk_bf16_f32 v17, v50, v51
  v_exp_f32 v53, v229
  v_sub_f32 v233, v233, v56
  v_mfma_f32_32x32x16_bf16 v[240:255], v[204:207], v[140:143], v[240:255]
  buffer_load_dwordx4 v2, s[20:23], s49 offen offset:2048 sc1 lds
  v_add_f32 v61, v61, v52
  v_exp_f32 v54, v230
  v_sub_f32 v234, v234, v56
  v_add_f32 v61, v61, v53
  v_cvt_pk_bf16_f32 v20, v52, v53
  v_exp_f32 v55, v231
  v_sub_f32 v235, v235, v56
  v_mfma_f32_32x32x16_bf16 v[240:255], v[208:211], v[144:147], v[240:255]
  buffer_load_dwordx4 v2, s[20:23], s49 offen offset:3072 sc1 lds
  v_add_f32 v61, v61, v54
  v_exp_f32 v48, v232
  v_sub_f32 v236, v236, v56
  v_add_f32 v61, v61, v55
  v_cvt_pk_bf16_f32 v21, v54, v55
  v_exp_f32 v49, v233
  v_sub_f32 v237, v237, v56
  v_mfma_f32_32x32x16_bf16 v[240:255], v[212:215], v[148:151], v[240:255]
  v_add_f32 v61, v61, v48
  v_exp_f32 v50, v234
  v_sub_f32 v238, v238, v56
  v_add_f32 v61, v61, v49
  v_cvt_pk_bf16_f32 v18, v48, v49
  v_exp_f32 v51, v235
  v_sub_f32 v239, v239, v56
  v_mfma_f32_32x32x16_bf16 v[240:255], v[216:219], v[152:155], v[240:255]
  v_add_f32 v61, v61, v50
  v_exp_f32 v52, v236
  v_add_f32 v61, v61, v51
  v_cvt_pk_bf16_f32 v19, v50, v51
  v_exp_f32 v53, v237
  v_add_f32 v61, v61, v52
  v_exp_f32 v54, v238
  v_mfma_f32_32x32x16_bf16 v[240:255], v[220:223], v[156:159], v[240:255]
  v_add_f32 v61, v61, v53
  v_cvt_pk_bf16_f32 v22, v52, v53
  v_exp_f32 v55, v239
  v_add_f32 v61, v61, v54
  v_add_f32 v61, v61, v55
  v_cvt_pk_bf16_f32 v23, v54, v55
  v_mov_b32 v60, v61
  s_nop 3
  s_waitcnt lgkmcnt(0)
  s_cmp_eq_u32 s43, 0
  s_cbranch_scc1 fused_kernel_lo32_tail
  s_cmp_eq_u32 s43, 1
  s_cbranch_scc1 fused_kernel_lo32_last
  s_sub_u32 s50, s43, 1
.p2align 6
fused_kernel_lo32_loop:
  v_mfma_f32_32x32x16_bf16 v[224:239], v[160:163], v[128:131], v[32:47]
  v_exp_f32_e64 v48, v240
  ds_read_b128 v[192:195], v3 offset:16384
  ds_read_b128 v[200:203], v3 offset:18432
  v_mfma_f32_32x32x16_bf16 v[224:239], v[164:167], v[132:135], v[224:239]
  v_exp_f32_e64 v49, v241
  ds_read_b128 v[208:211], v3 offset:20480
  ds_read_b128 v[216:219], v3 offset:22528
  v_mfma_f32_32x32x16_bf16 v[224:239], v[168:171], v[136:139], v[224:239]
  v_exp_f32 v50, v242
  v_add_f32 v61, v48, v49
  ds_read_b128 v[196:199], v3 offset:16640
  ds_read_b128 v[204:207], v3 offset:18688
  v_mfma_f32_32x32x16_bf16 v[224:239], v[172:175], v[140:143], v[224:239]
  v_exp_f32 v51, v243
  v_add_f32 v61, v61, v50
  ds_read_b128 v[212:215], v3 offset:20736
  ds_read_b128 v[220:223], v3 offset:22784
  v_mfma_f32_32x32x16_bf16 v[224:239], v[176:179], v[144:147], v[224:239]
  v_exp_f32_e64 v52, v244
  v_add_f32 v61, v61, v51
  v_exp_f32 v53, v245
  v_cvt_pk_bf16_f32 v24, v48, v49
  s_add_u32 m0, m0, 0x4000
  s_sub_u32 s49, s49, 0x4000
  buffer_load_dwordx4 v2, s[20:23], s49 offen offset:0 sc1 lds
  v_mfma_f32_32x32x16_bf16 v[224:239], v[180:183], v[148:151], v[224:239]
  v_exp_f32_e64 v54, v246
  v_add_f32 v61, v61, v52
  v_add_f32 v61, v61, v53
  v_cvt_pk_bf16_f32 v25, v50, v51
  buffer_load_dwordx4 v2, s[20:23], s49 offen offset:1024 sc1 lds
  v_mfma_f32_32x32x16_bf16 v[224:239], v[184:187], v[152:155], v[224:239]
  v_exp_f32_e64 v55, v247
  v_add_f32 v61, v61, v54
  v_exp_f32 v48, v248
  v_cvt_pk_bf16_f32 v28, v52, v53
  buffer_load_dwordx4 v2, s[20:23], s49 offen offset:2048 sc1 lds
  v_mfma_f32_32x32x16_bf16 v[224:239], v[188:191], v[156:159], v[224:239]
  v_exp_f32 v49, v249
  v_add_f32 v61, v61, v55
  v_cvt_pk_bf16_f32 v29, v54, v55
  v_add_f32_e64 v61, v61, v48
  buffer_load_dwordx4 v2, s[20:23], s49 offen offset:3072 sc1 lds
  s_add_u32 s46, s46, s62
  s_cmp_eq_u32 s46, s63
  s_cselect_b32 s46, 0, s46
  s_waitcnt lgkmcnt(0)
  v_mfma_f32_32x32x16_bf16 v[64:79], v[192:195], v[16:19], v[64:79]
  v_exp_f32 v50, v250
  v_add_f32 v61, v61, v49
  ds_read_b128 v[160:163], v3 offset:8192
  ds_read_b128 v[164:167], v3 offset:8448
  v_mfma_f32_32x32x16_bf16 v[80:95], v[200:203], v[16:19], v[80:95]
  v_exp_f32 v51, v251
  v_add_f32 v61, v61, v50
  ds_read_b128 v[168:171], v3 offset:10240
  ds_read_b128 v[172:175], v3 offset:10496
  v_mfma_f32_32x32x16_bf16 v[96:111], v[208:211], v[16:19], v[96:111]
  v_exp_f32 v52, v252
  v_add_f32 v61, v61, v51
  ds_read_b128 v[176:179], v3 offset:12288
  ds_read_b128 v[180:183], v3 offset:12544
  v_mfma_f32_32x32x16_bf16 v[112:127], v[216:219], v[16:19], v[112:127]
  v_exp_f32 v53, v253
  v_add_f32 v61, v61, v52
  ds_read_b128 v[184:187], v3 offset:14336
  ds_read_b128 v[188:191], v3 offset:14592
  v_mfma_f32_32x32x16_bf16 v[64:79], v[196:199], v[20:23], v[64:79]
  v_exp_f32_e64 v54, v254
  v_add_f32 v61, v61, v53
  v_exp_f32 v55, v255
  v_cvt_pk_bf16_f32 v26, v48, v49
  v_mfma_f32_32x32x16_bf16 v[80:95], v[204:207], v[20:23], v[80:95]
  v_add_f32_e64 v61, v61, v54
  v_cvt_pk_bf16_f32 v27, v50, v51
  v_add_f32_e64 v61, v61, v55
  v_cvt_pk_bf16_f32 v30, v52, v53
  s_add_u32 s45, s45, s62
  v_mfma_f32_32x32x16_bf16 v[96:111], v[212:215], v[20:23], v[96:111]
  v_cmp_lt_f32 vcc, s51, v61
  v_cvt_pk_bf16_f32 v31, v54, v55
  s_cmp_eq_u32 s45, s63
  s_cselect_b32 s45, 0, s45
  v_mfma_f32_32x32x16_bf16 v[112:127], v[220:223], v[20:23], v[112:127]
  s_cbranch_vccnz fix_47
cont_48:
  v_add_f32_e64 v60, v60, v61
  s_waitcnt lgkmcnt(0)
  v_mfma_f32_32x32x16_bf16 v[240:255], v[160:163], v[128:131], v[32:47]
  v_exp_f32_e64 v48, v224
  ds_read_b128 v[192:195], v3 offset:24576
  ds_read_b128 v[200:203], v3 offset:26624
  v_mfma_f32_32x32x16_bf16 v[240:255], v[164:167], v[132:135], v[240:255]
  v_exp_f32_e64 v49, v225
  ds_read_b128 v[208:211], v3 offset:28672
  ds_read_b128 v[216:219], v3 offset:30720
  v_mfma_f32_32x32x16_bf16 v[240:255], v[168:171], v[136:139], v[240:255]
  v_exp_f32 v50, v226
  v_add_f32 v61, v48, v49
  ds_read_b128 v[196:199], v3 offset:24832
  ds_read_b128 v[204:207], v3 offset:26880
  v_mfma_f32_32x32x16_bf16 v[240:255], v[172:175], v[140:143], v[240:255]
  v_exp_f32 v51, v227
  v_add_f32 v61, v61, v50
  ds_read_b128 v[212:215], v3 offset:28928
  ds_read_b128 v[220:223], v3 offset:30976
  v_mfma_f32_32x32x16_bf16 v[240:255], v[176:179], v[144:147], v[240:255]
  v_exp_f32_e64 v52, v228
  v_add_f32 v61, v61, v51
  v_exp_f32 v53, v229
  v_cvt_pk_bf16_f32 v16, v48, v49
  v_mfma_f32_32x32x16_bf16 v[240:255], v[180:183], v[148:151], v[240:255]
  v_exp_f32_e64 v54, v230
  v_add_f32 v61, v61, v52
  v_add_f32 v61, v61, v53
  v_cvt_pk_bf16_f32 v17, v50, v51
  v_add_u32_e64 v3, s45, v4
  v_mfma_f32_32x32x16_bf16 v[240:255], v[184:187], v[152:155], v[240:255]
  v_exp_f32_e64 v55, v231
  v_add_f32 v61, v61, v54
  v_exp_f32 v48, v232
  v_cvt_pk_bf16_f32 v20, v52, v53
  v_mfma_f32_32x32x16_bf16 v[240:255], v[188:191], v[156:159], v[240:255]
  v_exp_f32 v49, v233
  v_add_f32 v61, v61, v55
  v_cvt_pk_bf16_f32 v21, v54, v55
  v_add_f32 v61, v61, v48
  s_waitcnt lgkmcnt(0)
  v_mfma_f32_32x32x16_bf16 v[64:79], v[192:195], v[24:27], v[64:79]
  s_waitcnt vmcnt(16)
  s_barrier
  v_exp_f32 v50, v234
  v_add_f32 v61, v61, v49
  ds_read_b128 v[160:163], v3 offset:0
  ds_read_b128 v[164:167], v3 offset:256
  v_mfma_f32_32x32x16_bf16 v[80:95], v[200:203], v[24:27], v[80:95]
  v_exp_f32 v51, v235
  v_add_f32 v61, v61, v50
  ds_read_b128 v[168:171], v3 offset:2048
  ds_read_b128 v[172:175], v3 offset:2304
  v_mfma_f32_32x32x16_bf16 v[96:111], v[208:211], v[24:27], v[96:111]
  v_exp_f32 v52, v236
  v_add_f32 v61, v61, v51
  ds_read_b128 v[176:179], v3 offset:4096
  ds_read_b128 v[180:183], v3 offset:4352
  v_mfma_f32_32x32x16_bf16 v[112:127], v[216:219], v[24:27], v[112:127]
  v_exp_f32 v53, v237
  v_add_f32 v61, v61, v52
  ds_read_b128 v[184:187], v3 offset:6144
  ds_read_b128 v[188:191], v3 offset:6400
  v_mfma_f32_32x32x16_bf16 v[64:79], v[196:199], v[28:31], v[64:79]
  v_exp_f32_e64 v54, v238
  v_add_f32 v61, v61, v53
  v_exp_f32 v55, v239
  v_cvt_pk_bf16_f32 v18, v48, v49
  s_cmp_lt_u32 s47, s48
  s_cselect_b32 s49, s47, s54
  s_add_u32 m0, s46, s52
  s_add_u32 s47, s47, s62
  buffer_load_dwordx4 v2, s[20:23], s49 offen offset:0 sc1 lds
  v_mfma_f32_32x32x16_bf16 v[80:95], v[204:207], v[28:31], v[80:95]
  v_add_f32_e64 v61, v61, v54
  v_cvt_pk_bf16_f32 v19, v50, v51
  v_add_f32_e64 v61, v61, v55
  v_cvt_pk_bf16_f32 v22, v52, v53
  buffer_load_dwordx4 v2, s[20:23], s49 offen offset:1024 sc1 lds
  v_mfma_f32_32x32x16_bf16 v[96:111], v[212:215], v[28:31], v[96:111]
  v_cmp_lt_f32_e64 vcc, s51, v61
  v_cvt_pk_bf16_f32 v23, v54, v55
  buffer_load_dwordx4 v2, s[20:23], s49 offen offset:2048 sc1 lds
  s_sub_u32 s50, s50, 1
  s_cmp_lg_u32 s50, 0
  v_mfma_f32_32x32x16_bf16 v[112:127], v[220:223], v[28:31], v[112:127]
  s_cbranch_vccnz fix_49
cont_50:
  v_add_f32 v60, v60, v61
  buffer_load_dwordx4 v2, s[20:23], s49 offen offset:3072 sc1 lds
  s_waitcnt lgkmcnt(0)
  s_cbranch_scc1 fused_kernel_lo32_loop
.p2align 3
fused_kernel_lo32_last:
  v_mfma_f32_32x32x16_bf16 v[224:239], v[160:163], v[128:131], v[32:47]
  v_exp_f32_e64 v48, v240
  ds_read_b128 v[192:195], v3 offset:16384
  ds_read_b128 v[200:203], v3 offset:18432
  v_mfma_f32_32x32x16_bf16 v[224:239], v[164:167], v[132:135], v[224:239]
  v_exp_f32_e64 v49, v241
  ds_read_b128 v[208:211], v3 offset:20480
  ds_read_b128 v[216:219], v3 offset:22528
  v_mfma_f32_32x32x16_bf16 v[224:239], v[168:171], v[136:139], v[224:239]
  v_exp_f32 v50, v242
  v_add_f32 v61, v48, v49
  ds_read_b128 v[196:199], v3 offset:16640
  ds_read_b128 v[204:207], v3 offset:18688
  v_mfma_f32_32x32x16_bf16 v[224:239], v[172:175], v[140:143], v[224:239]
  v_exp_f32 v51, v243
  v_add_f32 v61, v61, v50
  ds_read_b128 v[212:215], v3 offset:20736
  ds_read_b128 v[220:223], v3 offset:22784
  v_mfma_f32_32x32x16_bf16 v[224:239], v[176:179], v[144:147], v[224:239]
  v_exp_f32_e64 v52, v244
  v_add_f32 v61, v61, v51
  v_exp_f32 v53, v245
  v_cvt_pk_bf16_f32 v24, v48, v49
  s_add_u32 m0, m0, 0x4000
  s_sub_u32 s49, s49, 0x4000
  buffer_load_dwordx4 v2, s[20:23], s49 offen offset:0 sc1 lds
  v_mfma_f32_32x32x16_bf16 v[224:239], v[180:183], v[148:151], v[224:239]
  v_exp_f32_e64 v54, v246
  v_add_f32 v61, v61, v52
  v_add_f32 v61, v61, v53
  v_cvt_pk_bf16_f32 v25, v50, v51
  buffer_load_dwordx4 v2, s[20:23], s49 offen offset:1024 sc1 lds
  v_mfma_f32_32x32x16_bf16 v[224:239], v[184:187], v[152:155], v[224:239]
  v_exp_f32_e64 v55, v247
  v_add_f32 v61, v61, v54
  v_exp_f32 v48, v248
  v_cvt_pk_bf16_f32 v28, v52, v53
  buffer_load_dwordx4 v2, s[20:23], s49 offen offset:2048 sc1 lds
  v_mfma_f32_32x32x16_bf16 v[224:239], v[188:191], v[156:159], v[224:239]
  v_exp_f32 v49, v249
  v_add_f32 v61, v61, v55
  v_cvt_pk_bf16_f32 v29, v54, v55
  v_add_f32_e64 v61, v61, v48
  buffer_load_dwordx4 v2, s[20:23], s49 offen offset:3072 sc1 lds
  s_add_u32 s46, s46, s62
  s_cmp_eq_u32 s46, s63
  s_cselect_b32 s46, 0, s46
  s_waitcnt lgkmcnt(0)
  v_mfma_f32_32x32x16_bf16 v[64:79], v[192:195], v[16:19], v[64:79]
  v_exp_f32 v50, v250
  v_add_f32 v61, v61, v49
  ds_read_b128 v[160:163], v3 offset:8192
  ds_read_b128 v[164:167], v3 offset:8448
  v_mfma_f32_32x32x16_bf16 v[80:95], v[200:203], v[16:19], v[80:95]
  v_exp_f32 v51, v251
  v_add_f32 v61, v61, v50
  ds_read_b128 v[168:171], v3 offset:10240
  ds_read_b128 v[172:175], v3 offset:10496
  v_mfma_f32_32x32x16_bf16 v[96:111], v[208:211], v[16:19], v[96:111]
  v_exp_f32 v52, v252
  v_add_f32 v61, v61, v51
  ds_read_b128 v[176:179], v3 offset:12288
  ds_read_b128 v[180:183], v3 offset:12544
  v_mfma_f32_32x32x16_bf16 v[112:127], v[216:219], v[16:19], v[112:127]
  v_exp_f32 v53, v253
  v_add_f32 v61, v61, v52
  ds_read_b128 v[184:187], v3 offset:14336
  ds_read_b128 v[188:191], v3 offset:14592
  v_mfma_f32_32x32x16_bf16 v[64:79], v[196:199], v[20:23], v[64:79]
  v_exp_f32_e64 v54, v254
  v_add_f32 v61, v61, v53
  v_exp_f32 v55, v255
  v_cvt_pk_bf16_f32 v26, v48, v49
  v_mfma_f32_32x32x16_bf16 v[80:95], v[204:207], v[20:23], v[80:95]
  v_add_f32_e64 v61, v61, v54
  v_cvt_pk_bf16_f32 v27, v50, v51
  v_add_f32_e64 v61, v61, v55
  v_cvt_pk_bf16_f32 v30, v52, v53
  s_add_u32 s45, s45, s62
  v_mfma_f32_32x32x16_bf16 v[96:111], v[212:215], v[20:23], v[96:111]
  v_cmp_lt_f32 vcc, s51, v61
  v_cvt_pk_bf16_f32 v31, v54, v55
  s_cmp_eq_u32 s45, s63
  s_cselect_b32 s45, 0, s45
  v_mfma_f32_32x32x16_bf16 v[112:127], v[220:223], v[20:23], v[112:127]
  s_cbranch_vccnz fix_51
cont_52:
  v_add_f32_e64 v60, v60, v61
  s_waitcnt lgkmcnt(0)
  v_mfma_f32_32x32x16_bf16 v[240:255], v[160:163], v[128:131], v[32:47]
  v_cmp_gt_i32 s[56:57], 0, v62
  v_cmp_gt_i32 s[58:59], 1, v62
  v_cmp_gt_i32 s[60:61], 2, v62
  v_cmp_gt_i32 s[38:39], 3, v62
  v_cndmask_b32 v224, v224, v63, s[56:57]
  v_cndmask_b32 v225, v225, v63, s[58:59]
  v_cndmask_b32 v226, v226, v63, s[60:61]
  v_cndmask_b32 v227, v227, v63, s[38:39]
  v_exp_f32_e64 v48, v224
  ds_read_b128 v[192:195], v3 offset:24576
  ds_read_b128 v[200:203], v3 offset:26624
  v_mfma_f32_32x32x16_bf16 v[240:255], v[164:167], v[132:135], v[240:255]
  v_exp_f32_e64 v49, v225
  ds_read_b128 v[208:211], v3 offset:28672
  ds_read_b128 v[216:219], v3 offset:30720
  v_mfma_f32_32x32x16_bf16 v[240:255], v[168:171], v[136:139], v[240:255]
  v_exp_f32 v50, v226
  v_add_f32 v61, v48, v49
  ds_read_b128 v[196:199], v3 offset:24832
  ds_read_b128 v[204:207], v3 offset:26880
  v_mfma_f32_32x32x16_bf16 v[240:255], v[172:175], v[140:143], v[240:255]
  v_exp_f32 v51, v227
  v_add_f32 v61, v61, v50
  ds_read_b128 v[212:215], v3 offset:28928
  ds_read_b128 v[220:223], v3 offset:30976
  v_cmp_gt_i32 s[56:57], 4, v62
  v_cmp_gt_i32 s[58:59], 5, v62
  v_cmp_gt_i32 s[60:61], 6, v62
  v_cmp_gt_i32 s[38:39], 7, v62
  v_cndmask_b32 v228, v228, v63, s[56:57]
  v_cndmask_b32 v229, v229, v63, s[58:59]
  v_cndmask_b32 v230, v230, v63, s[60:61]
  v_cndmask_b32 v231, v231, v63, s[38:39]
  v_mfma_f32_32x32x16_bf16 v[240:255], v[176:179], v[144:147], v[240:255]
  v_exp_f32_e64 v52, v228
  v_add_f32 v61, v61, v51
  v_exp_f32 v53, v229
  v_cvt_pk_bf16_f32 v16, v48, v49
  v_mfma_f32_32x32x16_bf16 v[240:255], v[180:183], v[148:151], v[240:255]
  v_exp_f32_e64 v54, v230
  v_add_f32 v61, v61, v52
  v_add_f32 v61, v61, v53
  v_cvt_pk_bf16_f32 v17, v50, v51
  v_cmp_gt_i32 s[56:57], 16, v62
  v_cmp_gt_i32 s[58:59], 17, v62
  v_cmp_gt_i32 s[60:61], 18, v62
  v_cmp_gt_i32 s[38:39], 19, v62
  v_cndmask_b32 v232, v232, v63, s[56:57]
  v_cndmask_b32 v233, v233, v63, s[58:59]
  v_cndmask_b32 v234, v234, v63, s[60:61]
  v_cndmask_b32 v235, v235, v63, s[38:39]
  v_add_u32_e64 v3, s45, v4
  v_mfma_f32_32x32x16_bf16 v[240:255], v[184:187], v[152:155], v[240:255]
  v_exp_f32_e64 v55, v231
  v_add_f32 v61, v61, v54
  v_exp_f32 v48, v232
  v_cvt_pk_bf16_f32 v20, v52, v53
  v_mfma_f32_32x32x16_bf16 v[240:255], v[188:191], v[156:159], v[240:255]
  v_exp_f32 v49, v233
  v_add_f32 v61, v61, v55
  v_cvt_pk_bf16_f32 v21, v54, v55
  v_add_f32 v61, v61, v48
  s_waitcnt lgkmcnt(0)
  v_mfma_f32_32x32x16_bf16 v[64:79], v[192:195], v[24:27], v[64:79]
  s_waitcnt vmcnt(16)
  s_barrier
  v_exp_f32 v50, v234
  v_add_f32 v61, v61, v49
  ds_read_b128 v[160:163], v3 offset:16384
  ds_read_b128 v[168:171], v3 offset:18432
  v_mfma_f32_32x32x16_bf16 v[80:95], v[200:203], v[24:27], v[80:95]
  v_exp_f32 v51, v235
  v_add_f32 v61, v61, v50
  ds_read_b128 v[176:179], v3 offset:20480
  ds_read_b128 v[184:187], v3 offset:22528
  v_cmp_gt_i32 s[56:57], 20, v62
  v_cmp_gt_i32 s[58:59], 21, v62
  v_cmp_gt_i32 s[60:61], 22, v62
  v_cmp_gt_i32 s[38:39], 23, v62
  v_cndmask_b32 v236, v236, v63, s[56:57]
  v_cndmask_b32 v237, v237, v63, s[58:59]
  v_cndmask_b32 v238, v238, v63, s[60:61]
  v_cndmask_b32 v239, v239, v63, s[38:39]
  v_mfma_f32_32x32x16_bf16 v[96:111], v[208:211], v[24:27], v[96:111]
  v_exp_f32 v52, v236
  v_add_f32 v61, v61, v51
  ds_read_b128 v[164:167], v3 offset:16640
  ds_read_b128 v[172:175], v3 offset:18688
  v_mfma_f32_32x32x16_bf16 v[112:127], v[216:219], v[24:27], v[112:127]
  v_exp_f32 v53, v237
  v_add_f32 v61, v61, v52
  ds_read_b128 v[180:183], v3 offset:20736
  ds_read_b128 v[188:191], v3 offset:22784
  v_mfma_f32_32x32x16_bf16 v[64:79], v[196:199], v[28:31], v[64:79]
  v_exp_f32_e64 v54, v238
  v_add_f32 v61, v61, v53
  v_exp_f32 v55, v239
  v_cvt_pk_bf16_f32 v18, v48, v49
  s_cmp_lt_u32 s47, s48
  s_cselect_b32 s49, s47, s54
  s_add_u32 m0, s46, s52
  s_add_u32 s47, s47, s62
  buffer_load_dwordx4 v2, s[20:23], s49 offen offset:0 sc1 lds
  v_mfma_f32_32x32x16_bf16 v[80:95], v[204:207], v[28:31], v[80:95]
  v_add_f32_e64 v61, v61, v54
  v_cvt_pk_bf16_f32 v19, v50, v51
  v_add_f32_e64 v61, v61, v55
  v_cvt_pk_bf16_f32 v22, v52, v53
  buffer_load_dwordx4 v2, s[20:23], s49 offen offset:1024 sc1 lds
  v_mfma_f32_32x32x16_bf16 v[96:111], v[212:215], v[28:31], v[96:111]
  v_cmp_lt_f32_e64 vcc, s51, v61
  v_cvt_pk_bf16_f32 v23, v54, v55
  buffer_load_dwordx4 v2, s[20:23], s49 offen offset:2048 sc1 lds
  v_mfma_f32_32x32x16_bf16 v[112:127], v[220:223], v[28:31], v[112:127]
  s_cbranch_vccnz fix_53
cont_54:
  v_add_f32 v60, v60, v61
  buffer_load_dwordx4 v2, s[20:23], s49 offen offset:3072 sc1 lds
  s_waitcnt lgkmcnt(0)
fused_kernel_lo32_tail:
  v_mfma_f32_32x32x16_bf16 v[64:79], v[160:163], v[16:19], v[64:79]
  ds_read_b128 v[192:195], v3 offset:24576
  ds_read_b128 v[200:203], v3 offset:26624
  v_cmp_gt_i32 s[56:57], 32, v62
  v_cmp_gt_i32 s[58:59], 33, v62
  v_cmp_gt_i32 s[60:61], 34, v62
  v_cmp_gt_i32 s[38:39], 35, v62
  v_cndmask_b32 v240, v240, v63, s[56:57]
  v_cndmask_b32 v241, v241, v63, s[58:59]
  v_cndmask_b32 v242, v242, v63, s[60:61]
  v_cndmask_b32 v243, v243, v63, s[38:39]
  v_exp_f32 v48, v240
  v_mfma_f32_32x32x16_bf16 v[80:95], v[168:171], v[16:19], v[80:95]
  ds_read_b128 v[208:211], v3 offset:28672
  ds_read_b128 v[216:219], v3 offset:30720
  v_exp_f32 v49, v241
  v_exp_f32 v50, v242
  v_add_f32 v61, v48, v49
  v_cvt_pk_bf16_f32 v24, v48, v49
  v_exp_f32 v51, v243
  v_add_f32 v61, v61, v50
  v_cmp_gt_i32 s[56:57], 36, v62
  v_cmp_gt_i32 s[58:59], 37, v62
  v_cmp_gt_i32 s[60:61], 38, v62
  v_mfma_f32_32x32x16_bf16 v[96:111], v[176:179], v[16:19], v[96:111]
  ds_read_b128 v[196:199], v3 offset:24832
  ds_read_b128 v[204:207], v3 offset:26880
  v_cmp_gt_i32 s[38:39], 39, v62
  v_cndmask_b32 v244, v244, v63, s[56:57]
  v_cndmask_b32 v245, v245, v63, s[58:59]
  v_cndmask_b32 v246, v246, v63, s[60:61]
  v_cndmask_b32 v247, v247, v63, s[38:39]
  v_exp_f32 v52, v244
  v_add_f32 v61, v61, v51
  v_cvt_pk_bf16_f32 v25, v50, v51
  v_exp_f32 v53, v245
  v_mfma_f32_32x32x16_bf16 v[112:127], v[184:187], v[16:19], v[112:127]
  ds_read_b128 v[212:215], v3 offset:28928
  ds_read_b128 v[220:223], v3 offset:30976
  v_add_f32 v61, v61, v52
  v_exp_f32 v54, v246
  v_add_f32 v61, v61, v53
  v_cvt_pk_bf16_f32 v28, v52, v53
  v_exp_f32 v55, v247
  v_add_f32 v61, v61, v54
  v_cmp_gt_i32 s[56:57], 48, v62
  v_cmp_gt_i32 s[58:59], 49, v62
  v_cmp_gt_i32 s[60:61], 50, v62
  v_mfma_f32_32x32x16_bf16 v[64:79], v[164:167], v[20:23], v[64:79]
  v_cmp_gt_i32 s[38:39], 51, v62
  v_cndmask_b32 v248, v248, v63, s[56:57]
  v_cndmask_b32 v249, v249, v63, s[58:59]
  v_cndmask_b32 v250, v250, v63, s[60:61]
  v_cndmask_b32 v251, v251, v63, s[38:39]
  v_exp_f32 v48, v248
  v_add_f32 v61, v61, v55
  v_cvt_pk_bf16_f32 v29, v54, v55
  v_exp_f32 v49, v249
  s_add_u32 m0, m0, 0x4000
  s_sub_u32 s49, s49, 0x4000
  buffer_load_dwordx4 v2, s[20:23], s49 offen offset:0 sc1 lds
  v_mfma_f32_32x32x16_bf16 v[80:95], v[172:175], v[20:23], v[80:95]
  v_add_f32 v61, v61, v48
  v_exp_f32 v50, v250
  v_add_f32 v61, v61, v49
  v_cvt_pk_bf16_f32 v26, v48, v49
  v_exp_f32 v51, v251
  v_add_f32 v61, v61, v50
  v_cmp_gt_i32 s[56:57], 52, v62
  v_cmp_gt_i32 s[58:59], 53, v62
  v_cmp_gt_i32 s[60:61], 54, v62
  buffer_load_dwordx4 v2, s[20:23], s49 offen offset:1024 sc1 lds
  v_mfma_f32_32x32x16_bf16 v[96:111], v[180:183], v[20:23], v[96:111]
  v_cmp_gt_i32 s[38:39], 55, v62
  v_cndmask_b32 v252, v252, v63, s[56:57]
  v_cndmask_b32 v253, v253, v63, s[58:59]
  v_cndmask_b32 v254, v254, v63, s[60:61]
  v_cndmask_b32 v255, v255, v63, s[38:39]
  v_exp_f32 v52, v252
  v_add_f32 v61, v61, v51
  v_cvt_pk_bf16_f32 v27, v50, v51
  v_exp_f32 v53, v253
  buffer_load_dwordx4 v2, s[20:23], s49 offen offset:2048 sc1 lds
  v_mfma_f32_32x32x16_bf16 v[112:127], v[188:191], v[20:23], v[112:127]
  v_add_f32 v61, v61, v52
  v_exp_f32 v54, v254
  v_add_f32 v61, v61, v53
  v_cvt_pk_bf16_f32 v30, v52, v53
  v_exp_f32 v55, v255
  v_add_f32 v61, v61, v54
  v_add_f32 v61, v61, v55
  v_cvt_pk_bf16_f32 v31, v54, v55
  buffer_load_dwordx4 v2, s[20:23], s49 offen offset:3072 sc1 lds
  s_add_u32 s46, s46, s62
  s_cmp_eq_u32 s46, s63
  s_cselect_b32 s46, 0, s46
  v_cmp_lt_f32 vcc, s51, v61
  s_nop 0
  s_cbranch_vccnz fix_55
cont_56:
  v_add_f32 v60, v60, v61
  s_waitcnt lgkmcnt(0)
  v_mfma_f32_32x32x16_bf16 v[64:79], v[192:195], v[24:27], v[64:79]
  v_mov_b32 v56, v60
  s_nop 0
  s_nop 0
  v_permlane32_swap_b32 v56, v60
  v_add_f32 v60, v60, v56
  v_mfma_f32_32x32x16_bf16 v[64:79], v[196:199], v[28:31], v[64:79]
  v_rcp_f32 v60, v60
  s_lshl_b32 s55, s42, 18
  s_lshl_b32 s49, s41, 13
  s_add_u32 s55, s55, s49
  v_mfma_f32_32x32x16_bf16 v[80:95], v[200:203], v[24:27], v[80:95]
  v_mfma_f32_32x32x16_bf16 v[80:95], v[204:207], v[28:31], v[80:95]
  s_nop 5
  v_mul_f32 v64, v64, v60
  v_mul_f32 v65, v65, v60
  v_mul_f32 v66, v66, v60
  v_mul_f32 v67, v67, v60
  v_mul_f32 v68, v68, v60
  v_mul_f32 v69, v69, v60
  v_mul_f32 v70, v70, v60
  v_mfma_f32_32x32x16_bf16 v[96:111], v[208:211], v[24:27], v[96:111]
  v_mul_f32 v71, v71, v60
  v_cvt_pk_bf16_f32 v224, v64, v65
  v_cvt_pk_bf16_f32 v225, v66, v67
  v_cvt_pk_bf16_f32 v226, v68, v69
  v_cvt_pk_bf16_f32 v227, v70, v71
  v_mul_f32 v72, v72, v60
  v_mul_f32 v73, v73, v60
  v_mfma_f32_32x32x16_bf16 v[96:111], v[212:215], v[28:31], v[96:111]
  v_mul_f32 v74, v74, v60
  v_mul_f32 v75, v75, v60
  v_mul_f32 v76, v76, v60
  v_mul_f32 v77, v77, v60
  v_mul_f32 v78, v78, v60
  v_mul_f32 v79, v79, v60
  v_cvt_pk_bf16_f32 v228, v72, v73
  v_mfma_f32_32x32x16_bf16 v[112:127], v[216:219], v[24:27], v[112:127]
  v_cvt_pk_bf16_f32 v229, v74, v75
  v_cvt_pk_bf16_f32 v230, v76, v77
  v_cvt_pk_bf16_f32 v231, v78, v79
  v_permlane16_swap_b32 v224, v228
  v_permlane16_swap_b32 v225, v229
  v_permlane16_swap_b32 v226, v230
  v_permlane16_swap_b32 v227, v231
  v_mfma_f32_32x32x16_bf16 v[112:127], v[220:223], v[28:31], v[112:127]
  buffer_store_dwordx4 v[224:227], v2, s[24:27], s55 offen offset:0 sc1
  buffer_store_dwordx4 v[228:231], v2, s[24:27], s55 offen offset:1024 sc1
  v_mul_f32 v80, v80, v60
  v_mul_f32 v81, v81, v60
  v_mul_f32 v82, v82, v60
  v_mul_f32 v83, v83, v60
  v_mul_f32 v84, v84, v60
  v_mul_f32 v85, v85, v60
  v_mul_f32 v86, v86, v60
  v_mul_f32 v87, v87, v60
  v_cvt_pk_bf16_f32 v232, v80, v81
  v_cvt_pk_bf16_f32 v233, v82, v83
  v_cvt_pk_bf16_f32 v234, v84, v85
  v_cvt_pk_bf16_f32 v235, v86, v87
  v_mul_f32 v88, v88, v60
  v_mul_f32 v89, v89, v60
  v_mul_f32 v90, v90, v60
  v_mul_f32 v91, v91, v60
  v_mul_f32 v92, v92, v60
  v_mul_f32 v93, v93, v60
  v_mul_f32 v94, v94, v60
  v_mul_f32 v95, v95, v60
  v_cvt_pk_bf16_f32 v236, v88, v89
  v_cvt_pk_bf16_f32 v237, v90, v91
  v_cvt_pk_bf16_f32 v238, v92, v93
  v_cvt_pk_bf16_f32 v239, v94, v95
  v_permlane16_swap_b32 v232, v236
  v_permlane16_swap_b32 v233, v237
  v_permlane16_swap_b32 v234, v238
  v_permlane16_swap_b32 v235, v239
  buffer_store_dwordx4 v[232:235], v2, s[24:27], s55 offen offset:2048 sc1
  buffer_store_dwordx4 v[236:239], v2, s[24:27], s55 offen offset:3072 sc1
  v_mul_f32 v96, v96, v60
  v_mul_f32 v97, v97, v60
  v_mul_f32 v98, v98, v60
  v_mul_f32 v99, v99, v60
  v_mul_f32 v100, v100, v60
  v_mul_f32 v101, v101, v60
  v_mul_f32 v102, v102, v60
  v_mul_f32 v103, v103, v60
  v_cvt_pk_bf16_f32 v240, v96, v97
  v_cvt_pk_bf16_f32 v241, v98, v99
  v_cvt_pk_bf16_f32 v242, v100, v101
  v_cvt_pk_bf16_f32 v243, v102, v103
  s_add_u32 s55, s55, 4096
  v_mul_f32 v104, v104, v60
  v_mul_f32 v105, v105, v60
  v_mul_f32 v106, v106, v60
  v_mul_f32 v107, v107, v60
  v_mul_f32 v108, v108, v60
  v_mul_f32 v109, v109, v60
  v_mul_f32 v110, v110, v60
  v_mul_f32 v111, v111, v60
  v_cvt_pk_bf16_f32 v244, v104, v105
  v_cvt_pk_bf16_f32 v245, v106, v107
  v_cvt_pk_bf16_f32 v246, v108, v109
  v_cvt_pk_bf16_f32 v247, v110, v111
  v_permlane16_swap_b32 v240, v244
  v_permlane16_swap_b32 v241, v245
  v_permlane16_swap_b32 v242, v246
  v_permlane16_swap_b32 v243, v247
  buffer_store_dwordx4 v[240:243], v2, s[24:27], s55 offen offset:0 sc1
  buffer_store_dwordx4 v[244:247], v2, s[24:27], s55 offen offset:1024 sc1
  v_mul_f32 v112, v112, v60
  v_mul_f32 v113, v113, v60
  v_mul_f32 v114, v114, v60
  v_mul_f32 v115, v115, v60
  v_mul_f32 v116, v116, v60
  v_mul_f32 v117, v117, v60
  v_mul_f32 v118, v118, v60
  v_mul_f32 v119, v119, v60
  v_cvt_pk_bf16_f32 v248, v112, v113
  v_cvt_pk_bf16_f32 v249, v114, v115
  v_cvt_pk_bf16_f32 v250, v116, v117
  v_cvt_pk_bf16_f32 v251, v118, v119
  v_mul_f32 v120, v120, v60
  v_mul_f32 v121, v121, v60
  v_mul_f32 v122, v122, v60
  v_mul_f32 v123, v123, v60
  v_mul_f32 v124, v124, v60
  v_mul_f32 v125, v125, v60
  v_mul_f32 v126, v126, v60
  v_mul_f32 v127, v127, v60
  v_cvt_pk_bf16_f32 v252, v120, v121
  v_cvt_pk_bf16_f32 v253, v122, v123
  v_cvt_pk_bf16_f32 v254, v124, v125
  v_cvt_pk_bf16_f32 v255, v126, v127
  v_permlane16_swap_b32 v248, v252
  v_permlane16_swap_b32 v249, v253
  v_permlane16_swap_b32 v250, v254
  v_permlane16_swap_b32 v251, v255
  buffer_store_dwordx4 v[248:251], v2, s[24:27], s55 offen offset:2048 sc1
  buffer_store_dwordx4 v[252:255], v2, s[24:27], s55 offen offset:3072 sc1
  s_branch fused_kernel_lo_ost
fused_kernel_lo:
  s_cmp_ge_u32 s2, 224
  s_cbranch_scc1 fused_kernel_lo32
  s_setprio 1
  s_waitcnt vmcnt(16)
  s_barrier
  ds_read_b128 v[160:163], v3 offset:0
  ds_read_b128 v[168:171], v3 offset:2048
  ds_read_b128 v[176:179], v3 offset:4096
  ds_read_b128 v[184:187], v3 offset:6144
  ds_read_b128 v[164:167], v3 offset:1024
  ds_read_b128 v[172:175], v3 offset:3072
  ds_read_b128 v[180:183], v3 offset:5120
  ds_read_b128 v[188:191], v3 offset:7168
  ds_read_b128 v[192:195], v3 offset:8192
  ds_read_b128 v[200:203], v3 offset:10240
  ds_read_b128 v[208:211], v3 offset:12288
  ds_read_b128 v[216:219], v3 offset:14336
  ds_read_b128 v[196:199], v3 offset:9216
  ds_read_b128 v[204:207], v3 offset:11264
  ds_read_b128 v[212:215], v3 offset:13312
  ds_read_b128 v[220:223], v3 offset:15360
  v_mov_b32 v24, 0
  v_mov_b32 v25, 0
  v_mov_b32 v26, 0
  v_mov_b32 v27, 0
  v_and_b32 v62, 15, v1
  v_lshrrev_b32 v5, 4, v1
  v_lshlrev_b32 v5, 2, v5
  v_sub_u32 v62, v62, v5
  s_and_b32 s53, s42, 1
  s_lshl_b32 s53, s53, 5
  v_add_u32 v62, s53, v62
  s_waitcnt lgkmcnt(12)
  v_mfma_f32_16x16x32_bf16 v[224:227], v[160:163], v[128:131], 0
  v_mfma_f32_16x16x32_bf16 v[224:227], v[168:171], v[136:139], v[224:227]
  v_mfma_f32_16x16x32_bf16 v[224:227], v[176:179], v[144:147], v[224:227]
  v_mfma_f32_16x16x32_bf16 v[224:227], v[184:187], v[152:155], v[224:227]
  v_mfma_f32_16x16x32_bf16 v[228:231], v[160:163], v[132:135], 0
  v_mfma_f32_16x16x32_bf16 v[228:231], v[168:171], v[140:143], v[228:231]
  v_mfma_f32_16x16x32_bf16 v[228:231], v[176:179], v[148:151], v[228:231]
  v_mfma_f32_16x16x32_bf16 v[228:231], v[184:187], v[156:159], v[228:231]
  s_waitcnt lgkmcnt(8)
  v_mfma_f32_16x16x32_bf16 v[232:235], v[164:167], v[128:131], 0
  v_mfma_f32_16x16x32_bf16 v[232:235], v[172:175], v[136:139], v[232:235]
  v_mfma_f32_16x16x32_bf16 v[232:235], v[180:183], v[144:147], v[232:235]
  v_mfma_f32_16x16x32_bf16 v[232:235], v[188:191], v[152:155], v[232:235]
  v_mfma_f32_16x16x32_bf16 v[236:239], v[164:167], v[132:135], 0
  v_mfma_f32_16x16x32_bf16 v[236:239], v[172:175], v[140:143], v[236:239]
  v_mfma_f32_16x16x32_bf16 v[236:239], v[180:183], v[148:151], v[236:239]
  v_mfma_f32_16x16x32_bf16 v[236:239], v[188:191], v[156:159], v[236:239]
  v_mfma_f32_32x32x16_bf16 v[64:79], v[24:27], v[24:27], 0
  v_mfma_f32_32x32x16_bf16 v[80:95], v[24:27], v[24:27], 0
  v_mfma_f32_32x32x16_bf16 v[96:111], v[24:27], v[24:27], 0
  v_mfma_f32_32x32x16_bf16 v[112:127], v[24:27], v[24:27], 0
  s_add_u32 s45, s45, s62
  s_cmp_eq_u32 s45, s63
  s_cselect_b32 s45, 0, s45
  s_nop 2
  s_cmp_lg_u32 s43, 0
  s_cbranch_scc1 mk_57
  v_cmp_gt_i32 s[56:57], 0, v62
  v_cmp_gt_i32 s[58:59], 1, v62
  v_cmp_gt_i32 s[60:61], 2, v62
  v_cmp_gt_i32 s[38:39], 3, v62
  v_cndmask_b32 v224, v224, v63, s[56:57]
  v_cndmask_b32 v225, v225, v63, s[58:59]
  v_cndmask_b32 v226, v226, v63, s[60:61]
  v_cndmask_b32 v227, v227, v63, s[38:39]
  v_cmp_gt_i32 s[56:57], -16, v62
  v_cmp_gt_i32 s[58:59], -15, v62
  v_cmp_gt_i32 s[60:61], -14, v62
  v_cmp_gt_i32 s[38:39], -13, v62
  v_cndmask_b32 v228, v228, v63, s[56:57]
  v_cndmask_b32 v229, v229, v63, s[58:59]
  v_cndmask_b32 v230, v230, v63, s[60:61]
  v_cndmask_b32 v231, v231, v63, s[38:39]
  v_cmp_gt_i32 s[56:57], 16, v62
  v_cmp_gt_i32 s[58:59], 17, v62
  v_cmp_gt_i32 s[60:61], 18, v62
  v_cmp_gt_i32 s[38:39], 19, v62
  v_cndmask_b32 v232, v232, v63, s[56:57]
  v_cndmask_b32 v233, v233, v63, s[58:59]
  v_cndmask_b32 v234, v234, v63, s[60:61]
  v_cndmask_b32 v235, v235, v63, s[38:39]
  v_cmp_gt_i32 s[56:57], 0, v62
  v_cmp_gt_i32 s[58:59], 1, v62
  v_cmp_gt_i32 s[60:61], 2, v62
  v_cmp_gt_i32 s[38:39], 3, v62
  v_cndmask_b32 v236, v236, v63, s[56:57]
  v_cndmask_b32 v237, v237, v63, s[58:59]
  v_cndmask_b32 v238, v238, v63, s[60:61]
  v_cndmask_b32 v239, v239, v63, s[38:39]
mk_57:
  v_max3_f32 v56, v224, v225, v226
  v_max3_f32 v57, v228, v229, v230
  v_max3_f32 v56, v56, v227, v232
  v_max3_f32 v57, v57, v231, v236
  v_max3_f32 v56, v56, v233, v234
  v_max3_f32 v57, v57, v237, v238
  v_max_f32 v56, v56, v235
  v_max_f32 v57, v57, v239
  s_nop 1
  v_permlane16_swap_b32 v56, v57
  v_max_f32 v56, v56, v57
  v_mov_b32 v57, v56
  s_nop 1
  v_permlane32_swap_b32 v57, v56
  v_max_f32 v56, v56, v57
  v_mov_b32 v57, v56
  s_nop 1
  v_permlane16_swap_b32 v56, v57
  v_sub_f32 v32, 0, v56
  v_sub_f32 v33, 0, v56
  v_sub_f32 v34, 0, v56
  v_sub_f32 v35, 0, v56
  v_sub_f32 v36, 0, v57
  v_sub_f32 v37, 0, v57
  v_sub_f32 v38, 0, v57
  v_sub_f32 v39, 0, v57
  s_waitcnt lgkmcnt(0)
  v_mfma_f32_16x16x32_bf16 v[240:243], v[192:195], v[128:131], v[32:35]
  v_add_u32 v3, s45, v2
  s_cmp_eq_u32 s43, 0
  s_cselect_b32 s53, 0x4000, 0
  v_add_u32 v59, s53, v3
  ds_read_b128 v[160:163], v59 offset:0
  ds_read_b128 v[168:171], v59 offset:2048
  ds_read_b128 v[176:179], v59 offset:4096
  ds_read_b128 v[184:187], v59 offset:6144
  ds_read_b128 v[164:167], v59 offset:1024
  ds_read_b128 v[172:175], v59 offset:3072
  ds_read_b128 v[180:183], v59 offset:5120
  ds_read_b128 v[188:191], v59 offset:7168
  v_sub_f32 v224, v224, v56
  v_sub_f32 v225, v225, v56
  v_sub_f32 v226, v226, v56
  v_sub_f32 v227, v227, v56
  v_mfma_f32_16x16x32_bf16 v[240:243], v[200:203], v[136:139], v[240:243]
  v_exp_f32 v48, v224
  v_sub_f32 v228, v228, v57
  v_exp_f32 v49, v225
  v_sub_f32 v229, v229, v57
  v_mfma_f32_16x16x32_bf16 v[240:243], v[208:211], v[144:147], v[240:243]
  s_cmp_lt_u32 s47, s48
  s_cselect_b32 s49, s47, s54
  s_add_u32 m0, s46, s52
  s_add_u32 s47, s47, s62
  buffer_load_dwordx4 v2, s[20:23], s49 offen offset:0 sc1 lds
  v_exp_f32 v50, v226
  v_sub_f32 v230, v230, v57
  v_add_f32 v40, v48, v49
  v_cvt_pk_bf16_f32 v16, v48, v49
  v_mfma_f32_16x16x32_bf16 v[240:243], v[216:219], v[152:155], v[240:243]
  v_exp_f32 v51, v227
  v_sub_f32 v231, v231, v57
  v_add_f32 v40, v40, v50
  v_exp_f32 v52, v228
  v_mfma_f32_16x16x32_bf16 v[244:247], v[192:195], v[132:135], v[36:39]
  buffer_load_dwordx4 v2, s[20:23], s49 offen offset:1024 sc1 lds
  v_sub_f32 v232, v232, v56
  v_add_f32 v40, v40, v51
  v_cvt_pk_bf16_f32 v17, v50, v51
  v_exp_f32 v53, v229
  v_mfma_f32_16x16x32_bf16 v[244:247], v[200:203], v[140:143], v[244:247]
  v_sub_f32 v233, v233, v56
  v_exp_f32 v54, v230
  v_sub_f32 v234, v234, v56
  v_add_f32 v41, v52, v53
  v_mfma_f32_16x16x32_bf16 v[244:247], v[208:211], v[148:151], v[244:247]
  buffer_load_dwordx4 v2, s[20:23], s49 offen offset:2048 sc1 lds
  v_cvt_pk_bf16_f32 v20, v52, v53
  v_exp_f32 v55, v231
  v_sub_f32 v235, v235, v56
  v_add_f32 v41, v41, v54
  v_mfma_f32_16x16x32_bf16 v[244:247], v[216:219], v[156:159], v[244:247]
  v_exp_f32 v48, v232
  v_sub_f32 v236, v236, v57
  v_add_f32 v41, v41, v55
  v_cvt_pk_bf16_f32 v21, v54, v55
  v_mfma_f32_16x16x32_bf16 v[248:251], v[196:199], v[128:131], v[32:35]
  buffer_load_dwordx4 v2, s[20:23], s49 offen offset:3072 sc1 lds
  v_exp_f32 v49, v233
  v_sub_f32 v237, v237, v57
  v_add_f32 v40, v40, v48
  v_exp_f32 v50, v234
  v_mfma_f32_16x16x32_bf16 v[248:251], v[204:207], v[136:139], v[248:251]
  v_sub_f32 v238, v238, v57
  v_add_f32 v40, v40, v49
  v_cvt_pk_bf16_f32 v18, v48, v49
  v_exp_f32 v51, v235
  v_mfma_f32_16x16x32_bf16 v[248:251], v[212:215], v[144:147], v[248:251]
  v_sub_f32 v239, v239, v57
  v_add_f32 v40, v40, v50
  v_exp_f32 v52, v236
  v_add_f32 v40, v40, v51
  v_mfma_f32_16x16x32_bf16 v[248:251], v[220:223], v[152:155], v[248:251]
  v_cvt_pk_bf16_f32 v19, v50, v51
  v_exp_f32 v53, v237
  v_add_f32 v41, v41, v52
  v_exp_f32 v54, v238
  v_mfma_f32_16x16x32_bf16 v[252:255], v[196:199], v[132:135], v[36:39]
  v_add_f32 v41, v41, v53
  v_cvt_pk_bf16_f32 v22, v52, v53
  v_exp_f32 v55, v239
  v_add_f32 v41, v41, v54
  v_mfma_f32_16x16x32_bf16 v[252:255], v[204:207], v[140:143], v[252:255]
  v_add_f32 v41, v41, v55
  v_cvt_pk_bf16_f32 v23, v54, v55
  v_mfma_f32_16x16x32_bf16 v[252:255], v[212:215], v[148:151], v[252:255]
  v_mfma_f32_16x16x32_bf16 v[252:255], v[220:223], v[156:159], v[252:255]
  v_mov_b32 v60, v40
  v_mov_b32 v61, v41
  s_nop 3
  s_waitcnt lgkmcnt(0)
  s_cmp_eq_u32 s43, 0
  s_cbranch_scc1 fused_kernel_lo_tail
  s_cmp_eq_u32 s43, 1
  s_cbranch_scc1 fused_kernel_lo_last
  s_sub_u32 s50, s43, 1
.p2align 6
fused_kernel_lo_loop:
  v_mfma_f32_16x16x32_bf16 v[224:227], v[160:163], v[128:131], v[32:35]
  v_exp_f32_e64 v48, v240
  ds_read_b128 v[192:195], v3 offset:16384
  v_mfma_f32_16x16x32_bf16 v[224:227], v[168:171], v[136:139], v[224:227]
  ds_read_b128 v[196:199], v3 offset:17408
  v_mfma_f32_16x16x32_bf16 v[224:227], v[176:179], v[144:147], v[224:227]
  v_exp_f32_e64 v49, v241
  ds_read_b128 v[200:203], v3 offset:18432
  v_mfma_f32_16x16x32_bf16 v[224:227], v[184:187], v[152:155], v[224:227]
  v_add_f32_e64 v40, v48, v49
  v_cvt_pk_bf16_f32 v24, v48, v49
  ds_read_b128 v[204:207], v3 offset:19456
  v_mfma_f32_16x16x32_bf16 v[228:231], v[160:163], v[132:135], v[36:39]
  v_exp_f32_e64 v50, v242
  ds_read_b128 v[208:211], v3 offset:20480
  v_mfma_f32_16x16x32_bf16 v[228:231], v[168:171], v[140:143], v[228:231]
  v_add_f32_e64 v40, v40, v50
  ds_read_b128 v[212:215], v3 offset:21504
  v_mfma_f32_16x16x32_bf16 v[228:231], v[176:179], v[148:151], v[228:231]
  v_exp_f32_e64 v51, v243
  ds_read_b128 v[216:219], v3 offset:22528
  v_mfma_f32_16x16x32_bf16 v[228:231], v[184:187], v[156:159], v[228:231]
  v_add_f32_e64 v40, v40, v51
  v_cvt_pk_bf16_f32 v25, v50, v51
  ds_read_b128 v[220:223], v3 offset:23552
  v_mfma_f32_16x16x32_bf16 v[232:235], v[164:167], v[128:131], v[32:35]
  v_exp_f32_e64 v52, v244
  v_mfma_f32_16x16x32_bf16 v[232:235], v[172:175], v[136:139], v[232:235]
  s_add_u32 m0, m0, 0x4000
  s_sub_u32 s49, s49, 0x4000
  buffer_load_dwordx4 v2, s[20:23], s49 offen offset:0 sc1 lds
  v_mfma_f32_16x16x32_bf16 v[232:235], v[180:183], v[144:147], v[232:235]
  v_exp_f32_e64 v53, v245
  v_mfma_f32_16x16x32_bf16 v[232:235], v[188:191], v[152:155], v[232:235]
  v_add_f32_e64 v41, v52, v53
  v_cvt_pk_bf16_f32 v28, v52, v53
  buffer_load_dwordx4 v2, s[20:23], s49 offen offset:1024 sc1 lds
  v_mfma_f32_16x16x32_bf16 v[236:239], v[164:167], v[132:135], v[36:39]
  v_exp_f32_e64 v54, v246
  v_mfma_f32_16x16x32_bf16 v[236:239], v[172:175], v[140:143], v[236:239]
  v_add_f32_e64 v41, v41, v54
  buffer_load_dwordx4 v2, s[20:23], s49 offen offset:2048 sc1 lds
  v_mfma_f32_16x16x32_bf16 v[236:239], v[180:183], v[148:151], v[236:239]
  v_exp_f32_e64 v55, v247
  v_mfma_f32_16x16x32_bf16 v[236:239], v[188:191], v[156:159], v[236:239]
  v_add_f32_e64 v41, v41, v55
  v_cvt_pk_bf16_f32 v29, v54, v55
  buffer_load_dwordx4 v2, s[20:23], s49 offen offset:3072 sc1 lds
  s_add_u32 s46, s46, s62
  s_cmp_eq_u32 s46, s63
  s_cselect_b32 s46, 0, s46
  s_waitcnt lgkmcnt(0)
  v_mfma_f32_16x16x32_bf16 v[64:67], v[192:195], v[16:19], v[64:67]
  v_exp_f32 v48, v248
  s_nop 0
  v_add_f32 v40, v40, v48
  ds_read_b128 v[160:163], v3 offset:8192
  v_mfma_f32_16x16x32_bf16 v[68:71], v[192:195], v[20:23], v[68:71]
  v_exp_f32_e64 v49, v249
  ds_read_b128 v[168:171], v3 offset:10240
  v_mfma_f32_16x16x32_bf16 v[72:75], v[196:199], v[16:19], v[72:75]
  v_add_f32_e64 v40, v40, v49
  v_cvt_pk_bf16_f32 v26, v48, v49
  ds_read_b128 v[176:179], v3 offset:12288
  v_mfma_f32_16x16x32_bf16 v[76:79], v[196:199], v[20:23], v[76:79]
  v_exp_f32_e64 v50, v250
  ds_read_b128 v[184:187], v3 offset:14336
  v_mfma_f32_16x16x32_bf16 v[80:83], v[200:203], v[16:19], v[80:83]
  v_add_f32_e64 v40, v40, v50
  ds_read_b128 v[164:167], v3 offset:9216
  v_mfma_f32_16x16x32_bf16 v[84:87], v[200:203], v[20:23], v[84:87]
  v_exp_f32_e64 v51, v251
  ds_read_b128 v[172:175], v3 offset:11264
  v_mfma_f32_16x16x32_bf16 v[88:91], v[204:207], v[16:19], v[88:91]
  v_add_f32_e64 v40, v40, v51
  v_cvt_pk_bf16_f32 v27, v50, v51
  ds_read_b128 v[180:183], v3 offset:13312
  v_mfma_f32_16x16x32_bf16 v[92:95], v[204:207], v[20:23], v[92:95]
  v_exp_f32_e64 v52, v252
  ds_read_b128 v[188:191], v3 offset:15360
  v_mfma_f32_16x16x32_bf16 v[96:99], v[208:211], v[16:19], v[96:99]
  v_add_f32_e64 v41, v41, v52
  v_mfma_f32_16x16x32_bf16 v[100:103], v[208:211], v[20:23], v[100:103]
  v_exp_f32_e64 v53, v253
  v_mfma_f32_16x16x32_bf16 v[104:107], v[212:215], v[16:19], v[104:107]
  v_add_f32_e64 v41, v41, v53
  v_cvt_pk_bf16_f32 v30, v52, v53
  v_mfma_f32_16x16x32_bf16 v[108:111], v[212:215], v[20:23], v[108:111]
  v_exp_f32 v54, v254
  s_add_u32 s45, s45, s62
  v_mfma_f32_16x16x32_bf16 v[112:115], v[216:219], v[16:19], v[112:115]
  v_add_f32_e64 v41, v41, v54
  v_mfma_f32_16x16x32_bf16 v[116:119], v[216:219], v[20:23], v[116:119]
  v_exp_f32_e64 v55, v255
  s_cmp_eq_u32 s45, s63
  s_cselect_b32 s45, 0, s45
  v_mfma_f32_16x16x32_bf16 v[120:123], v[220:223], v[16:19], v[120:123]
  v_add_f32_e64 v41, v41, v55
  v_cvt_pk_bf16_f32 v31, v54, v55
  v_mfma_f32_16x16x32_bf16 v[124:127], v[220:223], v[20:23], v[124:127]
  v_max_f32 v59, v40, v41
  v_cmp_lt_f32 vcc, s51, v59
  s_cbranch_vccnz fix_58
cont_59:
  v_add_f32 v60, v60, v40
  v_add_f32 v61, v61, v41
  s_waitcnt lgkmcnt(0)
  v_mfma_f32_16x16x32_bf16 v[240:243], v[160:163], v[128:131], v[32:35]
  v_exp_f32_e64 v48, v224
  ds_read_b128 v[192:195], v3 offset:24576
  v_mfma_f32_16x16x32_bf16 v[240:243], v[168:171], v[136:139], v[240:243]
  ds_read_b128 v[196:199], v3 offset:25600
  v_mfma_f32_16x16x32_bf16 v[240:243], v[176:179], v[144:147], v[240:243]
  v_exp_f32_e64 v49, v225
  ds_read_b128 v[200:203], v3 offset:26624
  v_mfma_f32_16x16x32_bf16 v[240:243], v[184:187], v[152:155], v[240:243]
  v_add_f32_e64 v40, v48, v49
  v_cvt_pk_bf16_f32 v16, v48, v49
  ds_read_b128 v[204:207], v3 offset:27648
  v_mfma_f32_16x16x32_bf16 v[244:247], v[160:163], v[132:135], v[36:39]
  v_exp_f32_e64 v50, v226
  ds_read_b128 v[208:211], v3 offset:28672
  v_mfma_f32_16x16x32_bf16 v[244:247], v[168:171], v[140:143], v[244:247]
  v_add_f32_e64 v40, v40, v50
  ds_read_b128 v[212:215], v3 offset:29696
  v_mfma_f32_16x16x32_bf16 v[244:247], v[176:179], v[148:151], v[244:247]
  v_exp_f32_e64 v51, v227
  ds_read_b128 v[216:219], v3 offset:30720
  v_mfma_f32_16x16x32_bf16 v[244:247], v[184:187], v[156:159], v[244:247]
  v_add_f32_e64 v40, v40, v51
  v_cvt_pk_bf16_f32 v17, v50, v51
  ds_read_b128 v[220:223], v3 offset:31744
  v_mfma_f32_16x16x32_bf16 v[248:251], v[164:167], v[128:131], v[32:35]
  v_exp_f32_e64 v52, v228
  v_mfma_f32_16x16x32_bf16 v[248:251], v[172:175], v[136:139], v[248:251]
  v_add_u32_e64 v3, s45, v2
  v_mfma_f32_16x16x32_bf16 v[248:251], v[180:183], v[144:147], v[248:251]
  v_exp_f32_e64 v53, v229
  v_mfma_f32_16x16x32_bf16 v[248:251], v[188:191], v[152:155], v[248:251]
  v_add_f32_e64 v41, v52, v53
  v_cvt_pk_bf16_f32 v20, v52, v53
  v_mfma_f32_16x16x32_bf16 v[252:255], v[164:167], v[132:135], v[36:39]
  v_exp_f32_e64 v54, v230
  v_mfma_f32_16x16x32_bf16 v[252:255], v[172:175], v[140:143], v[252:255]
  v_add_f32_e64 v41, v41, v54
  v_mfma_f32_16x16x32_bf16 v[252:255], v[180:183], v[148:151], v[252:255]
  v_exp_f32_e64 v55, v231
  v_mfma_f32_16x16x32_bf16 v[252:255], v[188:191], v[156:159], v[252:255]
  v_add_f32_e64 v41, v41, v55
  v_cvt_pk_bf16_f32 v21, v54, v55
  s_waitcnt lgkmcnt(0)
  v_mfma_f32_16x16x32_bf16 v[64:67], v[192:195], v[24:27], v[64:67]
  s_waitcnt vmcnt(16)
  s_barrier
  v_exp_f32_e64 v48, v232
  s_nop 0
  v_add_f32 v40, v40, v48
  ds_read_b128 v[160:163], v3 offset:0
  v_mfma_f32_16x16x32_bf16 v[68:71], v[192:195], v[28:31], v[68:71]
  v_exp_f32_e64 v49, v233
  ds_read_b128 v[168:171], v3 offset:2048
  v_mfma_f32_16x16x32_bf16 v[72:75], v[196:199], v[24:27], v[72:75]
  v_add_f32_e64 v40, v40, v49
  v_cvt_pk_bf16_f32 v18, v48, v49
  ds_read_b128 v[176:179], v3 offset:4096
  v_mfma_f32_16x16x32_bf16 v[76:79], v[196:199], v[28:31], v[76:79]
  v_exp_f32_e64 v50, v234
  ds_read_b128 v[184:187], v3 offset:6144
  v_mfma_f32_16x16x32_bf16 v[80:83], v[200:203], v[24:27], v[80:83]
  v_add_f32_e64 v40, v40, v50
  ds_read_b128 v[164:167], v3 offset:1024
  v_mfma_f32_16x16x32_bf16 v[84:87], v[200:203], v[28:31], v[84:87]
  v_exp_f32_e64 v51, v235
  ds_read_b128 v[172:175], v3 offset:3072
  v_mfma_f32_16x16x32_bf16 v[88:91], v[204:207], v[24:27], v[88:91]
  v_add_f32_e64 v40, v40, v51
  v_cvt_pk_bf16_f32 v19, v50, v51
  ds_read_b128 v[180:183], v3 offset:5120
  v_mfma_f32_16x16x32_bf16 v[92:95], v[204:207], v[28:31], v[92:95]
  v_exp_f32_e64 v52, v236
  ds_read_b128 v[188:191], v3 offset:7168
  v_mfma_f32_16x16x32_bf16 v[96:99], v[208:211], v[24:27], v[96:99]
  v_add_f32_e64 v41, v41, v52
  v_mfma_f32_16x16x32_bf16 v[100:103], v[208:211], v[28:31], v[100:103]
  v_exp_f32_e64 v53, v237
  s_cmp_lt_u32 s47, s48
  s_cselect_b32 s49, s47, s54
  s_add_u32 m0, s46, s52
  s_add_u32 s47, s47, s62
  buffer_load_dwordx4 v2, s[20:23], s49 offen offset:0 sc1 lds
  v_mfma_f32_16x16x32_bf16 v[104:107], v[212:215], v[24:27], v[104:107]
  v_add_f32_e64 v41, v41, v53
  v_cvt_pk_bf16_f32 v22, v52, v53
  v_mfma_f32_16x16x32_bf16 v[108:111], v[212:215], v[28:31], v[108:111]
  v_exp_f32_e64 v54, v238
  buffer_load_dwordx4 v2, s[20:23], s49 offen offset:1024 sc1 lds
  v_mfma_f32_16x16x32_bf16 v[112:115], v[216:219], v[24:27], v[112:115]
  v_add_f32_e64 v41, v41, v54
  v_mfma_f32_16x16x32_bf16 v[116:119], v[216:219], v[28:31], v[116:119]
  v_exp_f32_e64 v55, v239
  buffer_load_dwordx4 v2, s[20:23], s49 offen offset:2048 sc1 lds
  v_mfma_f32_16x16x32_bf16 v[120:123], v[220:223], v[24:27], v[120:123]
  v_add_f32_e64 v41, v41, v55
  v_cvt_pk_bf16_f32 v23, v54, v55
  v_mfma_f32_16x16x32_bf16 v[124:127], v[220:223], v[28:31], v[124:127]
  v_max_f32 v59, v40, v41
  v_cmp_lt_f32 vcc, s51, v59
  buffer_load_dwordx4 v2, s[20:23], s49 offen offset:3072 sc1 lds
  s_sub_u32 s50, s50, 1
  s_cmp_lg_u32 s50, 0
  s_cbranch_vccnz fix_60
cont_61:
  v_add_f32 v60, v60, v40
  v_add_f32 v61, v61, v41
  s_waitcnt lgkmcnt(0)
  s_cbranch_scc1 fused_kernel_lo_loop
.p2align 3
fused_kernel_lo_last:
  v_mfma_f32_16x16x32_bf16 v[224:227], v[160:163], v[128:131], v[32:35]
  v_exp_f32_e64 v48, v240
  ds_read_b128 v[192:195], v3 offset:16384
  v_mfma_f32_16x16x32_bf16 v[224:227], v[168:171], v[136:139], v[224:227]
  ds_read_b128 v[196:199], v3 offset:17408
  v_mfma_f32_16x16x32_bf16 v[224:227], v[176:179], v[144:147], v[224:227]
  v_exp_f32_e64 v49, v241
  ds_read_b128 v[200:203], v3 offset:18432
  v_mfma_f32_16x16x32_bf16 v[224:227], v[184:187], v[152:155], v[224:227]
  v_add_f32_e64 v40, v48, v49
  v_cvt_pk_bf16_f32 v24, v48, v49
  ds_read_b128 v[204:207], v3 offset:19456
  v_mfma_f32_16x16x32_bf16 v[228:231], v[160:163], v[132:135], v[36:39]
  v_exp_f32_e64 v50, v242
  ds_read_b128 v[208:211], v3 offset:20480
  v_mfma_f32_16x16x32_bf16 v[228:231], v[168:171], v[140:143], v[228:231]
  v_add_f32_e64 v40, v40, v50
  ds_read_b128 v[212:215], v3 offset:21504
  v_mfma_f32_16x16x32_bf16 v[228:231], v[176:179], v[148:151], v[228:231]
  v_exp_f32_e64 v51, v243
  ds_read_b128 v[216:219], v3 offset:22528
  v_mfma_f32_16x16x32_bf16 v[228:231], v[184:187], v[156:159], v[228:231]
  v_add_f32_e64 v40, v40, v51
  v_cvt_pk_bf16_f32 v25, v50, v51
  ds_read_b128 v[220:223], v3 offset:23552
  v_mfma_f32_16x16x32_bf16 v[232:235], v[164:167], v[128:131], v[32:35]
  v_exp_f32_e64 v52, v244
  v_mfma_f32_16x16x32_bf16 v[232:235], v[172:175], v[136:139], v[232:235]
  s_add_u32 m0, m0, 0x4000
  s_sub_u32 s49, s49, 0x4000
  buffer_load_dwordx4 v2, s[20:23], s49 offen offset:0 sc1 lds
  v_mfma_f32_16x16x32_bf16 v[232:235], v[180:183], v[144:147], v[232:235]
  v_exp_f32_e64 v53, v245
  v_mfma_f32_16x16x32_bf16 v[232:235], v[188:191], v[152:155], v[232:235]
  v_add_f32_e64 v41, v52, v53
  v_cvt_pk_bf16_f32 v28, v52, v53
  buffer_load_dwordx4 v2, s[20:23], s49 offen offset:1024 sc1 lds
  v_mfma_f32_16x16x32_bf16 v[236:239], v[164:167], v[132:135], v[36:39]
  v_exp_f32_e64 v54, v246
  v_mfma_f32_16x16x32_bf16 v[236:239], v[172:175], v[140:143], v[236:239]
  v_add_f32_e64 v41, v41, v54
  buffer_load_dwordx4 v2, s[20:23], s49 offen offset:2048 sc1 lds
  v_mfma_f32_16x16x32_bf16 v[236:239], v[180:183], v[148:151], v[236:239]
  v_exp_f32_e64 v55, v247
  v_mfma_f32_16x16x32_bf16 v[236:239], v[188:191], v[156:159], v[236:239]
  v_add_f32_e64 v41, v41, v55
  v_cvt_pk_bf16_f32 v29, v54, v55
  buffer_load_dwordx4 v2, s[20:23], s49 offen offset:3072 sc1 lds
  s_add_u32 s46, s46, s62
  s_cmp_eq_u32 s46, s63
  s_cselect_b32 s46, 0, s46
  s_waitcnt lgkmcnt(0)
  v_mfma_f32_16x16x32_bf16 v[64:67], v[192:195], v[16:19], v[64:67]
  v_exp_f32 v48, v248
  s_nop 0
  v_add_f32 v40, v40, v48
  ds_read_b128 v[160:163], v3 offset:8192
  v_mfma_f32_16x16x32_bf16 v[68:71], v[192:195], v[20:23], v[68:71]
  v_exp_f32_e64 v49, v249
  ds_read_b128 v[168:171], v3 offset:10240
  v_mfma_f32_16x16x32_bf16 v[72:75], v[196:199], v[16:19], v[72:75]
  v_add_f32_e64 v40, v40, v49
  v_cvt_pk_bf16_f32 v26, v48, v49
  ds_read_b128 v[176:179], v3 offset:12288
  v_mfma_f32_16x16x32_bf16 v[76:79], v[196:199], v[20:23], v[76:79]
  v_exp_f32_e64 v50, v250
  ds_read_b128 v[184:187], v3 offset:14336
  v_mfma_f32_16x16x32_bf16 v[80:83], v[200:203], v[16:19], v[80:83]
  v_add_f32_e64 v40, v40, v50
  ds_read_b128 v[164:167], v3 offset:9216
  v_mfma_f32_16x16x32_bf16 v[84:87], v[200:203], v[20:23], v[84:87]
  v_exp_f32_e64 v51, v251
  ds_read_b128 v[172:175], v3 offset:11264
  v_mfma_f32_16x16x32_bf16 v[88:91], v[204:207], v[16:19], v[88:91]
  v_add_f32_e64 v40, v40, v51
  v_cvt_pk_bf16_f32 v27, v50, v51
  ds_read_b128 v[180:183], v3 offset:13312
  v_mfma_f32_16x16x32_bf16 v[92:95], v[204:207], v[20:23], v[92:95]
  v_exp_f32_e64 v52, v252
  ds_read_b128 v[188:191], v3 offset:15360
  v_mfma_f32_16x16x32_bf16 v[96:99], v[208:211], v[16:19], v[96:99]
  v_add_f32_e64 v41, v41, v52
  v_mfma_f32_16x16x32_bf16 v[100:103], v[208:211], v[20:23], v[100:103]
  v_exp_f32_e64 v53, v253
  v_mfma_f32_16x16x32_bf16 v[104:107], v[212:215], v[16:19], v[104:107]
  v_add_f32_e64 v41, v41, v53
  v_cvt_pk_bf16_f32 v30, v52, v53
  v_mfma_f32_16x16x32_bf16 v[108:111], v[212:215], v[20:23], v[108:111]
  v_exp_f32 v54, v254
  s_add_u32 s45, s45, s62
  v_mfma_f32_16x16x32_bf16 v[112:115], v[216:219], v[16:19], v[112:115]
  v_add_f32_e64 v41, v41, v54
  v_mfma_f32_16x16x32_bf16 v[116:119], v[216:219], v[20:23], v[116:119]
  v_exp_f32_e64 v55, v255
  s_cmp_eq_u32 s45, s63
  s_cselect_b32 s45, 0, s45
  v_mfma_f32_16x16x32_bf16 v[120:123], v[220:223], v[16:19], v[120:123]
  v_add_f32_e64 v41, v41, v55
  v_cvt_pk_bf16_f32 v31, v54, v55
  v_mfma_f32_16x16x32_bf16 v[124:127], v[220:223], v[20:23], v[124:127]
  v_max_f32 v59, v40, v41
  v_cmp_lt_f32 vcc, s51, v59
  s_cbranch_vccnz fix_62
cont_63:
  v_add_f32 v60, v60, v40
  v_add_f32 v61, v61, v41
  s_waitcnt lgkmcnt(0)
  v_mfma_f32_16x16x32_bf16 v[240:243], v[160:163], v[128:131], v[32:35]
  v_cmp_gt_i32 s[56:57], 0, v62
  v_cmp_gt_i32 s[58:59], 1, v62
  v_cmp_gt_i32 s[60:61], 2, v62
  v_cmp_gt_i32 s[38:39], 3, v62
  v_cndmask_b32 v224, v224, v63, s[56:57]
  v_cndmask_b32 v225, v225, v63, s[58:59]
  v_cndmask_b32 v226, v226, v63, s[60:61]
  v_cndmask_b32 v227, v227, v63, s[38:39]
  v_exp_f32_e64 v48, v224
  ds_read_b128 v[192:195], v3 offset:24576
  v_mfma_f32_16x16x32_bf16 v[240:243], v[168:171], v[136:139], v[240:243]
  ds_read_b128 v[196:199], v3 offset:25600
  v_mfma_f32_16x16x32_bf16 v[240:243], v[176:179], v[144:147], v[240:243]
  v_exp_f32_e64 v49, v225
  ds_read_b128 v[200:203], v3 offset:26624
  v_mfma_f32_16x16x32_bf16 v[240:243], v[184:187], v[152:155], v[240:243]
  v_add_f32_e64 v40, v48, v49
  v_cvt_pk_bf16_f32 v16, v48, v49
  ds_read_b128 v[204:207], v3 offset:27648
  v_mfma_f32_16x16x32_bf16 v[244:247], v[160:163], v[132:135], v[36:39]
  v_exp_f32_e64 v50, v226
  ds_read_b128 v[208:211], v3 offset:28672
  v_mfma_f32_16x16x32_bf16 v[244:247], v[168:171], v[140:143], v[244:247]
  v_add_f32_e64 v40, v40, v50
  ds_read_b128 v[212:215], v3 offset:29696
  v_cmp_gt_i32 s[56:57], -16, v62
  v_cmp_gt_i32 s[58:59], -15, v62
  v_cmp_gt_i32 s[60:61], -14, v62
  v_cmp_gt_i32 s[38:39], -13, v62
  v_mfma_f32_16x16x32_bf16 v[244:247], v[176:179], v[148:151], v[244:247]
  v_exp_f32_e64 v51, v227
  ds_read_b128 v[216:219], v3 offset:30720
  v_cndmask_b32 v228, v228, v63, s[56:57]
  v_cndmask_b32 v229, v229, v63, s[58:59]
  v_cndmask_b32 v230, v230, v63, s[60:61]
  v_cndmask_b32 v231, v231, v63, s[38:39]
  v_mfma_f32_16x16x32_bf16 v[244:247], v[184:187], v[156:159], v[244:247]
  v_add_f32_e64 v40, v40, v51
  v_cvt_pk_bf16_f32 v17, v50, v51
  ds_read_b128 v[220:223], v3 offset:31744
  v_mfma_f32_16x16x32_bf16 v[248:251], v[164:167], v[128:131], v[32:35]
  v_exp_f32_e64 v52, v228
  v_mfma_f32_16x16x32_bf16 v[248:251], v[172:175], v[136:139], v[248:251]
  v_add_u32_e64 v3, s45, v2
  v_mfma_f32_16x16x32_bf16 v[248:251], v[180:183], v[144:147], v[248:251]
  v_exp_f32_e64 v53, v229
  v_mfma_f32_16x16x32_bf16 v[248:251], v[188:191], v[152:155], v[248:251]
  v_add_f32_e64 v41, v52, v53
  v_cvt_pk_bf16_f32 v20, v52, v53
  v_mfma_f32_16x16x32_bf16 v[252:255], v[164:167], v[132:135], v[36:39]
  v_exp_f32_e64 v54, v230
  v_mfma_f32_16x16x32_bf16 v[252:255], v[172:175], v[140:143], v[252:255]
  v_add_f32_e64 v41, v41, v54
  v_cmp_gt_i32 s[56:57], 16, v62
  v_cmp_gt_i32 s[58:59], 17, v62
  v_cmp_gt_i32 s[60:61], 18, v62
  v_cmp_gt_i32 s[38:39], 19, v62
  v_mfma_f32_16x16x32_bf16 v[252:255], v[180:183], v[148:151], v[252:255]
  v_exp_f32_e64 v55, v231
  v_cndmask_b32 v232, v232, v63, s[56:57]
  v_cndmask_b32 v233, v233, v63, s[58:59]
  v_cndmask_b32 v234, v234, v63, s[60:61]
  v_cndmask_b32 v235, v235, v63, s[38:39]
  v_mfma_f32_16x16x32_bf16 v[252:255], v[188:191], v[156:159], v[252:255]
  v_add_f32_e64 v41, v41, v55
  v_cvt_pk_bf16_f32 v21, v54, v55
  s_waitcnt lgkmcnt(0)
  v_mfma_f32_16x16x32_bf16 v[64:67], v[192:195], v[24:27], v[64:67]
  s_waitcnt vmcnt(16)
  s_barrier
  v_exp_f32_e64 v48, v232
  s_nop 0
  v_add_f32 v40, v40, v48
  ds_read_b128 v[160:163], v3 offset:16384
  v_mfma_f32_16x16x32_bf16 v[68:71], v[192:195], v[28:31], v[68:71]
  v_exp_f32_e64 v49, v233
  ds_read_b128 v[164:167], v3 offset:17408
  v_mfma_f32_16x16x32_bf16 v[72:75], v[196:199], v[24:27], v[72:75]
  v_add_f32_e64 v40, v40, v49
  v_cvt_pk_bf16_f32 v18, v48, v49
  ds_read_b128 v[168:171], v3 offset:18432
  v_mfma_f32_16x16x32_bf16 v[76:79], v[196:199], v[28:31], v[76:79]
  v_exp_f32_e64 v50, v234
  ds_read_b128 v[172:175], v3 offset:19456
  v_mfma_f32_16x16x32_bf16 v[80:83], v[200:203], v[24:27], v[80:83]
  v_add_f32_e64 v40, v40, v50
  ds_read_b128 v[176:179], v3 offset:20480
  v_cmp_gt_i32 s[56:57], 0, v62
  v_cmp_gt_i32 s[58:59], 1, v62
  v_cmp_gt_i32 s[60:61], 2, v62
  v_cmp_gt_i32 s[38:39], 3, v62
  v_mfma_f32_16x16x32_bf16 v[84:87], v[200:203], v[28:31], v[84:87]
  v_exp_f32_e64 v51, v235
  ds_read_b128 v[180:183], v3 offset:21504
  v_cndmask_b32 v236, v236, v63, s[56:57]
  v_cndmask_b32 v237, v237, v63, s[58:59]
  v_cndmask_b32 v238, v238, v63, s[60:61]
  v_cndmask_b32 v239, v239, v63, s[38:39]
  v_mfma_f32_16x16x32_bf16 v[88:91], v[204:207], v[24:27], v[88:91]
  v_add_f32_e64 v40, v40, v51
  v_cvt_pk_bf16_f32 v19, v50, v51
  ds_read_b128 v[184:187], v3 offset:22528
  v_mfma_f32_16x16x32_bf16 v[92:95], v[204:207], v[28:31], v[92:95]
  v_exp_f32_e64 v52, v236
  ds_read_b128 v[188:191], v3 offset:23552
  v_mfma_f32_16x16x32_bf16 v[96:99], v[208:211], v[24:27], v[96:99]
  v_add_f32_e64 v41, v41, v52
  v_mfma_f32_16x16x32_bf16 v[100:103], v[208:211], v[28:31], v[100:103]
  v_exp_f32_e64 v53, v237
  s_cmp_lt_u32 s47, s48
  s_cselect_b32 s49, s47, s54
  s_add_u32 m0, s46, s52
  s_add_u32 s47, s47, s62
  buffer_load_dwordx4 v2, s[20:23], s49 offen offset:0 sc1 lds
  v_mfma_f32_16x16x32_bf16 v[104:107], v[212:215], v[24:27], v[104:107]
  v_add_f32_e64 v41, v41, v53
  v_cvt_pk_bf16_f32 v22, v52, v53
  v_mfma_f32_16x16x32_bf16 v[108:111], v[212:215], v[28:31], v[108:111]
  v_exp_f32_e64 v54, v238
  buffer_load_dwordx4 v2, s[20:23], s49 offen offset:1024 sc1 lds
  v_mfma_f32_16x16x32_bf16 v[112:115], v[216:219], v[24:27], v[112:115]
  v_add_f32_e64 v41, v41, v54
  v_mfma_f32_16x16x32_bf16 v[116:119], v[216:219], v[28:31], v[116:119]
  v_exp_f32_e64 v55, v239
  buffer_load_dwordx4 v2, s[20:23], s49 offen offset:2048 sc1 lds
  v_mfma_f32_16x16x32_bf16 v[120:123], v[220:223], v[24:27], v[120:123]
  v_add_f32_e64 v41, v41, v55
  v_cvt_pk_bf16_f32 v23, v54, v55
  v_mfma_f32_16x16x32_bf16 v[124:127], v[220:223], v[28:31], v[124:127]
  v_max_f32 v59, v40, v41
  v_cmp_lt_f32 vcc, s51, v59
  buffer_load_dwordx4 v2, s[20:23], s49 offen offset:3072 sc1 lds
  s_cbranch_vccnz fix_64
cont_65:
  v_add_f32 v60, v60, v40
  v_add_f32 v61, v61, v41
  s_waitcnt lgkmcnt(0)
fused_kernel_lo_tail:
  v_mfma_f32_16x16x32_bf16 v[64:67], v[160:163], v[16:19], v[64:67]
  ds_read_b128 v[192:195], v3 offset:24576
  v_cmp_gt_i32 s[56:57], 32, v62
  v_cmp_gt_i32 s[58:59], 33, v62
  v_cmp_gt_i32 s[60:61], 34, v62
  v_cmp_gt_i32 s[38:39], 35, v62
  v_cndmask_b32 v240, v240, v63, s[56:57]
  v_mfma_f32_16x16x32_bf16 v[68:71], v[160:163], v[20:23], v[68:71]
  ds_read_b128 v[196:199], v3 offset:25600
  v_cndmask_b32 v241, v241, v63, s[58:59]
  v_cndmask_b32 v242, v242, v63, s[60:61]
  v_cndmask_b32 v243, v243, v63, s[38:39]
  v_exp_f32 v48, v240
  v_exp_f32 v49, v241
  v_mfma_f32_16x16x32_bf16 v[72:75], v[164:167], v[16:19], v[72:75]
  ds_read_b128 v[200:203], v3 offset:26624
  v_exp_f32 v50, v242
  v_add_f32 v40, v48, v49
  v_cvt_pk_bf16_f32 v24, v48, v49
  v_exp_f32 v51, v243
  v_add_f32 v40, v40, v50
  v_mfma_f32_16x16x32_bf16 v[76:79], v[164:167], v[20:23], v[76:79]
  ds_read_b128 v[204:207], v3 offset:27648
  v_cmp_gt_i32 s[56:57], 16, v62
  v_cmp_gt_i32 s[58:59], 17, v62
  v_cmp_gt_i32 s[60:61], 18, v62
  v_cmp_gt_i32 s[38:39], 19, v62
  v_cndmask_b32 v244, v244, v63, s[56:57]
  v_mfma_f32_16x16x32_bf16 v[80:83], v[168:171], v[16:19], v[80:83]
  ds_read_b128 v[208:211], v3 offset:28672
  v_cndmask_b32 v245, v245, v63, s[58:59]
  v_cndmask_b32 v246, v246, v63, s[60:61]
  v_cndmask_b32 v247, v247, v63, s[38:39]
  v_exp_f32 v52, v244
  v_add_f32 v40, v40, v51
  v_mfma_f32_16x16x32_bf16 v[84:87], v[168:171], v[20:23], v[84:87]
  ds_read_b128 v[212:215], v3 offset:29696
  v_cvt_pk_bf16_f32 v25, v50, v51
  v_exp_f32 v53, v245
  v_exp_f32 v54, v246
  v_add_f32 v41, v52, v53
  v_cvt_pk_bf16_f32 v28, v52, v53
  v_mfma_f32_16x16x32_bf16 v[88:91], v[172:175], v[16:19], v[88:91]
  ds_read_b128 v[216:219], v3 offset:30720
  v_exp_f32 v55, v247
  v_add_f32 v41, v41, v54
  v_cmp_gt_i32 s[56:57], 48, v62
  v_cmp_gt_i32 s[58:59], 49, v62
  v_cmp_gt_i32 s[60:61], 50, v62
  v_mfma_f32_16x16x32_bf16 v[92:95], v[172:175], v[20:23], v[92:95]
  ds_read_b128 v[220:223], v3 offset:31744
  v_cmp_gt_i32 s[38:39], 51, v62
  v_cndmask_b32 v248, v248, v63, s[56:57]
  v_cndmask_b32 v249, v249, v63, s[58:59]
  v_cndmask_b32 v250, v250, v63, s[60:61]
  v_cndmask_b32 v251, v251, v63, s[38:39]
  v_mfma_f32_16x16x32_bf16 v[96:99], v[176:179], v[16:19], v[96:99]
  v_exp_f32 v48, v248
  v_add_f32 v41, v41, v55
  v_cvt_pk_bf16_f32 v29, v54, v55
  v_exp_f32 v49, v249
  v_add_f32 v40, v40, v48
  s_add_u32 m0, m0, 0x4000
  s_sub_u32 s49, s49, 0x4000
  buffer_load_dwordx4 v2, s[20:23], s49 offen offset:0 sc1 lds
  v_mfma_f32_16x16x32_bf16 v[100:103], v[176:179], v[20:23], v[100:103]
  v_exp_f32 v50, v250
  v_add_f32 v40, v40, v49
  v_cvt_pk_bf16_f32 v26, v48, v49
  v_exp_f32 v51, v251
  v_add_f32 v40, v40, v50
  v_mfma_f32_16x16x32_bf16 v[104:107], v[180:183], v[16:19], v[104:107]
  v_cmp_gt_i32 s[56:57], 32, v62
  v_cmp_gt_i32 s[58:59], 33, v62
  v_cmp_gt_i32 s[60:61], 34, v62
  v_cmp_gt_i32 s[38:39], 35, v62
  v_cndmask_b32 v252, v252, v63, s[56:57]
  buffer_load_dwordx4 v2, s[20:23], s49 offen offset:1024 sc1 lds
  v_mfma_f32_16x16x32_bf16 v[108:111], v[180:183], v[20:23], v[108:111]
  v_cndmask_b32 v253, v253, v63, s[58:59]
  v_cndmask_b32 v254, v254, v63, s[60:61]
  v_cndmask_b32 v255, v255, v63, s[38:39]
  v_exp_f32 v52, v252
  v_add_f32 v40, v40, v51
  v_mfma_f32_16x16x32_bf16 v[112:115], v[184:187], v[16:19], v[112:115]
  v_cvt_pk_bf16_f32 v27, v50, v51
  v_exp_f32 v53, v253
  v_add_f32 v41, v41, v52
  v_exp_f32 v54, v254
  v_add_f32 v41, v41, v53
  buffer_load_dwordx4 v2, s[20:23], s49 offen offset:2048 sc1 lds
  v_mfma_f32_16x16x32_bf16 v[116:119], v[184:187], v[20:23], v[116:119]
  v_cvt_pk_bf16_f32 v30, v52, v53
  v_exp_f32 v55, v255
  v_add_f32 v41, v41, v54
  v_add_f32 v41, v41, v55
  v_cvt_pk_bf16_f32 v31, v54, v55
  v_mfma_f32_16x16x32_bf16 v[120:123], v[188:191], v[16:19], v[120:123]
  buffer_load_dwordx4 v2, s[20:23], s49 offen offset:3072 sc1 lds
  s_add_u32 s46, s46, s62
  s_cmp_eq_u32 s46, s63
  s_cselect_b32 s46, 0, s46
  v_mfma_f32_16x16x32_bf16 v[124:127], v[188:191], v[20:23], v[124:127]
  v_max_f32 v59, v40, v41
  v_cmp_lt_f32 vcc, s51, v59
  s_nop 0
  s_cbranch_vccnz fix_66
cont_67:
  v_add_f32 v60, v60, v40
  v_add_f32 v61, v61, v41
  s_waitcnt lgkmcnt(0)
  v_mfma_f32_16x16x32_bf16 v[64:67], v[192:195], v[24:27], v[64:67]
  v_permlane16_swap_b32 v60, v61
  v_add_f32 v60, v60, v61
  v_mfma_f32_16x16x32_bf16 v[68:71], v[192:195], v[28:31], v[68:71]
  v_mov_b32 v61, v60
  s_nop 1
  v_permlane32_swap_b32 v61, v60
  v_mfma_f32_16x16x32_bf16 v[72:75], v[196:199], v[24:27], v[72:75]
  v_add_f32 v60, v60, v61
  v_rcp_f32 v60, v60
  v_mfma_f32_16x16x32_bf16 v[76:79], v[196:199], v[28:31], v[76:79]
  s_nop 0
  v_mov_b32 v61, v60
  v_mfma_f32_16x16x32_bf16 v[80:83], v[200:203], v[24:27], v[80:83]
  s_nop 0
  v_permlane16_swap_b32 v60, v61
  s_lshl_b32 s55, s42, 18
  v_mfma_f32_16x16x32_bf16 v[84:87], v[200:203], v[28:31], v[84:87]
  s_lshl_b32 s49, s41, 13
  s_add_u32 s55, s55, s49
  v_mfma_f32_16x16x32_bf16 v[88:91], v[204:207], v[24:27], v[88:91]
  v_mul_f32 v64, v64, v60
  v_mul_f32 v65, v65, v60
  v_mul_f32 v66, v66, v60
  v_mfma_f32_16x16x32_bf16 v[92:95], v[204:207], v[28:31], v[92:95]
  v_mul_f32 v67, v67, v60
  v_mul_f32 v72, v72, v60
  v_mul_f32 v73, v73, v60
  v_mfma_f32_16x16x32_bf16 v[96:99], v[208:211], v[24:27], v[96:99]
  v_mul_f32 v74, v74, v60
  v_mul_f32 v75, v75, v60
  v_cvt_pk_bf16_f32 v224, v64, v65
  v_mfma_f32_16x16x32_bf16 v[100:103], v[208:211], v[28:31], v[100:103]
  v_cvt_pk_bf16_f32 v225, v66, v67
  v_cvt_pk_bf16_f32 v226, v72, v73
  v_cvt_pk_bf16_f32 v227, v74, v75
  v_mfma_f32_16x16x32_bf16 v[104:107], v[212:215], v[24:27], v[104:107]
  buffer_store_dwordx4 v[224:227], v2, s[24:27], s55 offen offset:0 sc1
  v_mul_f32 v68, v68, v61
  v_mul_f32 v69, v69, v61
  v_mfma_f32_16x16x32_bf16 v[108:111], v[212:215], v[28:31], v[108:111]
  v_mul_f32 v70, v70, v61
  v_mul_f32 v71, v71, v61
  v_mul_f32 v76, v76, v61
  v_mfma_f32_16x16x32_bf16 v[112:115], v[216:219], v[24:27], v[112:115]
  v_mul_f32 v77, v77, v61
  v_mul_f32 v78, v78, v61
  v_mul_f32 v79, v79, v61
  v_mfma_f32_16x16x32_bf16 v[116:119], v[216:219], v[28:31], v[116:119]
  v_cvt_pk_bf16_f32 v228, v68, v69
  v_cvt_pk_bf16_f32 v229, v70, v71
  v_cvt_pk_bf16_f32 v230, v76, v77
  v_mfma_f32_16x16x32_bf16 v[120:123], v[220:223], v[24:27], v[120:123]
  v_cvt_pk_bf16_f32 v231, v78, v79
  buffer_store_dwordx4 v[228:231], v2, s[24:27], s55 offen offset:1024 sc1
  v_mul_f32 v80, v80, v60
  v_mfma_f32_16x16x32_bf16 v[124:127], v[220:223], v[28:31], v[124:127]
  v_mul_f32 v81, v81, v60
  v_mul_f32 v82, v82, v60
  v_mul_f32 v83, v83, v60
  v_mul_f32 v88, v88, v60
  v_mul_f32 v89, v89, v60
  v_mul_f32 v90, v90, v60
  v_mul_f32 v91, v91, v60
  v_cvt_pk_bf16_f32 v232, v80, v81
  v_cvt_pk_bf16_f32 v233, v82, v83
  v_cvt_pk_bf16_f32 v234, v88, v89
  v_cvt_pk_bf16_f32 v235, v90, v91
  buffer_store_dwordx4 v[232:235], v2, s[24:27], s55 offen offset:2048 sc1
  v_mul_f32 v84, v84, v61
  v_mul_f32 v85, v85, v61
  v_mul_f32 v86, v86, v61
  v_mul_f32 v87, v87, v61
  v_mul_f32 v92, v92, v61
  v_mul_f32 v93, v93, v61
  v_mul_f32 v94, v94, v61
  v_mul_f32 v95, v95, v61
  v_cvt_pk_bf16_f32 v236, v84, v85
  v_cvt_pk_bf16_f32 v237, v86, v87
  v_cvt_pk_bf16_f32 v238, v92, v93
  v_cvt_pk_bf16_f32 v239, v94, v95
  buffer_store_dwordx4 v[236:239], v2, s[24:27], s55 offen offset:3072 sc1
  v_mul_f32 v96, v96, v60
  v_mul_f32 v97, v97, v60
  v_mul_f32 v98, v98, v60
  v_mul_f32 v99, v99, v60
  v_mul_f32 v104, v104, v60
  v_mul_f32 v105, v105, v60
  v_mul_f32 v106, v106, v60
  v_mul_f32 v107, v107, v60
  v_cvt_pk_bf16_f32 v240, v96, v97
  v_cvt_pk_bf16_f32 v241, v98, v99
  v_cvt_pk_bf16_f32 v242, v104, v105
  v_cvt_pk_bf16_f32 v243, v106, v107
  s_add_u32 s55, s55, 4096
  buffer_store_dwordx4 v[240:243], v2, s[24:27], s55 offen offset:0 sc1
  v_mul_f32 v100, v100, v61
  v_mul_f32 v101, v101, v61
  v_mul_f32 v102, v102, v61
  v_mul_f32 v103, v103, v61
  v_mul_f32 v108, v108, v61
  v_mul_f32 v109, v109, v61
  v_mul_f32 v110, v110, v61
  v_mul_f32 v111, v111, v61
  v_cvt_pk_bf16_f32 v244, v100, v101
  v_cvt_pk_bf16_f32 v245, v102, v103
  v_cvt_pk_bf16_f32 v246, v108, v109
  v_cvt_pk_bf16_f32 v247, v110, v111
  buffer_store_dwordx4 v[244:247], v2, s[24:27], s55 offen offset:1024 sc1
  v_mul_f32 v112, v112, v60
  v_mul_f32 v113, v113, v60
  v_mul_f32 v114, v114, v60
  v_mul_f32 v115, v115, v60
  v_mul_f32 v120, v120, v60
  v_mul_f32 v121, v121, v60
  v_mul_f32 v122, v122, v60
  v_mul_f32 v123, v123, v60
  v_cvt_pk_bf16_f32 v248, v112, v113
  v_cvt_pk_bf16_f32 v249, v114, v115
  v_cvt_pk_bf16_f32 v250, v120, v121
  v_cvt_pk_bf16_f32 v251, v122, v123
  buffer_store_dwordx4 v[248:251], v2, s[24:27], s55 offen offset:2048 sc1
  v_mul_f32 v116, v116, v61
  v_mul_f32 v117, v117, v61
  v_mul_f32 v118, v118, v61
  v_mul_f32 v119, v119, v61
  v_mul_f32 v124, v124, v61
  v_mul_f32 v125, v125, v61
  v_mul_f32 v126, v126, v61
  v_mul_f32 v127, v127, v61
  v_cvt_pk_bf16_f32 v252, v116, v117
  v_cvt_pk_bf16_f32 v253, v118, v119
  v_cvt_pk_bf16_f32 v254, v124, v125
  v_cvt_pk_bf16_f32 v255, v126, v127
  buffer_store_dwordx4 v[252:255], v2, s[24:27], s55 offen offset:3072 sc1
fused_kernel_lo_ost:
  s_lshl_b32 s36, s42, 18
  s_andn2_b32 s65, s41, 3
  s_lshl_b32 s65, s65, 13
  s_add_u32 s36, s36, s65
  s_cmp_ge_u32 s2, 224
  s_cselect_b32 s65, 3840, 0
  s_add_u32 s65, s65, 288
  v_and_b32 v6, 3, v1
  v_lshlrev_b32 v12, 3, v6
  v_bfe_u32 v6, v1, 2, 2
  v_lshl_add_u32 v12, v6, 6, v12
  v_bfe_u32 v7, v1, 4, 1
  v_mul_u32_u24 v7, s65, v7
  v_add_u32 v12, v12, v7
  v_lshrrev_b32 v7, 5, v1
  v_lshl_add_u32 v12, v7, 11, v12
  s_add_u32 s65, s72, 31744
  v_mov_b32 v14, s65
  v_mov_b32 v15, 1
  s_lshl_b32 s67, s3, 2
  s_add_u32 s75, s65, s67
  v_bfe_u32 v6, v1, 2, 3
  v_lshlrev_b32 v5, 10, v6
  v_lshrrev_b32 v6, 5, v1
  v_lshl_add_u32 v5, v6, 6, v5
  v_and_b32 v6, 1, v1
  v_lshl_add_u32 v5, v6, 5, v5
  v_bfe_u32 v6, v1, 1, 1
  s_bfe_u32 s65, s52, 0x1000c
  v_xor_b32 v6, s65, v6
  v_bfe_u32 v7, v1, 4, 1
  v_xor_b32 v6, v7, v6
  v_lshl_add_u32 v5, v6, 4, v5
  s_andn2_b32 s37, s41, 3
  s_lshl_b32 s37, s37, 17
  s_lshl_b32 s65, s52, 2
  s_add_u32 s37, s37, s65
  s_lshl_b32 s65, s35, 8
  s_add_u32 s37, s37, s65
  v_add_u32 v5, s37, v5
  s_mov_b32 s33, 0
  s_mov_b32 s37, s32
  s_add_u32 s53, s43, 2
  s_add_u32 s50, s43, 3
  s_add_u32 s5, s43, 5
  s_mov_b32 s4, 0
  v_mov_b32 v0, 0
fused_kernel_olo_ld:
  s_waitcnt vmcnt(16)
  s_barrier
  s_cmp_lg_u32 s53, s50
  s_cbranch_scc1 fused_kernel_olo_ns
  s_cmp_ge_u32 s5, s44
  s_cbranch_scc1 fused_kernel_olo_ns1
  s_waitcnt vmcnt(8)
fused_kernel_olo_ns1:
  s_atomic_add s74, s[16:17], s34
fused_kernel_olo_ns:
  s_cmp_lt_u32 s53, s5
  s_cbranch_scc1 fused_kernel_olo_np
  s_cmp_lg_u32 s53, s5
  s_cbranch_scc1 fused_kernel_olo_pb
  s_load_dword s9, s[16:17], s34 glc
  s_waitcnt lgkmcnt(0)
  s_cmp_ge_u32 s9, 4
  s_cbranch_scc0 spin_68
spc_69:
fused_kernel_olo_pb:
  s_cmp_ge_u32 s4, 6
  s_cbranch_scc1 fused_kernel_olo_np
  s_lshr_b32 s65, s4, 1
  s_add_u32 s65, s65, s35
  s_add_u32 s65, s65, 1
  s_and_b32 s65, s65, 3
  s_lshl_b32 s65, s65, 13
  s_add_u32 s65, s65, s36
  s_and_b32 s67, s4, 1
  s_lshl_b32 s67, s67, 12
  s_add_u32 s65, s65, s67
  s_add_u32 s4, s4, 1
  s_cmp_lg_u32 s4, 1
  s_cbranch_scc1 sb_70
  buffer_load_dwordx4 v[128:131], v2, s[24:27], s65 offen offset:0 sc1
  buffer_load_dwordx4 v[132:135], v2, s[24:27], s65 offen offset:1024 sc1
  buffer_load_dwordx4 v[136:139], v2, s[24:27], s65 offen offset:2048 sc1
  buffer_load_dwordx4 v[140:143], v2, s[24:27], s65 offen offset:3072 sc1
  s_branch fused_kernel_olo_np
sb_70:
  s_cmp_lg_u32 s4, 2
  s_cbranch_scc1 sb_71
  buffer_load_dwordx4 v[144:147], v2, s[24:27], s65 offen offset:0 sc1
  buffer_load_dwordx4 v[148:151], v2, s[24:27], s65 offen offset:1024 sc1
  buffer_load_dwordx4 v[152:155], v2, s[24:27], s65 offen offset:2048 sc1
  buffer_load_dwordx4 v[156:159], v2, s[24:27], s65 offen offset:3072 sc1
  s_branch fused_kernel_olo_np
sb_71:
  s_cmp_lg_u32 s4, 3
  s_cbranch_scc1 sb_72
  buffer_load_dwordx4 v[160:163], v2, s[24:27], s65 offen offset:0 sc1
  buffer_load_dwordx4 v[164:167], v2, s[24:27], s65 offen offset:1024 sc1
  buffer_load_dwordx4 v[168:171], v2, s[24:27], s65 offen offset:2048 sc1
  buffer_load_dwordx4 v[172:175], v2, s[24:27], s65 offen offset:3072 sc1
  s_branch fused_kernel_olo_np
sb_72:
  s_cmp_lg_u32 s4, 4
  s_cbranch_scc1 sb_73
  buffer_load_dwordx4 v[176:179], v2, s[24:27], s65 offen offset:0 sc1
  buffer_load_dwordx4 v[180:183], v2, s[24:27], s65 offen offset:1024 sc1
  buffer_load_dwordx4 v[184:187], v2, s[24:27], s65 offen offset:2048 sc1
  buffer_load_dwordx4 v[188:191], v2, s[24:27], s65 offen offset:3072 sc1
  s_branch fused_kernel_olo_np
sb_73:
  s_cmp_lg_u32 s4, 5
  s_cbranch_scc1 sb_74
  buffer_load_dwordx4 v[192:195], v2, s[24:27], s65 offen offset:0 sc1
  buffer_load_dwordx4 v[196:199], v2, s[24:27], s65 offen offset:1024 sc1
  buffer_load_dwordx4 v[200:203], v2, s[24:27], s65 offen offset:2048 sc1
  buffer_load_dwordx4 v[204:207], v2, s[24:27], s65 offen offset:3072 sc1
  s_branch fused_kernel_olo_np
sb_74:
  buffer_load_dwordx4 v[208:211], v2, s[24:27], s65 offen offset:0 sc1
  buffer_load_dwordx4 v[212:215], v2, s[24:27], s65 offen offset:1024 sc1
  buffer_load_dwordx4 v[216:219], v2, s[24:27], s65 offen offset:2048 sc1
  buffer_load_dwordx4 v[220:223], v2, s[24:27], s65 offen offset:3072 sc1
fused_kernel_olo_np:
  s_cmp_ge_u32 s2, 32
  s_cselect_b32 s8, 0, s3
  s_sub_u32 s6, s53, s43
  s_cmp_eq_u32 s6, 12
  s_cselect_b32 s8, s8, 0
  s_cmp_lg_u32 s8, 4
  s_cbranch_scc1 fin_76
  s_mov_b32 s28, s10
  s_mov_b32 s29, s11
  s_mov_b32 s30, 0x10000
  s_mov_b32 s31, 0x20000
  v_mov_b32 v0, 0
  s_movk_i32 s6, 128
  buffer_load_dword v3, v0, s[68:71], s6 offen sc1
  s_waitcnt vmcnt(0)
  v_readfirstlane_b32 s9, v3
  s_nop 0
  s_cmp_ge_u32 s9, 128
  s_cbranch_scc0 spin_77
spc_78:
  v_lshlrev_b32 v13, 2, v1
  s_lshl_b32 s67, s2, 8
  s_add_u32 s67, s67, 0x5000
  buffer_load_dword v8, v13, s[28:31], s67 offen sc1
  s_add_u32 s67, s67, 12288
  buffer_load_dword v9, v13, s[28:31], s67 offen sc1
  s_add_u32 s67, s67, 12288
  buffer_load_dword v10, v13, s[28:31], s67 offen sc1
  s_add_u32 s67, s67, 12288
  buffer_load_dword v11, v13, s[28:31], s67 offen sc1
fin_76:
  s_cmp_ge_u32 s2, 32
  s_cselect_b32 s8, 0, s3
  s_sub_u32 s6, s53, s43
  s_cmp_eq_u32 s6, 14
  s_cselect_b32 s8, s8, 0
  s_cmp_lg_u32 s8, 4
  s_cbranch_scc1 fin_79
  s_lshl_b32 s66, s2, 8
  s_add_u32 s66, s66, 4096
  s_lshr_b32 s67, s2, 3
  s_cmp_eq_u32 s67, 2
  s_cselect_b32 s67, 1.0, 0
  v_add_f32 v8, v8, v9
  v_add_f32 v10, v10, v11
  v_add_f32 v8, v8, v10
  v_cvt_pk_bf16_f32 v8, v8, v8
  v_lshlrev_b32 v8, 16, v8
  v_add_f32 v8, s67, v8
  v_cvt_pk_bf16_f32 v8, v8, v8
  v_lshlrev_b32 v8, 16, v8
  buffer_store_dword v8, v13, s[28:31], s66 offen sc1
fin_79:
  s_cmp_ge_u32 s2, 32
  s_cselect_b32 s8, 0, s3
  s_sub_u32 s6, s53, s43
  s_cmp_eq_u32 s6, 16
  s_cselect_b32 s8, s8, 0
  s_cmp_lg_u32 s8, 4
  s_cbranch_scc1 fin_80
  s_movk_i32 s6, 12800
  s_atomic_add s74, s[16:17], s6
fin_80:
  s_add_u32 s65, s53, 5
  s_cmp_lg_u32 s65, s44
  s_cbranch_scc1 fused_kernel_olo_tw
  s_sub_u32 s38, s2, 0
  s_cmp_ge_u32 s38, 128
  s_cbranch_scc1 fused_kernel_olo_tw
  s_cmp_ge_u32 s41, 28
  s_cbranch_scc1 fused_kernel_olo_tw
  s_load_dwordx2 s[56:57], s[0:1], 56
  s_load_dwordx2 s[60:61], s[0:1], 64
  s_lshr_b32 s65, s38, 5
  s_and_b32 s65, s65, 1
  s_lshl_b32 s65, s65, 14
  s_add_u32 s65, s65, s52
  s_mul_i32 s65, s65, 56
  s_lshl_b32 s67, s41, 7
  s_add_u32 s65, s65, s67
  v_mul_u32_u24 v6, 3584, v1
  s_mov_b32 s58, 0x1c0000
  s_mov_b32 s59, 0x20000
  s_waitcnt lgkmcnt(0)
  s_cmp_lt_u32 s38, 64
  s_cbranch_scc1 fused_kernel_olo_tw1
  s_mov_b32 s56, s60
  s_mov_b32 s57, s61
fused_kernel_olo_tw1:
  buffer_load_dword v7, v6, s[56:59], s65 offen
fused_kernel_olo_tw:
  s_add_u32 s65, s53, 4
  s_cmp_lg_u32 s65, s44
  s_cbranch_scc1 fused_kernel_olo_tv
  s_sub_u32 s38, s2, 0
  s_cmp_ge_u32 s38, 128
  s_cbranch_scc1 fused_kernel_olo_tv
  s_load_dwordx2 s[56:57], s[0:1], 72
  s_lshr_b32 s65, s38, 5
  s_mul_i32 s65, s65, 458752
  s_mul_i32 s67, s52, 28
  s_add_u32 s65, s65, s67
  s_and_b32 s67, s2, 1
  s_lshl_b32 s67, s67, 2
  s_add_u32 s67, s67, s35
  s_lshl_b32 s67, s67, 7
  s_add_u32 s65, s65, s67
  s_add_u32 s67, s65, 57344
  v_lshlrev_b32 v6, 10, v1
  s_mov_b32 s58, 0x1c0000
  s_mov_b32 s59, 0x20000
  s_waitcnt lgkmcnt(0)
  buffer_load_dword v7, v6, s[56:59], s65 offen
  buffer_load_dword v7, v6, s[56:59], s67 offen
fused_kernel_olo_tv:
  s_cmp_lg_u32 s53, s44
  s_cbranch_scc1 fused_kernel_olo_nf
  v_mov_b32 v0, 0
  buffer_load_dword v3, v0, s[16:19], s73 offen sc1
fused_kernel_olo_nf:
  s_add_u32 s65, s53, 3
  s_cmp_gt_u32 s65, s44
  s_cbranch_scc1 fused_kernel_olo_w
  s_cmp_lt_u32 s47, s48
  s_cselect_b32 s49, s47, s54
  s_add_u32 m0, s46, s52
  s_add_u32 s47, s47, s62
  buffer_load_dwordx4 v2, s[20:23], s49 offen offset:0 sc1 lds
  buffer_load_dwordx4 v2, s[20:23], s49 offen offset:1024 sc1 lds
  buffer_load_dwordx4 v2, s[20:23], s49 offen offset:2048 sc1 lds
  buffer_load_dwordx4 v2, s[20:23], s49 offen offset:3072 sc1 lds
  s_add_u32 m0, m0, 0x4000
  s_sub_u32 s49, s49, 0x4000
  buffer_load_dwordx4 v2, s[20:23], s49 offen offset:0 sc1 lds
  buffer_load_dwordx4 v2, s[20:23], s49 offen offset:1024 sc1 lds
  buffer_load_dwordx4 v2, s[20:23], s49 offen offset:2048 sc1 lds
  buffer_load_dwordx4 v2, s[20:23], s49 offen offset:3072 sc1 lds
  s_add_u32 s46, s46, s62
  s_cmp_eq_u32 s46, s63
  s_cselect_b32 s46, 0, s46
  s_add_u32 s65, s53, 3
  s_cmp_lt_u32 s65, s44
  s_cbranch_scc1 fused_kernel_olo_nx
fused_kernel_olo_w:
  s_add_u32 s65, s35, s33
  s_and_b32 s65, s65, 3
  s_lshl_b32 s65, s65, 17
  s_add_u32 m0, s37, s52
  s_add_u32 s67, s65, 0
  buffer_load_dwordx4 v5, s[12:15], s67 offen offset:0 lds
  s_add_u32 m0, m0, 896
  s_nop 0
  buffer_load_dwordx4 v5, s[12:15], s67 offen offset:128 lds
  s_add_u32 m0, m0, 1152
  s_add_u32 s67, s65, 8192
  buffer_load_dwordx4 v5, s[12:15], s67 offen offset:0 lds
  s_add_u32 m0, m0, 896
  s_nop 0
  buffer_load_dwordx4 v5, s[12:15], s67 offen offset:128 lds
  s_add_u32 m0, m0, 13440
  s_add_u32 s67, s65, 65536
  buffer_load_dwordx4 v5, s[12:15], s67 offen offset:0 lds
  s_add_u32 m0, m0, 896
  s_nop 0
  buffer_load_dwordx4 v5, s[12:15], s67 offen offset:128 lds
  s_add_u32 m0, m0, 1152
  s_add_u32 s67, s65, 73728
  buffer_load_dwordx4 v5, s[12:15], s67 offen offset:0 lds
  s_add_u32 m0, m0, 896
  s_nop 0
  buffer_load_dwordx4 v5, s[12:15], s67 offen offset:128 lds
  s_add_u32 s37, s37, s62
  s_cmp_eq_u32 s37, s63
  s_cselect_b32 s37, 0, s37
  s_add_u32 s33, s33, 1
  s_add_u32 s65, s33, s44
  s_add_u32 s67, s53, 3
  s_cmp_le_u32 s65, s67
  s_cbranch_scc1 fused_kernel_olo_w
fused_kernel_olo_nx:
  s_add_u32 s53, s53, 1
  s_cmp_gt_u32 s53, s44
  s_cbranch_scc0 fused_kernel_olo_ld
  s_cmp_le_u32 s50, s44
  s_cbranch_scc1 fused_kernel_olo_ns2
  s_waitcnt vmcnt(0)
  s_atomic_add s74, s[16:17], s34
fused_kernel_olo_ns2:
  s_cmp_lt_u32 s4, 6
  s_cbranch_scc1 fused_kernel_olo_w24
  s_waitcnt vmcnt(0)
  s_branch fused_kernel_olo_go
fused_kernel_olo_w24:
  s_cmp_eq_u32 s4, 0
  s_cbranch_scc1 fused_kernel_olo_w25
  s_waitcnt vmcnt(0)
fused_kernel_olo_w25:
  s_load_dword s9, s[16:17], s34 glc
  s_cmp_ge_u32 s4, 6
  s_cbranch_scc1 fused_kernel_olo_go
  s_waitcnt lgkmcnt(0)
  s_cmp_ge_u32 s9, 4
  s_cbranch_scc0 spin_81
spc_82:
fused_kernel_olo_rem:
  s_lshr_b32 s65, s4, 1
  s_add_u32 s65, s65, s35
  s_add_u32 s65, s65, 1
  s_and_b32 s65, s65, 3
  s_lshl_b32 s65, s65, 13
  s_add_u32 s65, s65, s36
  s_and_b32 s67, s4, 1
  s_lshl_b32 s67, s67, 12
  s_add_u32 s65, s65, s67
  s_add_u32 s4, s4, 1
  s_cmp_lg_u32 s4, 1
  s_cbranch_scc1 sb_83
  buffer_load_dwordx4 v[128:131], v2, s[24:27], s65 offen offset:0 sc1
  buffer_load_dwordx4 v[132:135], v2, s[24:27], s65 offen offset:1024 sc1
  buffer_load_dwordx4 v[136:139], v2, s[24:27], s65 offen offset:2048 sc1
  buffer_load_dwordx4 v[140:143], v2, s[24:27], s65 offen offset:3072 sc1
  s_branch fused_kernel_olo_rm2
sb_83:
  s_cmp_lg_u32 s4, 2
  s_cbranch_scc1 sb_84
  buffer_load_dwordx4 v[144:147], v2, s[24:27], s65 offen offset:0 sc1
  buffer_load_dwordx4 v[148:151], v2, s[24:27], s65 offen offset:1024 sc1
  buffer_load_dwordx4 v[152:155], v2, s[24:27], s65 offen offset:2048 sc1
  buffer_load_dwordx4 v[156:159], v2, s[24:27], s65 offen offset:3072 sc1
  s_branch fused_kernel_olo_rm2
sb_84:
  s_cmp_lg_u32 s4, 3
  s_cbranch_scc1 sb_85
  buffer_load_dwordx4 v[160:163], v2, s[24:27], s65 offen offset:0 sc1
  buffer_load_dwordx4 v[164:167], v2, s[24:27], s65 offen offset:1024 sc1
  buffer_load_dwordx4 v[168:171], v2, s[24:27], s65 offen offset:2048 sc1
  buffer_load_dwordx4 v[172:175], v2, s[24:27], s65 offen offset:3072 sc1
  s_branch fused_kernel_olo_rm2
sb_85:
  s_cmp_lg_u32 s4, 4
  s_cbranch_scc1 sb_86
  buffer_load_dwordx4 v[176:179], v2, s[24:27], s65 offen offset:0 sc1
  buffer_load_dwordx4 v[180:183], v2, s[24:27], s65 offen offset:1024 sc1
  buffer_load_dwordx4 v[184:187], v2, s[24:27], s65 offen offset:2048 sc1
  buffer_load_dwordx4 v[188:191], v2, s[24:27], s65 offen offset:3072 sc1
  s_branch fused_kernel_olo_rm2
sb_86:
  s_cmp_lg_u32 s4, 5
  s_cbranch_scc1 sb_87
  buffer_load_dwordx4 v[192:195], v2, s[24:27], s65 offen offset:0 sc1
  buffer_load_dwordx4 v[196:199], v2, s[24:27], s65 offen offset:1024 sc1
  buffer_load_dwordx4 v[200:203], v2, s[24:27], s65 offen offset:2048 sc1
  buffer_load_dwordx4 v[204:207], v2, s[24:27], s65 offen offset:3072 sc1
  s_branch fused_kernel_olo_rm2
sb_87:
  buffer_load_dwordx4 v[208:211], v2, s[24:27], s65 offen offset:0 sc1
  buffer_load_dwordx4 v[212:215], v2, s[24:27], s65 offen offset:1024 sc1
  buffer_load_dwordx4 v[216:219], v2, s[24:27], s65 offen offset:2048 sc1
  buffer_load_dwordx4 v[220:223], v2, s[24:27], s65 offen offset:3072 sc1
fused_kernel_olo_rm2:
  s_cmp_lt_u32 s4, 6
  s_cbranch_scc1 fused_kernel_olo_rem
  s_waitcnt vmcnt(24)
fused_kernel_olo_go:
  v_readfirstlane_b32 s9, v3
  s_nop 0
  s_cmp_ge_u32 s9, 32
  s_cbranch_scc0 spin_89
spc_90:
  s_setprio 1
  s_barrier
  v_mov_b32 v13, s75
  s_cmp_lg_u32 s3, 4
  s_cbranch_scc1 li_91
  v_lshl_add_u32 v6, v1, 2, v14
  v_mov_b32 v7, -1
  v_mov_b32 v0, 0
  ds_write_b32 v6, v7
  ds_write_b32 v6, v0 offset:256
li_91:
  s_cmp_ge_u32 s2, 224
  s_cselect_b32 s61, 0, 3840
  s_add_u32 s61, s61, 256
  v_add_u32 v8, s32, v12
  v_xor_b32 v10, 32, v8
  v_add_u32 v9, s61, v10
  v_add_u32 v11, s61, v8
  ds_read_b64_tr_b16 v[16:17], v8 offset:0
  ds_read_b64_tr_b16 v[18:19], v9 offset:0
  ds_read_b64_tr_b16 v[20:21], v8 offset:512
  ds_read_b64_tr_b16 v[22:23], v9 offset:512
  ds_read_b64_tr_b16 v[24:25], v8 offset:1024
  ds_read_b64_tr_b16 v[26:27], v9 offset:1024
  ds_read_b64_tr_b16 v[28:29], v8 offset:1536
  ds_read_b64_tr_b16 v[30:31], v9 offset:1536
  ds_read_b64_tr_b16 v[32:33], v10 offset:0
  ds_read_b64_tr_b16 v[34:35], v11 offset:0
  ds_read_b64_tr_b16 v[36:37], v10 offset:512
  ds_read_b64_tr_b16 v[38:39], v11 offset:512
  ds_read_b64_tr_b16 v[40:41], v10 offset:1024
  ds_read_b64_tr_b16 v[42:43], v11 offset:1024
  ds_read_b64_tr_b16 v[44:45], v10 offset:1536
  ds_read_b64_tr_b16 v[46:47], v11 offset:1536
  s_waitcnt lgkmcnt(12)
  v_mfma_f32_16x16x32_bf16 v[64:67], v[16:19], v[224:227], 0
  v_mfma_f32_16x16x32_bf16 v[68:71], v[16:19], v[228:231], 0
  s_barrier
  ds_read_b64_tr_b16 v[16:17], v8 offset:8192
  v_mfma_f32_16x16x32_bf16 v[80:83], v[20:23], v[224:227], 0
  ds_read_b64_tr_b16 v[18:19], v9 offset:8192
  v_mfma_f32_16x16x32_bf16 v[84:87], v[20:23], v[228:231], 0
  ds_read_b64_tr_b16 v[20:21], v8 offset:8704
  s_waitcnt lgkmcnt(11)
  v_mfma_f32_16x16x32_bf16 v[96:99], v[24:27], v[224:227], 0
  ds_read_b64_tr_b16 v[22:23], v9 offset:8704
  v_mfma_f32_16x16x32_bf16 v[100:103], v[24:27], v[228:231], 0
  ds_read_b64_tr_b16 v[24:25], v8 offset:9216
  v_mfma_f32_16x16x32_bf16 v[112:115], v[28:31], v[224:227], 0
  ds_read_b64_tr_b16 v[26:27], v9 offset:9216
  v_mfma_f32_16x16x32_bf16 v[116:119], v[28:31], v[228:231], 0
  ds_read_b64_tr_b16 v[28:29], v8 offset:9728
  s_waitcnt lgkmcnt(11)
  v_mfma_f32_16x16x32_bf16 v[72:75], v[32:35], v[224:227], 0
  ds_read_b64_tr_b16 v[30:31], v9 offset:9728
  v_mfma_f32_16x16x32_bf16 v[76:79], v[32:35], v[228:231], 0
  ds_read_b64_tr_b16 v[32:33], v10 offset:8192
  v_mfma_f32_16x16x32_bf16 v[88:91], v[36:39], v[224:227], 0
  ds_read_b64_tr_b16 v[34:35], v11 offset:8192
  v_mfma_f32_16x16x32_bf16 v[92:95], v[36:39], v[228:231], 0
  ds_read_b64_tr_b16 v[36:37], v10 offset:8704
  s_waitcnt lgkmcnt(11)
  v_mfma_f32_16x16x32_bf16 v[104:107], v[40:43], v[224:227], 0
  ds_read_b64_tr_b16 v[38:39], v11 offset:8704
  v_mfma_f32_16x16x32_bf16 v[108:111], v[40:43], v[228:231], 0
  ds_read_b64_tr_b16 v[40:41], v10 offset:9216
  v_mfma_f32_16x16x32_bf16 v[120:123], v[44:47], v[224:227], 0
  ds_read_b64_tr_b16 v[42:43], v11 offset:9216
  v_mfma_f32_16x16x32_bf16 v[124:127], v[44:47], v[228:231], 0
  ds_read_b64_tr_b16 v[44:45], v10 offset:9728
  s_waitcnt lgkmcnt(11)
  v_mfma_f32_16x16x32_bf16 v[64:67], v[16:19], v[232:235], v[64:67]
  ds_read_b64_tr_b16 v[46:47], v11 offset:9728
  v_mfma_f32_16x16x32_bf16 v[68:71], v[16:19], v[236:239], v[68:71]
  ds_read_b64_tr_b16 v[16:17], v8 offset:16384
  v_mfma_f32_16x16x32_bf16 v[80:83], v[20:23], v[232:235], v[80:83]
  ds_read_b64_tr_b16 v[18:19], v9 offset:16384
  v_mfma_f32_16x16x32_bf16 v[84:87], v[20:23], v[236:239], v[84:87]
  ds_read_b64_tr_b16 v[20:21], v8 offset:16896
  s_waitcnt lgkmcnt(11)
  v_mfma_f32_16x16x32_bf16 v[96:99], v[24:27], v[232:235], v[96:99]
  ds_read_b64_tr_b16 v[22:23], v9 offset:16896
  v_mfma_f32_16x16x32_bf16 v[100:103], v[24:27], v[236:239], v[100:103]
  ds_read_b64_tr_b16 v[24:25], v8 offset:17408
  v_mfma_f32_16x16x32_bf16 v[112:115], v[28:31], v[232:235], v[112:115]
  ds_read_b64_tr_b16 v[26:27], v9 offset:17408
  v_mfma_f32_16x16x32_bf16 v[116:119], v[28:31], v[236:239], v[116:119]
  ds_read_b64_tr_b16 v[28:29], v8 offset:17920
  s_waitcnt lgkmcnt(11)
  v_mfma_f32_16x16x32_bf16 v[72:75], v[32:35], v[232:235], v[72:75]
  ds_read_b64_tr_b16 v[30:31], v9 offset:17920
  v_mfma_f32_16x16x32_bf16 v[76:79], v[32:35], v[236:239], v[76:79]
  ds_read_b64_tr_b16 v[32:33], v10 offset:16384
  v_mfma_f32_16x16x32_bf16 v[88:91], v[36:39], v[232:235], v[88:91]
  ds_read_b64_tr_b16 v[34:35], v11 offset:16384
  v_mfma_f32_16x16x32_bf16 v[92:95], v[36:39], v[236:239], v[92:95]
  ds_read_b64_tr_b16 v[36:37], v10 offset:16896
  s_waitcnt lgkmcnt(11)
  v_mfma_f32_16x16x32_bf16 v[104:107], v[40:43], v[232:235], v[104:107]
  ds_read_b64_tr_b16 v[38:39], v11 offset:16896
  v_mfma_f32_16x16x32_bf16 v[108:111], v[40:43], v[236:239], v[108:111]
  ds_read_b64_tr_b16 v[40:41], v10 offset:17408
  v_mfma_f32_16x16x32_bf16 v[120:123], v[44:47], v[232:235], v[120:123]
  ds_read_b64_tr_b16 v[42:43], v11 offset:17408
  v_mfma_f32_16x16x32_bf16 v[124:127], v[44:47], v[236:239], v[124:127]
  ds_read_b64_tr_b16 v[44:45], v10 offset:17920
  s_waitcnt lgkmcnt(11)
  v_mfma_f32_16x16x32_bf16 v[64:67], v[16:19], v[240:243], v[64:67]
  ds_read_b64_tr_b16 v[46:47], v11 offset:17920
  v_mfma_f32_16x16x32_bf16 v[68:71], v[16:19], v[244:247], v[68:71]
  ds_read_b64_tr_b16 v[16:17], v8 offset:24576
  v_mfma_f32_16x16x32_bf16 v[80:83], v[20:23], v[240:243], v[80:83]
  ds_read_b64_tr_b16 v[18:19], v9 offset:24576
  v_mfma_f32_16x16x32_bf16 v[84:87], v[20:23], v[244:247], v[84:87]
  ds_read_b64_tr_b16 v[20:21], v8 offset:25088
  s_waitcnt lgkmcnt(11)
  v_mfma_f32_16x16x32_bf16 v[96:99], v[24:27], v[240:243], v[96:99]
  ds_read_b64_tr_b16 v[22:23], v9 offset:25088
  v_mfma_f32_16x16x32_bf16 v[100:103], v[24:27], v[244:247], v[100:103]
  ds_read_b64_tr_b16 v[24:25], v8 offset:25600
  v_mfma_f32_16x16x32_bf16 v[112:115], v[28:31], v[240:243], v[112:115]
  ds_read_b64_tr_b16 v[26:27], v9 offset:25600
  v_mfma_f32_16x16x32_bf16 v[116:119], v[28:31], v[244:247], v[116:119]
  ds_read_b64_tr_b16 v[28:29], v8 offset:26112
  s_waitcnt lgkmcnt(11)
  v_mfma_f32_16x16x32_bf16 v[72:75], v[32:35], v[240:243], v[72:75]
  ds_read_b64_tr_b16 v[30:31], v9 offset:26112
  v_mfma_f32_16x16x32_bf16 v[76:79], v[32:35], v[244:247], v[76:79]
  ds_read_b64_tr_b16 v[32:33], v10 offset:24576
  v_mfma_f32_16x16x32_bf16 v[88:91], v[36:39], v[240:243], v[88:91]
  ds_read_b64_tr_b16 v[34:35], v11 offset:24576
  v_mfma_f32_16x16x32_bf16 v[92:95], v[36:39], v[244:247], v[92:95]
  ds_read_b64_tr_b16 v[36:37], v10 offset:25088
  s_waitcnt lgkmcnt(11)
  v_mfma_f32_16x16x32_bf16 v[104:107], v[40:43], v[240:243], v[104:107]
  ds_read_b64_tr_b16 v[38:39], v11 offset:25088
  v_mfma_f32_16x16x32_bf16 v[108:111], v[40:43], v[244:247], v[108:111]
  ds_read_b64_tr_b16 v[40:41], v10 offset:25600
  v_mfma_f32_16x16x32_bf16 v[120:123], v[44:47], v[240:243], v[120:123]
  ds_read_b64_tr_b16 v[42:43], v11 offset:25600
  v_mfma_f32_16x16x32_bf16 v[124:127], v[44:47], v[244:247], v[124:127]
  ds_read_b64_tr_b16 v[44:45], v10 offset:26112
  ds_read_b64_tr_b16 v[46:47], v11 offset:26112
  s_waitcnt lgkmcnt(12)
  v_mfma_f32_16x16x32_bf16 v[64:67], v[16:19], v[248:251], v[64:67]
  v_mfma_f32_16x16x32_bf16 v[68:71], v[16:19], v[252:255], v[68:71]
  s_add_u32 s32, s32, s62
  s_cmp_eq_u32 s32, s63
  s_cselect_b32 s32, 0, s32
  v_add_u32 v8, s32, v12
  v_xor_b32 v10, 32, v8
  v_add_u32 v9, s61, v10
  v_add_u32 v11, s61, v8
  ds_read_b64_tr_b16 v[16:17], v8 offset:0
  v_mfma_f32_16x16x32_bf16 v[80:83], v[20:23], v[248:251], v[80:83]
  ds_read_b64_tr_b16 v[18:19], v9 offset:0
  v_mfma_f32_16x16x32_bf16 v[84:87], v[20:23], v[252:255], v[84:87]
  ds_read_b64_tr_b16 v[20:21], v8 offset:512
  s_waitcnt lgkmcnt(11)
  v_mfma_f32_16x16x32_bf16 v[96:99], v[24:27], v[248:251], v[96:99]
  ds_read_b64_tr_b16 v[22:23], v9 offset:512
  v_mfma_f32_16x16x32_bf16 v[100:103], v[24:27], v[252:255], v[100:103]
  ds_read_b64_tr_b16 v[24:25], v8 offset:1024
  v_mfma_f32_16x16x32_bf16 v[112:115], v[28:31], v[248:251], v[112:115]
  ds_read_b64_tr_b16 v[26:27], v9 offset:1024
  v_mfma_f32_16x16x32_bf16 v[116:119], v[28:31], v[252:255], v[116:119]
  ds_read_b64_tr_b16 v[28:29], v8 offset:1536
  s_waitcnt lgkmcnt(11)
  v_mfma_f32_16x16x32_bf16 v[72:75], v[32:35], v[248:251], v[72:75]
  ds_read_b64_tr_b16 v[30:31], v9 offset:1536
  v_mfma_f32_16x16x32_bf16 v[76:79], v[32:35], v[252:255], v[76:79]
  ds_read_b64_tr_b16 v[32:33], v10 offset:0
  v_mfma_f32_16x16x32_bf16 v[88:91], v[36:39], v[248:251], v[88:91]
  ds_read_b64_tr_b16 v[34:35], v11 offset:0
  v_mfma_f32_16x16x32_bf16 v[92:95], v[36:39], v[252:255], v[92:95]
  ds_read_b64_tr_b16 v[36:37], v10 offset:512
  s_waitcnt lgkmcnt(11)
  v_mfma_f32_16x16x32_bf16 v[104:107], v[40:43], v[248:251], v[104:107]
  ds_read_b64_tr_b16 v[38:39], v11 offset:512
  v_mfma_f32_16x16x32_bf16 v[108:111], v[40:43], v[252:255], v[108:111]
  ds_read_b64_tr_b16 v[40:41], v10 offset:1024
  v_mfma_f32_16x16x32_bf16 v[120:123], v[44:47], v[248:251], v[120:123]
  ds_read_b64_tr_b16 v[42:43], v11 offset:1024
  v_mfma_f32_16x16x32_bf16 v[124:127], v[44:47], v[252:255], v[124:127]
  s_mov_b64 exec, 1
  ds_add_u32 v13, v15 offset:288
  s_mov_b64 exec, -1
  ds_read_b64_tr_b16 v[44:45], v10 offset:1536
  s_waitcnt vmcnt(20)
  s_waitcnt lgkmcnt(11)
  v_mfma_f32_16x16x32_bf16 v[64:67], v[16:19], v[128:131], v[64:67]
  ds_read_b64_tr_b16 v[46:47], v11 offset:1536
  v_mfma_f32_16x16x32_bf16 v[68:71], v[16:19], v[132:135], v[68:71]
  ds_read_b64_tr_b16 v[16:17], v8 offset:8192
  v_mfma_f32_16x16x32_bf16 v[80:83], v[20:23], v[128:131], v[80:83]
  ds_read_b64_tr_b16 v[18:19], v9 offset:8192
  v_mfma_f32_16x16x32_bf16 v[84:87], v[20:23], v[132:135], v[84:87]
  ds_read_b64_tr_b16 v[20:21], v8 offset:8704
  s_waitcnt lgkmcnt(11)
  v_mfma_f32_16x16x32_bf16 v[96:99], v[24:27], v[128:131], v[96:99]
  ds_read_b64_tr_b16 v[22:23], v9 offset:8704
  v_mfma_f32_16x16x32_bf16 v[100:103], v[24:27], v[132:135], v[100:103]
  ds_read_b64_tr_b16 v[24:25], v8 offset:9216
  v_mfma_f32_16x16x32_bf16 v[112:115], v[28:31], v[128:131], v[112:115]
  ds_read_b64_tr_b16 v[26:27], v9 offset:9216
  v_mfma_f32_16x16x32_bf16 v[116:119], v[28:31], v[132:135], v[116:119]
  ds_read_b64_tr_b16 v[28:29], v8 offset:9728
  s_waitcnt lgkmcnt(11)
  v_mfma_f32_16x16x32_bf16 v[72:75], v[32:35], v[128:131], v[72:75]
  ds_read_b64_tr_b16 v[30:31], v9 offset:9728
  v_mfma_f32_16x16x32_bf16 v[76:79], v[32:35], v[132:135], v[76:79]
  ds_read_b64_tr_b16 v[32:33], v10 offset:8192
  v_mfma_f32_16x16x32_bf16 v[88:91], v[36:39], v[128:131], v[88:91]
  ds_read_b64_tr_b16 v[34:35], v11 offset:8192
  v_mfma_f32_16x16x32_bf16 v[92:95], v[36:39], v[132:135], v[92:95]
  ds_read_b64_tr_b16 v[36:37], v10 offset:8704
  s_waitcnt lgkmcnt(11)
  v_mfma_f32_16x16x32_bf16 v[104:107], v[40:43], v[128:131], v[104:107]
  ds_read_b64_tr_b16 v[38:39], v11 offset:8704
  v_mfma_f32_16x16x32_bf16 v[108:111], v[40:43], v[132:135], v[108:111]
  ds_read_b64_tr_b16 v[40:41], v10 offset:9216
  v_mfma_f32_16x16x32_bf16 v[120:123], v[44:47], v[128:131], v[120:123]
  ds_read_b64_tr_b16 v[42:43], v11 offset:9216
  v_mfma_f32_16x16x32_bf16 v[124:127], v[44:47], v[132:135], v[124:127]
  ds_read_b64_tr_b16 v[44:45], v10 offset:9728
  s_waitcnt lgkmcnt(11)
  v_mfma_f32_16x16x32_bf16 v[64:67], v[16:19], v[136:139], v[64:67]
  ds_read_b64_tr_b16 v[46:47], v11 offset:9728
  v_mfma_f32_16x16x32_bf16 v[68:71], v[16:19], v[140:143], v[68:71]
  ds_read_b64_tr_b16 v[16:17], v8 offset:16384
  v_mfma_f32_16x16x32_bf16 v[80:83], v[20:23], v[136:139], v[80:83]
  ds_read_b64_tr_b16 v[18:19], v9 offset:16384
  v_mfma_f32_16x16x32_bf16 v[84:87], v[20:23], v[140:143], v[84:87]
  ds_read_b64_tr_b16 v[20:21], v8 offset:16896
  s_waitcnt lgkmcnt(11)
  v_mfma_f32_16x16x32_bf16 v[96:99], v[24:27], v[136:139], v[96:99]
  ds_read_b64_tr_b16 v[22:23], v9 offset:16896
  v_mfma_f32_16x16x32_bf16 v[100:103], v[24:27], v[140:143], v[100:103]
  ds_read_b64_tr_b16 v[24:25], v8 offset:17408
  v_mfma_f32_16x16x32_bf16 v[112:115], v[28:31], v[136:139], v[112:115]
  ds_read_b64_tr_b16 v[26:27], v9 offset:17408
  v_mfma_f32_16x16x32_bf16 v[116:119], v[28:31], v[140:143], v[116:119]
  ds_read_b64_tr_b16 v[28:29], v8 offset:17920
  s_waitcnt lgkmcnt(11)
  v_mfma_f32_16x16x32_bf16 v[72:75], v[32:35], v[136:139], v[72:75]
  ds_read_b64_tr_b16 v[30:31], v9 offset:17920
  v_mfma_f32_16x16x32_bf16 v[76:79], v[32:35], v[140:143], v[76:79]
  ds_read_b64_tr_b16 v[32:33], v10 offset:16384
  v_mfma_f32_16x16x32_bf16 v[88:91], v[36:39], v[136:139], v[88:91]
  ds_read_b64_tr_b16 v[34:35], v11 offset:16384
  v_mfma_f32_16x16x32_bf16 v[92:95], v[36:39], v[140:143], v[92:95]
  ds_read_b64_tr_b16 v[36:37], v10 offset:16896
  s_waitcnt lgkmcnt(11)
  v_mfma_f32_16x16x32_bf16 v[104:107], v[40:43], v[136:139], v[104:107]
  ds_read_b64_tr_b16 v[38:39], v11 offset:16896
  v_mfma_f32_16x16x32_bf16 v[108:111], v[40:43], v[140:143], v[108:111]
  ds_read_b64_tr_b16 v[40:41], v10 offset:17408
  v_mfma_f32_16x16x32_bf16 v[120:123], v[44:47], v[136:139], v[120:123]
  ds_read_b64_tr_b16 v[42:43], v11 offset:17408
  v_mfma_f32_16x16x32_bf16 v[124:127], v[44:47], v[140:143], v[124:127]
  ds_read_b64_tr_b16 v[44:45], v10 offset:17920
  s_waitcnt vmcnt(16)
  s_waitcnt lgkmcnt(11)
  v_mfma_f32_16x16x32_bf16 v[64:67], v[16:19], v[144:147], v[64:67]
  ds_read_b64_tr_b16 v[46:47], v11 offset:17920
  v_mfma_f32_16x16x32_bf16 v[68:71], v[16:19], v[148:151], v[68:71]
  ds_read_b64_tr_b16 v[16:17], v8 offset:24576
  v_mfma_f32_16x16x32_bf16 v[80:83], v[20:23], v[144:147], v[80:83]
  ds_read_b64_tr_b16 v[18:19], v9 offset:24576
  v_mfma_f32_16x16x32_bf16 v[84:87], v[20:23], v[148:151], v[84:87]
  ds_read_b64_tr_b16 v[20:21], v8 offset:25088
  s_waitcnt lgkmcnt(11)
  v_mfma_f32_16x16x32_bf16 v[96:99], v[24:27], v[144:147], v[96:99]
  ds_read_b64_tr_b16 v[22:23], v9 offset:25088
  v_mfma_f32_16x16x32_bf16 v[100:103], v[24:27], v[148:151], v[100:103]
  ds_read_b64_tr_b16 v[24:25], v8 offset:25600
  v_mfma_f32_16x16x32_bf16 v[112:115], v[28:31], v[144:147], v[112:115]
  ds_read_b64_tr_b16 v[26:27], v9 offset:25600
  v_mfma_f32_16x16x32_bf16 v[116:119], v[28:31], v[148:151], v[116:119]
  ds_read_b64_tr_b16 v[28:29], v8 offset:26112
  s_waitcnt lgkmcnt(11)
  v_mfma_f32_16x16x32_bf16 v[72:75], v[32:35], v[144:147], v[72:75]
  ds_read_b64_tr_b16 v[30:31], v9 offset:26112
  v_mfma_f32_16x16x32_bf16 v[76:79], v[32:35], v[148:151], v[76:79]
  ds_read_b64_tr_b16 v[32:33], v10 offset:24576
  v_mfma_f32_16x16x32_bf16 v[88:91], v[36:39], v[144:147], v[88:91]
  ds_read_b64_tr_b16 v[34:35], v11 offset:24576
  v_mfma_f32_16x16x32_bf16 v[92:95], v[36:39], v[148:151], v[92:95]
  ds_read_b64_tr_b16 v[36:37], v10 offset:25088
  s_waitcnt lgkmcnt(11)
  v_mfma_f32_16x16x32_bf16 v[104:107], v[40:43], v[144:147], v[104:107]
  ds_read_b64_tr_b16 v[38:39], v11 offset:25088
  v_mfma_f32_16x16x32_bf16 v[108:111], v[40:43], v[148:151], v[108:111]
  ds_read_b64_tr_b16 v[40:41], v10 offset:25600
  v_mfma_f32_16x16x32_bf16 v[120:123], v[44:47], v[144:147], v[120:123]
  ds_read_b64_tr_b16 v[42:43], v11 offset:25600
  v_mfma_f32_16x16x32_bf16 v[124:127], v[44:47], v[148:151], v[124:127]
  ds_read_b64_tr_b16 v[44:45], v10 offset:26112
  ds_read_b64_tr_b16 v[46:47], v11 offset:26112
  s_waitcnt lgkmcnt(12)
  v_mfma_f32_16x16x32_bf16 v[64:67], v[16:19], v[152:155], v[64:67]
  v_mfma_f32_16x16x32_bf16 v[68:71], v[16:19], v[156:159], v[68:71]
  s_add_u32 s32, s32, s62
  s_cmp_eq_u32 s32, s63
  s_cselect_b32 s32, 0, s32
  v_add_u32 v8, s32, v12
  v_xor_b32 v10, 32, v8
  v_add_u32 v9, s61, v10
  v_add_u32 v11, s61, v8
  ds_read_b64_tr_b16 v[16:17], v8 offset:0
  v_mfma_f32_16x16x32_bf16 v[80:83], v[20:23], v[152:155], v[80:83]
  ds_read_b64_tr_b16 v[18:19], v9 offset:0
  v_mfma_f32_16x16x32_bf16 v[84:87], v[20:23], v[156:159], v[84:87]
  ds_read_b64_tr_b16 v[20:21], v8 offset:512
  s_waitcnt lgkmcnt(11)
  v_mfma_f32_16x16x32_bf16 v[96:99], v[24:27], v[152:155], v[96:99]
  ds_read_b64_tr_b16 v[22:23], v9 offset:512
  v_mfma_f32_16x16x32_bf16 v[100:103], v[24:27], v[156:159], v[100:103]
  ds_read_b64_tr_b16 v[24:25], v8 offset:1024
  v_mfma_f32_16x16x32_bf16 v[112:115], v[28:31], v[152:155], v[112:115]
  ds_read_b64_tr_b16 v[26:27], v9 offset:1024
  v_mfma_f32_16x16x32_bf16 v[116:119], v[28:31], v[156:159], v[116:119]
  ds_read_b64_tr_b16 v[28:29], v8 offset:1536
  s_waitcnt lgkmcnt(11)
  v_mfma_f32_16x16x32_bf16 v[72:75], v[32:35], v[152:155], v[72:75]
  ds_read_b64_tr_b16 v[30:31], v9 offset:1536
  v_mfma_f32_16x16x32_bf16 v[76:79], v[32:35], v[156:159], v[76:79]
  ds_read_b64_tr_b16 v[32:33], v10 offset:0
  v_mfma_f32_16x16x32_bf16 v[88:91], v[36:39], v[152:155], v[88:91]
  ds_read_b64_tr_b16 v[34:35], v11 offset:0
  v_mfma_f32_16x16x32_bf16 v[92:95], v[36:39], v[156:159], v[92:95]
  ds_read_b64_tr_b16 v[36:37], v10 offset:512
  s_waitcnt lgkmcnt(11)
  v_mfma_f32_16x16x32_bf16 v[104:107], v[40:43], v[152:155], v[104:107]
  ds_read_b64_tr_b16 v[38:39], v11 offset:512
  v_mfma_f32_16x16x32_bf16 v[108:111], v[40:43], v[156:159], v[108:111]
  ds_read_b64_tr_b16 v[40:41], v10 offset:1024
  v_mfma_f32_16x16x32_bf16 v[120:123], v[44:47], v[152:155], v[120:123]
  ds_read_b64_tr_b16 v[42:43], v11 offset:1024
  v_mfma_f32_16x16x32_bf16 v[124:127], v[44:47], v[156:159], v[124:127]
  s_mov_b64 exec, 1
  ds_add_u32 v13, v15 offset:288
  s_mov_b64 exec, -1
  ds_read_b64_tr_b16 v[44:45], v10 offset:1536
  s_waitcnt vmcnt(12)
  s_waitcnt lgkmcnt(11)
  v_mfma_f32_16x16x32_bf16 v[64:67], v[16:19], v[160:163], v[64:67]
  ds_read_b64_tr_b16 v[46:47], v11 offset:1536
  v_mfma_f32_16x16x32_bf16 v[68:71], v[16:19], v[164:167], v[68:71]
  ds_read_b64_tr_b16 v[16:17], v8 offset:8192
  v_mfma_f32_16x16x32_bf16 v[80:83], v[20:23], v[160:163], v[80:83]
  ds_read_b64_tr_b16 v[18:19], v9 offset:8192
  v_mfma_f32_16x16x32_bf16 v[84:87], v[20:23], v[164:167], v[84:87]
  ds_read_b64_tr_b16 v[20:21], v8 offset:8704
  s_waitcnt lgkmcnt(11)
  v_mfma_f32_16x16x32_bf16 v[96:99], v[24:27], v[160:163], v[96:99]
  ds_read_b64_tr_b16 v[22:23], v9 offset:8704
  v_mfma_f32_16x16x32_bf16 v[100:103], v[24:27], v[164:167], v[100:103]
  ds_read_b64_tr_b16 v[24:25], v8 offset:9216
  v_mfma_f32_16x16x32_bf16 v[112:115], v[28:31], v[160:163], v[112:115]
  ds_read_b64_tr_b16 v[26:27], v9 offset:9216
  v_mfma_f32_16x16x32_bf16 v[116:119], v[28:31], v[164:167], v[116:119]
  ds_read_b64_tr_b16 v[28:29], v8 offset:9728
  s_waitcnt lgkmcnt(11)
  v_mfma_f32_16x16x32_bf16 v[72:75], v[32:35], v[160:163], v[72:75]
  ds_read_b64_tr_b16 v[30:31], v9 offset:9728
  v_mfma_f32_16x16x32_bf16 v[76:79], v[32:35], v[164:167], v[76:79]
  ds_read_b64_tr_b16 v[32:33], v10 offset:8192
  v_mfma_f32_16x16x32_bf16 v[88:91], v[36:39], v[160:163], v[88:91]
  ds_read_b64_tr_b16 v[34:35], v11 offset:8192
  v_mfma_f32_16x16x32_bf16 v[92:95], v[36:39], v[164:167], v[92:95]
  ds_read_b64_tr_b16 v[36:37], v10 offset:8704
  s_waitcnt lgkmcnt(11)
  v_mfma_f32_16x16x32_bf16 v[104:107], v[40:43], v[160:163], v[104:107]
  ds_read_b64_tr_b16 v[38:39], v11 offset:8704
  v_mfma_f32_16x16x32_bf16 v[108:111], v[40:43], v[164:167], v[108:111]
  ds_read_b64_tr_b16 v[40:41], v10 offset:9216
  v_mfma_f32_16x16x32_bf16 v[120:123], v[44:47], v[160:163], v[120:123]
  ds_read_b64_tr_b16 v[42:43], v11 offset:9216
  v_mfma_f32_16x16x32_bf16 v[124:127], v[44:47], v[164:167], v[124:127]
  ds_read_b64_tr_b16 v[44:45], v10 offset:9728
  s_waitcnt lgkmcnt(11)
  v_mfma_f32_16x16x32_bf16 v[64:67], v[16:19], v[168:171], v[64:67]
  ds_read_b64_tr_b16 v[46:47], v11 offset:9728
  v_mfma_f32_16x16x32_bf16 v[68:71], v[16:19], v[172:175], v[68:71]
  ds_read_b64_tr_b16 v[16:17], v8 offset:16384
  v_mfma_f32_16x16x32_bf16 v[80:83], v[20:23], v[168:171], v[80:83]
  ds_read_b64_tr_b16 v[18:19], v9 offset:16384
  v_mfma_f32_16x16x32_bf16 v[84:87], v[20:23], v[172:175], v[84:87]
  ds_read_b64_tr_b16 v[20:21], v8 offset:16896
  s_waitcnt lgkmcnt(11)
  v_mfma_f32_16x16x32_bf16 v[96:99], v[24:27], v[168:171], v[96:99]
  ds_read_b64_tr_b16 v[22:23], v9 offset:16896
  v_mfma_f32_16x16x32_bf16 v[100:103], v[24:27], v[172:175], v[100:103]
  ds_read_b64_tr_b16 v[24:25], v8 offset:17408
  v_mfma_f32_16x16x32_bf16 v[112:115], v[28:31], v[168:171], v[112:115]
  ds_read_b64_tr_b16 v[26:27], v9 offset:17408
  v_mfma_f32_16x16x32_bf16 v[116:119], v[28:31], v[172:175], v[116:119]
  ds_read_b64_tr_b16 v[28:29], v8 offset:17920
  s_waitcnt lgkmcnt(11)
  v_mfma_f32_16x16x32_bf16 v[72:75], v[32:35], v[168:171], v[72:75]
  ds_read_b64_tr_b16 v[30:31], v9 offset:17920
  v_mfma_f32_16x16x32_bf16 v[76:79], v[32:35], v[172:175], v[76:79]
  ds_read_b64_tr_b16 v[32:33], v10 offset:16384
  v_mfma_f32_16x16x32_bf16 v[88:91], v[36:39], v[168:171], v[88:91]
  ds_read_b64_tr_b16 v[34:35], v11 offset:16384
  v_mfma_f32_16x16x32_bf16 v[92:95], v[36:39], v[172:175], v[92:95]
  ds_read_b64_tr_b16 v[36:37], v10 offset:16896
  s_waitcnt lgkmcnt(11)
  v_mfma_f32_16x16x32_bf16 v[104:107], v[40:43], v[168:171], v[104:107]
  ds_read_b64_tr_b16 v[38:39], v11 offset:16896
  v_mfma_f32_16x16x32_bf16 v[108:111], v[40:43], v[172:175], v[108:111]
  ds_read_b64_tr_b16 v[40:41], v10 offset:17408
  v_mfma_f32_16x16x32_bf16 v[120:123], v[44:47], v[168:171], v[120:123]
  ds_read_b64_tr_b16 v[42:43], v11 offset:17408
  v_mfma_f32_16x16x32_bf16 v[124:127], v[44:47], v[172:175], v[124:127]
  ds_read_b64_tr_b16 v[44:45], v10 offset:17920
  s_waitcnt vmcnt(8)
  s_waitcnt lgkmcnt(11)
  v_mfma_f32_16x16x32_bf16 v[64:67], v[16:19], v[176:179], v[64:67]
  ds_read_b64_tr_b16 v[46:47], v11 offset:17920
  v_mfma_f32_16x16x32_bf16 v[68:71], v[16:19], v[180:183], v[68:71]
  ds_read_b64_tr_b16 v[16:17], v8 offset:24576
  v_mfma_f32_16x16x32_bf16 v[80:83], v[20:23], v[176:179], v[80:83]
  ds_read_b64_tr_b16 v[18:19], v9 offset:24576
  v_mfma_f32_16x16x32_bf16 v[84:87], v[20:23], v[180:183], v[84:87]
  ds_read_b64_tr_b16 v[20:21], v8 offset:25088
  s_waitcnt lgkmcnt(11)
  v_mfma_f32_16x16x32_bf16 v[96:99], v[24:27], v[176:179], v[96:99]
  ds_read_b64_tr_b16 v[22:23], v9 offset:25088
  v_mfma_f32_16x16x32_bf16 v[100:103], v[24:27], v[180:183], v[100:103]
  ds_read_b64_tr_b16 v[24:25], v8 offset:25600
  v_mfma_f32_16x16x32_bf16 v[112:115], v[28:31], v[176:179], v[112:115]
  ds_read_b64_tr_b16 v[26:27], v9 offset:25600
  v_mfma_f32_16x16x32_bf16 v[116:119], v[28:31], v[180:183], v[116:119]
  ds_read_b64_tr_b16 v[28:29], v8 offset:26112
  s_waitcnt lgkmcnt(11)
  v_mfma_f32_16x16x32_bf16 v[72:75], v[32:35], v[176:179], v[72:75]
  ds_read_b64_tr_b16 v[30:31], v9 offset:26112
  v_mfma_f32_16x16x32_bf16 v[76:79], v[32:35], v[180:183], v[76:79]
  ds_read_b64_tr_b16 v[32:33], v10 offset:24576
  v_mfma_f32_16x16x32_bf16 v[88:91], v[36:39], v[176:179], v[88:91]
  ds_read_b64_tr_b16 v[34:35], v11 offset:24576
  v_mfma_f32_16x16x32_bf16 v[92:95], v[36:39], v[180:183], v[92:95]
  ds_read_b64_tr_b16 v[36:37], v10 offset:25088
  s_waitcnt lgkmcnt(11)
  v_mfma_f32_16x16x32_bf16 v[104:107], v[40:43], v[176:179], v[104:107]
  ds_read_b64_tr_b16 v[38:39], v11 offset:25088
  v_mfma_f32_16x16x32_bf16 v[108:111], v[40:43], v[180:183], v[108:111]
  ds_read_b64_tr_b16 v[40:41], v10 offset:25600
  v_mfma_f32_16x16x32_bf16 v[120:123], v[44:47], v[176:179], v[120:123]
  ds_read_b64_tr_b16 v[42:43], v11 offset:25600
  v_mfma_f32_16x16x32_bf16 v[124:127], v[44:47], v[180:183], v[124:127]
  ds_read_b64_tr_b16 v[44:45], v10 offset:26112
  ds_read_b64_tr_b16 v[46:47], v11 offset:26112
  s_waitcnt lgkmcnt(12)
  v_mfma_f32_16x16x32_bf16 v[64:67], v[16:19], v[184:187], v[64:67]
  v_mfma_f32_16x16x32_bf16 v[68:71], v[16:19], v[188:191], v[68:71]
  s_add_u32 s32, s32, s62
  s_cmp_eq_u32 s32, s63
  s_cselect_b32 s32, 0, s32
  v_add_u32 v8, s32, v12
  v_xor_b32 v10, 32, v8
  v_add_u32 v9, s61, v10
  v_add_u32 v11, s61, v8
  ds_read_b64_tr_b16 v[16:17], v8 offset:0
  v_mfma_f32_16x16x32_bf16 v[80:83], v[20:23], v[184:187], v[80:83]
  ds_read_b64_tr_b16 v[18:19], v9 offset:0
  v_mfma_f32_16x16x32_bf16 v[84:87], v[20:23], v[188:191], v[84:87]
  ds_read_b64_tr_b16 v[20:21], v10 offset:0
  s_waitcnt lgkmcnt(11)
  v_mfma_f32_16x16x32_bf16 v[96:99], v[24:27], v[184:187], v[96:99]
  ds_read_b64_tr_b16 v[22:23], v11 offset:0
  v_mfma_f32_16x16x32_bf16 v[100:103], v[24:27], v[188:191], v[100:103]
  ds_read_b64_tr_b16 v[24:25], v8 offset:8192
  s_add_u32 s28, s10, 0x5000000
  s_addc_u32 s29, s11, 0
  s_mov_b32 s30, 0x1000000
  s_mov_b32 s31, 0x20000
  v_mfma_f32_16x16x32_bf16 v[112:115], v[28:31], v[184:187], v[112:115]
  ds_read_b64_tr_b16 v[26:27], v9 offset:8192
  v_mfma_f32_16x16x32_bf16 v[116:119], v[28:31], v[188:191], v[116:119]
  ds_read_b64_tr_b16 v[28:29], v10 offset:8192
  s_waitcnt lgkmcnt(11)
  v_mfma_f32_16x16x32_bf16 v[72:75], v[32:35], v[184:187], v[72:75]
  ds_read_b64_tr_b16 v[30:31], v11 offset:8192
  v_mfma_f32_16x16x32_bf16 v[76:79], v[32:35], v[188:191], v[76:79]
  ds_read_b64_tr_b16 v[32:33], v8 offset:16384
  s_lshr_b32 s65, s41, 2
  s_lshl_b32 s65, s65, 21
  s_lshl_b32 s36, s42, 15
  s_add_u32 s65, s65, s36
  s_lshl_b32 s36, s35, 13
  s_add_u32 s65, s65, s36
  s_add_u32 s36, s65, 4096
  v_lshrrev_b32 v6, 4, v1
  v_lshlrev_b32 v6, 9, v6
  v_and_b32 v7, 15, v1
  v_lshl_add_u32 v6, v7, 4, v6
  v_mfma_f32_16x16x32_bf16 v[88:91], v[36:39], v[184:187], v[88:91]
  ds_read_b64_tr_b16 v[34:35], v9 offset:16384
  v_mfma_f32_16x16x32_bf16 v[92:95], v[36:39], v[188:191], v[92:95]
  ds_read_b64_tr_b16 v[36:37], v10 offset:16384
  s_waitcnt lgkmcnt(11)
  v_mfma_f32_16x16x32_bf16 v[104:107], v[40:43], v[184:187], v[104:107]
  ds_read_b64_tr_b16 v[38:39], v11 offset:16384
  v_mfma_f32_16x16x32_bf16 v[108:111], v[40:43], v[188:191], v[108:111]
  ds_read_b64_tr_b16 v[40:41], v8 offset:24576
  v_mfma_f32_16x16x32_bf16 v[120:123], v[44:47], v[184:187], v[120:123]
  ds_read_b64_tr_b16 v[42:43], v9 offset:24576
  v_mfma_f32_16x16x32_bf16 v[124:127], v[44:47], v[188:191], v[124:127]
  s_mov_b64 exec, 1
  ds_add_u32 v13, v15 offset:288
  s_mov_b64 exec, -1
  ds_read_b64_tr_b16 v[44:45], v10 offset:24576
  s_waitcnt vmcnt(0)
  s_waitcnt lgkmcnt(11)
  v_mfma_f32_16x16x32_bf16 v[64:67], v[16:19], v[192:195], v[64:67]
  ds_read_b64_tr_b16 v[46:47], v11 offset:24576
  v_mfma_f32_16x16x32_bf16 v[68:71], v[16:19], v[196:199], v[68:71]
  ds_read_b64_tr_b16 v[16:17], v8 offset:512
  v_mfma_f32_16x16x32_bf16 v[72:75], v[20:23], v[192:195], v[72:75]
  ds_read_b64_tr_b16 v[18:19], v9 offset:512
  v_mfma_f32_16x16x32_bf16 v[76:79], v[20:23], v[196:199], v[76:79]
  ds_read_b64_tr_b16 v[20:21], v10 offset:512
  s_waitcnt lgkmcnt(11)
  v_mfma_f32_16x16x32_bf16 v[64:67], v[24:27], v[200:203], v[64:67]
  ds_read_b64_tr_b16 v[22:23], v11 offset:512
  v_mfma_f32_16x16x32_bf16 v[68:71], v[24:27], v[204:207], v[68:71]
  ds_read_b64_tr_b16 v[24:25], v8 offset:8704
  v_mfma_f32_16x16x32_bf16 v[72:75], v[28:31], v[200:203], v[72:75]
  ds_read_b64_tr_b16 v[26:27], v9 offset:8704
  v_mfma_f32_16x16x32_bf16 v[76:79], v[28:31], v[204:207], v[76:79]
  ds_read_b64_tr_b16 v[28:29], v10 offset:8704
  s_waitcnt lgkmcnt(11)
  v_mfma_f32_16x16x32_bf16 v[64:67], v[32:35], v[208:211], v[64:67]
  ds_read_b64_tr_b16 v[30:31], v11 offset:8704
  v_mfma_f32_16x16x32_bf16 v[68:71], v[32:35], v[212:215], v[68:71]
  ds_read_b64_tr_b16 v[32:33], v8 offset:16896
  v_mfma_f32_16x16x32_bf16 v[72:75], v[36:39], v[208:211], v[72:75]
  ds_read_b64_tr_b16 v[34:35], v9 offset:16896
  v_mfma_f32_16x16x32_bf16 v[76:79], v[36:39], v[212:215], v[76:79]
  ds_read_b64_tr_b16 v[36:37], v10 offset:16896
  s_waitcnt lgkmcnt(11)
  v_mfma_f32_16x16x32_bf16 v[64:67], v[40:43], v[216:219], v[64:67]
  ds_read_b64_tr_b16 v[38:39], v11 offset:16896
  v_mfma_f32_16x16x32_bf16 v[68:71], v[40:43], v[220:223], v[68:71]
  ds_read_b64_tr_b16 v[40:41], v8 offset:25088
  v_mfma_f32_16x16x32_bf16 v[72:75], v[44:47], v[216:219], v[72:75]
  ds_read_b64_tr_b16 v[42:43], v9 offset:25088
  v_mfma_f32_16x16x32_bf16 v[76:79], v[44:47], v[220:223], v[76:79]
  ds_read_b64_tr_b16 v[44:45], v10 offset:25088
  s_waitcnt lgkmcnt(11)
  v_mfma_f32_16x16x32_bf16 v[80:83], v[16:19], v[192:195], v[80:83]
  ds_read_b64_tr_b16 v[46:47], v11 offset:25088
  v_mfma_f32_16x16x32_bf16 v[84:87], v[16:19], v[196:199], v[84:87]
  ds_read_b64_tr_b16 v[16:17], v8 offset:1024
  v_mfma_f32_16x16x32_bf16 v[88:91], v[20:23], v[192:195], v[88:91]
  ds_read_b64_tr_b16 v[18:19], v9 offset:1024
  v_mfma_f32_16x16x32_bf16 v[92:95], v[20:23], v[196:199], v[92:95]
  ds_read_b64_tr_b16 v[20:21], v10 offset:1024
  v_cvt_pk_bf16_f32 v128, v64, v65
  s_waitcnt lgkmcnt(11)
  v_mfma_f32_16x16x32_bf16 v[80:83], v[24:27], v[200:203], v[80:83]
  ds_read_b64_tr_b16 v[22:23], v11 offset:1024
  v_cvt_pk_bf16_f32 v129, v66, v67
  v_mfma_f32_16x16x32_bf16 v[84:87], v[24:27], v[204:207], v[84:87]
  ds_read_b64_tr_b16 v[24:25], v8 offset:9216
  v_cvt_pk_bf16_f32 v130, v72, v73
  v_mfma_f32_16x16x32_bf16 v[88:91], v[28:31], v[200:203], v[88:91]
  ds_read_b64_tr_b16 v[26:27], v9 offset:9216
  v_cvt_pk_bf16_f32 v131, v74, v75
  v_mfma_f32_16x16x32_bf16 v[92:95], v[28:31], v[204:207], v[92:95]
  ds_read_b64_tr_b16 v[28:29], v10 offset:9216
  buffer_store_dwordx4 v[128:131], v6, s[28:31], s65 offen offset:0 sc1
  s_waitcnt lgkmcnt(11)
  v_mfma_f32_16x16x32_bf16 v[80:83], v[32:35], v[208:211], v[80:83]
  ds_read_b64_tr_b16 v[30:31], v11 offset:9216
  v_cvt_pk_bf16_f32 v132, v68, v69
  v_mfma_f32_16x16x32_bf16 v[84:87], v[32:35], v[212:215], v[84:87]
  ds_read_b64_tr_b16 v[32:33], v8 offset:17408
  v_cvt_pk_bf16_f32 v133, v70, v71
  v_mfma_f32_16x16x32_bf16 v[88:91], v[36:39], v[208:211], v[88:91]
  ds_read_b64_tr_b16 v[34:35], v9 offset:17408
  v_cvt_pk_bf16_f32 v134, v76, v77
  v_mfma_f32_16x16x32_bf16 v[92:95], v[36:39], v[212:215], v[92:95]
  ds_read_b64_tr_b16 v[36:37], v10 offset:17408
  v_cvt_pk_bf16_f32 v135, v78, v79
  s_waitcnt lgkmcnt(11)
  v_mfma_f32_16x16x32_bf16 v[80:83], v[40:43], v[216:219], v[80:83]
  ds_read_b64_tr_b16 v[38:39], v11 offset:17408
  buffer_store_dwordx4 v[132:135], v6, s[28:31], s65 offen offset:256 sc1
  v_mfma_f32_16x16x32_bf16 v[84:87], v[40:43], v[220:223], v[84:87]
  ds_read_b64_tr_b16 v[40:41], v8 offset:25600
  v_mfma_f32_16x16x32_bf16 v[88:91], v[44:47], v[216:219], v[88:91]
  ds_read_b64_tr_b16 v[42:43], v9 offset:25600
  v_mfma_f32_16x16x32_bf16 v[92:95], v[44:47], v[220:223], v[92:95]
  ds_read_b64_tr_b16 v[44:45], v10 offset:25600
  s_waitcnt lgkmcnt(11)
  v_mfma_f32_16x16x32_bf16 v[96:99], v[16:19], v[192:195], v[96:99]
  ds_read_b64_tr_b16 v[46:47], v11 offset:25600
  v_mfma_f32_16x16x32_bf16 v[100:103], v[16:19], v[196:199], v[100:103]
  ds_read_b64_tr_b16 v[16:17], v8 offset:1536
  v_mfma_f32_16x16x32_bf16 v[104:107], v[20:23], v[192:195], v[104:107]
  ds_read_b64_tr_b16 v[18:19], v9 offset:1536
  v_mfma_f32_16x16x32_bf16 v[108:111], v[20:23], v[196:199], v[108:111]
  ds_read_b64_tr_b16 v[20:21], v10 offset:1536
  v_cvt_pk_bf16_f32 v136, v80, v81
  s_waitcnt lgkmcnt(11)
  v_mfma_f32_16x16x32_bf16 v[96:99], v[24:27], v[200:203], v[96:99]
  ds_read_b64_tr_b16 v[22:23], v11 offset:1536
  v_cvt_pk_bf16_f32 v137, v82, v83
  v_mfma_f32_16x16x32_bf16 v[100:103], v[24:27], v[204:207], v[100:103]
  ds_read_b64_tr_b16 v[24:25], v8 offset:9728
  v_cvt_pk_bf16_f32 v138, v88, v89
  v_mfma_f32_16x16x32_bf16 v[104:107], v[28:31], v[200:203], v[104:107]
  ds_read_b64_tr_b16 v[26:27], v9 offset:9728
  v_cvt_pk_bf16_f32 v139, v90, v91
  v_mfma_f32_16x16x32_bf16 v[108:111], v[28:31], v[204:207], v[108:111]
  ds_read_b64_tr_b16 v[28:29], v10 offset:9728
  buffer_store_dwordx4 v[136:139], v6, s[28:31], s65 offen offset:2048 sc1
  s_waitcnt lgkmcnt(11)
  v_mfma_f32_16x16x32_bf16 v[96:99], v[32:35], v[208:211], v[96:99]
  ds_read_b64_tr_b16 v[30:31], v11 offset:9728
  v_cvt_pk_bf16_f32 v140, v84, v85
  v_mfma_f32_16x16x32_bf16 v[100:103], v[32:35], v[212:215], v[100:103]
  ds_read_b64_tr_b16 v[32:33], v8 offset:17920
  v_cvt_pk_bf16_f32 v141, v86, v87
  v_mfma_f32_16x16x32_bf16 v[104:107], v[36:39], v[208:211], v[104:107]
  ds_read_b64_tr_b16 v[34:35], v9 offset:17920
  v_cvt_pk_bf16_f32 v142, v92, v93
  v_mfma_f32_16x16x32_bf16 v[108:111], v[36:39], v[212:215], v[108:111]
  ds_read_b64_tr_b16 v[36:37], v10 offset:17920
  v_cvt_pk_bf16_f32 v143, v94, v95
  s_waitcnt lgkmcnt(11)
  v_mfma_f32_16x16x32_bf16 v[96:99], v[40:43], v[216:219], v[96:99]
  ds_read_b64_tr_b16 v[38:39], v11 offset:17920
  buffer_store_dwordx4 v[140:143], v6, s[28:31], s65 offen offset:2304 sc1
  v_mfma_f32_16x16x32_bf16 v[100:103], v[40:43], v[220:223], v[100:103]
  ds_read_b64_tr_b16 v[40:41], v8 offset:26112
  v_mfma_f32_16x16x32_bf16 v[104:107], v[44:47], v[216:219], v[104:107]
  ds_read_b64_tr_b16 v[42:43], v9 offset:26112
  v_mfma_f32_16x16x32_bf16 v[108:111], v[44:47], v[220:223], v[108:111]
  ds_read_b64_tr_b16 v[44:45], v10 offset:26112
  ds_read_b64_tr_b16 v[46:47], v11 offset:26112
  s_waitcnt lgkmcnt(12)
  v_mfma_f32_16x16x32_bf16 v[112:115], v[16:19], v[192:195], v[112:115]
  v_mfma_f32_16x16x32_bf16 v[116:119], v[16:19], v[196:199], v[116:119]
  v_mfma_f32_16x16x32_bf16 v[120:123], v[20:23], v[192:195], v[120:123]
  v_mfma_f32_16x16x32_bf16 v[124:127], v[20:23], v[196:199], v[124:127]
  v_cvt_pk_bf16_f32 v144, v96, v97
  s_waitcnt lgkmcnt(8)
  v_mfma_f32_16x16x32_bf16 v[112:115], v[24:27], v[200:203], v[112:115]
  v_cvt_pk_bf16_f32 v145, v98, v99
  v_mfma_f32_16x16x32_bf16 v[116:119], v[24:27], v[204:207], v[116:119]
  v_cvt_pk_bf16_f32 v146, v104, v105
  v_mfma_f32_16x16x32_bf16 v[120:123], v[28:31], v[200:203], v[120:123]
  v_cvt_pk_bf16_f32 v147, v106, v107
  v_mfma_f32_16x16x32_bf16 v[124:127], v[28:31], v[204:207], v[124:127]
  buffer_store_dwordx4 v[144:147], v6, s[28:31], s36 offen offset:0 sc1
  s_waitcnt lgkmcnt(4)
  v_mfma_f32_16x16x32_bf16 v[112:115], v[32:35], v[208:211], v[112:115]
  v_cvt_pk_bf16_f32 v148, v100, v101
  v_mfma_f32_16x16x32_bf16 v[116:119], v[32:35], v[212:215], v[116:119]
  v_cvt_pk_bf16_f32 v149, v102, v103
  v_mfma_f32_16x16x32_bf16 v[120:123], v[36:39], v[208:211], v[120:123]
  v_cvt_pk_bf16_f32 v150, v108, v109
  v_mfma_f32_16x16x32_bf16 v[124:127], v[36:39], v[212:215], v[124:127]
  v_cvt_pk_bf16_f32 v151, v110, v111
  s_waitcnt lgkmcnt(0)
  v_mfma_f32_16x16x32_bf16 v[112:115], v[40:43], v[216:219], v[112:115]
  buffer_store_dwordx4 v[148:151], v6, s[28:31], s36 offen offset:256 sc1
  v_mfma_f32_16x16x32_bf16 v[116:119], v[40:43], v[220:223], v[116:119]
  v_mfma_f32_16x16x32_bf16 v[120:123], v[44:47], v[216:219], v[120:123]
  v_mfma_f32_16x16x32_bf16 v[124:127], v[44:47], v[220:223], v[124:127]
  s_mov_b64 exec, 1
  ds_add_u32 v13, v15 offset:288
  s_mov_b64 exec, -1
  s_setprio 0
  s_load_dwordx2 s[44:45], s[0:1], 0
  s_load_dwordx2 s[46:47], s[0:1], 56
  s_load_dwordx2 s[48:49], s[0:1], 64
  s_load_dwordx2 s[50:51], s[0:1], 72
  s_load_dwordx2 s[52:53], s[0:1], 96
  v_cvt_pk_bf16_f32 v152, v112, v113
  v_cvt_pk_bf16_f32 v153, v114, v115
  v_cvt_pk_bf16_f32 v154, v120, v121
  v_cvt_pk_bf16_f32 v155, v122, v123
  buffer_store_dwordx4 v[152:155], v6, s[28:31], s36 offen offset:2048 sc1
  v_cvt_pk_bf16_f32 v156, v116, v117
  v_cvt_pk_bf16_f32 v157, v118, v119
  v_cvt_pk_bf16_f32 v158, v124, v125
  v_cvt_pk_bf16_f32 v159, v126, v127
  buffer_store_dwordx4 v[156:159], v6, s[28:31], s36 offen offset:2304 sc1
fused_kernel_tail:
  s_lshr_b32 s54, s2, 5
  s_add_u32 s33, s54, s35
  s_add_u32 s34, s33, s35
  s_and_b32 s33, s33, 3
  s_sub_u32 s65, s34, 7
  s_cmp_ge_u32 s34, 7
  s_cselect_b32 s34, s65, s34
  s_and_b32 s55, s2, 7
  s_and_b32 s4, s3, 3
  s_andn2_b32 s5, s42, 3
  s_cmp_eq_u32 s40, 0
  s_cselect_b32 s7, 4, 0
  s_and_b32 s65, s55, 3
  s_add_u32 s56, s5, s65
  s_lshr_b32 s65, s55, 1
  s_add_u32 s43, s5, s65
  s_and_b32 s67, s55, 4
  s_add_u32 s67, s67, s35
  v_bfe_u32 v7, v1, 2, 3
  v_lshlrev_b32 v4, 10, v7
  v_lshlrev_b32 v5, 5, v7
  v_lshrrev_b32 v7, 5, v1
  v_lshl_add_u32 v4, v7, 9, v4
  v_lshl_add_u32 v5, v7, 4, v5
  v_lshlrev_b32 v6, 1, v5
  v_and_b32 v7, 3, v1
  v_lshl_add_u32 v4, v7, 4, v4
  v_lshl_add_u32 v5, v7, 10, v5
  v_lshl_add_u32 v8, v7, 3, v14
  s_lshl_b32 s65, s7, 5
  v_add_u32 v8, s65, v8
  v_add_u32 v13, s7, v14
  s_lshl_b32 s65, s4, 5
  v_add_u32 v7, s65, v8
  s_lshl_b32 s57, s56, 15
  s_lshl_b32 s65, s67, 12
  s_add_u32 s58, s57, s65
  s_lshl_b32 s65, s4, 8
  s_add_u32 s58, s58, s65
  s_lshl_b32 s65, s67, 6
  s_add_u32 s57, s57, s65
  s_lshl_b32 s65, s4, 13
  s_add_u32 s57, s57, s65
  s_lshl_b32 s59, s4, 9
  s_waitcnt lgkmcnt(0)
  s_mov_b32 s12, s44
  s_mov_b32 s13, s45
  s_mov_b32 s14, 0x200000
  s_mov_b32 s15, 0x20000
  s_mov_b32 s20, s10
  s_mov_b32 s21, s11
  s_mov_b32 s22, 0x3000
  s_mov_b32 s23, 0x20000
  buffer_load_dwordx4 v[72:75], v5, s[12:15], s58 offen
  s_add_u32 s65, s59, 4096
  buffer_load_dwordx4 v[48:51], v6, s[20:23], s65 offen sc1
  buffer_load_dwordx4 v[52:55], v6, s[20:23], s65 offen offset:16 sc1
  s_add_u32 s65, s59, 6144
  buffer_load_dwordx4 v[64:67], v6, s[20:23], s65 offen sc1
  buffer_load_dwordx4 v[68:71], v6, s[20:23], s65 offen offset:16 sc1
  s_add_u32 s65, s59, 8192
  buffer_load_dwordx4 v[56:59], v6, s[20:23], s65 offen sc1
  buffer_load_dwordx4 v[60:63], v6, s[20:23], s65 offen offset:16 sc1
  s_add_u32 s24, s10, 0x700000
  s_addc_u32 s25, s11, 0
  s_mov_b32 s26, 0x200000
  s_mov_b32 s27, 0x20000
  s_add_u32 s12, s10, 0x500000
  s_addc_u32 s13, s11, 0
  s_mov_b32 s14, 0x200000
  s_mov_b32 s15, 0x20000
  s_mov_b32 s20, s46
  s_mov_b32 s21, s47
  s_mov_b32 s22, 0x1c0000
  s_mov_b32 s23, 0x20000
  s_mov_b32 s68, s48
  s_mov_b32 s69, s49
  s_mov_b32 s70, 0x1c0000
  s_mov_b32 s71, 0x20000
  v_bfe_u32 v10, v1, 2, 3
  v_mul_u32_u24 v9, 3584, v10
  v_lshrrev_b32 v10, 5, v1
  v_lshl_add_u32 v9, v10, 6, v9
  v_and_b32 v11, 3, v1
  s_and_b32 s65, s4, 1
  s_lshl_b32 s65, s65, 1
  v_xor_b32 v11, s65, v11
  v_lshl_add_u32 v9, v11, 4, v9
  s_mul_i32 s36, s4, 114688
  s_lshl_b32 s37, s4, 12
  s_lshl_b32 s65, s41, 7
  s_add_u32 s36, s36, s65
  v_add_u32 v9, s36, v9
  s_mov_b32 s38, s72
  v_and_b32 v11, 7, v1
  v_lshl_add_u32 v11, v11, 2, v14
  s_cmp_ge_u32 s41, 28
  s_cselect_b32 s8, 4, s7
  s_mov_b32 s64, 262144
  s_waitcnt vmcnt(7)
  s_lshl_b32 s60, s35, 6
  s_add_u32 s60, s60, s42
  s_lshl_b32 s60, s60, 7
  s_add_u32 s60, s60, 36
  s_atomic_add s74, s[16:17], s60
  s_lshl_b32 s60, s4, 6
  s_add_u32 s60, s60, s56
  s_lshl_b32 s60, s60, 7
  s_add_u32 s60, s60, 36
fused_kernel_w1:
  s_load_dword s9, s[16:17], s60 glc
  ds_read_b32 v3, v11 offset:288
  s_waitcnt lgkmcnt(0)
  s_cmp_ge_u32 s9, 8
  s_cbranch_scc1 fused_kernel_w1d
  v_cmp_lt_u32 vcc, s8, v3
  s_sub_u32 s64, s64, 1
  s_cbranch_scc1 fused_kernel_w1d
  s_cmp_eq_u64 vcc, -1
  s_cbranch_scc1 fused_kernel_w1c
  s_sleep 4
  s_branch fused_kernel_w1
fused_kernel_w1c:
  s_add_u32 s38, s38, s62
  s_cmp_eq_u32 s38, s63
  s_cselect_b32 s38, 0, s38
  s_add_u32 s65, s33, s8
  s_and_b32 s65, s65, 3
  s_mul_i32 s65, s65, 458752
  s_add_u32 m0, s38, s37
  s_add_u32 s8, s8, 1
  s_add_u32 s66, s65, 0
  buffer_load_dwordx4 v9, s[20:23], s66 offen offset:0 lds
  s_add_u32 s66, s65, 27648
  buffer_load_dwordx4 v9, s[20:23], s66 offen offset:1024 lds
  s_add_u32 s66, s65, 55296
  buffer_load_dwordx4 v9, s[20:23], s66 offen offset:2048 lds
  s_add_u32 s66, s65, 82944
  buffer_load_dwordx4 v9, s[20:23], s66 offen offset:3072 lds
  s_add_u32 m0, m0, 0x4000
  s_add_u32 s66, s65, 0
  buffer_load_dwordx4 v9, s[68:71], s66 offen offset:0 lds
  s_add_u32 s66, s65, 27648
  buffer_load_dwordx4 v9, s[68:71], s66 offen offset:1024 lds
  s_add_u32 s66, s65, 55296
  buffer_load_dwordx4 v9, s[68:71], s66 offen offset:2048 lds
  s_add_u32 s66, s65, 82944
  buffer_load_dwordx4 v9, s[68:71], s66 offen offset:3072 lds
  s_branch fused_kernel_w1
fused_kernel_w1d:
  s_mov_b32 s65, s57
  buffer_load_dwordx4 v[16:19], v4, s[28:31], s65 offen sc1
  s_add_u32 s65, s65, 0x200000
  buffer_load_dwordx4 v[20:23], v4, s[28:31], s65 offen sc1
  s_add_u32 s65, s65, 0x200000
  buffer_load_dwordx4 v[24:27], v4, s[28:31], s65 offen sc1
  s_add_u32 s65, s65, 0x200000
  buffer_load_dwordx4 v[28:31], v4, s[28:31], s65 offen sc1
  s_add_u32 s65, s65, 0x200000
  buffer_load_dwordx4 v[32:35], v4, s[28:31], s65 offen sc1
  s_add_u32 s65, s65, 0x200000
  buffer_load_dwordx4 v[36:39], v4, s[28:31], s65 offen sc1
  s_add_u32 s65, s65, 0x200000
  buffer_load_dwordx4 v[40:43], v4, s[28:31], s65 offen sc1
  s_add_u32 s65, s65, 0x200000
  buffer_load_dwordx4 v[44:47], v4, s[28:31], s65 offen sc1
  v_lshrrev_b32 v3, 4, v1
  v_lshlrev_b32 v10, 12, v3
  v_and_b32 v3, 1, v3
  v_lshl_add_u32 v10, v3, 5, v10
  v_bfe_u32 v3, v1, 2, 2
  v_lshl_add_u32 v10, v3, 6, v10
  v_and_b32 v3, 3, v1
  v_lshl_add_u32 v10, v3, 3, v10
  s_mov_b32 s39, s72
  s_add_u32 s39, s39, s62
  s_cmp_eq_u32 s39, s63
  s_cselect_b32 s39, 0, s39
  v_add_u32 v96, s39, v10
  v_xor_b32 v97, 32, v96
  s_add_u32 s39, s39, s62
  s_cmp_eq_u32 s39, s63
  s_cselect_b32 s39, 0, s39
  v_add_u32 v98, s39, v10
  v_xor_b32 v99, 32, v98
  s_add_u32 s39, s39, s62
  s_cmp_eq_u32 s39, s63
  s_cselect_b32 s39, 0, s39
  v_add_u32 v100, s39, v10
  v_xor_b32 v101, 32, v100
  s_add_u32 s39, s39, s62
  s_cmp_eq_u32 s39, s63
  s_cselect_b32 s39, 0, s39
  v_add_u32 v102, s39, v10
  v_xor_b32 v103, 32, v102
  s_waitcnt vmcnt(7)
  v_lshlrev_b32 v76, 16, v16
  v_and_b32 v77, 0xffff0000, v16
  v_lshlrev_b32 v78, 16, v17
  v_and_b32 v79, 0xffff0000, v17
  v_lshlrev_b32 v80, 16, v18
  v_and_b32 v81, 0xffff0000, v18
  v_lshlrev_b32 v82, 16, v19
  v_and_b32 v83, 0xffff0000, v19
  s_waitcnt vmcnt(6)
  v_lshlrev_b32 v84, 16, v20
  v_and_b32 v85, 0xffff0000, v20
  v_lshlrev_b32 v86, 16, v21
  v_and_b32 v87, 0xffff0000, v21
  v_lshlrev_b32 v88, 16, v22
  v_and_b32 v89, 0xffff0000, v22
  v_lshlrev_b32 v90, 16, v23
  v_and_b32 v91, 0xffff0000, v23
  v_add_f32 v76, v76, v84
  v_add_f32 v77, v77, v85
  v_add_f32 v78, v78, v86
  v_add_f32 v79, v79, v87
  v_add_f32 v80, v80, v88
  v_add_f32 v81, v81, v89
  v_add_f32 v82, v82, v90
  v_add_f32 v83, v83, v91
  s_waitcnt vmcnt(5)
  v_lshlrev_b32 v84, 16, v24
  v_and_b32 v85, 0xffff0000, v24
  v_lshlrev_b32 v86, 16, v25
  v_and_b32 v87, 0xffff0000, v25
  v_lshlrev_b32 v88, 16, v26
  v_and_b32 v89, 0xffff0000, v26
  v_lshlrev_b32 v90, 16, v27
  v_and_b32 v91, 0xffff0000, v27
  v_add_f32 v76, v76, v84
  v_add_f32 v77, v77, v85
  v_add_f32 v78, v78, v86
  v_add_f32 v79, v79, v87
  v_add_f32 v80, v80, v88
  v_add_f32 v81, v81, v89
  v_add_f32 v82, v82, v90
  v_add_f32 v83, v83, v91
  s_waitcnt vmcnt(4)
  v_lshlrev_b32 v84, 16, v28
  v_and_b32 v85, 0xffff0000, v28
  v_lshlrev_b32 v86, 16, v29
  v_and_b32 v87, 0xffff0000, v29
  v_lshlrev_b32 v88, 16, v30
  v_and_b32 v89, 0xffff0000, v30
  v_lshlrev_b32 v90, 16, v31
  v_and_b32 v91, 0xffff0000, v31
  v_add_f32 v76, v76, v84
  v_add_f32 v77, v77, v85
  v_add_f32 v78, v78, v86
  v_add_f32 v79, v79, v87
  v_add_f32 v80, v80, v88
  v_add_f32 v81, v81, v89
  v_add_f32 v82, v82, v90
  v_add_f32 v83, v83, v91
  s_waitcnt vmcnt(3)
  v_lshlrev_b32 v84, 16, v32
  v_and_b32 v85, 0xffff0000, v32
  v_lshlrev_b32 v86, 16, v33
  v_and_b32 v87, 0xffff0000, v33
  v_lshlrev_b32 v88, 16, v34
  v_and_b32 v89, 0xffff0000, v34
  v_lshlrev_b32 v90, 16, v35
  v_and_b32 v91, 0xffff0000, v35
  v_add_f32 v76, v76, v84
  v_add_f32 v77, v77, v85
  v_add_f32 v78, v78, v86
  v_add_f32 v79, v79, v87
  v_add_f32 v80, v80, v88
  v_add_f32 v81, v81, v89
  v_add_f32 v82, v82, v90
  v_add_f32 v83, v83, v91
  s_waitcnt vmcnt(2)
  v_lshlrev_b32 v84, 16, v36
  v_and_b32 v85, 0xffff0000, v36
  v_lshlrev_b32 v86, 16, v37
  v_and_b32 v87, 0xffff0000, v37
  v_lshlrev_b32 v88, 16, v38
  v_and_b32 v89, 0xffff0000, v38
  v_lshlrev_b32 v90, 16, v39
  v_and_b32 v91, 0xffff0000, v39
  v_add_f32 v76, v76, v84
  v_add_f32 v77, v77, v85
  v_add_f32 v78, v78, v86
  v_add_f32 v79, v79, v87
  v_add_f32 v80, v80, v88
  v_add_f32 v81, v81, v89
  v_add_f32 v82, v82, v90
  v_add_f32 v83, v83, v91
  s_waitcnt vmcnt(1)
  v_lshlrev_b32 v84, 16, v40
  v_and_b32 v85, 0xffff0000, v40
  v_lshlrev_b32 v86, 16, v41
  v_and_b32 v87, 0xffff0000, v41
  v_lshlrev_b32 v88, 16, v42
  v_and_b32 v89, 0xffff0000, v42
  v_lshlrev_b32 v90, 16, v43
  v_and_b32 v91, 0xffff0000, v43
  v_add_f32 v76, v76, v84
  v_add_f32 v77, v77, v85
  v_add_f32 v78, v78, v86
  v_add_f32 v79, v79, v87
  v_add_f32 v80, v80, v88
  v_add_f32 v81, v81, v89
  v_add_f32 v82, v82, v90
  v_add_f32 v83, v83, v91
  s_waitcnt vmcnt(0)
  v_lshlrev_b32 v84, 16, v44
  v_and_b32 v85, 0xffff0000, v44
  v_lshlrev_b32 v86, 16, v45
  v_and_b32 v87, 0xffff0000, v45
  v_lshlrev_b32 v88, 16, v46
  v_and_b32 v89, 0xffff0000, v46
  v_lshlrev_b32 v90, 16, v47
  v_and_b32 v91, 0xffff0000, v47
  v_add_f32 v76, v76, v84
  v_add_f32 v77, v77, v85
  v_add_f32 v78, v78, v86
  v_add_f32 v79, v79, v87
  v_add_f32 v80, v80, v88
  v_add_f32 v81, v81, v89
  v_add_f32 v82, v82, v90
  v_add_f32 v83, v83, v91
  v_permlane32_swap_b32 v76, v80
  v_permlane32_swap_b32 v77, v81
  v_permlane32_swap_b32 v78, v82
  v_permlane32_swap_b32 v79, v83
  v_lshlrev_b32 v84, 16, v72
  v_and_b32 v85, 0xffff0000, v72
  v_lshlrev_b32 v86, 16, v73
  v_and_b32 v87, 0xffff0000, v73
  v_lshlrev_b32 v88, 16, v74
  v_and_b32 v89, 0xffff0000, v74
  v_lshlrev_b32 v90, 16, v75
  v_and_b32 v91, 0xffff0000, v75
  v_fmac_f32 v84, v76, v48
  v_fmac_f32 v85, v77, v49
  v_fmac_f32 v86, v78, v50
  v_fmac_f32 v87, v79, v51
  v_fmac_f32 v88, v80, v52
  v_fmac_f32 v89, v81, v53
  v_fmac_f32 v90, v82, v54
  v_fmac_f32 v91, v83, v55
  v_cvt_pk_bf16_f32 v72, v84, v85
  v_cvt_pk_bf16_f32 v73, v86, v87
  v_cvt_pk_bf16_f32 v74, v88, v89
  v_cvt_pk_bf16_f32 v75, v90, v91
  v_lshlrev_b32 v76, 16, v72
  v_and_b32 v77, 0xffff0000, v72
  v_lshlrev_b32 v78, 16, v73
  v_and_b32 v79, 0xffff0000, v73
  v_lshlrev_b32 v80, 16, v74
  v_and_b32 v81, 0xffff0000, v74
  v_lshlrev_b32 v82, 16, v75
  v_and_b32 v83, 0xffff0000, v75
  buffer_store_dwordx4 v[72:75], v5, s[24:27], s58 offen sc1
  v_add_f32 v84, v76, v77
  v_add_f32 v85, v78, v79
  v_add_f32 v86, v80, v81
  v_add_f32 v87, v82, v83
  v_add_f32 v84, v84, v85
  v_add_f32 v86, v86, v87
  v_add_f32 v92, v84, v86
  s_nop 1
  v_add_f32_dpp v92, v92, v92 row_ror:8 row_mask:0xf bank_mask:0xf
  s_nop 1
  v_add_f32_dpp v92, v92, v92 row_ror:4 row_mask:0xf bank_mask:0xf
  v_mov_b32 v84, v92
  s_nop 1
  v_permlane16_swap_b32 v84, v92
  v_add_f32 v92, v92, v84
  v_mov_b32 v84, v92
  s_nop 1
  v_permlane32_swap_b32 v84, v92
  v_add_f32 v92, v92, v84
  v_mul_f32 v92, 0x3c000000, v92
  v_sub_f32 v84, v76, v92
  v_sub_f32 v85, v77, v92
  v_sub_f32 v86, v78, v92
  v_sub_f32 v87, v79, v92
  v_sub_f32 v88, v80, v92
  v_sub_f32 v89, v81, v92
  v_sub_f32 v90, v82, v92
  v_sub_f32 v91, v83, v92
  v_mul_f32 v93, v84, v84
  v_mul_f32 v94, v85, v85
  v_fmac_f32 v93, v86, v86
  v_fmac_f32 v94, v87, v87
  v_fmac_f32 v93, v88, v88
  v_fmac_f32 v94, v89, v89
  v_fmac_f32 v93, v90, v90
  v_fmac_f32 v94, v91, v91
  v_add_f32 v93, v93, v94
  s_nop 1
  v_add_f32_dpp v93, v93, v93 row_ror:8 row_mask:0xf bank_mask:0xf
  s_nop 1
  v_add_f32_dpp v93, v93, v93 row_ror:4 row_mask:0xf bank_mask:0xf
  v_mov_b32 v84, v93
  s_nop 1
  v_permlane16_swap_b32 v84, v93
  v_add_f32 v93, v93, v84
  v_mov_b32 v84, v93
  s_nop 1
  v_permlane32_swap_b32 v84, v93
  v_add_f32 v93, v93, v84
  ds_write_b64 v7, v[92:93]
  ds_read2_b64 v[20:23], v8 offset1:4
  ds_read2_b64 v[24:27], v8 offset0:8 offset1:12
  s_waitcnt lgkmcnt(0)
  v_max3_u32 v84, v20, v21, v22
  v_max3_u32 v85, v23, v24, v25
  v_max3_u32 v84, v84, v26, v27
  v_max_u32 v84, v84, v85
  v_cmp_eq_u32 vcc, -1, v84
  s_nop 0
  s_cmp_eq_u64 vcc, 0
  s_cbranch_scc0 lsp_92
lsc_93:
  v_add_f32 v84, v20, v22
  v_add_f32 v85, v24, v26
  v_add_f32 v93, v21, v23
  v_add_f32 v88, v25, v27
  v_add_f32 v92, v84, v85
  v_add_f32 v93, v93, v88
  v_mul_f32 v92, 0x3e800000, v92
  v_sub_f32 v84, v20, v92
  v_sub_f32 v85, v22, v92
  v_sub_f32 v86, v24, v92
  v_sub_f32 v87, v26, v92
  v_sub_f32 v76, v76, v92
  v_sub_f32 v77, v77, v92
  v_sub_f32 v78, v78, v92
  v_sub_f32 v79, v79, v92
  v_mul_f32 v94, v84, v84
  v_mul_f32 v95, v85, v85
  v_fmac_f32 v94, v86, v86
  v_fmac_f32 v95, v87, v87
  v_sub_f32 v80, v80, v92
  v_sub_f32 v81, v81, v92
  v_sub_f32 v82, v82, v92
  v_sub_f32 v83, v83, v92
  v_add_f32 v94, v94, v95
  v_mov_b32 v84, 0x3727c5ac
  v_fmac_f32 v93, 0x43000000, v94
  v_mul_f32 v76, v76, v56
  v_mul_f32 v77, v77, v57
  v_mul_f32 v78, v78, v58
  v_mul_f32 v79, v79, v59
  v_fmac_f32 v84, 0x3b000000, v93
  v_mul_f32 v80, v80, v60
  v_mul_f32 v81, v81, v61
  v_mul_f32 v82, v82, v62
  v_mul_f32 v83, v83, v63
  v_rsq_f32 v84, v84
  s_nop 0
  v_fmac_f32 v64, v76, v84
  v_fmac_f32 v65, v77, v84
  v_fmac_f32 v66, v78, v84
  v_fmac_f32 v67, v79, v84
  v_fmac_f32 v68, v80, v84
  v_fmac_f32 v69, v81, v84
  v_fmac_f32 v70, v82, v84
  v_fmac_f32 v71, v83, v84
  v_cvt_pk_bf16_f32 v16, v64, v65
  v_cvt_pk_bf16_f32 v17, v66, v67
  v_cvt_pk_bf16_f32 v18, v68, v69
  v_cvt_pk_bf16_f32 v19, v70, v71
  buffer_store_dwordx4 v[16:19], v4, s[12:15], s57 offen sc1
  s_waitcnt vmcnt(0)
  s_mov_b64 exec, 1
  ds_add_rtn_u32 v3, v13, v15 offset:264
  s_mov_b64 exec, -1
  s_waitcnt lgkmcnt(0)
  v_readfirstlane_b32 s9, v3
  s_nop 0
  s_cmp_lg_u32 s9, 3
  s_cbranch_scc1 fused_kernel_c2w
  s_lshl_b32 s60, s56, 7
  s_add_u32 s60, s60, 40
  s_atomic_add s74, s[16:17], s60
  s_add_u32 s60, s60, 0x2000
  s_atomic_add s74, s[16:17], s60
  s_add_u32 s60, s60, 0x2000
  s_atomic_add s74, s[16:17], s60
  s_add_u32 s60, s60, 0x2000
  s_atomic_add s74, s[16:17], s60
fused_kernel_c2w:
  s_cmp_ge_u32 s8, 4
  s_cbranch_scc1 fused_kernel_c2x
  ds_read_b32 v3, v11 offset:288
  s_waitcnt lgkmcnt(0)
  v_cmp_lt_u32 vcc, s8, v3
  s_nop 0
  s_cmp_eq_u64 vcc, -1
  s_cbranch_scc0 lsp_94
lsc_95:
  s_add_u32 s38, s38, s62
  s_cmp_eq_u32 s38, s63
  s_cselect_b32 s38, 0, s38
  s_add_u32 s65, s33, s8
  s_and_b32 s65, s65, 3
  s_mul_i32 s65, s65, 458752
  s_add_u32 m0, s38, s37
  s_add_u32 s8, s8, 1
  s_add_u32 s66, s65, 0
  buffer_load_dwordx4 v9, s[20:23], s66 offen offset:0 lds
  s_add_u32 s66, s65, 27648
  buffer_load_dwordx4 v9, s[20:23], s66 offen offset:1024 lds
  s_add_u32 s66, s65, 55296
  buffer_load_dwordx4 v9, s[20:23], s66 offen offset:2048 lds
  s_add_u32 s66, s65, 82944
  buffer_load_dwordx4 v9, s[20:23], s66 offen offset:3072 lds
  s_add_u32 m0, m0, 0x4000
  s_add_u32 s66, s65, 0
  buffer_load_dwordx4 v9, s[68:71], s66 offen offset:0 lds
  s_add_u32 s66, s65, 27648
  buffer_load_dwordx4 v9, s[68:71], s66 offen offset:1024 lds
  s_add_u32 s66, s65, 55296
  buffer_load_dwordx4 v9, s[68:71], s66 offen offset:2048 lds
  s_add_u32 s66, s65, 82944
  buffer_load_dwordx4 v9, s[68:71], s66 offen offset:3072 lds
  s_branch fused_kernel_c2w
fused_kernel_c2x:
  s_setprio 0
  s_cmp_eq_u32 s40, 0
  s_cbranch_scc1 fused_kernel_c2y
  s_setprio 1
fused_kernel_c2y:
  s_lshl_b32 s60, s35, 6
  s_add_u32 s60, s60, s42
  s_lshl_b32 s60, s60, 7
  s_add_u32 s60, s60, 40
  s_load_dword s9, s[16:17], s60 glc
  v_mov_b32 v52, v96
  v_mov_b32 v53, v97
  v_mov_b32 v54, v98
  v_mov_b32 v55, v99
  v_mov_b32 v56, v100
  v_mov_b32 v57, v101
  v_mov_b32 v58, v102
  v_mov_b32 v59, v103
  v_lshrrev_b32 v7, 4, v1
  v_lshlrev_b32 v7, 11, v7
  v_and_b32 v10, 15, v1
  v_lshl_add_u32 v7, v10, 4, v7
  s_lshl_b32 s65, s42, 15
  v_add_u32 v7, s65, v7
  s_lshl_b32 s61, s33, 13
  v_mov_b32 v48, 0xbfb8aa3b
  v_mov_b32 v49, 0xbfb8aa3b
  v_mov_b32 v50, 1.0
  v_mov_b32 v51, 1.0
  s_and_b32 s32, s55, 1
  s_lshl_b32 s32, s32, 2
  s_add_u32 s32, s32, s35
  s_mov_b32 s28, s50
  s_mov_b32 s29, s51
  s_mov_b32 s30, 0x1c0000
  s_mov_b32 s31, 0x20000
  s_add_u32 s20, s10, 0x1000000
  s_addc_u32 s21, s11, 0
  s_mov_b32 s22, 0x700000
  s_mov_b32 s23, 0x20000
  v_bfe_u32 v10, v1, 2, 3
  v_mul_u32_u24 v9, 1024, v10
  v_lshrrev_b32 v10, 5, v1
  v_lshl_add_u32 v9, v10, 6, v9
  v_and_b32 v11, 3, v1
  v_bfe_u32 v10, v1, 4, 1
  v_lshlrev_b32 v10, 1, v10
  v_xor_b32 v11, v10, v11
  v_lshl_add_u32 v9, v11, 4, v9
  s_mul_i32 s65, s4, 458752
  s_lshl_b32 s66, s32, 7
  s_add_u32 s65, s65, s66
  v_add_u32 v9, s65, v9
  s_lshl_b32 s37, s4, 13
  s_lshl_b32 s36, s34, 16
  s_mov_b32 s38, s72
  s_mov_b32 s39, s72
  v_lshrrev_b32 v10, 5, v1
  v_lshlrev_b32 v12, 10, v10
  v_bfe_u32 v10, v1, 4, 1
  v_mul_u32_u24 v10, 288, v10
  v_add_u32 v12, v12, v10
  v_bfe_u32 v10, v1, 2, 2
  v_lshl_add_u32 v12, v10, 6, v12
  v_and_b32 v10, 3, v1
  v_lshl_add_u32 v12, v10, 3, v12
  v_add_u32 v12, s37, v12
  s_lshl_b32 s65, s3, 3
  v_lshrrev_b32 v5, 3, v1
  v_add_u32 v5, s65, v5
  v_and_b32 v10, 7, v1
  v_mul_u32_u24 v6, 272, v5
  v_lshl_add_u32 v6, v10, 5, v6
  v_lshlrev_b32 v8, 5, v10
  v_and_b32 v5, 31, v5
  v_lshlrev_b32 v5, 10, v5
  v_lshl_add_u32 v5, v10, 4, v5
  s_lshl_b32 s58, s43, 15
  s_lshl_b32 s65, s32, 7
  s_add_u32 s58, s58, s65
  s_lshl_b32 s59, s32, 8
  s_add_u32 s59, s59, 10240
  s_mul_i32 s65, s43, 114688
  s_mul_i32 s66, s4, 28672
  s_add_u32 s65, s65, s66
  v_add_u32 v4, s65, v2
  s_mul_i32 s6, s42, 114688
  s_lshl_b32 s67, s41, 12
  s_add_u32 s6, s6, s67
  s_mul_i32 s5, s41, 37
  s_lshr_b32 s5, s5, 8
  s_cmp_ge_u32 s41, 28
  s_cbranch_scc1 fused_kernel_noup
  s_cmp_eq_u32 s40, 0
  s_cbranch_scc1 fused_kernel_c2p
  s_waitcnt vmcnt(0)
  s_mov_b64 exec, 1
  ds_add_u32 v14, v15 offset:260
  s_mov_b64 exec, -1
fused_kernel_c2p:
  s_waitcnt lgkmcnt(0)
  s_cmp_ge_u32 s9, 8
  s_cbranch_scc0 spin_96
spc_97:
  buffer_load_dwordx4 v[128:131], v7, s[12:15], s61 offen offset:0 sc1
  buffer_load_dwordx4 v[132:135], v7, s[12:15], s61 offen offset:256 sc1
  buffer_load_dwordx4 v[136:139], v7, s[12:15], s61 offen offset:512 sc1
  buffer_load_dwordx4 v[140:143], v7, s[12:15], s61 offen offset:768 sc1
  buffer_load_dwordx4 v[144:147], v7, s[12:15], s61 offen offset:1024 sc1
  buffer_load_dwordx4 v[148:151], v7, s[12:15], s61 offen offset:1280 sc1
  buffer_load_dwordx4 v[152:155], v7, s[12:15], s61 offen offset:1536 sc1
  buffer_load_dwordx4 v[156:159], v7, s[12:15], s61 offen offset:1792 sc1
  s_add_u32 s61, s61, 0x2000
  s_and_b32 s61, s61, 0x7fff
  ds_read_b32 v3, v14 offset:260
  s_waitcnt lgkmcnt(0)
  v_readfirstlane_b32 s9, v3
  s_nop 0
  s_cmp_ge_u32 s9, 4
  s_cbranch_scc0 lsp_98
lsc_99:
  ds_read_b64_tr_b16 v[16:17], v52 offset:0
  ds_read_b64_tr_b16 v[18:19], v52 offset:256
  ds_read_b64_tr_b16 v[20:21], v52 offset:512
  ds_read_b64_tr_b16 v[22:23], v52 offset:768
  ds_read_b64_tr_b16 v[24:25], v52 offset:16384
  ds_read_b64_tr_b16 v[26:27], v52 offset:16640
  ds_read_b64_tr_b16 v[28:29], v52 offset:16896
  ds_read_b64_tr_b16 v[30:31], v52 offset:17152
  ds_read_b64_tr_b16 v[32:33], v53 offset:0
  ds_read_b64_tr_b16 v[34:35], v53 offset:256
  ds_read_b64_tr_b16 v[36:37], v53 offset:512
  ds_read_b64_tr_b16 v[38:39], v53 offset:768
  ds_read_b64_tr_b16 v[40:41], v53 offset:16384
  ds_read_b64_tr_b16 v[42:43], v53 offset:16640
  ds_read_b64_tr_b16 v[44:45], v53 offset:16896
  ds_read_b64_tr_b16 v[46:47], v53 offset:17152
  s_waitcnt vmcnt(6)
  s_waitcnt lgkmcnt(12)
  v_mfma_f32_16x16x32_bf16 v[64:67], v[16:19], v[128:131], 0
  v_mfma_f32_16x16x32_bf16 v[68:71], v[16:19], v[132:135], 0
  ds_read_b64_tr_b16 v[16:17], v52 offset:1024
  v_mfma_f32_16x16x32_bf16 v[80:83], v[20:23], v[128:131], 0
  ds_read_b64_tr_b16 v[18:19], v52 offset:1280
  v_mfma_f32_16x16x32_bf16 v[84:87], v[20:23], v[132:135], 0
  ds_read_b64_tr_b16 v[20:21], v52 offset:1536
  buffer_load_dwordx4 v[160:163], v7, s[12:15], s61 offen offset:0 sc1
  s_waitcnt lgkmcnt(11)
  v_mfma_f32_16x16x32_bf16 v[96:99], v[24:27], v[128:131], 0
  ds_read_b64_tr_b16 v[22:23], v52 offset:1792
  v_mfma_f32_16x16x32_bf16 v[100:103], v[24:27], v[132:135], 0
  ds_read_b64_tr_b16 v[24:25], v52 offset:17408
  v_mfma_f32_16x16x32_bf16 v[112:115], v[28:31], v[128:131], 0
  ds_read_b64_tr_b16 v[26:27], v52 offset:17664
  v_mfma_f32_16x16x32_bf16 v[116:119], v[28:31], v[132:135], 0
  ds_read_b64_tr_b16 v[28:29], v52 offset:17920
  buffer_load_dwordx4 v[164:167], v7, s[12:15], s61 offen offset:256 sc1
  s_waitcnt lgkmcnt(11)
  v_mfma_f32_16x16x32_bf16 v[72:75], v[32:35], v[128:131], 0
  ds_read_b64_tr_b16 v[30:31], v52 offset:18176
  v_mfma_f32_16x16x32_bf16 v[76:79], v[32:35], v[132:135], 0
  ds_read_b64_tr_b16 v[32:33], v53 offset:1024
  v_mfma_f32_16x16x32_bf16 v[88:91], v[36:39], v[128:131], 0
  ds_read_b64_tr_b16 v[34:35], v53 offset:1280
  v_mfma_f32_16x16x32_bf16 v[92:95], v[36:39], v[132:135], 0
  ds_read_b64_tr_b16 v[36:37], v53 offset:1536
  buffer_load_dwordx4 v[168:171], v7, s[12:15], s61 offen offset:512 sc1
  s_waitcnt lgkmcnt(11)
  v_mfma_f32_16x16x32_bf16 v[104:107], v[40:43], v[128:131], 0
  ds_read_b64_tr_b16 v[38:39], v53 offset:1792
  v_mfma_f32_16x16x32_bf16 v[108:111], v[40:43], v[132:135], 0
  ds_read_b64_tr_b16 v[40:41], v53 offset:17408
  v_mfma_f32_16x16x32_bf16 v[120:123], v[44:47], v[128:131], 0
  ds_read_b64_tr_b16 v[42:43], v53 offset:17664
  v_mfma_f32_16x16x32_bf16 v[124:127], v[44:47], v[132:135], 0
  ds_read_b64_tr_b16 v[44:45], v53 offset:17920
  buffer_load_dwordx4 v[172:175], v7, s[12:15], s61 offen offset:768 sc1
  s_waitcnt vmcnt(8)
  s_waitcnt lgkmcnt(11)
  v_mfma_f32_16x16x32_bf16 v[64:67], v[16:19], v[136:139], v[64:67]
  ds_read_b64_tr_b16 v[46:47], v53 offset:18176
  v_mfma_f32_16x16x32_bf16 v[68:71], v[16:19], v[140:143], v[68:71]
  ds_read_b64_tr_b16 v[16:17], v52 offset:2048
  v_mfma_f32_16x16x32_bf16 v[80:83], v[20:23], v[136:139], v[80:83]
  ds_read_b64_tr_b16 v[18:19], v52 offset:2304
  v_mfma_f32_16x16x32_bf16 v[84:87], v[20:23], v[140:143], v[84:87]
  ds_read_b64_tr_b16 v[20:21], v52 offset:2560
  buffer_load_dwordx4 v[176:179], v7, s[12:15], s61 offen offset:1024 sc1
  s_waitcnt lgkmcnt(11)
  v_mfma_f32_16x16x32_bf16 v[96:99], v[24:27], v[136:139], v[96:99]
  ds_read_b64_tr_b16 v[22:23], v52 offset:2816
  v_mfma_f32_16x16x32_bf16 v[100:103], v[24:27], v[140:143], v[100:103]
  ds_read_b64_tr_b16 v[24:25], v52 offset:18432
  v_mfma_f32_16x16x32_bf16 v[112:115], v[28:31], v[136:139], v[112:115]
  ds_read_b64_tr_b16 v[26:27], v52 offset:18688
  v_mfma_f32_16x16x32_bf16 v[116:119], v[28:31], v[140:143], v[116:119]
  ds_read_b64_tr_b16 v[28:29], v52 offset:18944
  buffer_load_dwordx4 v[180:183], v7, s[12:15], s61 offen offset:1280 sc1
  s_waitcnt lgkmcnt(11)
  v_mfma_f32_16x16x32_bf16 v[72:75], v[32:35], v[136:139], v[72:75]
  ds_read_b64_tr_b16 v[30:31], v52 offset:19200
  v_mfma_f32_16x16x32_bf16 v[76:79], v[32:35], v[140:143], v[76:79]
  ds_read_b64_tr_b16 v[32:33], v53 offset:2048
  v_mfma_f32_16x16x32_bf16 v[88:91], v[36:39], v[136:139], v[88:91]
  ds_read_b64_tr_b16 v[34:35], v53 offset:2304
  v_mfma_f32_16x16x32_bf16 v[92:95], v[36:39], v[140:143], v[92:95]
  ds_read_b64_tr_b16 v[36:37], v53 offset:2560
  buffer_load_dwordx4 v[184:187], v7, s[12:15], s61 offen offset:1536 sc1
  s_waitcnt lgkmcnt(11)
  v_mfma_f32_16x16x32_bf16 v[104:107], v[40:43], v[136:139], v[104:107]
  ds_read_b64_tr_b16 v[38:39], v53 offset:2816
  v_mfma_f32_16x16x32_bf16 v[108:111], v[40:43], v[140:143], v[108:111]
  ds_read_b64_tr_b16 v[40:41], v53 offset:18432
  v_mfma_f32_16x16x32_bf16 v[120:123], v[44:47], v[136:139], v[120:123]
  ds_read_b64_tr_b16 v[42:43], v53 offset:18688
  v_mfma_f32_16x16x32_bf16 v[124:127], v[44:47], v[140:143], v[124:127]
  ds_read_b64_tr_b16 v[44:45], v53 offset:18944
  buffer_load_dwordx4 v[188:191], v7, s[12:15], s61 offen offset:1792 sc1
  s_add_u32 s61, s61, 0x2000
  s_and_b32 s61, s61, 0x7fff
  s_waitcnt vmcnt(10)
  s_waitcnt lgkmcnt(11)
  v_mfma_f32_16x16x32_bf16 v[64:67], v[16:19], v[144:147], v[64:67]
  ds_read_b64_tr_b16 v[46:47], v53 offset:19200
  v_mfma_f32_16x16x32_bf16 v[68:71], v[16:19], v[148:151], v[68:71]
  ds_read_b64_tr_b16 v[16:17], v52 offset:3072
  v_mfma_f32_16x16x32_bf16 v[80:83], v[20:23], v[144:147], v[80:83]
  ds_read_b64_tr_b16 v[18:19], v52 offset:3328
  v_mfma_f32_16x16x32_bf16 v[84:87], v[20:23], v[148:151], v[84:87]
  ds_read_b64_tr_b16 v[20:21], v52 offset:3584
  buffer_load_dwordx4 v[192:195], v7, s[12:15], s61 offen offset:0 sc1
  s_waitcnt lgkmcnt(11)
  v_mfma_f32_16x16x32_bf16 v[96:99], v[24:27], v[144:147], v[96:99]
  ds_read_b64_tr_b16 v[22:23], v52 offset:3840
  v_mfma_f32_16x16x32_bf16 v[100:103], v[24:27], v[148:151], v[100:103]
  ds_read_b64_tr_b16 v[24:25], v52 offset:19456
  v_mfma_f32_16x16x32_bf16 v[112:115], v[28:31], v[144:147], v[112:115]
  ds_read_b64_tr_b16 v[26:27], v52 offset:19712
  v_mfma_f32_16x16x32_bf16 v[116:119], v[28:31], v[148:151], v[116:119]
  ds_read_b64_tr_b16 v[28:29], v52 offset:19968
  buffer_load_dwordx4 v[196:199], v7, s[12:15], s61 offen offset:256 sc1
  s_waitcnt lgkmcnt(11)
  v_mfma_f32_16x16x32_bf16 v[72:75], v[32:35], v[144:147], v[72:75]
  ds_read_b64_tr_b16 v[30:31], v52 offset:20224
  v_mfma_f32_16x16x32_bf16 v[76:79], v[32:35], v[148:151], v[76:79]
  ds_read_b64_tr_b16 v[32:33], v53 offset:3072
  v_mfma_f32_16x16x32_bf16 v[88:91], v[36:39], v[144:147], v[88:91]
  ds_read_b64_tr_b16 v[34:35], v53 offset:3328
  v_mfma_f32_16x16x32_bf16 v[92:95], v[36:39], v[148:151], v[92:95]
  ds_read_b64_tr_b16 v[36:37], v53 offset:3584
  buffer_load_dwordx4 v[200:203], v7, s[12:15], s61 offen offset:512 sc1
  s_waitcnt lgkmcnt(11)
  v_mfma_f32_16x16x32_bf16 v[104:107], v[40:43], v[144:147], v[104:107]
  ds_read_b64_tr_b16 v[38:39], v53 offset:3840
  v_mfma_f32_16x16x32_bf16 v[108:111], v[40:43], v[148:151], v[108:111]
  ds_read_b64_tr_b16 v[40:41], v53 offset:19456
  v_mfma_f32_16x16x32_bf16 v[120:123], v[44:47], v[144:147], v[120:123]
  ds_read_b64_tr_b16 v[42:43], v53 offset:19712
  v_mfma_f32_16x16x32_bf16 v[124:127], v[44:47], v[148:151], v[124:127]
  ds_read_b64_tr_b16 v[44:45], v53 offset:19968
  buffer_load_dwordx4 v[204:207], v7, s[12:15], s61 offen offset:768 sc1
  s_waitcnt vmcnt(12)
  s_waitcnt lgkmcnt(11)
  v_mfma_f32_16x16x32_bf16 v[64:67], v[16:19], v[152:155], v[64:67]
  ds_read_b64_tr_b16 v[46:47], v53 offset:20224
  v_mfma_f32_16x16x32_bf16 v[68:71], v[16:19], v[156:159], v[68:71]
  ds_read_b64_tr_b16 v[16:17], v54 offset:0
  v_mfma_f32_16x16x32_bf16 v[80:83], v[20:23], v[152:155], v[80:83]
  ds_read_b64_tr_b16 v[18:19], v54 offset:256
  v_mfma_f32_16x16x32_bf16 v[84:87], v[20:23], v[156:159], v[84:87]
  ds_read_b64_tr_b16 v[20:21], v54 offset:512
  buffer_load_dwordx4 v[208:211], v7, s[12:15], s61 offen offset:1024 sc1
  s_waitcnt lgkmcnt(11)
  v_mfma_f32_16x16x32_bf16 v[96:99], v[24:27], v[152:155], v[96:99]
  ds_read_b64_tr_b16 v[22:23], v54 offset:768
  v_mfma_f32_16x16x32_bf16 v[100:103], v[24:27], v[156:159], v[100:103]
  ds_read_b64_tr_b16 v[24:25], v54 offset:16384
  v_mfma_f32_16x16x32_bf16 v[112:115], v[28:31], v[152:155], v[112:115]
  ds_read_b64_tr_b16 v[26:27], v54 offset:16640
  v_mfma_f32_16x16x32_bf16 v[116:119], v[28:31], v[156:159], v[116:119]
  ds_read_b64_tr_b16 v[28:29], v54 offset:16896
  buffer_load_dwordx4 v[212:215], v7, s[12:15], s61 offen offset:1280 sc1
  s_waitcnt lgkmcnt(11)
  v_mfma_f32_16x16x32_bf16 v[72:75], v[32:35], v[152:155], v[72:75]
  ds_read_b64_tr_b16 v[30:31], v54 offset:17152
  v_mfma_f32_16x16x32_bf16 v[76:79], v[32:35], v[156:159], v[76:79]
  ds_read_b64_tr_b16 v[32:33], v55 offset:0
  v_mfma_f32_16x16x32_bf16 v[88:91], v[36:39], v[152:155], v[88:91]
  ds_read_b64_tr_b16 v[34:35], v55 offset:256
  v_mfma_f32_16x16x32_bf16 v[92:95], v[36:39], v[156:159], v[92:95]
  ds_read_b64_tr_b16 v[36:37], v55 offset:512
  buffer_load_dwordx4 v[216:219], v7, s[12:15], s61 offen offset:1536 sc1
  s_waitcnt lgkmcnt(11)
  v_mfma_f32_16x16x32_bf16 v[104:107], v[40:43], v[152:155], v[104:107]
  ds_read_b64_tr_b16 v[38:39], v55 offset:768
  v_mfma_f32_16x16x32_bf16 v[108:111], v[40:43], v[156:159], v[108:111]
  ds_read_b64_tr_b16 v[40:41], v55 offset:16384
  v_mfma_f32_16x16x32_bf16 v[120:123], v[44:47], v[152:155], v[120:123]
  ds_read_b64_tr_b16 v[42:43], v55 offset:16640
  v_mfma_f32_16x16x32_bf16 v[124:127], v[44:47], v[156:159], v[124:127]
  ds_read_b64_tr_b16 v[44:45], v55 offset:16896
  buffer_load_dwordx4 v[220:223], v7, s[12:15], s61 offen offset:1792 sc1
  s_add_u32 s61, s61, 0x2000
  s_and_b32 s61, s61, 0x7fff
  s_waitcnt vmcnt(14)
  s_waitcnt lgkmcnt(11)
  v_mfma_f32_16x16x32_bf16 v[64:67], v[16:19], v[160:163], v[64:67]
  ds_read_b64_tr_b16 v[46:47], v55 offset:17152
  v_mfma_f32_16x16x32_bf16 v[68:71], v[16:19], v[164:167], v[68:71]
  ds_read_b64_tr_b16 v[16:17], v54 offset:1024
  v_mfma_f32_16x16x32_bf16 v[80:83], v[20:23], v[160:163], v[80:83]
  ds_read_b64_tr_b16 v[18:19], v54 offset:1280
  v_mfma_f32_16x16x32_bf16 v[84:87], v[20:23], v[164:167], v[84:87]
  ds_read_b64_tr_b16 v[20:21], v54 offset:1536
  buffer_load_dwordx4 v[224:227], v7, s[12:15], s61 offen offset:0 sc1
  s_waitcnt lgkmcnt(11)
  v_mfma_f32_16x16x32_bf16 v[96:99], v[24:27], v[160:163], v[96:99]
  ds_read_b64_tr_b16 v[22:23], v54 offset:1792
  v_mfma_f32_16x16x32_bf16 v[100:103], v[24:27], v[164:167], v[100:103]
  ds_read_b64_tr_b16 v[24:25], v54 offset:17408
  v_mfma_f32_16x16x32_bf16 v[112:115], v[28:31], v[160:163], v[112:115]
  ds_read_b64_tr_b16 v[26:27], v54 offset:17664
  v_mfma_f32_16x16x32_bf16 v[116:119], v[28:31], v[164:167], v[116:119]
  ds_read_b64_tr_b16 v[28:29], v54 offset:17920
  buffer_load_dwordx4 v[228:231], v7, s[12:15], s61 offen offset:256 sc1
  s_waitcnt lgkmcnt(11)
  v_mfma_f32_16x16x32_bf16 v[72:75], v[32:35], v[160:163], v[72:75]
  ds_read_b64_tr_b16 v[30:31], v54 offset:18176
  v_mfma_f32_16x16x32_bf16 v[76:79], v[32:35], v[164:167], v[76:79]
  ds_read_b64_tr_b16 v[32:33], v55 offset:1024
  v_mfma_f32_16x16x32_bf16 v[88:91], v[36:39], v[160:163], v[88:91]
  ds_read_b64_tr_b16 v[34:35], v55 offset:1280
  v_mfma_f32_16x16x32_bf16 v[92:95], v[36:39], v[164:167], v[92:95]
  ds_read_b64_tr_b16 v[36:37], v55 offset:1536
  buffer_load_dwordx4 v[232:235], v7, s[12:15], s61 offen offset:512 sc1
  s_waitcnt lgkmcnt(11)
  v_mfma_f32_16x16x32_bf16 v[104:107], v[40:43], v[160:163], v[104:107]
  ds_read_b64_tr_b16 v[38:39], v55 offset:1792
  v_mfma_f32_16x16x32_bf16 v[108:111], v[40:43], v[164:167], v[108:111]
  ds_read_b64_tr_b16 v[40:41], v55 offset:17408
  v_mfma_f32_16x16x32_bf16 v[120:123], v[44:47], v[160:163], v[120:123]
  ds_read_b64_tr_b16 v[42:43], v55 offset:17664
  v_mfma_f32_16x16x32_bf16 v[124:127], v[44:47], v[164:167], v[124:127]
  ds_read_b64_tr_b16 v[44:45], v55 offset:17920
  buffer_load_dwordx4 v[236:239], v7, s[12:15], s61 offen offset:768 sc1
  s_waitcnt vmcnt(16)
  s_waitcnt lgkmcnt(11)
  v_mfma_f32_16x16x32_bf16 v[64:67], v[16:19], v[168:171], v[64:67]
  ds_read_b64_tr_b16 v[46:47], v55 offset:18176
  v_mfma_f32_16x16x32_bf16 v[68:71], v[16:19], v[172:175], v[68:71]
  ds_read_b64_tr_b16 v[16:17], v54 offset:2048
  v_mfma_f32_16x16x32_bf16 v[80:83], v[20:23], v[168:171], v[80:83]
  ds_read_b64_tr_b16 v[18:19], v54 offset:2304
  v_mfma_f32_16x16x32_bf16 v[84:87], v[20:23], v[172:175], v[84:87]
  ds_read_b64_tr_b16 v[20:21], v54 offset:2560
  buffer_load_dwordx4 v[240:243], v7, s[12:15], s61 offen offset:1024 sc1
  s_waitcnt lgkmcnt(11)
  v_mfma_f32_16x16x32_bf16 v[96:99], v[24:27], v[168:171], v[96:99]
  ds_read_b64_tr_b16 v[22:23], v54 offset:2816
  v_mfma_f32_16x16x32_bf16 v[100:103], v[24:27], v[172:175], v[100:103]
  ds_read_b64_tr_b16 v[24:25], v54 offset:18432
  v_mfma_f32_16x16x32_bf16 v[112:115], v[28:31], v[168:171], v[112:115]
  ds_read_b64_tr_b16 v[26:27], v54 offset:18688
  v_mfma_f32_16x16x32_bf16 v[116:119], v[28:31], v[172:175], v[116:119]
  ds_read_b64_tr_b16 v[28:29], v54 offset:18944
  buffer_load_dwordx4 v[244:247], v7, s[12:15], s61 offen offset:1280 sc1
  s_waitcnt lgkmcnt(11)
  v_mfma_f32_16x16x32_bf16 v[72:75], v[32:35], v[168:171], v[72:75]
  ds_read_b64_tr_b16 v[30:31], v54 offset:19200
  v_mfma_f32_16x16x32_bf16 v[76:79], v[32:35], v[172:175], v[76:79]
  ds_read_b64_tr_b16 v[32:33], v55 offset:2048
  v_mfma_f32_16x16x32_bf16 v[88:91], v[36:39], v[168:171], v[88:91]
  ds_read_b64_tr_b16 v[34:35], v55 offset:2304
  v_mfma_f32_16x16x32_bf16 v[92:95], v[36:39], v[172:175], v[92:95]
  ds_read_b64_tr_b16 v[36:37], v55 offset:2560
  buffer_load_dwordx4 v[248:251], v7, s[12:15], s61 offen offset:1536 sc1
  s_waitcnt lgkmcnt(11)
  v_mfma_f32_16x16x32_bf16 v[104:107], v[40:43], v[168:171], v[104:107]
  ds_read_b64_tr_b16 v[38:39], v55 offset:2816
  v_mfma_f32_16x16x32_bf16 v[108:111], v[40:43], v[172:175], v[108:111]
  ds_read_b64_tr_b16 v[40:41], v55 offset:18432
  v_mfma_f32_16x16x32_bf16 v[120:123], v[44:47], v[168:171], v[120:123]
  ds_read_b64_tr_b16 v[42:43], v55 offset:18688
  v_mfma_f32_16x16x32_bf16 v[124:127], v[44:47], v[172:175], v[124:127]
  ds_read_b64_tr_b16 v[44:45], v55 offset:18944
  buffer_load_dwordx4 v[252:255], v7, s[12:15], s61 offen offset:1792 sc1
  s_add_u32 s61, s61, 0x2000
  s_and_b32 s61, s61, 0x7fff
  s_waitcnt vmcnt(18)
  s_waitcnt lgkmcnt(11)
  v_mfma_f32_16x16x32_bf16 v[64:67], v[16:19], v[176:179], v[64:67]
  ds_read_b64_tr_b16 v[46:47], v55 offset:19200
  v_mfma_f32_16x16x32_bf16 v[68:71], v[16:19], v[180:183], v[68:71]
  ds_read_b64_tr_b16 v[16:17], v54 offset:3072
  v_mfma_f32_16x16x32_bf16 v[80:83], v[20:23], v[176:179], v[80:83]
  ds_read_b64_tr_b16 v[18:19], v54 offset:3328
  v_mfma_f32_16x16x32_bf16 v[84:87], v[20:23], v[180:183], v[84:87]
  ds_read_b64_tr_b16 v[20:21], v54 offset:3584
  s_waitcnt lgkmcnt(11)
  v_mfma_f32_16x16x32_bf16 v[96:99], v[24:27], v[176:179], v[96:99]
  ds_read_b64_tr_b16 v[22:23], v54 offset:3840
  v_mfma_f32_16x16x32_bf16 v[100:103], v[24:27], v[180:183], v[100:103]
  ds_read_b64_tr_b16 v[24:25], v54 offset:19456
  v_mfma_f32_16x16x32_bf16 v[112:115], v[28:31], v[176:179], v[112:115]
  ds_read_b64_tr_b16 v[26:27], v54 offset:19712
  v_mfma_f32_16x16x32_bf16 v[116:119], v[28:31], v[180:183], v[116:119]
  ds_read_b64_tr_b16 v[28:29], v54 offset:19968
  s_waitcnt lgkmcnt(11)
  v_mfma_f32_16x16x32_bf16 v[72:75], v[32:35], v[176:179], v[72:75]
  ds_read_b64_tr_b16 v[30:31], v54 offset:20224
  v_mfma_f32_16x16x32_bf16 v[76:79], v[32:35], v[180:183], v[76:79]
  ds_read_b64_tr_b16 v[32:33], v55 offset:3072
  v_mfma_f32_16x16x32_bf16 v[88:91], v[36:39], v[176:179], v[88:91]
  ds_read_b64_tr_b16 v[34:35], v55 offset:3328
  v_mfma_f32_16x16x32_bf16 v[92:95], v[36:39], v[180:183], v[92:95]
  ds_read_b64_tr_b16 v[36:37], v55 offset:3584
  s_waitcnt lgkmcnt(11)
  v_mfma_f32_16x16x32_bf16 v[104:107], v[40:43], v[176:179], v[104:107]
  ds_read_b64_tr_b16 v[38:39], v55 offset:3840
  v_mfma_f32_16x16x32_bf16 v[108:111], v[40:43], v[180:183], v[108:111]
  ds_read_b64_tr_b16 v[40:41], v55 offset:19456
  v_mfma_f32_16x16x32_bf16 v[120:123], v[44:47], v[176:179], v[120:123]
  ds_read_b64_tr_b16 v[42:43], v55 offset:19712
  v_mfma_f32_16x16x32_bf16 v[124:127], v[44:47], v[180:183], v[124:127]
  ds_read_b64_tr_b16 v[44:45], v55 offset:19968
  s_waitcnt vmcnt(16)
  s_waitcnt lgkmcnt(11)
  v_mfma_f32_16x16x32_bf16 v[64:67], v[16:19], v[184:187], v[64:67]
  ds_read_b64_tr_b16 v[46:47], v55 offset:20224
  v_mfma_f32_16x16x32_bf16 v[68:71], v[16:19], v[188:191], v[68:71]
  ds_read_b64_tr_b16 v[16:17], v56 offset:0
  v_mfma_f32_16x16x32_bf16 v[80:83], v[20:23], v[184:187], v[80:83]
  ds_read_b64_tr_b16 v[18:19], v56 offset:256
  v_mfma_f32_16x16x32_bf16 v[84:87], v[20:23], v[188:191], v[84:87]
  ds_read_b64_tr_b16 v[20:21], v57 offset:0
  s_waitcnt lgkmcnt(11)
  v_mfma_f32_16x16x32_bf16 v[96:99], v[24:27], v[184:187], v[96:99]
  ds_read_b64_tr_b16 v[22:23], v57 offset:256
  v_mfma_f32_16x16x32_bf16 v[100:103], v[24:27], v[188:191], v[100:103]
  ds_read_b64_tr_b16 v[24:25], v56 offset:1024
  v_mfma_f32_16x16x32_bf16 v[112:115], v[28:31], v[184:187], v[112:115]
  ds_read_b64_tr_b16 v[26:27], v56 offset:1280
  v_mfma_f32_16x16x32_bf16 v[116:119], v[28:31], v[188:191], v[116:119]
  ds_read_b64_tr_b16 v[28:29], v57 offset:1024
  s_waitcnt lgkmcnt(11)
  v_mfma_f32_16x16x32_bf16 v[72:75], v[32:35], v[184:187], v[72:75]
  ds_read_b64_tr_b16 v[30:31], v57 offset:1280
  v_mfma_f32_16x16x32_bf16 v[76:79], v[32:35], v[188:191], v[76:79]
  ds_read_b64_tr_b16 v[32:33], v56 offset:2048
  v_mfma_f32_16x16x32_bf16 v[88:91], v[36:39], v[184:187], v[88:91]
  ds_read_b64_tr_b16 v[34:35], v56 offset:2304
  v_mfma_f32_16x16x32_bf16 v[92:95], v[36:39], v[188:191], v[92:95]
  ds_read_b64_tr_b16 v[36:37], v57 offset:2048
  s_waitcnt lgkmcnt(11)
  v_mfma_f32_16x16x32_bf16 v[104:107], v[40:43], v[184:187], v[104:107]
  ds_read_b64_tr_b16 v[38:39], v57 offset:2304
  v_mfma_f32_16x16x32_bf16 v[108:111], v[40:43], v[188:191], v[108:111]
  ds_read_b64_tr_b16 v[40:41], v56 offset:3072
  v_mfma_f32_16x16x32_bf16 v[120:123], v[44:47], v[184:187], v[120:123]
  ds_read_b64_tr_b16 v[42:43], v56 offset:3328
  v_mfma_f32_16x16x32_bf16 v[124:127], v[44:47], v[188:191], v[124:127]
  ds_read_b64_tr_b16 v[44:45], v57 offset:3072
  s_waitcnt vmcnt(14)
  s_waitcnt lgkmcnt(11)
  v_mfma_f32_16x16x32_bf16 v[64:67], v[16:19], v[192:195], v[64:67]
  ds_read_b64_tr_b16 v[46:47], v57 offset:3328
  v_mfma_f32_16x16x32_bf16 v[68:71], v[16:19], v[196:199], v[68:71]
  s_cmp_lg_u32 s40, 0
  s_cbranch_scc1 fused_kernel_mb
  s_barrier
fused_kernel_mb:
  ds_read_b64_tr_b16 v[16:17], v58 offset:0
  v_mfma_f32_16x16x32_bf16 v[72:75], v[20:23], v[192:195], v[72:75]
  ds_read_b64_tr_b16 v[18:19], v58 offset:256
  v_mfma_f32_16x16x32_bf16 v[76:79], v[20:23], v[196:199], v[76:79]
  ds_read_b64_tr_b16 v[20:21], v59 offset:0
  s_waitcnt vmcnt(12)
  s_waitcnt lgkmcnt(11)
  v_mfma_f32_16x16x32_bf16 v[64:67], v[24:27], v[200:203], v[64:67]
  ds_read_b64_tr_b16 v[22:23], v59 offset:256
  v_mfma_f32_16x16x32_bf16 v[68:71], v[24:27], v[204:207], v[68:71]
  ds_read_b64_tr_b16 v[24:25], v58 offset:1024
  v_mfma_f32_16x16x32_bf16 v[72:75], v[28:31], v[200:203], v[72:75]
  ds_read_b64_tr_b16 v[26:27], v58 offset:1280
  v_mfma_f32_16x16x32_bf16 v[76:79], v[28:31], v[204:207], v[76:79]
  ds_read_b64_tr_b16 v[28:29], v59 offset:1024
  s_waitcnt vmcnt(10)
  s_waitcnt lgkmcnt(11)
  v_mfma_f32_16x16x32_bf16 v[64:67], v[32:35], v[208:211], v[64:67]
  ds_read_b64_tr_b16 v[30:31], v59 offset:1280
  v_mfma_f32_16x16x32_bf16 v[68:71], v[32:35], v[212:215], v[68:71]
  ds_read_b64_tr_b16 v[32:33], v58 offset:2048
  v_mfma_f32_16x16x32_bf16 v[72:75], v[36:39], v[208:211], v[72:75]
  ds_read_b64_tr_b16 v[34:35], v58 offset:2304
  v_mfma_f32_16x16x32_bf16 v[76:79], v[36:39], v[212:215], v[76:79]
  ds_read_b64_tr_b16 v[36:37], v59 offset:2048
  s_waitcnt vmcnt(8)
  s_waitcnt lgkmcnt(11)
  v_mfma_f32_16x16x32_bf16 v[64:67], v[40:43], v[216:219], v[64:67]
  ds_read_b64_tr_b16 v[38:39], v59 offset:2304
  v_mfma_f32_16x16x32_bf16 v[68:71], v[40:43], v[220:223], v[68:71]
  ds_read_b64_tr_b16 v[40:41], v58 offset:3072
  v_mfma_f32_16x16x32_bf16 v[72:75], v[44:47], v[216:219], v[72:75]
  ds_read_b64_tr_b16 v[42:43], v58 offset:3328
  v_mfma_f32_16x16x32_bf16 v[76:79], v[44:47], v[220:223], v[76:79]
  ds_read_b64_tr_b16 v[44:45], v59 offset:3072
  s_waitcnt vmcnt(6)
  s_waitcnt lgkmcnt(11)
  v_mfma_f32_16x16x32_bf16 v[64:67], v[16:19], v[224:227], v[64:67]
  ds_read_b64_tr_b16 v[46:47], v59 offset:3328
  v_mfma_f32_16x16x32_bf16 v[68:71], v[16:19], v[228:231], v[68:71]
  ds_read_b64_tr_b16 v[16:17], v56 offset:16384
  v_mfma_f32_16x16x32_bf16 v[72:75], v[20:23], v[224:227], v[72:75]
  ds_read_b64_tr_b16 v[18:19], v56 offset:16640
  v_mfma_f32_16x16x32_bf16 v[76:79], v[20:23], v[228:231], v[76:79]
  ds_read_b64_tr_b16 v[20:21], v57 offset:16384
  s_waitcnt vmcnt(4)
  s_waitcnt lgkmcnt(11)
  v_mfma_f32_16x16x32_bf16 v[64:67], v[24:27], v[232:235], v[64:67]
  ds_read_b64_tr_b16 v[22:23], v57 offset:16640
  v_mfma_f32_16x16x32_bf16 v[68:71], v[24:27], v[236:239], v[68:71]
  ds_read_b64_tr_b16 v[24:25], v56 offset:17408
  v_mfma_f32_16x16x32_bf16 v[72:75], v[28:31], v[232:235], v[72:75]
  ds_read_b64_tr_b16 v[26:27], v56 offset:17664
  v_mfma_f32_16x16x32_bf16 v[76:79], v[28:31], v[236:239], v[76:79]
  ds_read_b64_tr_b16 v[28:29], v57 offset:17408
  s_waitcnt vmcnt(2)
  s_waitcnt lgkmcnt(11)
  v_mfma_f32_16x16x32_bf16 v[64:67], v[32:35], v[240:243], v[64:67]
  ds_read_b64_tr_b16 v[30:31], v57 offset:17664
  v_mfma_f32_16x16x32_bf16 v[68:71], v[32:35], v[244:247], v[68:71]
  ds_read_b64_tr_b16 v[32:33], v56 offset:18432
  v_mfma_f32_16x16x32_bf16 v[72:75], v[36:39], v[240:243], v[72:75]
  ds_read_b64_tr_b16 v[34:35], v56 offset:18688
  v_mfma_f32_16x16x32_bf16 v[76:79], v[36:39], v[244:247], v[76:79]
  ds_read_b64_tr_b16 v[36:37], v57 offset:18432
  s_waitcnt vmcnt(0)
  s_waitcnt lgkmcnt(11)
  v_mfma_f32_16x16x32_bf16 v[64:67], v[40:43], v[248:251], v[64:67]
  ds_read_b64_tr_b16 v[38:39], v57 offset:18688
  v_mfma_f32_16x16x32_bf16 v[68:71], v[40:43], v[252:255], v[68:71]
  ds_read_b64_tr_b16 v[40:41], v56 offset:19456
  v_mfma_f32_16x16x32_bf16 v[72:75], v[44:47], v[248:251], v[72:75]
  ds_read_b64_tr_b16 v[42:43], v56 offset:19712
  v_mfma_f32_16x16x32_bf16 v[76:79], v[44:47], v[252:255], v[76:79]
  ds_read_b64_tr_b16 v[44:45], v57 offset:19456
  s_waitcnt lgkmcnt(11)
  v_mfma_f32_16x16x32_bf16 v[96:99], v[16:19], v[192:195], v[96:99]
  ds_read_b64_tr_b16 v[46:47], v57 offset:19712
  v_mfma_f32_16x16x32_bf16 v[100:103], v[16:19], v[196:199], v[100:103]
  ds_read_b64_tr_b16 v[16:17], v58 offset:16384
  v_mfma_f32_16x16x32_bf16 v[104:107], v[20:23], v[192:195], v[104:107]
  ds_read_b64_tr_b16 v[18:19], v58 offset:16640
  v_mfma_f32_16x16x32_bf16 v[108:111], v[20:23], v[196:199], v[108:111]
  ds_read_b64_tr_b16 v[20:21], v59 offset:16384
  s_waitcnt lgkmcnt(11)
  v_mfma_f32_16x16x32_bf16 v[96:99], v[24:27], v[200:203], v[96:99]
  ds_read_b64_tr_b16 v[22:23], v59 offset:16640
  v_mfma_f32_16x16x32_bf16 v[100:103], v[24:27], v[204:207], v[100:103]
  ds_read_b64_tr_b16 v[24:25], v58 offset:17408
  v_mul_f32 v128, v64, v48
  v_mul_f32 v129, v65, v48
  v_mfma_f32_16x16x32_bf16 v[104:107], v[28:31], v[200:203], v[104:107]
  ds_read_b64_tr_b16 v[26:27], v58 offset:17664
  v_mul_f32 v130, v66, v48
  v_mul_f32 v131, v67, v48
  v_mfma_f32_16x16x32_bf16 v[108:111], v[28:31], v[204:207], v[108:111]
  ds_read_b64_tr_b16 v[28:29], v59 offset:17408
  v_mul_f32 v132, v68, v48
  v_mul_f32 v133, v69, v48
  s_waitcnt lgkmcnt(11)
  v_mfma_f32_16x16x32_bf16 v[96:99], v[32:35], v[208:211], v[96:99]
  ds_read_b64_tr_b16 v[30:31], v59 offset:17664
  v_mul_f32 v134, v70, v48
  v_mul_f32 v135, v71, v48
  v_mfma_f32_16x16x32_bf16 v[100:103], v[32:35], v[212:215], v[100:103]
  ds_read_b64_tr_b16 v[32:33], v58 offset:18432
  v_exp_f32 v128, v128
  v_exp_f32 v129, v129
  v_mfma_f32_16x16x32_bf16 v[104:107], v[36:39], v[208:211], v[104:107]
  ds_read_b64_tr_b16 v[34:35], v58 offset:18688
  v_exp_f32 v130, v130
  v_exp_f32 v131, v131
  v_mfma_f32_16x16x32_bf16 v[108:111], v[36:39], v[212:215], v[108:111]
  ds_read_b64_tr_b16 v[36:37], v59 offset:18432
  v_exp_f32 v132, v132
  v_exp_f32 v133, v133
  s_waitcnt lgkmcnt(11)
  v_mfma_f32_16x16x32_bf16 v[96:99], v[40:43], v[216:219], v[96:99]
  ds_read_b64_tr_b16 v[38:39], v59 offset:18688
  v_exp_f32 v134, v134
  v_exp_f32 v135, v135
  v_mfma_f32_16x16x32_bf16 v[100:103], v[40:43], v[220:223], v[100:103]
  ds_read_b64_tr_b16 v[40:41], v58 offset:19456
  v_add_f32 v128, 1.0, v128
  v_add_f32 v129, 1.0, v129
  v_mfma_f32_16x16x32_bf16 v[104:107], v[44:47], v[216:219], v[104:107]
  ds_read_b64_tr_b16 v[42:43], v58 offset:19712
  v_add_f32 v130, 1.0, v130
  v_add_f32 v131, 1.0, v131
  v_mfma_f32_16x16x32_bf16 v[108:111], v[44:47], v[220:223], v[108:111]
  ds_read_b64_tr_b16 v[44:45], v59 offset:19456
  v_add_f32 v132, 1.0, v132
  v_add_f32 v133, 1.0, v133
  s_waitcnt lgkmcnt(11)
  v_mfma_f32_16x16x32_bf16 v[96:99], v[16:19], v[224:227], v[96:99]
  ds_read_b64_tr_b16 v[46:47], v59 offset:19712
  v_add_f32 v134, 1.0, v134
  v_add_f32 v135, 1.0, v135
  v_mfma_f32_16x16x32_bf16 v[100:103], v[16:19], v[228:231], v[100:103]
  ds_read_b64_tr_b16 v[16:17], v56 offset:512
  v_rcp_f32 v128, v128
  v_rcp_f32 v129, v129
  v_mfma_f32_16x16x32_bf16 v[104:107], v[20:23], v[224:227], v[104:107]
  ds_read_b64_tr_b16 v[18:19], v56 offset:768
  v_rcp_f32 v130, v130
  v_rcp_f32 v131, v131
  v_mfma_f32_16x16x32_bf16 v[108:111], v[20:23], v[228:231], v[108:111]
  ds_read_b64_tr_b16 v[20:21], v57 offset:512
  v_rcp_f32 v132, v132
  v_rcp_f32 v133, v133
  s_waitcnt lgkmcnt(11)
  v_mfma_f32_16x16x32_bf16 v[96:99], v[24:27], v[232:235], v[96:99]
  ds_read_b64_tr_b16 v[22:23], v57 offset:768
  v_rcp_f32 v134, v134
  v_rcp_f32 v135, v135
  v_mfma_f32_16x16x32_bf16 v[100:103], v[24:27], v[236:239], v[100:103]
  ds_read_b64_tr_b16 v[24:25], v56 offset:1536
  v_mul_f32 v128, v64, v128
  v_mul_f32 v129, v65, v129
  v_mfma_f32_16x16x32_bf16 v[104:107], v[28:31], v[232:235], v[104:107]
  ds_read_b64_tr_b16 v[26:27], v56 offset:1792
  v_mul_f32 v130, v66, v130
  v_mul_f32 v131, v67, v131
  v_mfma_f32_16x16x32_bf16 v[108:111], v[28:31], v[236:239], v[108:111]
  ds_read_b64_tr_b16 v[28:29], v57 offset:1536
  v_mul_f32 v132, v68, v132
  v_mul_f32 v133, v69, v133
  s_waitcnt lgkmcnt(11)
  v_mfma_f32_16x16x32_bf16 v[96:99], v[32:35], v[240:243], v[96:99]
  ds_read_b64_tr_b16 v[30:31], v57 offset:1792
  v_mul_f32 v134, v70, v134
  v_mul_f32 v135, v71, v135
  v_mfma_f32_16x16x32_bf16 v[100:103], v[32:35], v[244:247], v[100:103]
  ds_read_b64_tr_b16 v[32:33], v56 offset:2560
  v_mul_f32 v136, v72, v48
  v_mul_f32 v137, v73, v48
  v_mfma_f32_16x16x32_bf16 v[104:107], v[36:39], v[240:243], v[104:107]
  ds_read_b64_tr_b16 v[34:35], v56 offset:2816
  v_mul_f32 v138, v74, v48
  v_mul_f32 v139, v75, v48
  v_mfma_f32_16x16x32_bf16 v[108:111], v[36:39], v[244:247], v[108:111]
  ds_read_b64_tr_b16 v[36:37], v57 offset:2560
  v_mul_f32 v140, v76, v48
  v_mul_f32 v141, v77, v48
  s_waitcnt lgkmcnt(11)
  v_mfma_f32_16x16x32_bf16 v[96:99], v[40:43], v[248:251], v[96:99]
  ds_read_b64_tr_b16 v[38:39], v57 offset:2816
  v_mul_f32 v142, v78, v48
  v_mul_f32 v143, v79, v48
  v_mfma_f32_16x16x32_bf16 v[100:103], v[40:43], v[252:255], v[100:103]
  ds_read_b64_tr_b16 v[40:41], v56 offset:3584
  v_exp_f32 v136, v136
  v_exp_f32 v137, v137
  v_mfma_f32_16x16x32_bf16 v[104:107], v[44:47], v[248:251], v[104:107]
  ds_read_b64_tr_b16 v[42:43], v56 offset:3840
  v_exp_f32 v138, v138
  v_exp_f32 v139, v139
  v_mfma_f32_16x16x32_bf16 v[108:111], v[44:47], v[252:255], v[108:111]
  ds_read_b64_tr_b16 v[44:45], v57 offset:3584
  v_exp_f32 v140, v140
  v_exp_f32 v141, v141
  s_waitcnt lgkmcnt(11)
  v_mfma_f32_16x16x32_bf16 v[80:83], v[16:19], v[192:195], v[80:83]
  ds_read_b64_tr_b16 v[46:47], v57 offset:3840
  v_exp_f32 v142, v142
  v_exp_f32 v143, v143
  v_mfma_f32_16x16x32_bf16 v[84:87], v[16:19], v[196:199], v[84:87]
  ds_read_b64_tr_b16 v[16:17], v58 offset:512
  v_add_f32 v136, 1.0, v136
  v_add_f32 v137, 1.0, v137
  v_mfma_f32_16x16x32_bf16 v[88:91], v[20:23], v[192:195], v[88:91]
  ds_read_b64_tr_b16 v[18:19], v58 offset:768
  v_add_f32 v138, 1.0, v138
  v_add_f32 v139, 1.0, v139
  v_mfma_f32_16x16x32_bf16 v[92:95], v[20:23], v[196:199], v[92:95]
  ds_read_b64_tr_b16 v[20:21], v59 offset:512
  v_add_f32 v140, 1.0, v140
  v_add_f32 v141, 1.0, v141
  s_waitcnt lgkmcnt(11)
  v_mfma_f32_16x16x32_bf16 v[80:83], v[24:27], v[200:203], v[80:83]
  ds_read_b64_tr_b16 v[22:23], v59 offset:768
  v_add_f32 v142, 1.0, v142
  v_add_f32 v143, 1.0, v143
  v_mfma_f32_16x16x32_bf16 v[84:87], v[24:27], v[204:207], v[84:87]
  ds_read_b64_tr_b16 v[24:25], v58 offset:1536
  v_rcp_f32 v136, v136
  v_rcp_f32 v137, v137
  v_mfma_f32_16x16x32_bf16 v[88:91], v[28:31], v[200:203], v[88:91]
  ds_read_b64_tr_b16 v[26:27], v58 offset:1792
  v_rcp_f32 v138, v138
  v_rcp_f32 v139, v139
  v_mfma_f32_16x16x32_bf16 v[92:95], v[28:31], v[204:207], v[92:95]
  ds_read_b64_tr_b16 v[28:29], v59 offset:1536
  v_rcp_f32 v140, v140
  v_rcp_f32 v141, v141
  s_waitcnt lgkmcnt(11)
  v_mfma_f32_16x16x32_bf16 v[80:83], v[32:35], v[208:211], v[80:83]
  ds_read_b64_tr_b16 v[30:31], v59 offset:1792
  v_rcp_f32 v142, v142
  v_rcp_f32 v143, v143
  v_mfma_f32_16x16x32_bf16 v[84:87], v[32:35], v[212:215], v[84:87]
  ds_read_b64_tr_b16 v[32:33], v58 offset:2560
  v_mul_f32 v136, v72, v136
  v_mul_f32 v137, v73, v137
  v_mfma_f32_16x16x32_bf16 v[88:91], v[36:39], v[208:211], v[88:91]
  ds_read_b64_tr_b16 v[34:35], v58 offset:2816
  v_mul_f32 v138, v74, v138
  v_mul_f32 v139, v75, v139
  v_mfma_f32_16x16x32_bf16 v[92:95], v[36:39], v[212:215], v[92:95]
  ds_read_b64_tr_b16 v[36:37], v59 offset:2560
  v_mul_f32 v140, v76, v140
  v_mul_f32 v141, v77, v141
  s_waitcnt lgkmcnt(11)
  v_mfma_f32_16x16x32_bf16 v[80:83], v[40:43], v[216:219], v[80:83]
  ds_read_b64_tr_b16 v[38:39], v59 offset:2816
  v_mul_f32 v142, v78, v142
  v_mul_f32 v143, v79, v143
  v_mfma_f32_16x16x32_bf16 v[84:87], v[40:43], v[220:223], v[84:87]
  ds_read_b64_tr_b16 v[40:41], v58 offset:3584
  v_mul_f32 v128, v128, v96
  v_mul_f32 v129, v129, v97
  v_mfma_f32_16x16x32_bf16 v[88:91], v[44:47], v[216:219], v[88:91]
  ds_read_b64_tr_b16 v[42:43], v58 offset:3840
  v_mul_f32 v130, v130, v98
  v_mul_f32 v131, v131, v99
  v_mfma_f32_16x16x32_bf16 v[92:95], v[44:47], v[220:223], v[92:95]
  ds_read_b64_tr_b16 v[44:45], v59 offset:3584
  v_mul_f32 v132, v132, v100
  v_mul_f32 v133, v133, v101
  s_waitcnt lgkmcnt(11)
  v_mfma_f32_16x16x32_bf16 v[80:83], v[16:19], v[224:227], v[80:83]
  ds_read_b64_tr_b16 v[46:47], v59 offset:3840
  v_mul_f32 v134, v134, v102
  v_mul_f32 v135, v135, v103
  v_mfma_f32_16x16x32_bf16 v[84:87], v[16:19], v[228:231], v[84:87]
  ds_read_b64_tr_b16 v[16:17], v56 offset:16896
  v_mul_f32 v136, v136, v104
  v_mul_f32 v137, v137, v105
  v_mfma_f32_16x16x32_bf16 v[88:91], v[20:23], v[224:227], v[88:91]
  ds_read_b64_tr_b16 v[18:19], v56 offset:17152
  v_mul_f32 v138, v138, v106
  v_mul_f32 v139, v139, v107
  v_mfma_f32_16x16x32_bf16 v[92:95], v[20:23], v[228:231], v[92:95]
  ds_read_b64_tr_b16 v[20:21], v57 offset:16896
  v_mul_f32 v140, v140, v108
  v_mul_f32 v141, v141, v109
  s_waitcnt lgkmcnt(11)
  v_mfma_f32_16x16x32_bf16 v[80:83], v[24:27], v[232:235], v[80:83]
  ds_read_b64_tr_b16 v[22:23], v57 offset:17152
  v_mul_f32 v142, v142, v110
  v_mul_f32 v143, v143, v111
  v_mfma_f32_16x16x32_bf16 v[84:87], v[24:27], v[236:239], v[84:87]
  ds_read_b64_tr_b16 v[24:25], v56 offset:17920
  v_cvt_pk_bf16_f32 v160, v128, v129
  v_cvt_pk_bf16_f32 v161, v130, v131
  v_mfma_f32_16x16x32_bf16 v[88:91], v[28:31], v[232:235], v[88:91]
  ds_read_b64_tr_b16 v[26:27], v56 offset:18176
  v_cvt_pk_bf16_f32 v162, v136, v137
  v_cvt_pk_bf16_f32 v163, v138, v139
  v_mfma_f32_16x16x32_bf16 v[92:95], v[28:31], v[236:239], v[92:95]
  ds_read_b64_tr_b16 v[28:29], v57 offset:17920
  buffer_store_dwordx4 v[160:163], v2, s[20:23], s6 offen offset:0 sc1
  v_cvt_pk_bf16_f32 v164, v132, v133
  s_waitcnt lgkmcnt(11)
  v_mfma_f32_16x16x32_bf16 v[80:83], v[32:35], v[240:243], v[80:83]
  ds_read_b64_tr_b16 v[30:31], v57 offset:18176
  v_cvt_pk_bf16_f32 v165, v134, v135
  v_cvt_pk_bf16_f32 v166, v140, v141
  v_mfma_f32_16x16x32_bf16 v[84:87], v[32:35], v[244:247], v[84:87]
  ds_read_b64_tr_b16 v[32:33], v56 offset:18944
  v_cvt_pk_bf16_f32 v167, v142, v143
  buffer_store_dwordx4 v[164:167], v2, s[20:23], s6 offen offset:1024 sc1
  v_mfma_f32_16x16x32_bf16 v[88:91], v[36:39], v[240:243], v[88:91]
  ds_read_b64_tr_b16 v[34:35], v56 offset:19200
  v_mfma_f32_16x16x32_bf16 v[92:95], v[36:39], v[244:247], v[92:95]
  ds_read_b64_tr_b16 v[36:37], v57 offset:18944
  s_waitcnt lgkmcnt(11)
  v_mfma_f32_16x16x32_bf16 v[80:83], v[40:43], v[248:251], v[80:83]
  ds_read_b64_tr_b16 v[38:39], v57 offset:19200
  v_mfma_f32_16x16x32_bf16 v[84:87], v[40:43], v[252:255], v[84:87]
  ds_read_b64_tr_b16 v[40:41], v56 offset:19968
  v_mfma_f32_16x16x32_bf16 v[88:91], v[44:47], v[248:251], v[88:91]
  ds_read_b64_tr_b16 v[42:43], v56 offset:20224
  v_mfma_f32_16x16x32_bf16 v[92:95], v[44:47], v[252:255], v[92:95]
  ds_read_b64_tr_b16 v[44:45], v57 offset:19968
  s_waitcnt lgkmcnt(11)
  v_mfma_f32_16x16x32_bf16 v[112:115], v[16:19], v[192:195], v[112:115]
  ds_read_b64_tr_b16 v[46:47], v57 offset:20224
  v_mfma_f32_16x16x32_bf16 v[116:119], v[16:19], v[196:199], v[116:119]
  ds_read_b64_tr_b16 v[16:17], v58 offset:16896
  v_mfma_f32_16x16x32_bf16 v[120:123], v[20:23], v[192:195], v[120:123]
  ds_read_b64_tr_b16 v[18:19], v58 offset:17152
  v_mfma_f32_16x16x32_bf16 v[124:127], v[20:23], v[196:199], v[124:127]
  ds_read_b64_tr_b16 v[20:21], v59 offset:16896
  s_waitcnt lgkmcnt(11)
  v_mfma_f32_16x16x32_bf16 v[112:115], v[24:27], v[200:203], v[112:115]
  ds_read_b64_tr_b16 v[22:23], v59 offset:17152
  v_mfma_f32_16x16x32_bf16 v[116:119], v[24:27], v[204:207], v[116:119]
  ds_read_b64_tr_b16 v[24:25], v58 offset:17920
  v_mul_f32 v144, v80, v48
  v_mul_f32 v145, v81, v48
  v_mfma_f32_16x16x32_bf16 v[120:123], v[28:31], v[200:203], v[120:123]
  ds_read_b64_tr_b16 v[26:27], v58 offset:18176
  v_mul_f32 v146, v82, v48
  v_mul_f32 v147, v83, v48
  v_mfma_f32_16x16x32_bf16 v[124:127], v[28:31], v[204:207], v[124:127]
  ds_read_b64_tr_b16 v[28:29], v59 offset:17920
  v_mul_f32 v148, v84, v48
  v_mul_f32 v149, v85, v48
  s_waitcnt lgkmcnt(11)
  v_mfma_f32_16x16x32_bf16 v[112:115], v[32:35], v[208:211], v[112:115]
  ds_read_b64_tr_b16 v[30:31], v59 offset:18176
  v_mul_f32 v150, v86, v48
  v_mul_f32 v151, v87, v48
  v_mfma_f32_16x16x32_bf16 v[116:119], v[32:35], v[212:215], v[116:119]
  ds_read_b64_tr_b16 v[32:33], v58 offset:18944
  v_exp_f32 v144, v144
  v_exp_f32 v145, v145
  v_mfma_f32_16x16x32_bf16 v[120:123], v[36:39], v[208:211], v[120:123]
  ds_read_b64_tr_b16 v[34:35], v58 offset:19200
  v_exp_f32 v146, v146
  v_exp_f32 v147, v147
  v_mfma_f32_16x16x32_bf16 v[124:127], v[36:39], v[212:215], v[124:127]
  ds_read_b64_tr_b16 v[36:37], v59 offset:18944
  v_exp_f32 v148, v148
  v_exp_f32 v149, v149
  s_waitcnt lgkmcnt(11)
  v_mfma_f32_16x16x32_bf16 v[112:115], v[40:43], v[216:219], v[112:115]
  ds_read_b64_tr_b16 v[38:39], v59 offset:19200
  v_exp_f32 v150, v150
  v_exp_f32 v151, v151
  v_mfma_f32_16x16x32_bf16 v[116:119], v[40:43], v[220:223], v[116:119]
  ds_read_b64_tr_b16 v[40:41], v58 offset:19968
  v_add_f32 v144, 1.0, v144
  v_add_f32 v145, 1.0, v145
  v_mfma_f32_16x16x32_bf16 v[120:123], v[44:47], v[216:219], v[120:123]
  ds_read_b64_tr_b16 v[42:43], v58 offset:20224
  v_add_f32 v146, 1.0, v146
  v_add_f32 v147, 1.0, v147
  v_mfma_f32_16x16x32_bf16 v[124:127], v[44:47], v[220:223], v[124:127]
  ds_read_b64_tr_b16 v[44:45], v59 offset:19968
  v_add_f32 v148, 1.0, v148
  v_add_f32 v149, 1.0, v149
  s_waitcnt lgkmcnt(11)
  v_mfma_f32_16x16x32_bf16 v[112:115], v[16:19], v[224:227], v[112:115]
  ds_read_b64_tr_b16 v[46:47], v59 offset:20224
  v_add_f32 v150, 1.0, v150
  v_add_f32 v151, 1.0, v151
  v_mfma_f32_16x16x32_bf16 v[116:119], v[16:19], v[228:231], v[116:119]
  v_rcp_f32 v144, v144
  v_rcp_f32 v145, v145
  v_mfma_f32_16x16x32_bf16 v[120:123], v[20:23], v[224:227], v[120:123]
  v_rcp_f32 v146, v146
  v_rcp_f32 v147, v147
  v_mfma_f32_16x16x32_bf16 v[124:127], v[20:23], v[228:231], v[124:127]
  v_rcp_f32 v148, v148
  v_rcp_f32 v149, v149
  s_waitcnt lgkmcnt(8)
  v_mfma_f32_16x16x32_bf16 v[112:115], v[24:27], v[232:235], v[112:115]
  v_rcp_f32 v150, v150
  v_rcp_f32 v151, v151
  v_mfma_f32_16x16x32_bf16 v[116:119], v[24:27], v[236:239], v[116:119]
  v_mul_f32 v144, v80, v144
  v_mul_f32 v145, v81, v145
  v_mfma_f32_16x16x32_bf16 v[120:123], v[28:31], v[232:235], v[120:123]
  v_mul_f32 v146, v82, v146
  v_mul_f32 v147, v83, v147
  v_mfma_f32_16x16x32_bf16 v[124:127], v[28:31], v[236:239], v[124:127]
  v_mul_f32 v148, v84, v148
  v_mul_f32 v149, v85, v149
  s_waitcnt lgkmcnt(4)
  v_mfma_f32_16x16x32_bf16 v[112:115], v[32:35], v[240:243], v[112:115]
  v_mul_f32 v150, v86, v150
  v_mul_f32 v151, v87, v151
  v_mfma_f32_16x16x32_bf16 v[116:119], v[32:35], v[244:247], v[116:119]
  v_mul_f32 v152, v88, v48
  v_mul_f32 v153, v89, v48
  v_mfma_f32_16x16x32_bf16 v[120:123], v[36:39], v[240:243], v[120:123]
  v_mul_f32 v154, v90, v48
  v_mul_f32 v155, v91, v48
  v_mfma_f32_16x16x32_bf16 v[124:127], v[36:39], v[244:247], v[124:127]
  v_mul_f32 v156, v92, v48
  v_mul_f32 v157, v93, v48
  s_waitcnt lgkmcnt(0)
  v_mfma_f32_16x16x32_bf16 v[112:115], v[40:43], v[248:251], v[112:115]
  v_mul_f32 v158, v94, v48
  v_mul_f32 v159, v95, v48
  v_mfma_f32_16x16x32_bf16 v[116:119], v[40:43], v[252:255], v[116:119]
  v_exp_f32 v152, v152
  v_exp_f32 v153, v153
  v_mfma_f32_16x16x32_bf16 v[120:123], v[44:47], v[248:251], v[120:123]
  v_exp_f32 v154, v154
  v_exp_f32 v155, v155
  v_mfma_f32_16x16x32_bf16 v[124:127], v[44:47], v[252:255], v[124:127]
  v_exp_f32 v156, v156
  v_exp_f32 v157, v157
  s_cmp_eq_u32 s40, 0
  s_cbranch_scc1 fused_kernel_hp
  v_exp_f32 v158, v158
  v_exp_f32 v159, v159
  v_add_f32 v152, 1.0, v152
  v_add_f32 v153, 1.0, v153
  v_add_f32 v154, 1.0, v154
  v_add_f32 v155, 1.0, v155
  v_add_f32 v156, 1.0, v156
  v_add_f32 v157, 1.0, v157
  v_add_f32 v158, 1.0, v158
  v_add_f32 v159, 1.0, v159
  v_rcp_f32 v152, v152
  v_rcp_f32 v153, v153
  v_rcp_f32 v154, v154
  v_rcp_f32 v155, v155
  v_rcp_f32 v156, v156
  v_rcp_f32 v157, v157
  v_rcp_f32 v158, v158
  v_rcp_f32 v159, v159
  v_mul_f32 v152, v88, v152
  v_mul_f32 v153, v89, v153
  v_mul_f32 v154, v90, v154
  v_mul_f32 v155, v91, v155
  v_mul_f32 v156, v92, v156
  v_mul_f32 v157, v93, v157
  v_mul_f32 v158, v94, v158
  v_mul_f32 v159, v95, v159
  v_mul_f32 v144, v144, v112
  v_mul_f32 v145, v145, v113
  v_mul_f32 v146, v146, v114
  v_mul_f32 v147, v147, v115
  v_mul_f32 v148, v148, v116
  v_mul_f32 v149, v149, v117
  v_mul_f32 v150, v150, v118
  v_mul_f32 v151, v151, v119
  v_mul_f32 v152, v152, v120
  v_mul_f32 v153, v153, v121
  v_mul_f32 v154, v154, v122
  v_mul_f32 v155, v155, v123
  v_mul_f32 v156, v156, v124
  v_mul_f32 v157, v157, v125
  v_mul_f32 v158, v158, v126
  v_mul_f32 v159, v159, v127
  v_cvt_pk_bf16_f32 v168, v144, v145
  v_cvt_pk_bf16_f32 v169, v146, v147
  v_cvt_pk_bf16_f32 v170, v152, v153
  v_cvt_pk_bf16_f32 v171, v154, v155
  buffer_store_dwordx4 v[168:171], v2, s[20:23], s6 offen offset:2048 sc1
  v_cvt_pk_bf16_f32 v172, v148, v149
  v_cvt_pk_bf16_f32 v173, v150, v151
  v_cvt_pk_bf16_f32 v174, v156, v157
  v_cvt_pk_bf16_f32 v175, v158, v159
  buffer_store_dwordx4 v[172:175], v2, s[20:23], s6 offen offset:3072 sc1
  s_waitcnt vmcnt(0)
  s_lshl_b32 s60, s5, 6
  s_add_u32 s60, s60, s42
  s_lshl_b32 s60, s60, 7
  s_add_u32 s60, s60, 44
  s_atomic_add s74, s[16:17], s60
fused_kernel_lp:
  s_barrier
  s_add_u32 m0, s38, s37
  s_add_u32 s66, s36, 0
  buffer_load_dwordx4 v9, s[28:31], s66 offen offset:0 lds
  s_add_u32 s66, s36, 7168
  buffer_load_dwordx4 v9, s[28:31], s66 offen offset:1024 lds
  s_add_u32 s66, s36, 14336
  buffer_load_dwordx4 v9, s[28:31], s66 offen offset:2048 lds
  s_add_u32 s66, s36, 21504
  buffer_load_dwordx4 v9, s[28:31], s66 offen offset:3072 lds
  s_add_u32 m0, m0, 0x1000
  s_add_u32 s66, s36, 32768
  buffer_load_dwordx4 v9, s[28:31], s66 offen offset:0 lds
  s_add_u32 s66, s36, 39936
  buffer_load_dwordx4 v9, s[28:31], s66 offen offset:1024 lds
  s_add_u32 s66, s36, 47104
  buffer_load_dwordx4 v9, s[28:31], s66 offen offset:2048 lds
  s_add_u32 s66, s36, 54272
  buffer_load_dwordx4 v9, s[28:31], s66 offen offset:3072 lds
  s_add_u32 s38, s38, s62
  s_cmp_eq_u32 s38, s63
  s_cselect_b32 s38, 0, s38
  s_add_u32 s36, s36, 0x10000
  s_cmp_eq_u32 s36, 0x70000
  s_cselect_b32 s36, 0, s36
  s_add_u32 m0, s38, s37
  s_add_u32 s66, s36, 0
  buffer_load_dwordx4 v9, s[28:31], s66 offen offset:0 lds
  s_add_u32 s66, s36, 7168
  buffer_load_dwordx4 v9, s[28:31], s66 offen offset:1024 lds
  s_add_u32 s66, s36, 14336
  buffer_load_dwordx4 v9, s[28:31], s66 offen offset:2048 lds
  s_add_u32 s66, s36, 21504
  buffer_load_dwordx4 v9, s[28:31], s66 offen offset:3072 lds
  s_add_u32 m0, m0, 0x1000
  s_add_u32 s66, s36, 32768
  buffer_load_dwordx4 v9, s[28:31], s66 offen offset:0 lds
  s_add_u32 s66, s36, 39936
  buffer_load_dwordx4 v9, s[28:31], s66 offen offset:1024 lds
  s_add_u32 s66, s36, 47104
  buffer_load_dwordx4 v9, s[28:31], s66 offen offset:2048 lds
  s_add_u32 s66, s36, 54272
  buffer_load_dwordx4 v9, s[28:31], s66 offen offset:3072 lds
  s_add_u32 s38, s38, s62
  s_cmp_eq_u32 s38, s63
  s_cselect_b32 s38, 0, s38
  s_add_u32 s36, s36, 0x10000
  s_cmp_eq_u32 s36, 0x70000
  s_cselect_b32 s36, 0, s36
  s_add_u32 m0, s38, s37
  s_add_u32 s66, s36, 0
  buffer_load_dwordx4 v9, s[28:31], s66 offen offset:0 lds
  s_add_u32 s66, s36, 7168
  buffer_load_dwordx4 v9, s[28:31], s66 offen offset:1024 lds
  s_add_u32 s66, s36, 14336
  buffer_load_dwordx4 v9, s[28:31], s66 offen offset:2048 lds
  s_add_u32 s66, s36, 21504
  buffer_load_dwordx4 v9, s[28:31], s66 offen offset:3072 lds
  s_add_u32 m0, m0, 0x1000
  s_add_u32 s66, s36, 32768
  buffer_load_dwordx4 v9, s[28:31], s66 offen offset:0 lds
  s_add_u32 s66, s36, 39936
  buffer_load_dwordx4 v9, s[28:31], s66 offen offset:1024 lds
  s_add_u32 s66, s36, 47104
  buffer_load_dwordx4 v9, s[28:31], s66 offen offset:2048 lds
  s_add_u32 s66, s36, 54272
  buffer_load_dwordx4 v9, s[28:31], s66 offen offset:3072 lds
  s_add_u32 s38, s38, s62
  s_cmp_eq_u32 s38, s63
  s_cselect_b32 s38, 0, s38
  s_add_u32 s36, s36, 0x10000
  s_cmp_eq_u32 s36, 0x70000
  s_cselect_b32 s36, 0, s36
  s_mov_b32 s12, s10
  s_mov_b32 s13, s11
  s_mov_b32 s14, 0x3000
  s_mov_b32 s15, 0x20000
  s_mov_b32 s68, s52
  s_mov_b32 s69, s53
  s_mov_b32 s70, 0x200000
  s_mov_b32 s71, 0x20000
  s_lshl_b32 s60, s4, 6
  s_add_u32 s60, s60, s43
  s_lshl_b32 s60, s60, 7
  s_add_u32 s60, s60, 44
  s_waitcnt vmcnt(8)
  s_barrier
  s_add_u32 m0, s38, s37
  s_add_u32 s66, s36, 0
  buffer_load_dwordx4 v9, s[28:31], s66 offen offset:0 lds
  s_add_u32 s66, s36, 7168
  buffer_load_dwordx4 v9, s[28:31], s66 offen offset:1024 lds
  s_add_u32 s66, s36, 14336
  buffer_load_dwordx4 v9, s[28:31], s66 offen offset:2048 lds
  s_add_u32 s66, s36, 21504
  buffer_load_dwordx4 v9, s[28:31], s66 offen offset:3072 lds
  s_add_u32 m0, m0, 0x1000
  s_add_u32 s66, s36, 32768
  buffer_load_dwordx4 v9, s[28:31], s66 offen offset:0 lds
  s_add_u32 s66, s36, 39936
  buffer_load_dwordx4 v9, s[28:31], s66 offen offset:1024 lds
  s_add_u32 s66, s36, 47104
  buffer_load_dwordx4 v9, s[28:31], s66 offen offset:2048 lds
  s_add_u32 s66, s36, 54272
  buffer_load_dwordx4 v9, s[28:31], s66 offen offset:3072 lds
  s_add_u32 s38, s38, s62
  s_cmp_eq_u32 s38, s63
  s_cselect_b32 s38, 0, s38
  s_add_u32 s36, s36, 0x10000
  s_cmp_eq_u32 s36, 0x70000
  s_cselect_b32 s36, 0, s36
  v_add_u32 v10, s39, v12
  v_xor_b32 v11, 32, v10
  s_add_u32 s39, s39, s62
  s_cmp_eq_u32 s39, s63
  s_cselect_b32 s39, 0, s39
  ds_read_b64_tr_b16 v[192:193], v10 offset:0
  ds_read_b64_tr_b16 v[194:195], v10 offset:2048
  ds_read_b64_tr_b16 v[196:197], v10 offset:512
  ds_read_b64_tr_b16 v[198:199], v10 offset:2560
  ds_read_b64_tr_b16 v[200:201], v11 offset:0
  ds_read_b64_tr_b16 v[202:203], v11 offset:2048
  ds_read_b64_tr_b16 v[204:205], v11 offset:512
  ds_read_b64_tr_b16 v[206:207], v11 offset:2560
  ds_read_b64_tr_b16 v[208:209], v10 offset:4096
  ds_read_b64_tr_b16 v[210:211], v10 offset:6144
  ds_read_b64_tr_b16 v[212:213], v10 offset:4608
  ds_read_b64_tr_b16 v[214:215], v10 offset:6656
  ds_read_b64_tr_b16 v[216:217], v11 offset:4096
  ds_read_b64_tr_b16 v[218:219], v11 offset:6144
  ds_read_b64_tr_b16 v[220:221], v11 offset:4608
  ds_read_b64_tr_b16 v[222:223], v11 offset:6656
  v_add_u32 v10, s39, v12
  v_xor_b32 v11, 32, v10
  s_add_u32 s39, s39, s62
  s_cmp_eq_u32 s39, s63
  s_cselect_b32 s39, 0, s39
  ds_read_b64_tr_b16 v[224:225], v10 offset:0
  ds_read_b64_tr_b16 v[226:227], v10 offset:2048
  ds_read_b64_tr_b16 v[228:229], v10 offset:512
  ds_read_b64_tr_b16 v[230:231], v10 offset:2560
  ds_read_b64_tr_b16 v[232:233], v11 offset:0
  ds_read_b64_tr_b16 v[234:235], v11 offset:2048
  ds_read_b64_tr_b16 v[236:237], v11 offset:512
  ds_read_b64_tr_b16 v[238:239], v11 offset:2560
  ds_read_b64_tr_b16 v[240:241], v10 offset:4096
  ds_read_b64_tr_b16 v[242:243], v10 offset:6144
  ds_read_b64_tr_b16 v[244:245], v10 offset:4608
  ds_read_b64_tr_b16 v[246:247], v10 offset:6656
  ds_read_b64_tr_b16 v[248:249], v11 offset:4096
  ds_read_b64_tr_b16 v[250:251], v11 offset:6144
  ds_read_b64_tr_b16 v[252:253], v11 offset:4608
  ds_read_b64_tr_b16 v[254:255], v11 offset:6656
  s_add_u32 m0, s38, s37
  s_add_u32 s66, s36, 0
  buffer_load_dwordx4 v9, s[28:31], s66 offen offset:0 lds
  s_add_u32 s66, s36, 7168
  buffer_load_dwordx4 v9, s[28:31], s66 offen offset:1024 lds
  s_add_u32 s66, s36, 14336
  buffer_load_dwordx4 v9, s[28:31], s66 offen offset:2048 lds
  s_add_u32 s66, s36, 21504
  buffer_load_dwordx4 v9, s[28:31], s66 offen offset:3072 lds
  s_add_u32 m0, m0, 0x1000
  s_add_u32 s66, s36, 32768
  buffer_load_dwordx4 v9, s[28:31], s66 offen offset:0 lds
  s_add_u32 s66, s36, 39936
  buffer_load_dwordx4 v9, s[28:31], s66 offen offset:1024 lds
  s_add_u32 s66, s36, 47104
  buffer_load_dwordx4 v9, s[28:31], s66 offen offset:2048 lds
  s_add_u32 s66, s36, 54272
  buffer_load_dwordx4 v9, s[28:31], s66 offen offset:3072 lds
  s_add_u32 s38, s38, s62
  s_cmp_eq_u32 s38, s63
  s_cselect_b32 s38, 0, s38
  s_add_u32 s36, s36, 0x10000
  s_cmp_eq_u32 s36, 0x70000
  s_cselect_b32 s36, 0, s36
  s_waitcnt lgkmcnt(0)
  s_barrier
  s_load_dword s9, s[16:17], s60 glc
  s_add_u32 m0, s38, s37
  s_add_u32 s66, s36, 0
  buffer_load_dwordx4 v9, s[28:31], s66 offen offset:0 lds
  s_add_u32 s66, s36, 7168
  buffer_load_dwordx4 v9, s[28:31], s66 offen offset:1024 lds
  s_add_u32 s66, s36, 14336
  buffer_load_dwordx4 v9, s[28:31], s66 offen offset:2048 lds
  s_add_u32 s66, s36, 21504
  buffer_load_dwordx4 v9, s[28:31], s66 offen offset:3072 lds
  s_add_u32 m0, m0, 0x1000
  s_add_u32 s66, s36, 32768
  buffer_load_dwordx4 v9, s[28:31], s66 offen offset:0 lds
  s_add_u32 s66, s36, 39936
  buffer_load_dwordx4 v9, s[28:31], s66 offen offset:1024 lds
  s_add_u32 s66, s36, 47104
  buffer_load_dwordx4 v9, s[28:31], s66 offen offset:2048 lds
  s_add_u32 s66, s36, 54272
  buffer_load_dwordx4 v9, s[28:31], s66 offen offset:3072 lds
  s_add_u32 s38, s38, s62
  s_cmp_eq_u32 s38, s63
  s_cselect_b32 s38, 0, s38
  s_add_u32 s36, s36, 0x10000
  s_cmp_eq_u32 s36, 0x70000
  s_cselect_b32 s36, 0, s36
  s_add_u32 m0, s38, s37
  s_add_u32 s66, s36, 0
  buffer_load_dwordx4 v9, s[28:31], s66 offen offset:0 lds
  s_add_u32 s66, s36, 7168
  buffer_load_dwordx4 v9, s[28:31], s66 offen offset:1024 lds
  s_add_u32 s66, s36, 14336
  buffer_load_dwordx4 v9, s[28:31], s66 offen offset:2048 lds
  s_add_u32 s66, s36, 21504
  buffer_load_dwordx4 v9, s[28:31], s66 offen offset:3072 lds
  s_add_u32 m0, m0, 0x1000
  s_add_u32 s66, s36, 32768
  buffer_load_dwordx4 v9, s[28:31], s66 offen offset:0 lds
  s_add_u32 s66, s36, 39936
  buffer_load_dwordx4 v9, s[28:31], s66 offen offset:1024 lds
  s_add_u32 s66, s36, 47104
  buffer_load_dwordx4 v9, s[28:31], s66 offen offset:2048 lds
  s_add_u32 s66, s36, 54272
  buffer_load_dwordx4 v9, s[28:31], s66 offen offset:3072 lds
  s_add_u32 s38, s38, s62
  s_cmp_eq_u32 s38, s63
  s_cselect_b32 s38, 0, s38
  s_add_u32 s36, s36, 0x10000
  s_cmp_eq_u32 s36, 0x70000
  s_cselect_b32 s36, 0, s36
  s_waitcnt lgkmcnt(0)
  s_cmp_lt_u32 s9, 7
  s_cbranch_scc1 fused_kernel_la
  s_lshl_b32 s61, s34, 12
  buffer_load_dwordx4 v[80:83], v4, s[20:23], s61 offen offset:0 sc1
  buffer_load_dwordx4 v[84:87], v4, s[20:23], s61 offen offset:1024 sc1
  buffer_load_dwordx4 v[88:91], v4, s[20:23], s61 offen offset:2048 sc1
  buffer_load_dwordx4 v[92:95], v4, s[20:23], s61 offen offset:3072 sc1
  s_add_u32 s61, s61, 0x1000
  s_cmp_eq_u32 s61, 0x7000
  s_cselect_b32 s61, 0, s61
  buffer_load_dwordx4 v[96:99], v4, s[20:23], s61 offen offset:0 sc1
  buffer_load_dwordx4 v[100:103], v4, s[20:23], s61 offen offset:1024 sc1
  buffer_load_dwordx4 v[104:107], v4, s[20:23], s61 offen offset:2048 sc1
  buffer_load_dwordx4 v[108:111], v4, s[20:23], s61 offen offset:3072 sc1
  s_add_u32 s61, s61, 0x1000
  s_cmp_eq_u32 s61, 0x7000
  s_cselect_b32 s61, 0, s61
  buffer_load_dwordx4 v[112:115], v4, s[20:23], s61 offen offset:0 sc1
  buffer_load_dwordx4 v[116:119], v4, s[20:23], s61 offen offset:1024 sc1
  buffer_load_dwordx4 v[120:123], v4, s[20:23], s61 offen offset:2048 sc1
  buffer_load_dwordx4 v[124:127], v4, s[20:23], s61 offen offset:3072 sc1
  s_add_u32 s61, s61, 0x1000
  s_cmp_eq_u32 s61, 0x7000
  s_cselect_b32 s61, 0, s61
  buffer_load_dwordx4 v[128:131], v4, s[20:23], s61 offen offset:0 sc1
  buffer_load_dwordx4 v[132:135], v4, s[20:23], s61 offen offset:1024 sc1
  buffer_load_dwordx4 v[136:139], v4, s[20:23], s61 offen offset:2048 sc1
  buffer_load_dwordx4 v[140:143], v4, s[20:23], s61 offen offset:3072 sc1
  s_add_u32 s61, s61, 0x1000
  s_cmp_eq_u32 s61, 0x7000
  s_cselect_b32 s61, 0, s61
  buffer_load_dwordx4 v[144:147], v4, s[20:23], s61 offen offset:0 sc1
  buffer_load_dwordx4 v[148:151], v4, s[20:23], s61 offen offset:1024 sc1
  buffer_load_dwordx4 v[152:155], v4, s[20:23], s61 offen offset:2048 sc1
  buffer_load_dwordx4 v[156:159], v4, s[20:23], s61 offen offset:3072 sc1
  s_add_u32 s61, s61, 0x1000
  s_cmp_eq_u32 s61, 0x7000
  s_cselect_b32 s61, 0, s61
  s_waitcnt vmcnt(20)
  s_barrier
  buffer_load_dwordx4 v[160:163], v4, s[20:23], s61 offen offset:0 sc1
  buffer_load_dwordx4 v[164:167], v4, s[20:23], s61 offen offset:1024 sc1
  buffer_load_dwordx4 v[168:171], v4, s[20:23], s61 offen offset:2048 sc1
  buffer_load_dwordx4 v[172:175], v4, s[20:23], s61 offen offset:3072 sc1
  s_add_u32 s61, s61, 0x1000
  s_cmp_eq_u32 s61, 0x7000
  s_cselect_b32 s61, 0, s61
  buffer_load_dwordx4 v[176:179], v4, s[20:23], s61 offen offset:0 sc1
  buffer_load_dwordx4 v[180:183], v4, s[20:23], s61 offen offset:1024 sc1
  buffer_load_dwordx4 v[184:187], v4, s[20:23], s61 offen offset:2048 sc1
  buffer_load_dwordx4 v[188:191], v4, s[20:23], s61 offen offset:3072 sc1
  s_add_u32 s61, s61, 0x1000
  s_cmp_eq_u32 s61, 0x7000
  s_cselect_b32 s61, 0, s61
  v_add_u32 v10, s39, v12
  v_xor_b32 v11, 32, v10
  s_add_u32 s39, s39, s62
  s_cmp_eq_u32 s39, s63
  s_cselect_b32 s39, 0, s39
  ds_read_b64_tr_b16 v[16:17], v10 offset:0
  ds_read_b64_tr_b16 v[18:19], v10 offset:2048
  ds_read_b64_tr_b16 v[20:21], v10 offset:512
  ds_read_b64_tr_b16 v[22:23], v10 offset:2560
  ds_read_b64_tr_b16 v[24:25], v11 offset:0
  ds_read_b64_tr_b16 v[26:27], v11 offset:2048
  ds_read_b64_tr_b16 v[28:29], v11 offset:512
  ds_read_b64_tr_b16 v[30:31], v11 offset:2560
  ds_read_b64_tr_b16 v[32:33], v10 offset:4096
  ds_read_b64_tr_b16 v[34:35], v10 offset:6144
  ds_read_b64_tr_b16 v[36:37], v10 offset:4608
  ds_read_b64_tr_b16 v[38:39], v10 offset:6656
  ds_read_b64_tr_b16 v[40:41], v11 offset:4096
  ds_read_b64_tr_b16 v[42:43], v11 offset:6144
  ds_read_b64_tr_b16 v[44:45], v11 offset:4608
  ds_read_b64_tr_b16 v[46:47], v11 offset:6656
  s_waitcnt vmcnt(26)
  v_mfma_f32_16x16x32_bf16 v[48:51], v[192:195], v[80:83], 0
  v_mfma_f32_16x16x32_bf16 v[52:55], v[192:195], v[84:87], 0
  v_mfma_f32_16x16x32_bf16 v[64:67], v[196:199], v[80:83], 0
  v_mfma_f32_16x16x32_bf16 v[68:71], v[196:199], v[84:87], 0
  v_mfma_f32_16x16x32_bf16 v[56:59], v[200:203], v[80:83], 0
  v_mfma_f32_16x16x32_bf16 v[60:63], v[200:203], v[84:87], 0
  v_mfma_f32_16x16x32_bf16 v[72:75], v[204:207], v[80:83], 0
  v_mfma_f32_16x16x32_bf16 v[76:79], v[204:207], v[84:87], 0
  s_waitcnt vmcnt(24)
  v_mfma_f32_16x16x32_bf16 v[48:51], v[208:211], v[88:91], v[48:51]
  v_mfma_f32_16x16x32_bf16 v[52:55], v[208:211], v[92:95], v[52:55]
  v_mfma_f32_16x16x32_bf16 v[64:67], v[212:215], v[88:91], v[64:67]
  v_mfma_f32_16x16x32_bf16 v[68:71], v[212:215], v[92:95], v[68:71]
  v_mfma_f32_16x16x32_bf16 v[56:59], v[216:219], v[88:91], v[56:59]
  v_mfma_f32_16x16x32_bf16 v[60:63], v[216:219], v[92:95], v[60:63]
  v_mfma_f32_16x16x32_bf16 v[72:75], v[220:223], v[88:91], v[72:75]
  v_mfma_f32_16x16x32_bf16 v[76:79], v[220:223], v[92:95], v[76:79]
  s_waitcnt vmcnt(22)
  v_mfma_f32_16x16x32_bf16 v[48:51], v[224:227], v[96:99], v[48:51]
  v_mfma_f32_16x16x32_bf16 v[52:55], v[224:227], v[100:103], v[52:55]
  v_mfma_f32_16x16x32_bf16 v[64:67], v[228:231], v[96:99], v[64:67]
  v_mfma_f32_16x16x32_bf16 v[68:71], v[228:231], v[100:103], v[68:71]
  v_mfma_f32_16x16x32_bf16 v[56:59], v[232:235], v[96:99], v[56:59]
  v_mfma_f32_16x16x32_bf16 v[60:63], v[232:235], v[100:103], v[60:63]
  v_mfma_f32_16x16x32_bf16 v[72:75], v[236:239], v[96:99], v[72:75]
  v_mfma_f32_16x16x32_bf16 v[76:79], v[236:239], v[100:103], v[76:79]
  s_waitcnt vmcnt(20)
  v_mfma_f32_16x16x32_bf16 v[48:51], v[240:243], v[104:107], v[48:51]
  v_mfma_f32_16x16x32_bf16 v[52:55], v[240:243], v[108:111], v[52:55]
  v_mfma_f32_16x16x32_bf16 v[64:67], v[244:247], v[104:107], v[64:67]
  v_mfma_f32_16x16x32_bf16 v[68:71], v[244:247], v[108:111], v[68:71]
  v_mfma_f32_16x16x32_bf16 v[56:59], v[248:251], v[104:107], v[56:59]
  v_mfma_f32_16x16x32_bf16 v[60:63], v[248:251], v[108:111], v[60:63]
  v_mfma_f32_16x16x32_bf16 v[72:75], v[252:255], v[104:107], v[72:75]
  v_mfma_f32_16x16x32_bf16 v[76:79], v[252:255], v[108:111], v[76:79]
  s_waitcnt vmcnt(18)
  s_waitcnt lgkmcnt(12)
  v_mfma_f32_16x16x32_bf16 v[48:51], v[16:19], v[112:115], v[48:51]
  v_mfma_f32_16x16x32_bf16 v[52:55], v[16:19], v[116:119], v[52:55]
  v_add_u32 v10, s39, v12
  v_xor_b32 v11, 32, v10
  s_add_u32 s39, s39, s62
  s_cmp_eq_u32 s39, s63
  s_cselect_b32 s39, 0, s39
  ds_read_b64_tr_b16 v[16:17], v10 offset:0
  v_mfma_f32_16x16x32_bf16 v[64:67], v[20:23], v[112:115], v[64:67]
  ds_read_b64_tr_b16 v[18:19], v10 offset:2048
  v_mfma_f32_16x16x32_bf16 v[68:71], v[20:23], v[116:119], v[68:71]
  ds_read_b64_tr_b16 v[20:21], v10 offset:512
  s_waitcnt lgkmcnt(11)
  v_mfma_f32_16x16x32_bf16 v[56:59], v[24:27], v[112:115], v[56:59]
  ds_read_b64_tr_b16 v[22:23], v10 offset:2560
  v_mfma_f32_16x16x32_bf16 v[60:63], v[24:27], v[116:119], v[60:63]
  ds_read_b64_tr_b16 v[24:25], v11 offset:0
  v_mfma_f32_16x16x32_bf16 v[72:75], v[28:31], v[112:115], v[72:75]
  ds_read_b64_tr_b16 v[26:27], v11 offset:2048
  v_mfma_f32_16x16x32_bf16 v[76:79], v[28:31], v[116:119], v[76:79]
  ds_read_b64_tr_b16 v[28:29], v11 offset:512
  s_waitcnt vmcnt(16)
  s_waitcnt lgkmcnt(11)
  v_mfma_f32_16x16x32_bf16 v[48:51], v[32:35], v[120:123], v[48:51]
  ds_read_b64_tr_b16 v[30:31], v11 offset:2560
  v_mfma_f32_16x16x32_bf16 v[52:55], v[32:35], v[124:127], v[52:55]
  ds_read_b64_tr_b16 v[32:33], v10 offset:4096
  v_mfma_f32_16x16x32_bf16 v[64:67], v[36:39], v[120:123], v[64:67]
  ds_read_b64_tr_b16 v[34:35], v10 offset:6144
  v_mfma_f32_16x16x32_bf16 v[68:71], v[36:39], v[124:127], v[68:71]
  ds_read_b64_tr_b16 v[36:37], v10 offset:4608
  buffer_load_dwordx4 v[192:195], v5, s[24:27], s58 offen sc1
  s_waitcnt lgkmcnt(11)
  v_mfma_f32_16x16x32_bf16 v[56:59], v[40:43], v[120:123], v[56:59]
  ds_read_b64_tr_b16 v[38:39], v10 offset:6656
  v_mfma_f32_16x16x32_bf16 v[60:63], v[40:43], v[124:127], v[60:63]
  ds_read_b64_tr_b16 v[40:41], v11 offset:4096
  buffer_load_dwordx4 v[196:199], v8, s[12:15], s59 offen sc1
  v_mfma_f32_16x16x32_bf16 v[72:75], v[44:47], v[120:123], v[72:75]
  ds_read_b64_tr_b16 v[42:43], v11 offset:6144
  v_mfma_f32_16x16x32_bf16 v[76:79], v[44:47], v[124:127], v[76:79]
  ds_read_b64_tr_b16 v[44:45], v11 offset:4608
  buffer_load_dwordx4 v[200:203], v8, s[12:15], s59 offen offset:16 sc1
  s_waitcnt vmcnt(17)
  s_waitcnt lgkmcnt(11)
  v_mfma_f32_16x16x32_bf16 v[48:51], v[16:19], v[128:131], v[48:51]
  ds_read_b64_tr_b16 v[46:47], v11 offset:6656
  v_mfma_f32_16x16x32_bf16 v[52:55], v[16:19], v[132:135], v[52:55]
  v_add_u32 v10, s39, v12
  v_xor_b32 v11, 32, v10
  s_add_u32 s39, s39, s62
  s_cmp_eq_u32 s39, s63
  s_cselect_b32 s39, 0, s39
  ds_read_b64_tr_b16 v[16:17], v10 offset:0
  v_mfma_f32_16x16x32_bf16 v[64:67], v[20:23], v[128:131], v[64:67]
  ds_read_b64_tr_b16 v[18:19], v10 offset:2048
  v_mfma_f32_16x16x32_bf16 v[68:71], v[20:23], v[132:135], v[68:71]
  ds_read_b64_tr_b16 v[20:21], v10 offset:512
  s_waitcnt lgkmcnt(11)
  v_mfma_f32_16x16x32_bf16 v[56:59], v[24:27], v[128:131], v[56:59]
  ds_read_b64_tr_b16 v[22:23], v10 offset:2560
  v_mfma_f32_16x16x32_bf16 v[60:63], v[24:27], v[132:135], v[60:63]
  ds_read_b64_tr_b16 v[24:25], v11 offset:0
  v_mfma_f32_16x16x32_bf16 v[72:75], v[28:31], v[128:131], v[72:75]
  ds_read_b64_tr_b16 v[26:27], v11 offset:2048
  v_mfma_f32_16x16x32_bf16 v[76:79], v[28:31], v[132:135], v[76:79]
  ds_read_b64_tr_b16 v[28:29], v11 offset:512
  s_waitcnt vmcnt(15)
  s_waitcnt lgkmcnt(11)
  v_mfma_f32_16x16x32_bf16 v[48:51], v[32:35], v[136:139], v[48:51]
  ds_read_b64_tr_b16 v[30:31], v11 offset:2560
  v_mfma_f32_16x16x32_bf16 v[52:55], v[32:35], v[140:143], v[52:55]
  ds_read_b64_tr_b16 v[32:33], v10 offset:4096
  v_mfma_f32_16x16x32_bf16 v[64:67], v[36:39], v[136:139], v[64:67]
  ds_read_b64_tr_b16 v[34:35], v10 offset:6144
  v_mfma_f32_16x16x32_bf16 v[68:71], v[36:39], v[140:143], v[68:71]
  ds_read_b64_tr_b16 v[36:37], v10 offset:4608
  s_waitcnt lgkmcnt(11)
  v_mfma_f32_16x16x32_bf16 v[56:59], v[40:43], v[136:139], v[56:59]
  ds_read_b64_tr_b16 v[38:39], v10 offset:6656
  v_mfma_f32_16x16x32_bf16 v[60:63], v[40:43], v[140:143], v[60:63]
  ds_read_b64_tr_b16 v[40:41], v11 offset:4096
  v_mfma_f32_16x16x32_bf16 v[72:75], v[44:47], v[136:139], v[72:75]
  ds_read_b64_tr_b16 v[42:43], v11 offset:6144
  v_mfma_f32_16x16x32_bf16 v[76:79], v[44:47], v[140:143], v[76:79]
  ds_read_b64_tr_b16 v[44:45], v11 offset:4608
  s_waitcnt vmcnt(13)
  s_waitcnt lgkmcnt(11)
  v_mfma_f32_16x16x32_bf16 v[48:51], v[16:19], v[144:147], v[48:51]
  ds_read_b64_tr_b16 v[46:47], v11 offset:6656
  v_mfma_f32_16x16x32_bf16 v[52:55], v[16:19], v[148:151], v[52:55]
  v_add_u32 v10, s39, v12
  v_xor_b32 v11, 32, v10
  s_add_u32 s39, s39, s62
  s_cmp_eq_u32 s39, s63
  s_cselect_b32 s39, 0, s39
  ds_read_b64_tr_b16 v[16:17], v10 offset:0
  v_mfma_f32_16x16x32_bf16 v[64:67], v[20:23], v[144:147], v[64:67]
  ds_read_b64_tr_b16 v[18:19], v10 offset:2048
  v_mfma_f32_16x16x32_bf16 v[68:71], v[20:23], v[148:151], v[68:71]
  ds_read_b64_tr_b16 v[20:21], v10 offset:512
  s_waitcnt lgkmcnt(11)
  v_mfma_f32_16x16x32_bf16 v[56:59], v[24:27], v[144:147], v[56:59]
  ds_read_b64_tr_b16 v[22:23], v10 offset:2560
  v_mfma_f32_16x16x32_bf16 v[60:63], v[24:27], v[148:151], v[60:63]
  ds_read_b64_tr_b16 v[24:25], v11 offset:0
  v_mfma_f32_16x16x32_bf16 v[72:75], v[28:31], v[144:147], v[72:75]
  ds_read_b64_tr_b16 v[26:27], v11 offset:2048
  v_mfma_f32_16x16x32_bf16 v[76:79], v[28:31], v[148:151], v[76:79]
  ds_read_b64_tr_b16 v[28:29], v11 offset:512
  s_waitcnt vmcnt(11)
  s_waitcnt lgkmcnt(11)
  v_mfma_f32_16x16x32_bf16 v[48:51], v[32:35], v[152:155], v[48:51]
  ds_read_b64_tr_b16 v[30:31], v11 offset:2560
  v_mfma_f32_16x16x32_bf16 v[52:55], v[32:35], v[156:159], v[52:55]
  ds_read_b64_tr_b16 v[32:33], v10 offset:4096
  v_mfma_f32_16x16x32_bf16 v[64:67], v[36:39], v[152:155], v[64:67]
  ds_read_b64_tr_b16 v[34:35], v10 offset:6144
  v_mfma_f32_16x16x32_bf16 v[68:71], v[36:39], v[156:159], v[68:71]
  ds_read_b64_tr_b16 v[36:37], v10 offset:4608
  s_waitcnt lgkmcnt(11)
  v_mfma_f32_16x16x32_bf16 v[56:59], v[40:43], v[152:155], v[56:59]
  ds_read_b64_tr_b16 v[38:39], v10 offset:6656
  v_mfma_f32_16x16x32_bf16 v[60:63], v[40:43], v[156:159], v[60:63]
  ds_read_b64_tr_b16 v[40:41], v11 offset:4096
  v_mfma_f32_16x16x32_bf16 v[72:75], v[44:47], v[152:155], v[72:75]
  ds_read_b64_tr_b16 v[42:43], v11 offset:6144
  v_mfma_f32_16x16x32_bf16 v[76:79], v[44:47], v[156:159], v[76:79]
  ds_read_b64_tr_b16 v[44:45], v11 offset:4608
  s_waitcnt vmcnt(9)
  s_waitcnt lgkmcnt(11)
  v_mfma_f32_16x16x32_bf16 v[48:51], v[16:19], v[160:163], v[48:51]
  ds_read_b64_tr_b16 v[46:47], v11 offset:6656
  v_mfma_f32_16x16x32_bf16 v[52:55], v[16:19], v[164:167], v[52:55]
  v_add_u32 v10, s39, v12
  v_xor_b32 v11, 32, v10
  s_add_u32 s39, s39, s62
  s_cmp_eq_u32 s39, s63
  s_cselect_b32 s39, 0, s39
  ds_read_b64_tr_b16 v[16:17], v10 offset:0
  v_mfma_f32_16x16x32_bf16 v[64:67], v[20:23], v[160:163], v[64:67]
  ds_read_b64_tr_b16 v[18:19], v10 offset:2048
  v_mfma_f32_16x16x32_bf16 v[68:71], v[20:23], v[164:167], v[68:71]
  ds_read_b64_tr_b16 v[20:21], v10 offset:512
  s_waitcnt lgkmcnt(11)
  v_mfma_f32_16x16x32_bf16 v[56:59], v[24:27], v[160:163], v[56:59]
  ds_read_b64_tr_b16 v[22:23], v10 offset:2560
  v_mfma_f32_16x16x32_bf16 v[60:63], v[24:27], v[164:167], v[60:63]
  ds_read_b64_tr_b16 v[24:25], v11 offset:0
  v_mfma_f32_16x16x32_bf16 v[72:75], v[28:31], v[160:163], v[72:75]
  ds_read_b64_tr_b16 v[26:27], v11 offset:2048
  v_mfma_f32_16x16x32_bf16 v[76:79], v[28:31], v[164:167], v[76:79]
  ds_read_b64_tr_b16 v[28:29], v11 offset:512
  s_waitcnt vmcnt(7)
  s_waitcnt lgkmcnt(11)
  v_mfma_f32_16x16x32_bf16 v[48:51], v[32:35], v[168:171], v[48:51]
  ds_read_b64_tr_b16 v[30:31], v11 offset:2560
  v_mfma_f32_16x16x32_bf16 v[52:55], v[32:35], v[172:175], v[52:55]
  ds_read_b64_tr_b16 v[32:33], v10 offset:4096
  v_mfma_f32_16x16x32_bf16 v[64:67], v[36:39], v[168:171], v[64:67]
  ds_read_b64_tr_b16 v[34:35], v10 offset:6144
  v_mfma_f32_16x16x32_bf16 v[68:71], v[36:39], v[172:175], v[68:71]
  ds_read_b64_tr_b16 v[36:37], v10 offset:4608
  s_waitcnt lgkmcnt(11)
  v_mfma_f32_16x16x32_bf16 v[56:59], v[40:43], v[168:171], v[56:59]
  ds_read_b64_tr_b16 v[38:39], v10 offset:6656
  v_mfma_f32_16x16x32_bf16 v[60:63], v[40:43], v[172:175], v[60:63]
  ds_read_b64_tr_b16 v[40:41], v11 offset:4096
  v_mfma_f32_16x16x32_bf16 v[72:75], v[44:47], v[168:171], v[72:75]
  ds_read_b64_tr_b16 v[42:43], v11 offset:6144
  v_mfma_f32_16x16x32_bf16 v[76:79], v[44:47], v[172:175], v[76:79]
  ds_read_b64_tr_b16 v[44:45], v11 offset:4608
  s_waitcnt vmcnt(5)
  s_waitcnt lgkmcnt(11)
  v_mfma_f32_16x16x32_bf16 v[48:51], v[16:19], v[176:179], v[48:51]
  ds_read_b64_tr_b16 v[46:47], v11 offset:6656
  v_mfma_f32_16x16x32_bf16 v[52:55], v[16:19], v[180:183], v[52:55]
  v_mfma_f32_16x16x32_bf16 v[64:67], v[20:23], v[176:179], v[64:67]
  v_mfma_f32_16x16x32_bf16 v[68:71], v[20:23], v[180:183], v[68:71]
  s_waitcnt lgkmcnt(8)
  v_mfma_f32_16x16x32_bf16 v[56:59], v[24:27], v[176:179], v[56:59]
  v_mfma_f32_16x16x32_bf16 v[60:63], v[24:27], v[180:183], v[60:63]
  v_mfma_f32_16x16x32_bf16 v[72:75], v[28:31], v[176:179], v[72:75]
  v_mfma_f32_16x16x32_bf16 v[76:79], v[28:31], v[180:183], v[76:79]
  s_waitcnt vmcnt(3)
  s_waitcnt lgkmcnt(4)
  v_mfma_f32_16x16x32_bf16 v[48:51], v[32:35], v[184:187], v[48:51]
  v_mfma_f32_16x16x32_bf16 v[52:55], v[32:35], v[188:191], v[52:55]
  v_mfma_f32_16x16x32_bf16 v[64:67], v[36:39], v[184:187], v[64:67]
  v_mfma_f32_16x16x32_bf16 v[68:71], v[36:39], v[188:191], v[68:71]
  s_waitcnt lgkmcnt(0)
  v_mfma_f32_16x16x32_bf16 v[56:59], v[40:43], v[184:187], v[56:59]
  v_mfma_f32_16x16x32_bf16 v[60:63], v[40:43], v[188:191], v[60:63]
  v_mfma_f32_16x16x32_bf16 v[72:75], v[44:47], v[184:187], v[72:75]
  v_mfma_f32_16x16x32_bf16 v[76:79], v[44:47], v[188:191], v[76:79]
  s_branch fused_kernel_fin
fused_kernel_la:
  s_waitcnt vmcnt(0)
  s_barrier
  s_branch fused_kernel_hd
fused_kernel_noup:
  s_waitcnt lgkmcnt(0)
  s_cmp_lg_u32 s40, 0
  s_cbranch_scc1 fused_kernel_lp
  s_barrier
  s_mov_b32 s6, 0x40000000
fused_kernel_hp:
  s_setprio 2
  s_barrier
  s_nop 7
  v_add_u32 v10, s39, v12
  v_xor_b32 v11, 32, v10
  s_add_u32 s39, s39, s62
  s_cmp_eq_u32 s39, s63
  s_cselect_b32 s39, 0, s39
  ds_read_b64_tr_b16 v[192:193], v10 offset:0
  ds_read_b64_tr_b16 v[194:195], v10 offset:2048
  ds_read_b64_tr_b16 v[196:197], v10 offset:512
  ds_read_b64_tr_b16 v[198:199], v10 offset:2560
  ds_read_b64_tr_b16 v[200:201], v11 offset:0
  ds_read_b64_tr_b16 v[202:203], v11 offset:2048
  ds_read_b64_tr_b16 v[204:205], v11 offset:512
  ds_read_b64_tr_b16 v[206:207], v11 offset:2560
  ds_read_b64_tr_b16 v[208:209], v10 offset:4096
  ds_read_b64_tr_b16 v[210:211], v10 offset:6144
  ds_read_b64_tr_b16 v[212:213], v10 offset:4608
  ds_read_b64_tr_b16 v[214:215], v10 offset:6656
  ds_read_b64_tr_b16 v[216:217], v11 offset:4096
  ds_read_b64_tr_b16 v[218:219], v11 offset:6144
  ds_read_b64_tr_b16 v[220:221], v11 offset:4608
  ds_read_b64_tr_b16 v[222:223], v11 offset:6656
  v_add_u32 v10, s39, v12
  v_xor_b32 v11, 32, v10
  s_add_u32 s39, s39, s62
  s_cmp_eq_u32 s39, s63
  s_cselect_b32 s39, 0, s39
  ds_read_b64_tr_b16 v[224:225], v10 offset:0
  ds_read_b64_tr_b16 v[226:227], v10 offset:2048
  ds_read_b64_tr_b16 v[228:229], v10 offset:512
  ds_read_b64_tr_b16 v[230:231], v10 offset:2560
  ds_read_b64_tr_b16 v[232:233], v11 offset:0
  ds_read_b64_tr_b16 v[234:235], v11 offset:2048
  ds_read_b64_tr_b16 v[236:237], v11 offset:512
  ds_read_b64_tr_b16 v[238:239], v11 offset:2560
  ds_read_b64_tr_b16 v[240:241], v10 offset:4096
  ds_read_b64_tr_b16 v[242:243], v10 offset:6144
  ds_read_b64_tr_b16 v[244:245], v10 offset:4608
  ds_read_b64_tr_b16 v[246:247], v10 offset:6656
  ds_read_b64_tr_b16 v[248:249], v11 offset:4096
  ds_read_b64_tr_b16 v[250:251], v11 offset:6144
  ds_read_b64_tr_b16 v[252:253], v11 offset:4608
  ds_read_b64_tr_b16 v[254:255], v11 offset:6656
  v_exp_f32 v158, v158
  v_exp_f32 v159, v159
  v_add_f32 v152, 1.0, v152
  v_add_f32 v153, 1.0, v153
  v_add_f32 v154, 1.0, v154
  v_add_f32 v155, 1.0, v155
  v_add_f32 v156, 1.0, v156
  v_add_f32 v157, 1.0, v157
  v_add_f32 v158, 1.0, v158
  v_add_f32 v159, 1.0, v159
  v_rcp_f32 v152, v152
  v_rcp_f32 v153, v153
  v_rcp_f32 v154, v154
  v_rcp_f32 v155, v155
  v_rcp_f32 v156, v156
  v_rcp_f32 v157, v157
  v_rcp_f32 v158, v158
  v_rcp_f32 v159, v159
  v_mul_f32 v152, v88, v152
  v_mul_f32 v153, v89, v153
  v_mul_f32 v154, v90, v154
  v_mul_f32 v155, v91, v155
  v_mul_f32 v156, v92, v156
  v_mul_f32 v157, v93, v157
  v_mul_f32 v158, v94, v158
  v_mul_f32 v159, v95, v159
  v_mul_f32 v144, v144, v112
  v_mul_f32 v145, v145, v113
  v_mul_f32 v146, v146, v114
  v_mul_f32 v147, v147, v115
  v_mul_f32 v148, v148, v116
  v_mul_f32 v149, v149, v117
  v_mul_f32 v150, v150, v118
  v_mul_f32 v151, v151, v119
  v_mul_f32 v152, v152, v120
  v_mul_f32 v153, v153, v121
  v_mul_f32 v154, v154, v122
  v_mul_f32 v155, v155, v123
  v_mul_f32 v156, v156, v124
  v_mul_f32 v157, v157, v125
  v_mul_f32 v158, v158, v126
  v_mul_f32 v159, v159, v127
  v_cvt_pk_bf16_f32 v168, v144, v145
  v_cvt_pk_bf16_f32 v169, v146, v147
  v_cvt_pk_bf16_f32 v170, v152, v153
  v_cvt_pk_bf16_f32 v171, v154, v155
  buffer_store_dwordx4 v[168:171], v2, s[20:23], s6 offen offset:2048 sc1
  v_cvt_pk_bf16_f32 v172, v148, v149
  v_cvt_pk_bf16_f32 v173, v150, v151
  v_cvt_pk_bf16_f32 v174, v156, v157
  v_cvt_pk_bf16_f32 v175, v158, v159
  buffer_store_dwordx4 v[172:175], v2, s[20:23], s6 offen offset:3072 sc1
  s_waitcnt lgkmcnt(0)
  s_barrier
  s_mov_b32 s12, s10
  s_mov_b32 s13, s11
  s_mov_b32 s14, 0x3000
  s_mov_b32 s15, 0x20000
  s_mov_b32 s68, s52
  s_mov_b32 s69, s53
  s_mov_b32 s70, 0x200000
  s_mov_b32 s71, 0x20000
  s_waitcnt vmcnt(0)
  s_cmp_ge_u32 s41, 28
  s_cbranch_scc1 fused_kernel_na
  s_lshl_b32 s60, s5, 6
  s_add_u32 s60, s60, s42
  s_lshl_b32 s60, s60, 7
  s_add_u32 s60, s60, 44
  s_atomic_add s74, s[16:17], s60
fused_kernel_na:
  s_barrier
fused_kernel_hd:
  v_add_u32 v10, s39, v12
  v_xor_b32 v11, 32, v10
  s_add_u32 s39, s39, s62
  s_cmp_eq_u32 s39, s63
  s_cselect_b32 s39, 0, s39
  ds_read_b64_tr_b16 v[16:17], v10 offset:0
  ds_read_b64_tr_b16 v[18:19], v10 offset:2048
  ds_read_b64_tr_b16 v[20:21], v10 offset:512
  ds_read_b64_tr_b16 v[22:23], v10 offset:2560
  ds_read_b64_tr_b16 v[24:25], v11 offset:0
  ds_read_b64_tr_b16 v[26:27], v11 offset:2048
  ds_read_b64_tr_b16 v[28:29], v11 offset:512
  ds_read_b64_tr_b16 v[30:31], v11 offset:2560
  ds_read_b64_tr_b16 v[32:33], v10 offset:4096
  ds_read_b64_tr_b16 v[34:35], v10 offset:6144
  ds_read_b64_tr_b16 v[36:37], v10 offset:4608
  ds_read_b64_tr_b16 v[38:39], v10 offset:6656
  ds_read_b64_tr_b16 v[40:41], v11 offset:4096
  ds_read_b64_tr_b16 v[42:43], v11 offset:6144
  ds_read_b64_tr_b16 v[44:45], v11 offset:4608
  ds_read_b64_tr_b16 v[46:47], v11 offset:6656
  s_lshl_b32 s60, s4, 6
  s_add_u32 s60, s60, s43
  s_lshl_b32 s60, s60, 7
  s_add_u32 s60, s60, 44
  s_load_dword s9, s[16:17], s60 glc
  s_waitcnt lgkmcnt(0)
  s_cmp_ge_u32 s9, 7
  s_cbranch_scc0 spin_100
spc_101:
  s_lshl_b32 s61, s34, 12
  buffer_load_dwordx4 v[80:83], v4, s[20:23], s61 offen offset:0 sc1
  buffer_load_dwordx4 v[84:87], v4, s[20:23], s61 offen offset:1024 sc1
  buffer_load_dwordx4 v[88:91], v4, s[20:23], s61 offen offset:2048 sc1
  buffer_load_dwordx4 v[92:95], v4, s[20:23], s61 offen offset:3072 sc1
  s_add_u32 s61, s61, 0x1000
  s_cmp_eq_u32 s61, 0x7000
  s_cselect_b32 s61, 0, s61
  buffer_load_dwordx4 v[96:99], v4, s[20:23], s61 offen offset:0 sc1
  buffer_load_dwordx4 v[100:103], v4, s[20:23], s61 offen offset:1024 sc1
  buffer_load_dwordx4 v[104:107], v4, s[20:23], s61 offen offset:2048 sc1
  buffer_load_dwordx4 v[108:111], v4, s[20:23], s61 offen offset:3072 sc1
  s_add_u32 s61, s61, 0x1000
  s_cmp_eq_u32 s61, 0x7000
  s_cselect_b32 s61, 0, s61
  buffer_load_dwordx4 v[112:115], v4, s[20:23], s61 offen offset:0 sc1
  buffer_load_dwordx4 v[116:119], v4, s[20:23], s61 offen offset:1024 sc1
  buffer_load_dwordx4 v[120:123], v4, s[20:23], s61 offen offset:2048 sc1
  buffer_load_dwordx4 v[124:127], v4, s[20:23], s61 offen offset:3072 sc1
  s_add_u32 s61, s61, 0x1000
  s_cmp_eq_u32 s61, 0x7000
  s_cselect_b32 s61, 0, s61
  s_waitcnt vmcnt(10)
  v_mfma_f32_16x16x32_bf16 v[48:51], v[192:195], v[80:83], 0
  v_mfma_f32_16x16x32_bf16 v[52:55], v[192:195], v[84:87], 0
  v_mfma_f32_16x16x32_bf16 v[64:67], v[196:199], v[80:83], 0
  buffer_load_dwordx4 v[128:131], v4, s[20:23], s61 offen offset:0 sc1
  v_mfma_f32_16x16x32_bf16 v[68:71], v[196:199], v[84:87], 0
  v_mfma_f32_16x16x32_bf16 v[56:59], v[200:203], v[80:83], 0
  buffer_load_dwordx4 v[132:135], v4, s[20:23], s61 offen offset:1024 sc1
  v_mfma_f32_16x16x32_bf16 v[60:63], v[200:203], v[84:87], 0
  v_mfma_f32_16x16x32_bf16 v[72:75], v[204:207], v[80:83], 0
  buffer_load_dwordx4 v[136:139], v4, s[20:23], s61 offen offset:2048 sc1
  v_mfma_f32_16x16x32_bf16 v[76:79], v[204:207], v[84:87], 0
  s_waitcnt vmcnt(11)
  v_mfma_f32_16x16x32_bf16 v[48:51], v[208:211], v[88:91], v[48:51]
  buffer_load_dwordx4 v[140:143], v4, s[20:23], s61 offen offset:3072 sc1
  s_add_u32 s61, s61, 0x1000
  s_cmp_eq_u32 s61, 0x7000
  s_cselect_b32 s61, 0, s61
  v_mfma_f32_16x16x32_bf16 v[52:55], v[208:211], v[92:95], v[52:55]
  v_mfma_f32_16x16x32_bf16 v[64:67], v[212:215], v[88:91], v[64:67]
  buffer_load_dwordx4 v[144:147], v4, s[20:23], s61 offen offset:0 sc1
  v_mfma_f32_16x16x32_bf16 v[68:71], v[212:215], v[92:95], v[68:71]
  v_mfma_f32_16x16x32_bf16 v[56:59], v[216:219], v[88:91], v[56:59]
  buffer_load_dwordx4 v[148:151], v4, s[20:23], s61 offen offset:1024 sc1
  v_mfma_f32_16x16x32_bf16 v[60:63], v[216:219], v[92:95], v[60:63]
  v_mfma_f32_16x16x32_bf16 v[72:75], v[220:223], v[88:91], v[72:75]
  buffer_load_dwordx4 v[152:155], v4, s[20:23], s61 offen offset:2048 sc1
  v_mfma_f32_16x16x32_bf16 v[76:79], v[220:223], v[92:95], v[76:79]
  s_waitcnt vmcnt(13)
  v_mfma_f32_16x16x32_bf16 v[48:51], v[224:227], v[96:99], v[48:51]
  buffer_load_dwordx4 v[156:159], v4, s[20:23], s61 offen offset:3072 sc1
  s_add_u32 s61, s61, 0x1000
  s_cmp_eq_u32 s61, 0x7000
  s_cselect_b32 s61, 0, s61
  v_mfma_f32_16x16x32_bf16 v[52:55], v[224:227], v[100:103], v[52:55]
  v_mfma_f32_16x16x32_bf16 v[64:67], v[228:231], v[96:99], v[64:67]
  buffer_load_dwordx4 v[160:163], v4, s[20:23], s61 offen offset:0 sc1
  v_mfma_f32_16x16x32_bf16 v[68:71], v[228:231], v[100:103], v[68:71]
  v_mfma_f32_16x16x32_bf16 v[56:59], v[232:235], v[96:99], v[56:59]
  buffer_load_dwordx4 v[164:167], v4, s[20:23], s61 offen offset:1024 sc1
  v_mfma_f32_16x16x32_bf16 v[60:63], v[232:235], v[100:103], v[60:63]
  v_mfma_f32_16x16x32_bf16 v[72:75], v[236:239], v[96:99], v[72:75]
  buffer_load_dwordx4 v[168:171], v4, s[20:23], s61 offen offset:2048 sc1
  v_mfma_f32_16x16x32_bf16 v[76:79], v[236:239], v[100:103], v[76:79]
  s_waitcnt vmcnt(15)
  v_mfma_f32_16x16x32_bf16 v[48:51], v[240:243], v[104:107], v[48:51]
  buffer_load_dwordx4 v[172:175], v4, s[20:23], s61 offen offset:3072 sc1
  s_add_u32 s61, s61, 0x1000
  s_cmp_eq_u32 s61, 0x7000
  s_cselect_b32 s61, 0, s61
  v_mfma_f32_16x16x32_bf16 v[52:55], v[240:243], v[108:111], v[52:55]
  v_mfma_f32_16x16x32_bf16 v[64:67], v[244:247], v[104:107], v[64:67]
  buffer_load_dwordx4 v[176:179], v4, s[20:23], s61 offen offset:0 sc1
  v_mfma_f32_16x16x32_bf16 v[68:71], v[244:247], v[108:111], v[68:71]
  v_mfma_f32_16x16x32_bf16 v[56:59], v[248:251], v[104:107], v[56:59]
  buffer_load_dwordx4 v[180:183], v4, s[20:23], s61 offen offset:1024 sc1
  v_mfma_f32_16x16x32_bf16 v[60:63], v[248:251], v[108:111], v[60:63]
  v_mfma_f32_16x16x32_bf16 v[72:75], v[252:255], v[104:107], v[72:75]
  buffer_load_dwordx4 v[184:187], v4, s[20:23], s61 offen offset:2048 sc1
  v_mfma_f32_16x16x32_bf16 v[76:79], v[252:255], v[108:111], v[76:79]
  s_waitcnt vmcnt(17)
  s_waitcnt lgkmcnt(12)
  v_mfma_f32_16x16x32_bf16 v[48:51], v[16:19], v[112:115], v[48:51]
  buffer_load_dwordx4 v[188:191], v4, s[20:23], s61 offen offset:3072 sc1
  s_add_u32 s61, s61, 0x1000
  s_cmp_eq_u32 s61, 0x7000
  s_cselect_b32 s61, 0, s61
  v_mfma_f32_16x16x32_bf16 v[52:55], v[16:19], v[116:119], v[52:55]
  v_add_u32 v10, s39, v12
  v_xor_b32 v11, 32, v10
  s_add_u32 s39, s39, s62
  s_cmp_eq_u32 s39, s63
  s_cselect_b32 s39, 0, s39
  ds_read_b64_tr_b16 v[16:17], v10 offset:0
  v_mfma_f32_16x16x32_bf16 v[64:67], v[20:23], v[112:115], v[64:67]
  ds_read_b64_tr_b16 v[18:19], v10 offset:2048
  v_mfma_f32_16x16x32_bf16 v[68:71], v[20:23], v[116:119], v[68:71]
  ds_read_b64_tr_b16 v[20:21], v10 offset:512
  s_waitcnt lgkmcnt(11)
  v_mfma_f32_16x16x32_bf16 v[56:59], v[24:27], v[112:115], v[56:59]
  ds_read_b64_tr_b16 v[22:23], v10 offset:2560
  v_mfma_f32_16x16x32_bf16 v[60:63], v[24:27], v[116:119], v[60:63]
  ds_read_b64_tr_b16 v[24:25], v11 offset:0
  v_mfma_f32_16x16x32_bf16 v[72:75], v[28:31], v[112:115], v[72:75]
  ds_read_b64_tr_b16 v[26:27], v11 offset:2048
  v_mfma_f32_16x16x32_bf16 v[76:79], v[28:31], v[116:119], v[76:79]
  ds_read_b64_tr_b16 v[28:29], v11 offset:512
  s_waitcnt vmcnt(16)
  s_waitcnt lgkmcnt(11)
  v_mfma_f32_16x16x32_bf16 v[48:51], v[32:35], v[120:123], v[48:51]
  ds_read_b64_tr_b16 v[30:31], v11 offset:2560
  v_mfma_f32_16x16x32_bf16 v[52:55], v[32:35], v[124:127], v[52:55]
  ds_read_b64_tr_b16 v[32:33], v10 offset:4096
  v_mfma_f32_16x16x32_bf16 v[64:67], v[36:39], v[120:123], v[64:67]
  ds_read_b64_tr_b16 v[34:35], v10 offset:6144
  v_mfma_f32_16x16x32_bf16 v[68:71], v[36:39], v[124:127], v[68:71]
  ds_read_b64_tr_b16 v[36:37], v10 offset:4608
  buffer_load_dwordx4 v[192:195], v5, s[24:27], s58 offen sc1
  s_waitcnt lgkmcnt(11)
  v_mfma_f32_16x16x32_bf16 v[56:59], v[40:43], v[120:123], v[56:59]
  ds_read_b64_tr_b16 v[38:39], v10 offset:6656
  v_mfma_f32_16x16x32_bf16 v[60:63], v[40:43], v[124:127], v[60:63]
  ds_read_b64_tr_b16 v[40:41], v11 offset:4096
  buffer_load_dwordx4 v[196:199], v8, s[12:15], s59 offen sc1
  v_mfma_f32_16x16x32_bf16 v[72:75], v[44:47], v[120:123], v[72:75]
  ds_read_b64_tr_b16 v[42:43], v11 offset:6144
  v_mfma_f32_16x16x32_bf16 v[76:79], v[44:47], v[124:127], v[76:79]
  ds_read_b64_tr_b16 v[44:45], v11 offset:4608
  buffer_load_dwordx4 v[200:203], v8, s[12:15], s59 offen offset:16 sc1
  s_waitcnt vmcnt(17)
  s_waitcnt lgkmcnt(11)
  v_mfma_f32_16x16x32_bf16 v[48:51], v[16:19], v[128:131], v[48:51]
  ds_read_b64_tr_b16 v[46:47], v11 offset:6656
  v_mfma_f32_16x16x32_bf16 v[52:55], v[16:19], v[132:135], v[52:55]
  v_add_u32 v10, s39, v12
  v_xor_b32 v11, 32, v10
  s_add_u32 s39, s39, s62
  s_cmp_eq_u32 s39, s63
  s_cselect_b32 s39, 0, s39
  ds_read_b64_tr_b16 v[16:17], v10 offset:0
  v_mfma_f32_16x16x32_bf16 v[64:67], v[20:23], v[128:131], v[64:67]
  ds_read_b64_tr_b16 v[18:19], v10 offset:2048
  v_mfma_f32_16x16x32_bf16 v[68:71], v[20:23], v[132:135], v[68:71]
  ds_read_b64_tr_b16 v[20:21], v10 offset:512
  s_waitcnt lgkmcnt(11)
  v_mfma_f32_16x16x32_bf16 v[56:59], v[24:27], v[128:131], v[56:59]
  ds_read_b64_tr_b16 v[22:23], v10 offset:2560
  v_mfma_f32_16x16x32_bf16 v[60:63], v[24:27], v[132:135], v[60:63]
  ds_read_b64_tr_b16 v[24:25], v11 offset:0
  v_mfma_f32_16x16x32_bf16 v[72:75], v[28:31], v[128:131], v[72:75]
  ds_read_b64_tr_b16 v[26:27], v11 offset:2048
  v_mfma_f32_16x16x32_bf16 v[76:79], v[28:31], v[132:135], v[76:79]
  ds_read_b64_tr_b16 v[28:29], v11 offset:512
  s_waitcnt vmcnt(15)
  s_waitcnt lgkmcnt(11)
  v_mfma_f32_16x16x32_bf16 v[48:51], v[32:35], v[136:139], v[48:51]
  ds_read_b64_tr_b16 v[30:31], v11 offset:2560
  v_mfma_f32_16x16x32_bf16 v[52:55], v[32:35], v[140:143], v[52:55]
  ds_read_b64_tr_b16 v[32:33], v10 offset:4096
  v_mfma_f32_16x16x32_bf16 v[64:67], v[36:39], v[136:139], v[64:67]
  ds_read_b64_tr_b16 v[34:35], v10 offset:6144
  v_mfma_f32_16x16x32_bf16 v[68:71], v[36:39], v[140:143], v[68:71]
  ds_read_b64_tr_b16 v[36:37], v10 offset:4608
  s_waitcnt lgkmcnt(11)
  v_mfma_f32_16x16x32_bf16 v[56:59], v[40:43], v[136:139], v[56:59]
  ds_read_b64_tr_b16 v[38:39], v10 offset:6656
  v_mfma_f32_16x16x32_bf16 v[60:63], v[40:43], v[140:143], v[60:63]
  ds_read_b64_tr_b16 v[40:41], v11 offset:4096
  v_mfma_f32_16x16x32_bf16 v[72:75], v[44:47], v[136:139], v[72:75]
  ds_read_b64_tr_b16 v[42:43], v11 offset:6144
  v_mfma_f32_16x16x32_bf16 v[76:79], v[44:47], v[140:143], v[76:79]
  ds_read_b64_tr_b16 v[44:45], v11 offset:4608
  ds_read_b64_tr_b16 v[46:47], v11 offset:6656
  s_waitcnt vmcnt(13)
  s_waitcnt lgkmcnt(12)
  v_mfma_f32_16x16x32_bf16 v[48:51], v[16:19], v[144:147], v[48:51]
  v_mfma_f32_16x16x32_bf16 v[52:55], v[16:19], v[148:151], v[52:55]
  v_add_u32 v10, s39, v12
  v_xor_b32 v11, 32, v10
  s_add_u32 s39, s39, s62
  s_cmp_eq_u32 s39, s63
  s_cselect_b32 s39, 0, s39
  ds_read_b64_tr_b16 v[16:17], v10 offset:0
  v_mfma_f32_16x16x32_bf16 v[64:67], v[20:23], v[144:147], v[64:67]
  ds_read_b64_tr_b16 v[18:19], v10 offset:2048
  v_mfma_f32_16x16x32_bf16 v[68:71], v[20:23], v[148:151], v[68:71]
  ds_read_b64_tr_b16 v[20:21], v10 offset:512
  s_waitcnt lgkmcnt(11)
  v_mfma_f32_16x16x32_bf16 v[56:59], v[24:27], v[144:147], v[56:59]
  ds_read_b64_tr_b16 v[22:23], v10 offset:2560
  v_mfma_f32_16x16x32_bf16 v[60:63], v[24:27], v[148:151], v[60:63]
  ds_read_b64_tr_b16 v[24:25], v11 offset:0
  v_mfma_f32_16x16x32_bf16 v[72:75], v[28:31], v[144:147], v[72:75]
  ds_read_b64_tr_b16 v[26:27], v11 offset:2048
  v_mfma_f32_16x16x32_bf16 v[76:79], v[28:31], v[148:151], v[76:79]
  ds_read_b64_tr_b16 v[28:29], v11 offset:512
  s_waitcnt vmcnt(11)
  s_waitcnt lgkmcnt(11)
  v_mfma_f32_16x16x32_bf16 v[48:51], v[32:35], v[152:155], v[48:51]
  ds_read_b64_tr_b16 v[30:31], v11 offset:2560
  v_mfma_f32_16x16x32_bf16 v[52:55], v[32:35], v[156:159], v[52:55]
  ds_read_b64_tr_b16 v[32:33], v10 offset:4096
  v_mfma_f32_16x16x32_bf16 v[64:67], v[36:39], v[152:155], v[64:67]
  ds_read_b64_tr_b16 v[34:35], v10 offset:6144
  v_mfma_f32_16x16x32_bf16 v[68:71], v[36:39], v[156:159], v[68:71]
  ds_read_b64_tr_b16 v[36:37], v10 offset:4608
  s_waitcnt lgkmcnt(11)
  v_mfma_f32_16x16x32_bf16 v[56:59], v[40:43], v[152:155], v[56:59]
  ds_read_b64_tr_b16 v[38:39], v10 offset:6656
  v_mfma_f32_16x16x32_bf16 v[60:63], v[40:43], v[156:159], v[60:63]
  ds_read_b64_tr_b16 v[40:41], v11 offset:4096
  v_mfma_f32_16x16x32_bf16 v[72:75], v[44:47], v[152:155], v[72:75]
  ds_read_b64_tr_b16 v[42:43], v11 offset:6144
  v_mfma_f32_16x16x32_bf16 v[76:79], v[44:47], v[156:159], v[76:79]
  ds_read_b64_tr_b16 v[44:45], v11 offset:4608
  s_waitcnt vmcnt(9)
  s_waitcnt lgkmcnt(11)
  v_mfma_f32_16x16x32_bf16 v[48:51], v[16:19], v[160:163], v[48:51]
  ds_read_b64_tr_b16 v[46:47], v11 offset:6656
  v_mfma_f32_16x16x32_bf16 v[52:55], v[16:19], v[164:167], v[52:55]
  v_add_u32 v10, s39, v12
  v_xor_b32 v11, 32, v10
  s_add_u32 s39, s39, s62
  s_cmp_eq_u32 s39, s63
  s_cselect_b32 s39, 0, s39
  ds_read_b64_tr_b16 v[16:17], v10 offset:0
  v_mfma_f32_16x16x32_bf16 v[64:67], v[20:23], v[160:163], v[64:67]
  ds_read_b64_tr_b16 v[18:19], v10 offset:2048
  v_mfma_f32_16x16x32_bf16 v[68:71], v[20:23], v[164:167], v[68:71]
  ds_read_b64_tr_b16 v[20:21], v10 offset:512
  s_waitcnt lgkmcnt(11)
  v_mfma_f32_16x16x32_bf16 v[56:59], v[24:27], v[160:163], v[56:59]
  ds_read_b64_tr_b16 v[22:23], v10 offset:2560
  v_mfma_f32_16x16x32_bf16 v[60:63], v[24:27], v[164:167], v[60:63]
  ds_read_b64_tr_b16 v[24:25], v11 offset:0
  v_mfma_f32_16x16x32_bf16 v[72:75], v[28:31], v[160:163], v[72:75]
  ds_read_b64_tr_b16 v[26:27], v11 offset:2048
  v_mfma_f32_16x16x32_bf16 v[76:79], v[28:31], v[164:167], v[76:79]
  ds_read_b64_tr_b16 v[28:29], v11 offset:512
  s_waitcnt vmcnt(7)
  s_waitcnt lgkmcnt(11)
  v_mfma_f32_16x16x32_bf16 v[48:51], v[32:35], v[168:171], v[48:51]
  ds_read_b64_tr_b16 v[30:31], v11 offset:2560
  v_mfma_f32_16x16x32_bf16 v[52:55], v[32:35], v[172:175], v[52:55]
  ds_read_b64_tr_b16 v[32:33], v10 offset:4096
  v_mfma_f32_16x16x32_bf16 v[64:67], v[36:39], v[168:171], v[64:67]
  ds_read_b64_tr_b16 v[34:35], v10 offset:6144
  v_mfma_f32_16x16x32_bf16 v[68:71], v[36:39], v[172:175], v[68:71]
  ds_read_b64_tr_b16 v[36:37], v10 offset:4608
  s_waitcnt lgkmcnt(11)
  v_mfma_f32_16x16x32_bf16 v[56:59], v[40:43], v[168:171], v[56:59]
  ds_read_b64_tr_b16 v[38:39], v10 offset:6656
  v_mfma_f32_16x16x32_bf16 v[60:63], v[40:43], v[172:175], v[60:63]
  ds_read_b64_tr_b16 v[40:41], v11 offset:4096
  v_mfma_f32_16x16x32_bf16 v[72:75], v[44:47], v[168:171], v[72:75]
  ds_read_b64_tr_b16 v[42:43], v11 offset:6144
  v_mfma_f32_16x16x32_bf16 v[76:79], v[44:47], v[172:175], v[76:79]
  ds_read_b64_tr_b16 v[44:45], v11 offset:4608
  s_waitcnt vmcnt(5)
  s_waitcnt lgkmcnt(11)
  v_mfma_f32_16x16x32_bf16 v[48:51], v[16:19], v[176:179], v[48:51]
  ds_read_b64_tr_b16 v[46:47], v11 offset:6656
  v_mfma_f32_16x16x32_bf16 v[52:55], v[16:19], v[180:183], v[52:55]
  v_mfma_f32_16x16x32_bf16 v[64:67], v[20:23], v[176:179], v[64:67]
  v_mfma_f32_16x16x32_bf16 v[68:71], v[20:23], v[180:183], v[68:71]
  s_waitcnt lgkmcnt(8)
  v_mfma_f32_16x16x32_bf16 v[56:59], v[24:27], v[176:179], v[56:59]
  v_mfma_f32_16x16x32_bf16 v[60:63], v[24:27], v[180:183], v[60:63]
  v_mfma_f32_16x16x32_bf16 v[72:75], v[28:31], v[176:179], v[72:75]
  v_mfma_f32_16x16x32_bf16 v[76:79], v[28:31], v[180:183], v[76:79]
  s_waitcnt vmcnt(3)
  s_waitcnt lgkmcnt(4)
  v_mfma_f32_16x16x32_bf16 v[48:51], v[32:35], v[184:187], v[48:51]
  v_mfma_f32_16x16x32_bf16 v[52:55], v[32:35], v[188:191], v[52:55]
  v_mfma_f32_16x16x32_bf16 v[64:67], v[36:39], v[184:187], v[64:67]
  v_mfma_f32_16x16x32_bf16 v[68:71], v[36:39], v[188:191], v[68:71]
  s_waitcnt lgkmcnt(0)
  v_mfma_f32_16x16x32_bf16 v[56:59], v[40:43], v[184:187], v[56:59]
  v_mfma_f32_16x16x32_bf16 v[60:63], v[40:43], v[188:191], v[60:63]
  v_mfma_f32_16x16x32_bf16 v[72:75], v[44:47], v[184:187], v[72:75]
  v_mfma_f32_16x16x32_bf16 v[76:79], v[44:47], v[188:191], v[76:79]
fused_kernel_fin:
  v_and_b32 v7, 15, v1
  v_mul_u32_u24 v7, 272, v7
  v_lshrrev_b32 v8, 4, v1
  v_lshl_add_u32 v7, v8, 4, v7
  s_mul_i32 s65, s4, 17408
  s_mul_i32 s66, s40, 8704
  s_add_u32 s65, s65, s66
  v_add_u32 v7, s65, v7
  s_barrier
  ds_write_b128 v7, v[48:51] offset:0
  ds_write_b128 v7, v[52:55] offset:4352
  ds_write_b128 v7, v[56:59] offset:64
  ds_write_b128 v7, v[60:63] offset:4416
  ds_write_b128 v7, v[64:67] offset:128
  ds_write_b128 v7, v[68:71] offset:4480
  ds_write_b128 v7, v[72:75] offset:192
  ds_write_b128 v7, v[76:79] offset:4544
  s_waitcnt vmcnt(0)
  v_lshlrev_b32 v208, 16, v192
  v_and_b32 v209, 0xffff0000, v192
  v_lshlrev_b32 v210, 16, v193
  v_and_b32 v211, 0xffff0000, v193
  v_lshlrev_b32 v212, 16, v194
  v_and_b32 v213, 0xffff0000, v194
  v_lshlrev_b32 v214, 16, v195
  v_and_b32 v215, 0xffff0000, v195
  s_waitcnt lgkmcnt(0)
  s_barrier
  ds_read_b128 v[80:83], v6 offset:0
  ds_read_b128 v[84:87], v6 offset:16
  ds_read_b128 v[88:91], v6 offset:17408
  ds_read_b128 v[92:95], v6 offset:17424
  ds_read_b128 v[96:99], v6 offset:34816
  ds_read_b128 v[100:103], v6 offset:34832
  ds_read_b128 v[104:107], v6 offset:52224
  ds_read_b128 v[108:111], v6 offset:52240
  s_waitcnt lgkmcnt(4)
  v_add_f32 v80, v80, v88
  v_add_f32 v81, v81, v89
  v_add_f32 v82, v82, v90
  v_add_f32 v83, v83, v91
  v_add_f32 v84, v84, v92
  v_add_f32 v85, v85, v93
  v_add_f32 v86, v86, v94
  v_add_f32 v87, v87, v95
  s_waitcnt lgkmcnt(0)
  v_add_f32 v96, v96, v104
  v_add_f32 v97, v97, v105
  v_add_f32 v98, v98, v106
  v_add_f32 v99, v99, v107
  v_add_f32 v100, v100, v108
  v_add_f32 v101, v101, v109
  v_add_f32 v102, v102, v110
  v_add_f32 v103, v103, v111
  v_add_f32 v80, v80, v96
  v_add_f32 v81, v81, v97
  v_add_f32 v82, v82, v98
  v_add_f32 v83, v83, v99
  v_add_f32 v84, v84, v100
  v_add_f32 v85, v85, v101
  v_add_f32 v86, v86, v102
  v_add_f32 v87, v87, v103
  v_cvt_pk_bf16_f32 v112, v80, v81
  v_cvt_pk_bf16_f32 v113, v82, v83
  v_cvt_pk_bf16_f32 v114, v84, v85
  v_cvt_pk_bf16_f32 v115, v86, v87
  v_lshlrev_b32 v80, 16, v112
  v_and_b32 v81, 0xffff0000, v112
  v_lshlrev_b32 v82, 16, v113
  v_and_b32 v83, 0xffff0000, v113
  v_lshlrev_b32 v84, 16, v114
  v_and_b32 v85, 0xffff0000, v114
  v_lshlrev_b32 v86, 16, v115
  v_and_b32 v87, 0xffff0000, v115
  v_mul_f32 v80, v80, v196
  v_mul_f32 v81, v81, v197
  v_mul_f32 v82, v82, v198
  v_mul_f32 v83, v83, v199
  v_mul_f32 v84, v84, v200
  v_mul_f32 v85, v85, v201
  v_mul_f32 v86, v86, v202
  v_mul_f32 v87, v87, v203
  v_cvt_pk_bf16_f32 v112, v80, v81
  v_cvt_pk_bf16_f32 v113, v82, v83
  v_cvt_pk_bf16_f32 v114, v84, v85
  v_cvt_pk_bf16_f32 v115, v86, v87
  v_lshlrev_b32 v80, 16, v112
  v_and_b32 v81, 0xffff0000, v112
  v_lshlrev_b32 v82, 16, v113
  v_and_b32 v83, 0xffff0000, v113
  v_lshlrev_b32 v84, 16, v114
  v_and_b32 v85, 0xffff0000, v114
  v_lshlrev_b32 v86, 16, v115
  v_and_b32 v87, 0xffff0000, v115
  v_add_f32 v208, v208, v80
  v_add_f32 v209, v209, v81
  v_add_f32 v210, v210, v82
  v_add_f32 v211, v211, v83
  v_add_f32 v212, v212, v84
  v_add_f32 v213, v213, v85
  v_add_f32 v214, v214, v86
  v_add_f32 v215, v215, v87
  v_cvt_pk_bf16_f32 v192, v208, v209
  v_cvt_pk_bf16_f32 v193, v210, v211
  v_cvt_pk_bf16_f32 v194, v212, v213
  v_cvt_pk_bf16_f32 v195, v214, v215
  buffer_store_dwordx4 v[192:195], v5, s[68:71], s58 offen
  s_endpgm
lsp_92:
  s_mov_b32 s64, 262144
lsp_92_l:
  s_sleep 1
  ds_read2_b64 v[20:23], v8 offset1:4
  ds_read2_b64 v[24:27], v8 offset0:8 offset1:12
  s_waitcnt lgkmcnt(0)
  v_max3_u32 v84, v20, v21, v22
  v_max3_u32 v85, v23, v24, v25
  v_max3_u32 v84, v84, v26, v27
  v_max_u32 v84, v84, v85
  v_cmp_eq_u32 vcc, -1, v84
  s_nop 0
  s_cmp_eq_u64 vcc, 0
  s_cbranch_scc1 lsc_93
  s_sub_u32 s64, s64, 1
  s_cmp_lg_u32 s64, 0
  s_cbranch_scc1 lsp_92_l
  s_branch lsc_93
lsp_94:
  s_mov_b32 s64, 262144
lsp_94_l:
  s_sleep 1
  ds_read_b32 v3, v11 offset:288
  s_waitcnt lgkmcnt(0)
  v_cmp_lt_u32 vcc, s8, v3
  s_nop 0
  s_cmp_eq_u64 vcc, -1
  s_cbranch_scc1 lsc_95
  s_sub_u32 s64, s64, 1
  s_cmp_lg_u32 s64, 0
  s_cbranch_scc1 lsp_94_l
  s_branch lsc_95
lsp_98:
  s_mov_b32 s64, 262144
lsp_98_l:
  s_sleep 1
  ds_read_b32 v3, v14 offset:260
  s_waitcnt lgkmcnt(0)
  v_readfirstlane_b32 s9, v3
  s_nop 0
  s_cmp_ge_u32 s9, 4
  s_cbranch_scc1 lsc_99
  s_sub_u32 s64, s64, 1
  s_cmp_lg_u32 s64, 0
  s_cbranch_scc1 lsp_98_l
  s_branch lsc_99
fix_31:
  s_nop 15
  v_max3_f32 v56, v240, v241, v242
  v_max3_f32 v57, v243, v244, v245
  v_max3_f32 v56, v56, v246, v247
  v_max3_f32 v57, v57, v248, v249
  v_max3_f32 v56, v56, v250, v251
  v_max3_f32 v57, v57, v252, v253
  v_max3_f32 v56, v56, v254, v255
  v_max_f32 v56, v56, v57
  v_mov_b32 v57, v56
  s_nop 1
  v_permlane32_swap_b32 v57, v56
  v_max_f32 v56, v56, v57
  v_max_f32 v56, 0, v56
  v_sub_f32 v57, 0, v56
  v_exp_f32 v57, v57
  v_sub_f32 v32, v32, v56
  v_sub_f32 v33, v33, v56
  v_sub_f32 v34, v34, v56
  v_sub_f32 v35, v35, v56
  v_sub_f32 v36, v36, v56
  v_sub_f32 v37, v37, v56
  v_sub_f32 v38, v38, v56
  v_sub_f32 v39, v39, v56
  v_sub_f32 v40, v40, v56
  v_sub_f32 v41, v41, v56
  v_sub_f32 v42, v42, v56
  v_sub_f32 v43, v43, v56
  v_sub_f32 v44, v44, v56
  v_sub_f32 v45, v45, v56
  v_sub_f32 v46, v46, v56
  v_sub_f32 v47, v47, v56
  v_sub_f32 v224, v224, v56
  v_sub_f32 v225, v225, v56
  v_sub_f32 v226, v226, v56
  v_sub_f32 v227, v227, v56
  v_sub_f32 v228, v228, v56
  v_sub_f32 v229, v229, v56
  v_sub_f32 v230, v230, v56
  v_sub_f32 v231, v231, v56
  v_sub_f32 v232, v232, v56
  v_sub_f32 v233, v233, v56
  v_sub_f32 v234, v234, v56
  v_sub_f32 v235, v235, v56
  v_sub_f32 v236, v236, v56
  v_sub_f32 v237, v237, v56
  v_sub_f32 v238, v238, v56
  v_sub_f32 v239, v239, v56
  v_sub_f32 v240, v240, v56
  v_sub_f32 v241, v241, v56
  v_sub_f32 v242, v242, v56
  v_sub_f32 v243, v243, v56
  v_sub_f32 v244, v244, v56
  v_sub_f32 v245, v245, v56
  v_sub_f32 v246, v246, v56
  v_sub_f32 v247, v247, v56
  v_sub_f32 v248, v248, v56
  v_sub_f32 v249, v249, v56
  v_sub_f32 v250, v250, v56
  v_sub_f32 v251, v251, v56
  v_sub_f32 v252, v252, v56
  v_sub_f32 v253, v253, v56
  v_sub_f32 v254, v254, v56
  v_sub_f32 v255, v255, v56
  v_mul_f32 v64, v64, v57
  v_mul_f32 v65, v65, v57
  v_mul_f32 v66, v66, v57
  v_mul_f32 v67, v67, v57
  v_mul_f32 v68, v68, v57
  v_mul_f32 v69, v69, v57
  v_mul_f32 v70, v70, v57
  v_mul_f32 v71, v71, v57
  v_mul_f32 v72, v72, v57
  v_mul_f32 v73, v73, v57
  v_mul_f32 v74, v74, v57
  v_mul_f32 v75, v75, v57
  v_mul_f32 v76, v76, v57
  v_mul_f32 v77, v77, v57
  v_mul_f32 v78, v78, v57
  v_mul_f32 v79, v79, v57
  v_mul_f32 v80, v80, v57
  v_mul_f32 v81, v81, v57
  v_mul_f32 v82, v82, v57
  v_mul_f32 v83, v83, v57
  v_mul_f32 v84, v84, v57
  v_mul_f32 v85, v85, v57
  v_mul_f32 v86, v86, v57
  v_mul_f32 v87, v87, v57
  v_mul_f32 v88, v88, v57
  v_mul_f32 v89, v89, v57
  v_mul_f32 v90, v90, v57
  v_mul_f32 v91, v91, v57
  v_mul_f32 v92, v92, v57
  v_mul_f32 v93, v93, v57
  v_mul_f32 v94, v94, v57
  v_mul_f32 v95, v95, v57
  v_mul_f32 v96, v96, v57
  v_mul_f32 v97, v97, v57
  v_mul_f32 v98, v98, v57
  v_mul_f32 v99, v99, v57
  v_mul_f32 v100, v100, v57
  v_mul_f32 v101, v101, v57
  v_mul_f32 v102, v102, v57
  v_mul_f32 v103, v103, v57
  v_mul_f32 v104, v104, v57
  v_mul_f32 v105, v105, v57
  v_mul_f32 v106, v106, v57
  v_mul_f32 v107, v107, v57
  v_mul_f32 v108, v108, v57
  v_mul_f32 v109, v109, v57
  v_mul_f32 v110, v110, v57
  v_mul_f32 v111, v111, v57
  v_mul_f32 v112, v112, v57
  v_mul_f32 v113, v113, v57
  v_mul_f32 v114, v114, v57
  v_mul_f32 v115, v115, v57
  v_mul_f32 v116, v116, v57
  v_mul_f32 v117, v117, v57
  v_mul_f32 v118, v118, v57
  v_mul_f32 v119, v119, v57
  v_mul_f32 v120, v120, v57
  v_mul_f32 v121, v121, v57
  v_mul_f32 v122, v122, v57
  v_mul_f32 v123, v123, v57
  v_mul_f32 v124, v124, v57
  v_mul_f32 v125, v125, v57
  v_mul_f32 v126, v126, v57
  v_mul_f32 v127, v127, v57
  v_mul_f32 v60, v60, v57
  v_exp_f32 v48, v240
  v_exp_f32 v49, v241
  v_exp_f32 v50, v242
  v_add_f32 v61, v48, v49
  v_cvt_pk_bf16_f32 v24, v48, v49
  v_exp_f32 v51, v243
  v_add_f32 v61, v61, v50
  v_exp_f32 v52, v244
  v_add_f32 v61, v61, v51
  v_cvt_pk_bf16_f32 v25, v50, v51
  v_exp_f32 v53, v245
  v_add_f32 v61, v61, v52
  v_exp_f32 v54, v246
  v_add_f32 v61, v61, v53
  v_cvt_pk_bf16_f32 v28, v52, v53
  v_exp_f32 v55, v247
  v_add_f32 v61, v61, v54
  v_exp_f32 v48, v248
  v_add_f32 v61, v61, v55
  v_cvt_pk_bf16_f32 v29, v54, v55
  v_exp_f32 v49, v249
  v_add_f32 v61, v61, v48
  v_exp_f32 v50, v250
  v_add_f32 v61, v61, v49
  v_cvt_pk_bf16_f32 v26, v48, v49
  v_exp_f32 v51, v251
  v_add_f32 v61, v61, v50
  v_exp_f32 v52, v252
  v_add_f32 v61, v61, v51
  v_cvt_pk_bf16_f32 v27, v50, v51
  v_exp_f32 v53, v253
  v_add_f32 v61, v61, v52
  v_exp_f32 v54, v254
  v_add_f32 v61, v61, v53
  v_cvt_pk_bf16_f32 v30, v52, v53
  v_exp_f32 v55, v255
  v_add_f32 v61, v61, v54
  v_add_f32 v61, v61, v55
  v_cvt_pk_bf16_f32 v31, v54, v55
  s_nop 1
  s_branch cont_32
fix_33:
  s_nop 15
  v_max3_f32 v56, v224, v225, v226
  v_max3_f32 v57, v227, v228, v229
  v_max3_f32 v56, v56, v230, v231
  v_max3_f32 v57, v57, v232, v233
  v_max3_f32 v56, v56, v234, v235
  v_max3_f32 v57, v57, v236, v237
  v_max3_f32 v56, v56, v238, v239
  v_max_f32 v56, v56, v57
  v_mov_b32 v57, v56
  s_nop 1
  v_permlane32_swap_b32 v57, v56
  v_max_f32 v56, v56, v57
  v_max_f32 v56, 0, v56
  v_sub_f32 v57, 0, v56
  v_exp_f32 v57, v57
  v_sub_f32 v32, v32, v56
  v_sub_f32 v33, v33, v56
  v_sub_f32 v34, v34, v56
  v_sub_f32 v35, v35, v56
  v_sub_f32 v36, v36, v56
  v_sub_f32 v37, v37, v56
  v_sub_f32 v38, v38, v56
  v_sub_f32 v39, v39, v56
  v_sub_f32 v40, v40, v56
  v_sub_f32 v41, v41, v56
  v_sub_f32 v42, v42, v56
  v_sub_f32 v43, v43, v56
  v_sub_f32 v44, v44, v56
  v_sub_f32 v45, v45, v56
  v_sub_f32 v46, v46, v56
  v_sub_f32 v47, v47, v56
  v_sub_f32 v224, v224, v56
  v_sub_f32 v225, v225, v56
  v_sub_f32 v226, v226, v56
  v_sub_f32 v227, v227, v56
  v_sub_f32 v228, v228, v56
  v_sub_f32 v229, v229, v56
  v_sub_f32 v230, v230, v56
  v_sub_f32 v231, v231, v56
  v_sub_f32 v232, v232, v56
  v_sub_f32 v233, v233, v56
  v_sub_f32 v234, v234, v56
  v_sub_f32 v235, v235, v56
  v_sub_f32 v236, v236, v56
  v_sub_f32 v237, v237, v56
  v_sub_f32 v238, v238, v56
  v_sub_f32 v239, v239, v56
  v_sub_f32 v240, v240, v56
  v_sub_f32 v241, v241, v56
  v_sub_f32 v242, v242, v56
  v_sub_f32 v243, v243, v56
  v_sub_f32 v244, v244, v56
  v_sub_f32 v245, v245, v56
  v_sub_f32 v246, v246, v56
  v_sub_f32 v247, v247, v56
  v_sub_f32 v248, v248, v56
  v_sub_f32 v249, v249, v56
  v_sub_f32 v250, v250, v56
  v_sub_f32 v251, v251, v56
  v_sub_f32 v252, v252, v56
  v_sub_f32 v253, v253, v56
  v_sub_f32 v254, v254, v56
  v_sub_f32 v255, v255, v56
  v_mul_f32 v64, v64, v57
  v_mul_f32 v65, v65, v57
  v_mul_f32 v66, v66, v57
  v_mul_f32 v67, v67, v57
  v_mul_f32 v68, v68, v57
  v_mul_f32 v69, v69, v57
  v_mul_f32 v70, v70, v57
  v_mul_f32 v71, v71, v57
  v_mul_f32 v72, v72, v57
  v_mul_f32 v73, v73, v57
  v_mul_f32 v74, v74, v57
  v_mul_f32 v75, v75, v57
  v_mul_f32 v76, v76, v57
  v_mul_f32 v77, v77, v57
  v_mul_f32 v78, v78, v57
  v_mul_f32 v79, v79, v57
  v_mul_f32 v80, v80, v57
  v_mul_f32 v81, v81, v57
  v_mul_f32 v82, v82, v57
  v_mul_f32 v83, v83, v57
  v_mul_f32 v84, v84, v57
  v_mul_f32 v85, v85, v57
  v_mul_f32 v86, v86, v57
  v_mul_f32 v87, v87, v57
  v_mul_f32 v88, v88, v57
  v_mul_f32 v89, v89, v57
  v_mul_f32 v90, v90, v57
  v_mul_f32 v91, v91, v57
  v_mul_f32 v92, v92, v57
  v_mul_f32 v93, v93, v57
  v_mul_f32 v94, v94, v57
  v_mul_f32 v95, v95, v57
  v_mul_f32 v96, v96, v57
  v_mul_f32 v97, v97, v57
  v_mul_f32 v98, v98, v57
  v_mul_f32 v99, v99, v57
  v_mul_f32 v100, v100, v57
  v_mul_f32 v101, v101, v57
  v_mul_f32 v102, v102, v57
  v_mul_f32 v103, v103, v57
  v_mul_f32 v104, v104, v57
  v_mul_f32 v105, v105, v57
  v_mul_f32 v106, v106, v57
  v_mul_f32 v107, v107, v57
  v_mul_f32 v108, v108, v57
  v_mul_f32 v109, v109, v57
  v_mul_f32 v110, v110, v57
  v_mul_f32 v111, v111, v57
  v_mul_f32 v112, v112, v57
  v_mul_f32 v113, v113, v57
  v_mul_f32 v114, v114, v57
  v_mul_f32 v115, v115, v57
  v_mul_f32 v116, v116, v57
  v_mul_f32 v117, v117, v57
  v_mul_f32 v118, v118, v57
  v_mul_f32 v119, v119, v57
  v_mul_f32 v120, v120, v57
  v_mul_f32 v121, v121, v57
  v_mul_f32 v122, v122, v57
  v_mul_f32 v123, v123, v57
  v_mul_f32 v124, v124, v57
  v_mul_f32 v125, v125, v57
  v_mul_f32 v126, v126, v57
  v_mul_f32 v127, v127, v57
  v_mul_f32 v60, v60, v57
  v_exp_f32 v48, v224
  v_exp_f32 v49, v225
  v_exp_f32 v50, v226
  v_add_f32 v61, v48, v49
  v_cvt_pk_bf16_f32 v16, v48, v49
  v_exp_f32 v51, v227
  v_add_f32 v61, v61, v50
  v_exp_f32 v52, v228
  v_add_f32 v61, v61, v51
  v_cvt_pk_bf16_f32 v17, v50, v51
  v_exp_f32 v53, v229
  v_add_f32 v61, v61, v52
  v_exp_f32 v54, v230
  v_add_f32 v61, v61, v53
  v_cvt_pk_bf16_f32 v20, v52, v53
  v_exp_f32 v55, v231
  v_add_f32 v61, v61, v54
  v_exp_f32 v48, v232
  v_add_f32 v61, v61, v55
  v_cvt_pk_bf16_f32 v21, v54, v55
  v_exp_f32 v49, v233
  v_add_f32 v61, v61, v48
  v_exp_f32 v50, v234
  v_add_f32 v61, v61, v49
  v_cvt_pk_bf16_f32 v18, v48, v49
  v_exp_f32 v51, v235
  v_add_f32 v61, v61, v50
  v_exp_f32 v52, v236
  v_add_f32 v61, v61, v51
  v_cvt_pk_bf16_f32 v19, v50, v51
  v_exp_f32 v53, v237
  v_add_f32 v61, v61, v52
  v_exp_f32 v54, v238
  v_add_f32 v61, v61, v53
  v_cvt_pk_bf16_f32 v22, v52, v53
  v_exp_f32 v55, v239
  v_add_f32 v61, v61, v54
  v_add_f32 v61, v61, v55
  v_cvt_pk_bf16_f32 v23, v54, v55
  s_nop 1
  s_branch cont_34
fix_35:
  s_nop 15
  v_max3_f32 v56, v240, v241, v242
  v_max3_f32 v57, v243, v244, v245
  v_max3_f32 v56, v56, v246, v247
  v_max3_f32 v57, v57, v248, v249
  v_max3_f32 v56, v56, v250, v251
  v_max3_f32 v57, v57, v252, v253
  v_max3_f32 v56, v56, v254, v255
  v_max_f32 v56, v56, v57
  v_mov_b32 v57, v56
  s_nop 1
  v_permlane32_swap_b32 v57, v56
  v_max_f32 v56, v56, v57
  v_max_f32 v56, 0, v56
  v_sub_f32 v57, 0, v56
  v_exp_f32 v57, v57
  v_sub_f32 v32, v32, v56
  v_sub_f32 v33, v33, v56
  v_sub_f32 v34, v34, v56
  v_sub_f32 v35, v35, v56
  v_sub_f32 v36, v36, v56
  v_sub_f32 v37, v37, v56
  v_sub_f32 v38, v38, v56
  v_sub_f32 v39, v39, v56
  v_sub_f32 v40, v40, v56
  v_sub_f32 v41, v41, v56
  v_sub_f32 v42, v42, v56
  v_sub_f32 v43, v43, v56
  v_sub_f32 v44, v44, v56
  v_sub_f32 v45, v45, v56
  v_sub_f32 v46, v46, v56
  v_sub_f32 v47, v47, v56
  v_sub_f32 v224, v224, v56
  v_sub_f32 v225, v225, v56
  v_sub_f32 v226, v226, v56
  v_sub_f32 v227, v227, v56
  v_sub_f32 v228, v228, v56
  v_sub_f32 v229, v229, v56
  v_sub_f32 v230, v230, v56
  v_sub_f32 v231, v231, v56
  v_sub_f32 v232, v232, v56
  v_sub_f32 v233, v233, v56
  v_sub_f32 v234, v234, v56
  v_sub_f32 v235, v235, v56
  v_sub_f32 v236, v236, v56
  v_sub_f32 v237, v237, v56
  v_sub_f32 v238, v238, v56
  v_sub_f32 v239, v239, v56
  v_sub_f32 v240, v240, v56
  v_sub_f32 v241, v241, v56
  v_sub_f32 v242, v242, v56
  v_sub_f32 v243, v243, v56
  v_sub_f32 v244, v244, v56
  v_sub_f32 v245, v245, v56
  v_sub_f32 v246, v246, v56
  v_sub_f32 v247, v247, v56
  v_sub_f32 v248, v248, v56
  v_sub_f32 v249, v249, v56
  v_sub_f32 v250, v250, v56
  v_sub_f32 v251, v251, v56
  v_sub_f32 v252, v252, v56
  v_sub_f32 v253, v253, v56
  v_sub_f32 v254, v254, v56
  v_sub_f32 v255, v255, v56
  v_mul_f32 v64, v64, v57
  v_mul_f32 v65, v65, v57
  v_mul_f32 v66, v66, v57
  v_mul_f32 v67, v67, v57
  v_mul_f32 v68, v68, v57
  v_mul_f32 v69, v69, v57
  v_mul_f32 v70, v70, v57
  v_mul_f32 v71, v71, v57
  v_mul_f32 v72, v72, v57
  v_mul_f32 v73, v73, v57
  v_mul_f32 v74, v74, v57
  v_mul_f32 v75, v75, v57
  v_mul_f32 v76, v76, v57
  v_mul_f32 v77, v77, v57
  v_mul_f32 v78, v78, v57
  v_mul_f32 v79, v79, v57
  v_mul_f32 v80, v80, v57
  v_mul_f32 v81, v81, v57
  v_mul_f32 v82, v82, v57
  v_mul_f32 v83, v83, v57
  v_mul_f32 v84, v84, v57
  v_mul_f32 v85, v85, v57
  v_mul_f32 v86, v86, v57
  v_mul_f32 v87, v87, v57
  v_mul_f32 v88, v88, v57
  v_mul_f32 v89, v89, v57
  v_mul_f32 v90, v90, v57
  v_mul_f32 v91, v91, v57
  v_mul_f32 v92, v92, v57
  v_mul_f32 v93, v93, v57
  v_mul_f32 v94, v94, v57
  v_mul_f32 v95, v95, v57
  v_mul_f32 v96, v96, v57
  v_mul_f32 v97, v97, v57
  v_mul_f32 v98, v98, v57
  v_mul_f32 v99, v99, v57
  v_mul_f32 v100, v100, v57
  v_mul_f32 v101, v101, v57
  v_mul_f32 v102, v102, v57
  v_mul_f32 v103, v103, v57
  v_mul_f32 v104, v104, v57
  v_mul_f32 v105, v105, v57
  v_mul_f32 v106, v106, v57
  v_mul_f32 v107, v107, v57
  v_mul_f32 v108, v108, v57
  v_mul_f32 v109, v109, v57
  v_mul_f32 v110, v110, v57
  v_mul_f32 v111, v111, v57
  v_mul_f32 v112, v112, v57
  v_mul_f32 v113, v113, v57
  v_mul_f32 v114, v114, v57
  v_mul_f32 v115, v115, v57
  v_mul_f32 v116, v116, v57
  v_mul_f32 v117, v117, v57
  v_mul_f32 v118, v118, v57
  v_mul_f32 v119, v119, v57
  v_mul_f32 v120, v120, v57
  v_mul_f32 v121, v121, v57
  v_mul_f32 v122, v122, v57
  v_mul_f32 v123, v123, v57
  v_mul_f32 v124, v124, v57
  v_mul_f32 v125, v125, v57
  v_mul_f32 v126, v126, v57
  v_mul_f32 v127, v127, v57
  v_mul_f32 v60, v60, v57
  v_exp_f32 v48, v240
  v_exp_f32 v49, v241
  v_exp_f32 v50, v242
  v_add_f32 v61, v48, v49
  v_cvt_pk_bf16_f32 v24, v48, v49
  v_exp_f32 v51, v243
  v_add_f32 v61, v61, v50
  v_exp_f32 v52, v244
  v_add_f32 v61, v61, v51
  v_cvt_pk_bf16_f32 v25, v50, v51
  v_exp_f32 v53, v245
  v_add_f32 v61, v61, v52
  v_exp_f32 v54, v246
  v_add_f32 v61, v61, v53
  v_cvt_pk_bf16_f32 v28, v52, v53
  v_exp_f32 v55, v247
  v_add_f32 v61, v61, v54
  v_exp_f32 v48, v248
  v_add_f32 v61, v61, v55
  v_cvt_pk_bf16_f32 v29, v54, v55
  v_exp_f32 v49, v249
  v_add_f32 v61, v61, v48
  v_exp_f32 v50, v250
  v_add_f32 v61, v61, v49
  v_cvt_pk_bf16_f32 v26, v48, v49
  v_exp_f32 v51, v251
  v_add_f32 v61, v61, v50
  v_exp_f32 v52, v252
  v_add_f32 v61, v61, v51
  v_cvt_pk_bf16_f32 v27, v50, v51
  v_exp_f32 v53, v253
  v_add_f32 v61, v61, v52
  v_exp_f32 v54, v254
  v_add_f32 v61, v61, v53
  v_cvt_pk_bf16_f32 v30, v52, v53
  v_exp_f32 v55, v255
  v_add_f32 v61, v61, v54
  v_add_f32 v61, v61, v55
  v_cvt_pk_bf16_f32 v31, v54, v55
  s_nop 1
  s_branch cont_36
fix_37:
  s_nop 15
  v_max3_f32 v56, v224, v225, v226
  v_max3_f32 v57, v227, v228, v229
  v_max3_f32 v56, v56, v230, v231
  v_max3_f32 v57, v57, v232, v233
  v_max3_f32 v56, v56, v234, v235
  v_max3_f32 v57, v57, v236, v237
  v_max3_f32 v56, v56, v238, v239
  v_max_f32 v56, v56, v57
  v_mov_b32 v57, v56
  s_nop 1
  v_permlane32_swap_b32 v57, v56
  v_max_f32 v56, v56, v57
  v_max_f32 v56, 0, v56
  v_sub_f32 v57, 0, v56
  v_exp_f32 v57, v57
  v_sub_f32 v32, v32, v56
  v_sub_f32 v33, v33, v56
  v_sub_f32 v34, v34, v56
  v_sub_f32 v35, v35, v56
  v_sub_f32 v36, v36, v56
  v_sub_f32 v37, v37, v56
  v_sub_f32 v38, v38, v56
  v_sub_f32 v39, v39, v56
  v_sub_f32 v40, v40, v56
  v_sub_f32 v41, v41, v56
  v_sub_f32 v42, v42, v56
  v_sub_f32 v43, v43, v56
  v_sub_f32 v44, v44, v56
  v_sub_f32 v45, v45, v56
  v_sub_f32 v46, v46, v56
  v_sub_f32 v47, v47, v56
  v_sub_f32 v224, v224, v56
  v_sub_f32 v225, v225, v56
  v_sub_f32 v226, v226, v56
  v_sub_f32 v227, v227, v56
  v_sub_f32 v228, v228, v56
  v_sub_f32 v229, v229, v56
  v_sub_f32 v230, v230, v56
  v_sub_f32 v231, v231, v56
  v_sub_f32 v232, v232, v56
  v_sub_f32 v233, v233, v56
  v_sub_f32 v234, v234, v56
  v_sub_f32 v235, v235, v56
  v_sub_f32 v236, v236, v56
  v_sub_f32 v237, v237, v56
  v_sub_f32 v238, v238, v56
  v_sub_f32 v239, v239, v56
  v_sub_f32 v240, v240, v56
  v_sub_f32 v241, v241, v56
  v_sub_f32 v242, v242, v56
  v_sub_f32 v243, v243, v56
  v_sub_f32 v244, v244, v56
  v_sub_f32 v245, v245, v56
  v_sub_f32 v246, v246, v56
  v_sub_f32 v247, v247, v56
  v_sub_f32 v248, v248, v56
  v_sub_f32 v249, v249, v56
  v_sub_f32 v250, v250, v56
  v_sub_f32 v251, v251, v56
  v_sub_f32 v252, v252, v56
  v_sub_f32 v253, v253, v56
  v_sub_f32 v254, v254, v56
  v_sub_f32 v255, v255, v56
  v_mul_f32 v64, v64, v57
  v_mul_f32 v65, v65, v57
  v_mul_f32 v66, v66, v57
  v_mul_f32 v67, v67, v57
  v_mul_f32 v68, v68, v57
  v_mul_f32 v69, v69, v57
  v_mul_f32 v70, v70, v57
  v_mul_f32 v71, v71, v57
  v_mul_f32 v72, v72, v57
  v_mul_f32 v73, v73, v57
  v_mul_f32 v74, v74, v57
  v_mul_f32 v75, v75, v57
  v_mul_f32 v76, v76, v57
  v_mul_f32 v77, v77, v57
  v_mul_f32 v78, v78, v57
  v_mul_f32 v79, v79, v57
  v_mul_f32 v80, v80, v57
  v_mul_f32 v81, v81, v57
  v_mul_f32 v82, v82, v57
  v_mul_f32 v83, v83, v57
  v_mul_f32 v84, v84, v57
  v_mul_f32 v85, v85, v57
  v_mul_f32 v86, v86, v57
  v_mul_f32 v87, v87, v57
  v_mul_f32 v88, v88, v57
  v_mul_f32 v89, v89, v57
  v_mul_f32 v90, v90, v57
  v_mul_f32 v91, v91, v57
  v_mul_f32 v92, v92, v57
  v_mul_f32 v93, v93, v57
  v_mul_f32 v94, v94, v57
  v_mul_f32 v95, v95, v57
  v_mul_f32 v96, v96, v57
  v_mul_f32 v97, v97, v57
  v_mul_f32 v98, v98, v57
  v_mul_f32 v99, v99, v57
  v_mul_f32 v100, v100, v57
  v_mul_f32 v101, v101, v57
  v_mul_f32 v102, v102, v57
  v_mul_f32 v103, v103, v57
  v_mul_f32 v104, v104, v57
  v_mul_f32 v105, v105, v57
  v_mul_f32 v106, v106, v57
  v_mul_f32 v107, v107, v57
  v_mul_f32 v108, v108, v57
  v_mul_f32 v109, v109, v57
  v_mul_f32 v110, v110, v57
  v_mul_f32 v111, v111, v57
  v_mul_f32 v112, v112, v57
  v_mul_f32 v113, v113, v57
  v_mul_f32 v114, v114, v57
  v_mul_f32 v115, v115, v57
  v_mul_f32 v116, v116, v57
  v_mul_f32 v117, v117, v57
  v_mul_f32 v118, v118, v57
  v_mul_f32 v119, v119, v57
  v_mul_f32 v120, v120, v57
  v_mul_f32 v121, v121, v57
  v_mul_f32 v122, v122, v57
  v_mul_f32 v123, v123, v57
  v_mul_f32 v124, v124, v57
  v_mul_f32 v125, v125, v57
  v_mul_f32 v126, v126, v57
  v_mul_f32 v127, v127, v57
  v_mul_f32 v60, v60, v57
  v_exp_f32 v48, v224
  v_exp_f32 v49, v225
  v_exp_f32 v50, v226
  v_add_f32 v61, v48, v49
  v_cvt_pk_bf16_f32 v16, v48, v49
  v_exp_f32 v51, v227
  v_add_f32 v61, v61, v50
  v_exp_f32 v52, v228
  v_add_f32 v61, v61, v51
  v_cvt_pk_bf16_f32 v17, v50, v51
  v_exp_f32 v53, v229
  v_add_f32 v61, v61, v52
  v_exp_f32 v54, v230
  v_add_f32 v61, v61, v53
  v_cvt_pk_bf16_f32 v20, v52, v53
  v_exp_f32 v55, v231
  v_add_f32 v61, v61, v54
  v_exp_f32 v48, v232
  v_add_f32 v61, v61, v55
  v_cvt_pk_bf16_f32 v21, v54, v55
  v_exp_f32 v49, v233
  v_add_f32 v61, v61, v48
  v_exp_f32 v50, v234
  v_add_f32 v61, v61, v49
  v_cvt_pk_bf16_f32 v18, v48, v49
  v_exp_f32 v51, v235
  v_add_f32 v61, v61, v50
  v_exp_f32 v52, v236
  v_add_f32 v61, v61, v51
  v_cvt_pk_bf16_f32 v19, v50, v51
  v_exp_f32 v53, v237
  v_add_f32 v61, v61, v52
  v_exp_f32 v54, v238
  v_add_f32 v61, v61, v53
  v_cvt_pk_bf16_f32 v22, v52, v53
  v_exp_f32 v55, v239
  v_add_f32 v61, v61, v54
  v_add_f32 v61, v61, v55
  v_cvt_pk_bf16_f32 v23, v54, v55
  s_nop 1
  s_branch cont_38
fix_39:
  s_nop 15
  v_max3_f32 v56, v240, v241, v242
  v_max3_f32 v57, v243, v244, v245
  v_max3_f32 v56, v56, v246, v247
  v_max3_f32 v57, v57, v248, v249
  v_max3_f32 v56, v56, v250, v251
  v_max3_f32 v57, v57, v252, v253
  v_max3_f32 v56, v56, v254, v255
  v_max_f32 v56, v56, v57
  v_mov_b32 v57, v56
  s_nop 1
  v_permlane32_swap_b32 v57, v56
  v_max_f32 v56, v56, v57
  v_max_f32 v56, 0, v56
  v_sub_f32 v57, 0, v56
  v_exp_f32 v57, v57
  v_sub_f32 v32, v32, v56
  v_sub_f32 v33, v33, v56
  v_sub_f32 v34, v34, v56
  v_sub_f32 v35, v35, v56
  v_sub_f32 v36, v36, v56
  v_sub_f32 v37, v37, v56
  v_sub_f32 v38, v38, v56
  v_sub_f32 v39, v39, v56
  v_sub_f32 v40, v40, v56
  v_sub_f32 v41, v41, v56
  v_sub_f32 v42, v42, v56
  v_sub_f32 v43, v43, v56
  v_sub_f32 v44, v44, v56
  v_sub_f32 v45, v45, v56
  v_sub_f32 v46, v46, v56
  v_sub_f32 v47, v47, v56
  v_sub_f32 v224, v224, v56
  v_sub_f32 v225, v225, v56
  v_sub_f32 v226, v226, v56
  v_sub_f32 v227, v227, v56
  v_sub_f32 v228, v228, v56
  v_sub_f32 v229, v229, v56
  v_sub_f32 v230, v230, v56
  v_sub_f32 v231, v231, v56
  v_sub_f32 v232, v232, v56
  v_sub_f32 v233, v233, v56
  v_sub_f32 v234, v234, v56
  v_sub_f32 v235, v235, v56
  v_sub_f32 v236, v236, v56
  v_sub_f32 v237, v237, v56
  v_sub_f32 v238, v238, v56
  v_sub_f32 v239, v239, v56
  v_sub_f32 v240, v240, v56
  v_sub_f32 v241, v241, v56
  v_sub_f32 v242, v242, v56
  v_sub_f32 v243, v243, v56
  v_sub_f32 v244, v244, v56
  v_sub_f32 v245, v245, v56
  v_sub_f32 v246, v246, v56
  v_sub_f32 v247, v247, v56
  v_sub_f32 v248, v248, v56
  v_sub_f32 v249, v249, v56
  v_sub_f32 v250, v250, v56
  v_sub_f32 v251, v251, v56
  v_sub_f32 v252, v252, v56
  v_sub_f32 v253, v253, v56
  v_sub_f32 v254, v254, v56
  v_sub_f32 v255, v255, v56
  v_mul_f32 v64, v64, v57
  v_mul_f32 v65, v65, v57
  v_mul_f32 v66, v66, v57
  v_mul_f32 v67, v67, v57
  v_mul_f32 v68, v68, v57
  v_mul_f32 v69, v69, v57
  v_mul_f32 v70, v70, v57
  v_mul_f32 v71, v71, v57
  v_mul_f32 v72, v72, v57
  v_mul_f32 v73, v73, v57
  v_mul_f32 v74, v74, v57
  v_mul_f32 v75, v75, v57
  v_mul_f32 v76, v76, v57
  v_mul_f32 v77, v77, v57
  v_mul_f32 v78, v78, v57
  v_mul_f32 v79, v79, v57
  v_mul_f32 v80, v80, v57
  v_mul_f32 v81, v81, v57
  v_mul_f32 v82, v82, v57
  v_mul_f32 v83, v83, v57
  v_mul_f32 v84, v84, v57
  v_mul_f32 v85, v85, v57
  v_mul_f32 v86, v86, v57
  v_mul_f32 v87, v87, v57
  v_mul_f32 v88, v88, v57
  v_mul_f32 v89, v89, v57
  v_mul_f32 v90, v90, v57
  v_mul_f32 v91, v91, v57
  v_mul_f32 v92, v92, v57
  v_mul_f32 v93, v93, v57
  v_mul_f32 v94, v94, v57
  v_mul_f32 v95, v95, v57
  v_mul_f32 v96, v96, v57
  v_mul_f32 v97, v97, v57
  v_mul_f32 v98, v98, v57
  v_mul_f32 v99, v99, v57
  v_mul_f32 v100, v100, v57
  v_mul_f32 v101, v101, v57
  v_mul_f32 v102, v102, v57
  v_mul_f32 v103, v103, v57
  v_mul_f32 v104, v104, v57
  v_mul_f32 v105, v105, v57
  v_mul_f32 v106, v106, v57
  v_mul_f32 v107, v107, v57
  v_mul_f32 v108, v108, v57
  v_mul_f32 v109, v109, v57
  v_mul_f32 v110, v110, v57
  v_mul_f32 v111, v111, v57
  v_mul_f32 v112, v112, v57
  v_mul_f32 v113, v113, v57
  v_mul_f32 v114, v114, v57
  v_mul_f32 v115, v115, v57
  v_mul_f32 v116, v116, v57
  v_mul_f32 v117, v117, v57
  v_mul_f32 v118, v118, v57
  v_mul_f32 v119, v119, v57
  v_mul_f32 v120, v120, v57
  v_mul_f32 v121, v121, v57
  v_mul_f32 v122, v122, v57
  v_mul_f32 v123, v123, v57
  v_mul_f32 v124, v124, v57
  v_mul_f32 v125, v125, v57
  v_mul_f32 v126, v126, v57
  v_mul_f32 v127, v127, v57
  v_mul_f32 v60, v60, v57
  v_exp_f32 v48, v240
  v_exp_f32 v49, v241
  v_exp_f32 v50, v242
  v_add_f32 v61, v48, v49
  v_cvt_pk_bf16_f32 v24, v48, v49
  v_exp_f32 v51, v243
  v_add_f32 v61, v61, v50
  v_exp_f32 v52, v244
  v_add_f32 v61, v61, v51
  v_cvt_pk_bf16_f32 v25, v50, v51
  v_exp_f32 v53, v245
  v_add_f32 v61, v61, v52
  v_exp_f32 v54, v246
  v_add_f32 v61, v61, v53
  v_cvt_pk_bf16_f32 v28, v52, v53
  v_exp_f32 v55, v247
  v_add_f32 v61, v61, v54
  v_exp_f32 v48, v248
  v_add_f32 v61, v61, v55
  v_cvt_pk_bf16_f32 v29, v54, v55
  v_exp_f32 v49, v249
  v_add_f32 v61, v61, v48
  v_exp_f32 v50, v250
  v_add_f32 v61, v61, v49
  v_cvt_pk_bf16_f32 v26, v48, v49
  v_exp_f32 v51, v251
  v_add_f32 v61, v61, v50
  v_exp_f32 v52, v252
  v_add_f32 v61, v61, v51
  v_cvt_pk_bf16_f32 v27, v50, v51
  v_exp_f32 v53, v253
  v_add_f32 v61, v61, v52
  v_exp_f32 v54, v254
  v_add_f32 v61, v61, v53
  v_cvt_pk_bf16_f32 v30, v52, v53
  v_exp_f32 v55, v255
  v_add_f32 v61, v61, v54
  v_add_f32 v61, v61, v55
  v_cvt_pk_bf16_f32 v31, v54, v55
  s_nop 1
  s_branch cont_40
fix_47:
  s_nop 15
  v_max3_f32 v56, v240, v241, v242
  v_max3_f32 v57, v243, v244, v245
  v_max3_f32 v56, v56, v246, v247
  v_max3_f32 v57, v57, v248, v249
  v_max3_f32 v56, v56, v250, v251
  v_max3_f32 v57, v57, v252, v253
  v_max3_f32 v56, v56, v254, v255
  v_max_f32 v56, v56, v57
  v_mov_b32 v57, v56
  s_nop 1
  v_permlane32_swap_b32 v57, v56
  v_max_f32 v56, v56, v57
  v_max_f32 v56, 0, v56
  v_sub_f32 v57, 0, v56
  v_exp_f32 v57, v57
  v_sub_f32 v32, v32, v56
  v_sub_f32 v33, v33, v56
  v_sub_f32 v34, v34, v56
  v_sub_f32 v35, v35, v56
  v_sub_f32 v36, v36, v56
  v_sub_f32 v37, v37, v56
  v_sub_f32 v38, v38, v56
  v_sub_f32 v39, v39, v56
  v_sub_f32 v40, v40, v56
  v_sub_f32 v41, v41, v56
  v_sub_f32 v42, v42, v56
  v_sub_f32 v43, v43, v56
  v_sub_f32 v44, v44, v56
  v_sub_f32 v45, v45, v56
  v_sub_f32 v46, v46, v56
  v_sub_f32 v47, v47, v56
  v_sub_f32 v224, v224, v56
  v_sub_f32 v225, v225, v56
  v_sub_f32 v226, v226, v56
  v_sub_f32 v227, v227, v56
  v_sub_f32 v228, v228, v56
  v_sub_f32 v229, v229, v56
  v_sub_f32 v230, v230, v56
  v_sub_f32 v231, v231, v56
  v_sub_f32 v232, v232, v56
  v_sub_f32 v233, v233, v56
  v_sub_f32 v234, v234, v56
  v_sub_f32 v235, v235, v56
  v_sub_f32 v236, v236, v56
  v_sub_f32 v237, v237, v56
  v_sub_f32 v238, v238, v56
  v_sub_f32 v239, v239, v56
  v_sub_f32 v240, v240, v56
  v_sub_f32 v241, v241, v56
  v_sub_f32 v242, v242, v56
  v_sub_f32 v243, v243, v56
  v_sub_f32 v244, v244, v56
  v_sub_f32 v245, v245, v56
  v_sub_f32 v246, v246, v56
  v_sub_f32 v247, v247, v56
  v_sub_f32 v248, v248, v56
  v_sub_f32 v249, v249, v56
  v_sub_f32 v250, v250, v56
  v_sub_f32 v251, v251, v56
  v_sub_f32 v252, v252, v56
  v_sub_f32 v253, v253, v56
  v_sub_f32 v254, v254, v56
  v_sub_f32 v255, v255, v56
  v_mul_f32 v64, v64, v57
  v_mul_f32 v65, v65, v57
  v_mul_f32 v66, v66, v57
  v_mul_f32 v67, v67, v57
  v_mul_f32 v68, v68, v57
  v_mul_f32 v69, v69, v57
  v_mul_f32 v70, v70, v57
  v_mul_f32 v71, v71, v57
  v_mul_f32 v72, v72, v57
  v_mul_f32 v73, v73, v57
  v_mul_f32 v74, v74, v57
  v_mul_f32 v75, v75, v57
  v_mul_f32 v76, v76, v57
  v_mul_f32 v77, v77, v57
  v_mul_f32 v78, v78, v57
  v_mul_f32 v79, v79, v57
  v_mul_f32 v80, v80, v57
  v_mul_f32 v81, v81, v57
  v_mul_f32 v82, v82, v57
  v_mul_f32 v83, v83, v57
  v_mul_f32 v84, v84, v57
  v_mul_f32 v85, v85, v57
  v_mul_f32 v86, v86, v57
  v_mul_f32 v87, v87, v57
  v_mul_f32 v88, v88, v57
  v_mul_f32 v89, v89, v57
  v_mul_f32 v90, v90, v57
  v_mul_f32 v91, v91, v57
  v_mul_f32 v92, v92, v57
  v_mul_f32 v93, v93, v57
  v_mul_f32 v94, v94, v57
  v_mul_f32 v95, v95, v57
  v_mul_f32 v96, v96, v57
  v_mul_f32 v97, v97, v57
  v_mul_f32 v98, v98, v57
  v_mul_f32 v99, v99, v57
  v_mul_f32 v100, v100, v57
  v_mul_f32 v101, v101, v57
  v_mul_f32 v102, v102, v57
  v_mul_f32 v103, v103, v57
  v_mul_f32 v104, v104, v57
  v_mul_f32 v105, v105, v57
  v_mul_f32 v106, v106, v57
  v_mul_f32 v107, v107, v57
  v_mul_f32 v108, v108, v57
  v_mul_f32 v109, v109, v57
  v_mul_f32 v110, v110, v57
  v_mul_f32 v111, v111, v57
  v_mul_f32 v112, v112, v57
  v_mul_f32 v113, v113, v57
  v_mul_f32 v114, v114, v57
  v_mul_f32 v115, v115, v57
  v_mul_f32 v116, v116, v57
  v_mul_f32 v117, v117, v57
  v_mul_f32 v118, v118, v57
  v_mul_f32 v119, v119, v57
  v_mul_f32 v120, v120, v57
  v_mul_f32 v121, v121, v57
  v_mul_f32 v122, v122, v57
  v_mul_f32 v123, v123, v57
  v_mul_f32 v124, v124, v57
  v_mul_f32 v125, v125, v57
  v_mul_f32 v126, v126, v57
  v_mul_f32 v127, v127, v57
  v_mul_f32 v60, v60, v57
  v_exp_f32 v48, v240
  v_exp_f32 v49, v241
  v_exp_f32 v50, v242
  v_add_f32 v61, v48, v49
  v_cvt_pk_bf16_f32 v24, v48, v49
  v_exp_f32 v51, v243
  v_add_f32 v61, v61, v50
  v_exp_f32 v52, v244
  v_add_f32 v61, v61, v51
  v_cvt_pk_bf16_f32 v25, v50, v51
  v_exp_f32 v53, v245
  v_add_f32 v61, v61, v52
  v_exp_f32 v54, v246
  v_add_f32 v61, v61, v53
  v_cvt_pk_bf16_f32 v28, v52, v53
  v_exp_f32 v55, v247
  v_add_f32 v61, v61, v54
  v_exp_f32 v48, v248
  v_add_f32 v61, v61, v55
  v_cvt_pk_bf16_f32 v29, v54, v55
  v_exp_f32 v49, v249
  v_add_f32 v61, v61, v48
  v_exp_f32 v50, v250
  v_add_f32 v61, v61, v49
  v_cvt_pk_bf16_f32 v26, v48, v49
  v_exp_f32 v51, v251
  v_add_f32 v61, v61, v50
  v_exp_f32 v52, v252
  v_add_f32 v61, v61, v51
  v_cvt_pk_bf16_f32 v27, v50, v51
  v_exp_f32 v53, v253
  v_add_f32 v61, v61, v52
  v_exp_f32 v54, v254
  v_add_f32 v61, v61, v53
  v_cvt_pk_bf16_f32 v30, v52, v53
  v_exp_f32 v55, v255
  v_add_f32 v61, v61, v54
  v_add_f32 v61, v61, v55
  v_cvt_pk_bf16_f32 v31, v54, v55
  s_nop 1
  s_branch cont_48
fix_49:
  s_nop 15
  v_max3_f32 v56, v224, v225, v226
  v_max3_f32 v57, v227, v228, v229
  v_max3_f32 v56, v56, v230, v231
  v_max3_f32 v57, v57, v232, v233
  v_max3_f32 v56, v56, v234, v235
  v_max3_f32 v57, v57, v236, v237
  v_max3_f32 v56, v56, v238, v239
  v_max_f32 v56, v56, v57
  v_mov_b32 v57, v56
  s_nop 1
  v_permlane32_swap_b32 v57, v56
  v_max_f32 v56, v56, v57
  v_max_f32 v56, 0, v56
  v_sub_f32 v57, 0, v56
  v_exp_f32 v57, v57
  v_sub_f32 v32, v32, v56
  v_sub_f32 v33, v33, v56
  v_sub_f32 v34, v34, v56
  v_sub_f32 v35, v35, v56
  v_sub_f32 v36, v36, v56
  v_sub_f32 v37, v37, v56
  v_sub_f32 v38, v38, v56
  v_sub_f32 v39, v39, v56
  v_sub_f32 v40, v40, v56
  v_sub_f32 v41, v41, v56
  v_sub_f32 v42, v42, v56
  v_sub_f32 v43, v43, v56
  v_sub_f32 v44, v44, v56
  v_sub_f32 v45, v45, v56
  v_sub_f32 v46, v46, v56
  v_sub_f32 v47, v47, v56
  v_sub_f32 v224, v224, v56
  v_sub_f32 v225, v225, v56
  v_sub_f32 v226, v226, v56
  v_sub_f32 v227, v227, v56
  v_sub_f32 v228, v228, v56
  v_sub_f32 v229, v229, v56
  v_sub_f32 v230, v230, v56
  v_sub_f32 v231, v231, v56
  v_sub_f32 v232, v232, v56
  v_sub_f32 v233, v233, v56
  v_sub_f32 v234, v234, v56
  v_sub_f32 v235, v235, v56
  v_sub_f32 v236, v236, v56
  v_sub_f32 v237, v237, v56
  v_sub_f32 v238, v238, v56
  v_sub_f32 v239, v239, v56
  v_sub_f32 v240, v240, v56
  v_sub_f32 v241, v241, v56
  v_sub_f32 v242, v242, v56
  v_sub_f32 v243, v243, v56
  v_sub_f32 v244, v244, v56
  v_sub_f32 v245, v245, v56
  v_sub_f32 v246, v246, v56
  v_sub_f32 v247, v247, v56
  v_sub_f32 v248, v248, v56
  v_sub_f32 v249, v249, v56
  v_sub_f32 v250, v250, v56
  v_sub_f32 v251, v251, v56
  v_sub_f32 v252, v252, v56
  v_sub_f32 v253, v253, v56
  v_sub_f32 v254, v254, v56
  v_sub_f32 v255, v255, v56
  v_mul_f32 v64, v64, v57
  v_mul_f32 v65, v65, v57
  v_mul_f32 v66, v66, v57
  v_mul_f32 v67, v67, v57
  v_mul_f32 v68, v68, v57
  v_mul_f32 v69, v69, v57
  v_mul_f32 v70, v70, v57
  v_mul_f32 v71, v71, v57
  v_mul_f32 v72, v72, v57
  v_mul_f32 v73, v73, v57
  v_mul_f32 v74, v74, v57
  v_mul_f32 v75, v75, v57
  v_mul_f32 v76, v76, v57
  v_mul_f32 v77, v77, v57
  v_mul_f32 v78, v78, v57
  v_mul_f32 v79, v79, v57
  v_mul_f32 v80, v80, v57
  v_mul_f32 v81, v81, v57
  v_mul_f32 v82, v82, v57
  v_mul_f32 v83, v83, v57
  v_mul_f32 v84, v84, v57
  v_mul_f32 v85, v85, v57
  v_mul_f32 v86, v86, v57
  v_mul_f32 v87, v87, v57
  v_mul_f32 v88, v88, v57
  v_mul_f32 v89, v89, v57
  v_mul_f32 v90, v90, v57
  v_mul_f32 v91, v91, v57
  v_mul_f32 v92, v92, v57
  v_mul_f32 v93, v93, v57
  v_mul_f32 v94, v94, v57
  v_mul_f32 v95, v95, v57
  v_mul_f32 v96, v96, v57
  v_mul_f32 v97, v97, v57
  v_mul_f32 v98, v98, v57
  v_mul_f32 v99, v99, v57
  v_mul_f32 v100, v100, v57
  v_mul_f32 v101, v101, v57
  v_mul_f32 v102, v102, v57
  v_mul_f32 v103, v103, v57
  v_mul_f32 v104, v104, v57
  v_mul_f32 v105, v105, v57
  v_mul_f32 v106, v106, v57
  v_mul_f32 v107, v107, v57
  v_mul_f32 v108, v108, v57
  v_mul_f32 v109, v109, v57
  v_mul_f32 v110, v110, v57
  v_mul_f32 v111, v111, v57
  v_mul_f32 v112, v112, v57
  v_mul_f32 v113, v113, v57
  v_mul_f32 v114, v114, v57
  v_mul_f32 v115, v115, v57
  v_mul_f32 v116, v116, v57
  v_mul_f32 v117, v117, v57
  v_mul_f32 v118, v118, v57
  v_mul_f32 v119, v119, v57
  v_mul_f32 v120, v120, v57
  v_mul_f32 v121, v121, v57
  v_mul_f32 v122, v122, v57
  v_mul_f32 v123, v123, v57
  v_mul_f32 v124, v124, v57
  v_mul_f32 v125, v125, v57
  v_mul_f32 v126, v126, v57
  v_mul_f32 v127, v127, v57
  v_mul_f32 v60, v60, v57
  v_exp_f32 v48, v224
  v_exp_f32 v49, v225
  v_exp_f32 v50, v226
  v_add_f32 v61, v48, v49
  v_cvt_pk_bf16_f32 v16, v48, v49
  v_exp_f32 v51, v227
  v_add_f32 v61, v61, v50
  v_exp_f32 v52, v228
  v_add_f32 v61, v61, v51
  v_cvt_pk_bf16_f32 v17, v50, v51
  v_exp_f32 v53, v229
  v_add_f32 v61, v61, v52
  v_exp_f32 v54, v230
  v_add_f32 v61, v61, v53
  v_cvt_pk_bf16_f32 v20, v52, v53
  v_exp_f32 v55, v231
  v_add_f32 v61, v61, v54
  v_exp_f32 v48, v232
  v_add_f32 v61, v61, v55
  v_cvt_pk_bf16_f32 v21, v54, v55
  v_exp_f32 v49, v233
  v_add_f32 v61, v61, v48
  v_exp_f32 v50, v234
  v_add_f32 v61, v61, v49
  v_cvt_pk_bf16_f32 v18, v48, v49
  v_exp_f32 v51, v235
  v_add_f32 v61, v61, v50
  v_exp_f32 v52, v236
  v_add_f32 v61, v61, v51
  v_cvt_pk_bf16_f32 v19, v50, v51
  v_exp_f32 v53, v237
  v_add_f32 v61, v61, v52
  v_exp_f32 v54, v238
  v_add_f32 v61, v61, v53
  v_cvt_pk_bf16_f32 v22, v52, v53
  v_exp_f32 v55, v239
  v_add_f32 v61, v61, v54
  v_add_f32 v61, v61, v55
  v_cvt_pk_bf16_f32 v23, v54, v55
  s_nop 1
  s_branch cont_50
fix_51:
  s_nop 15
  v_max3_f32 v56, v240, v241, v242
  v_max3_f32 v57, v243, v244, v245
  v_max3_f32 v56, v56, v246, v247
  v_max3_f32 v57, v57, v248, v249
  v_max3_f32 v56, v56, v250, v251
  v_max3_f32 v57, v57, v252, v253
  v_max3_f32 v56, v56, v254, v255
  v_max_f32 v56, v56, v57
  v_mov_b32 v57, v56
  s_nop 1
  v_permlane32_swap_b32 v57, v56
  v_max_f32 v56, v56, v57
  v_max_f32 v56, 0, v56
  v_sub_f32 v57, 0, v56
  v_exp_f32 v57, v57
  v_sub_f32 v32, v32, v56
  v_sub_f32 v33, v33, v56
  v_sub_f32 v34, v34, v56
  v_sub_f32 v35, v35, v56
  v_sub_f32 v36, v36, v56
  v_sub_f32 v37, v37, v56
  v_sub_f32 v38, v38, v56
  v_sub_f32 v39, v39, v56
  v_sub_f32 v40, v40, v56
  v_sub_f32 v41, v41, v56
  v_sub_f32 v42, v42, v56
  v_sub_f32 v43, v43, v56
  v_sub_f32 v44, v44, v56
  v_sub_f32 v45, v45, v56
  v_sub_f32 v46, v46, v56
  v_sub_f32 v47, v47, v56
  v_sub_f32 v224, v224, v56
  v_sub_f32 v225, v225, v56
  v_sub_f32 v226, v226, v56
  v_sub_f32 v227, v227, v56
  v_sub_f32 v228, v228, v56
  v_sub_f32 v229, v229, v56
  v_sub_f32 v230, v230, v56
  v_sub_f32 v231, v231, v56
  v_sub_f32 v232, v232, v56
  v_sub_f32 v233, v233, v56
  v_sub_f32 v234, v234, v56
  v_sub_f32 v235, v235, v56
  v_sub_f32 v236, v236, v56
  v_sub_f32 v237, v237, v56
  v_sub_f32 v238, v238, v56
  v_sub_f32 v239, v239, v56
  v_sub_f32 v240, v240, v56
  v_sub_f32 v241, v241, v56
  v_sub_f32 v242, v242, v56
  v_sub_f32 v243, v243, v56
  v_sub_f32 v244, v244, v56
  v_sub_f32 v245, v245, v56
  v_sub_f32 v246, v246, v56
  v_sub_f32 v247, v247, v56
  v_sub_f32 v248, v248, v56
  v_sub_f32 v249, v249, v56
  v_sub_f32 v250, v250, v56
  v_sub_f32 v251, v251, v56
  v_sub_f32 v252, v252, v56
  v_sub_f32 v253, v253, v56
  v_sub_f32 v254, v254, v56
  v_sub_f32 v255, v255, v56
  v_mul_f32 v64, v64, v57
  v_mul_f32 v65, v65, v57
  v_mul_f32 v66, v66, v57
  v_mul_f32 v67, v67, v57
  v_mul_f32 v68, v68, v57
  v_mul_f32 v69, v69, v57
  v_mul_f32 v70, v70, v57
  v_mul_f32 v71, v71, v57
  v_mul_f32 v72, v72, v57
  v_mul_f32 v73, v73, v57
  v_mul_f32 v74, v74, v57
  v_mul_f32 v75, v75, v57
  v_mul_f32 v76, v76, v57
  v_mul_f32 v77, v77, v57
  v_mul_f32 v78, v78, v57
  v_mul_f32 v79, v79, v57
  v_mul_f32 v80, v80, v57
  v_mul_f32 v81, v81, v57
  v_mul_f32 v82, v82, v57
  v_mul_f32 v83, v83, v57
  v_mul_f32 v84, v84, v57
  v_mul_f32 v85, v85, v57
  v_mul_f32 v86, v86, v57
  v_mul_f32 v87, v87, v57
  v_mul_f32 v88, v88, v57
  v_mul_f32 v89, v89, v57
  v_mul_f32 v90, v90, v57
  v_mul_f32 v91, v91, v57
  v_mul_f32 v92, v92, v57
  v_mul_f32 v93, v93, v57
  v_mul_f32 v94, v94, v57
  v_mul_f32 v95, v95, v57
  v_mul_f32 v96, v96, v57
  v_mul_f32 v97, v97, v57
  v_mul_f32 v98, v98, v57
  v_mul_f32 v99, v99, v57
  v_mul_f32 v100, v100, v57
  v_mul_f32 v101, v101, v57
  v_mul_f32 v102, v102, v57
  v_mul_f32 v103, v103, v57
  v_mul_f32 v104, v104, v57
  v_mul_f32 v105, v105, v57
  v_mul_f32 v106, v106, v57
  v_mul_f32 v107, v107, v57
  v_mul_f32 v108, v108, v57
  v_mul_f32 v109, v109, v57
  v_mul_f32 v110, v110, v57
  v_mul_f32 v111, v111, v57
  v_mul_f32 v112, v112, v57
  v_mul_f32 v113, v113, v57
  v_mul_f32 v114, v114, v57
  v_mul_f32 v115, v115, v57
  v_mul_f32 v116, v116, v57
  v_mul_f32 v117, v117, v57
  v_mul_f32 v118, v118, v57
  v_mul_f32 v119, v119, v57
  v_mul_f32 v120, v120, v57
  v_mul_f32 v121, v121, v57
  v_mul_f32 v122, v122, v57
  v_mul_f32 v123, v123, v57
  v_mul_f32 v124, v124, v57
  v_mul_f32 v125, v125, v57
  v_mul_f32 v126, v126, v57
  v_mul_f32 v127, v127, v57
  v_mul_f32 v60, v60, v57
  v_exp_f32 v48, v240
  v_exp_f32 v49, v241
  v_exp_f32 v50, v242
  v_add_f32 v61, v48, v49
  v_cvt_pk_bf16_f32 v24, v48, v49
  v_exp_f32 v51, v243
  v_add_f32 v61, v61, v50
  v_exp_f32 v52, v244
  v_add_f32 v61, v61, v51
  v_cvt_pk_bf16_f32 v25, v50, v51
  v_exp_f32 v53, v245
  v_add_f32 v61, v61, v52
  v_exp_f32 v54, v246
  v_add_f32 v61, v61, v53
  v_cvt_pk_bf16_f32 v28, v52, v53
  v_exp_f32 v55, v247
  v_add_f32 v61, v61, v54
  v_exp_f32 v48, v248
  v_add_f32 v61, v61, v55
  v_cvt_pk_bf16_f32 v29, v54, v55
  v_exp_f32 v49, v249
  v_add_f32 v61, v61, v48
  v_exp_f32 v50, v250
  v_add_f32 v61, v61, v49
  v_cvt_pk_bf16_f32 v26, v48, v49
  v_exp_f32 v51, v251
  v_add_f32 v61, v61, v50
  v_exp_f32 v52, v252
  v_add_f32 v61, v61, v51
  v_cvt_pk_bf16_f32 v27, v50, v51
  v_exp_f32 v53, v253
  v_add_f32 v61, v61, v52
  v_exp_f32 v54, v254
  v_add_f32 v61, v61, v53
  v_cvt_pk_bf16_f32 v30, v52, v53
  v_exp_f32 v55, v255
  v_add_f32 v61, v61, v54
  v_add_f32 v61, v61, v55
  v_cvt_pk_bf16_f32 v31, v54, v55
  s_nop 1
  s_branch cont_52
fix_53:
  s_nop 15
  v_max3_f32 v56, v224, v225, v226
  v_max3_f32 v57, v227, v228, v229
  v_max3_f32 v56, v56, v230, v231
  v_max3_f32 v57, v57, v232, v233
  v_max3_f32 v56, v56, v234, v235
  v_max3_f32 v57, v57, v236, v237
  v_max3_f32 v56, v56, v238, v239
  v_max_f32 v56, v56, v57
  v_mov_b32 v57, v56
  s_nop 1
  v_permlane32_swap_b32 v57, v56
  v_max_f32 v56, v56, v57
  v_max_f32 v56, 0, v56
  v_sub_f32 v57, 0, v56
  v_exp_f32 v57, v57
  v_sub_f32 v32, v32, v56
  v_sub_f32 v33, v33, v56
  v_sub_f32 v34, v34, v56
  v_sub_f32 v35, v35, v56
  v_sub_f32 v36, v36, v56
  v_sub_f32 v37, v37, v56
  v_sub_f32 v38, v38, v56
  v_sub_f32 v39, v39, v56
  v_sub_f32 v40, v40, v56
  v_sub_f32 v41, v41, v56
  v_sub_f32 v42, v42, v56
  v_sub_f32 v43, v43, v56
  v_sub_f32 v44, v44, v56
  v_sub_f32 v45, v45, v56
  v_sub_f32 v46, v46, v56
  v_sub_f32 v47, v47, v56
  v_sub_f32 v224, v224, v56
  v_sub_f32 v225, v225, v56
  v_sub_f32 v226, v226, v56
  v_sub_f32 v227, v227, v56
  v_sub_f32 v228, v228, v56
  v_sub_f32 v229, v229, v56
  v_sub_f32 v230, v230, v56
  v_sub_f32 v231, v231, v56
  v_sub_f32 v232, v232, v56
  v_sub_f32 v233, v233, v56
  v_sub_f32 v234, v234, v56
  v_sub_f32 v235, v235, v56
  v_sub_f32 v236, v236, v56
  v_sub_f32 v237, v237, v56
  v_sub_f32 v238, v238, v56
  v_sub_f32 v239, v239, v56
  v_sub_f32 v240, v240, v56
  v_sub_f32 v241, v241, v56
  v_sub_f32 v242, v242, v56
  v_sub_f32 v243, v243, v56
  v_sub_f32 v244, v244, v56
  v_sub_f32 v245, v245, v56
  v_sub_f32 v246, v246, v56
  v_sub_f32 v247, v247, v56
  v_sub_f32 v248, v248, v56
  v_sub_f32 v249, v249, v56
  v_sub_f32 v250, v250, v56
  v_sub_f32 v251, v251, v56
  v_sub_f32 v252, v252, v56
  v_sub_f32 v253, v253, v56
  v_sub_f32 v254, v254, v56
  v_sub_f32 v255, v255, v56
  v_mul_f32 v64, v64, v57
  v_mul_f32 v65, v65, v57
  v_mul_f32 v66, v66, v57
  v_mul_f32 v67, v67, v57
  v_mul_f32 v68, v68, v57
  v_mul_f32 v69, v69, v57
  v_mul_f32 v70, v70, v57
  v_mul_f32 v71, v71, v57
  v_mul_f32 v72, v72, v57
  v_mul_f32 v73, v73, v57
  v_mul_f32 v74, v74, v57
  v_mul_f32 v75, v75, v57
  v_mul_f32 v76, v76, v57
  v_mul_f32 v77, v77, v57
  v_mul_f32 v78, v78, v57
  v_mul_f32 v79, v79, v57
  v_mul_f32 v80, v80, v57
  v_mul_f32 v81, v81, v57
  v_mul_f32 v82, v82, v57
  v_mul_f32 v83, v83, v57
  v_mul_f32 v84, v84, v57
  v_mul_f32 v85, v85, v57
  v_mul_f32 v86, v86, v57
  v_mul_f32 v87, v87, v57
  v_mul_f32 v88, v88, v57
  v_mul_f32 v89, v89, v57
  v_mul_f32 v90, v90, v57
  v_mul_f32 v91, v91, v57
  v_mul_f32 v92, v92, v57
  v_mul_f32 v93, v93, v57
  v_mul_f32 v94, v94, v57
  v_mul_f32 v95, v95, v57
  v_mul_f32 v96, v96, v57
  v_mul_f32 v97, v97, v57
  v_mul_f32 v98, v98, v57
  v_mul_f32 v99, v99, v57
  v_mul_f32 v100, v100, v57
  v_mul_f32 v101, v101, v57
  v_mul_f32 v102, v102, v57
  v_mul_f32 v103, v103, v57
  v_mul_f32 v104, v104, v57
  v_mul_f32 v105, v105, v57
  v_mul_f32 v106, v106, v57
  v_mul_f32 v107, v107, v57
  v_mul_f32 v108, v108, v57
  v_mul_f32 v109, v109, v57
  v_mul_f32 v110, v110, v57
  v_mul_f32 v111, v111, v57
  v_mul_f32 v112, v112, v57
  v_mul_f32 v113, v113, v57
  v_mul_f32 v114, v114, v57
  v_mul_f32 v115, v115, v57
  v_mul_f32 v116, v116, v57
  v_mul_f32 v117, v117, v57
  v_mul_f32 v118, v118, v57
  v_mul_f32 v119, v119, v57
  v_mul_f32 v120, v120, v57
  v_mul_f32 v121, v121, v57
  v_mul_f32 v122, v122, v57
  v_mul_f32 v123, v123, v57
  v_mul_f32 v124, v124, v57
  v_mul_f32 v125, v125, v57
  v_mul_f32 v126, v126, v57
  v_mul_f32 v127, v127, v57
  v_mul_f32 v60, v60, v57
  v_exp_f32 v48, v224
  v_exp_f32 v49, v225
  v_exp_f32 v50, v226
  v_add_f32 v61, v48, v49
  v_cvt_pk_bf16_f32 v16, v48, v49
  v_exp_f32 v51, v227
  v_add_f32 v61, v61, v50
  v_exp_f32 v52, v228
  v_add_f32 v61, v61, v51
  v_cvt_pk_bf16_f32 v17, v50, v51
  v_exp_f32 v53, v229
  v_add_f32 v61, v61, v52
  v_exp_f32 v54, v230
  v_add_f32 v61, v61, v53
  v_cvt_pk_bf16_f32 v20, v52, v53
  v_exp_f32 v55, v231
  v_add_f32 v61, v61, v54
  v_exp_f32 v48, v232
  v_add_f32 v61, v61, v55
  v_cvt_pk_bf16_f32 v21, v54, v55
  v_exp_f32 v49, v233
  v_add_f32 v61, v61, v48
  v_exp_f32 v50, v234
  v_add_f32 v61, v61, v49
  v_cvt_pk_bf16_f32 v18, v48, v49
  v_exp_f32 v51, v235
  v_add_f32 v61, v61, v50
  v_exp_f32 v52, v236
  v_add_f32 v61, v61, v51
  v_cvt_pk_bf16_f32 v19, v50, v51
  v_exp_f32 v53, v237
  v_add_f32 v61, v61, v52
  v_exp_f32 v54, v238
  v_add_f32 v61, v61, v53
  v_cvt_pk_bf16_f32 v22, v52, v53
  v_exp_f32 v55, v239
  v_add_f32 v61, v61, v54
  v_add_f32 v61, v61, v55
  v_cvt_pk_bf16_f32 v23, v54, v55
  s_nop 1
  s_branch cont_54
fix_55:
  s_nop 15
  v_max3_f32 v56, v240, v241, v242
  v_max3_f32 v57, v243, v244, v245
  v_max3_f32 v56, v56, v246, v247
  v_max3_f32 v57, v57, v248, v249
  v_max3_f32 v56, v56, v250, v251
  v_max3_f32 v57, v57, v252, v253
  v_max3_f32 v56, v56, v254, v255
  v_max_f32 v56, v56, v57
  v_mov_b32 v57, v56
  s_nop 1
  v_permlane32_swap_b32 v57, v56
  v_max_f32 v56, v56, v57
  v_max_f32 v56, 0, v56
  v_sub_f32 v57, 0, v56
  v_exp_f32 v57, v57
  v_sub_f32 v32, v32, v56
  v_sub_f32 v33, v33, v56
  v_sub_f32 v34, v34, v56
  v_sub_f32 v35, v35, v56
  v_sub_f32 v36, v36, v56
  v_sub_f32 v37, v37, v56
  v_sub_f32 v38, v38, v56
  v_sub_f32 v39, v39, v56
  v_sub_f32 v40, v40, v56
  v_sub_f32 v41, v41, v56
  v_sub_f32 v42, v42, v56
  v_sub_f32 v43, v43, v56
  v_sub_f32 v44, v44, v56
  v_sub_f32 v45, v45, v56
  v_sub_f32 v46, v46, v56
  v_sub_f32 v47, v47, v56
  v_sub_f32 v224, v224, v56
  v_sub_f32 v225, v225, v56
  v_sub_f32 v226, v226, v56
  v_sub_f32 v227, v227, v56
  v_sub_f32 v228, v228, v56
  v_sub_f32 v229, v229, v56
  v_sub_f32 v230, v230, v56
  v_sub_f32 v231, v231, v56
  v_sub_f32 v232, v232, v56
  v_sub_f32 v233, v233, v56
  v_sub_f32 v234, v234, v56
  v_sub_f32 v235, v235, v56
  v_sub_f32 v236, v236, v56
  v_sub_f32 v237, v237, v56
  v_sub_f32 v238, v238, v56
  v_sub_f32 v239, v239, v56
  v_sub_f32 v240, v240, v56
  v_sub_f32 v241, v241, v56
  v_sub_f32 v242, v242, v56
  v_sub_f32 v243, v243, v56
  v_sub_f32 v244, v244, v56
  v_sub_f32 v245, v245, v56
  v_sub_f32 v246, v246, v56
  v_sub_f32 v247, v247, v56
  v_sub_f32 v248, v248, v56
  v_sub_f32 v249, v249, v56
  v_sub_f32 v250, v250, v56
  v_sub_f32 v251, v251, v56
  v_sub_f32 v252, v252, v56
  v_sub_f32 v253, v253, v56
  v_sub_f32 v254, v254, v56
  v_sub_f32 v255, v255, v56
  v_mul_f32 v64, v64, v57
  v_mul_f32 v65, v65, v57
  v_mul_f32 v66, v66, v57
  v_mul_f32 v67, v67, v57
  v_mul_f32 v68, v68, v57
  v_mul_f32 v69, v69, v57
  v_mul_f32 v70, v70, v57
  v_mul_f32 v71, v71, v57
  v_mul_f32 v72, v72, v57
  v_mul_f32 v73, v73, v57
  v_mul_f32 v74, v74, v57
  v_mul_f32 v75, v75, v57
  v_mul_f32 v76, v76, v57
  v_mul_f32 v77, v77, v57
  v_mul_f32 v78, v78, v57
  v_mul_f32 v79, v79, v57
  v_mul_f32 v80, v80, v57
  v_mul_f32 v81, v81, v57
  v_mul_f32 v82, v82, v57
  v_mul_f32 v83, v83, v57
  v_mul_f32 v84, v84, v57
  v_mul_f32 v85, v85, v57
  v_mul_f32 v86, v86, v57
  v_mul_f32 v87, v87, v57
  v_mul_f32 v88, v88, v57
  v_mul_f32 v89, v89, v57
  v_mul_f32 v90, v90, v57
  v_mul_f32 v91, v91, v57
  v_mul_f32 v92, v92, v57
  v_mul_f32 v93, v93, v57
  v_mul_f32 v94, v94, v57
  v_mul_f32 v95, v95, v57
  v_mul_f32 v96, v96, v57
  v_mul_f32 v97, v97, v57
  v_mul_f32 v98, v98, v57
  v_mul_f32 v99, v99, v57
  v_mul_f32 v100, v100, v57
  v_mul_f32 v101, v101, v57
  v_mul_f32 v102, v102, v57
  v_mul_f32 v103, v103, v57
  v_mul_f32 v104, v104, v57
  v_mul_f32 v105, v105, v57
  v_mul_f32 v106, v106, v57
  v_mul_f32 v107, v107, v57
  v_mul_f32 v108, v108, v57
  v_mul_f32 v109, v109, v57
  v_mul_f32 v110, v110, v57
  v_mul_f32 v111, v111, v57
  v_mul_f32 v112, v112, v57
  v_mul_f32 v113, v113, v57
  v_mul_f32 v114, v114, v57
  v_mul_f32 v115, v115, v57
  v_mul_f32 v116, v116, v57
  v_mul_f32 v117, v117, v57
  v_mul_f32 v118, v118, v57
  v_mul_f32 v119, v119, v57
  v_mul_f32 v120, v120, v57
  v_mul_f32 v121, v121, v57
  v_mul_f32 v122, v122, v57
  v_mul_f32 v123, v123, v57
  v_mul_f32 v124, v124, v57
  v_mul_f32 v125, v125, v57
  v_mul_f32 v126, v126, v57
  v_mul_f32 v127, v127, v57
  v_mul_f32 v60, v60, v57
  v_exp_f32 v48, v240
  v_exp_f32 v49, v241
  v_exp_f32 v50, v242
  v_add_f32 v61, v48, v49
  v_cvt_pk_bf16_f32 v24, v48, v49
  v_exp_f32 v51, v243
  v_add_f32 v61, v61, v50
  v_exp_f32 v52, v244
  v_add_f32 v61, v61, v51
  v_cvt_pk_bf16_f32 v25, v50, v51
  v_exp_f32 v53, v245
  v_add_f32 v61, v61, v52
  v_exp_f32 v54, v246
  v_add_f32 v61, v61, v53
  v_cvt_pk_bf16_f32 v28, v52, v53
  v_exp_f32 v55, v247
  v_add_f32 v61, v61, v54
  v_exp_f32 v48, v248
  v_add_f32 v61, v61, v55
  v_cvt_pk_bf16_f32 v29, v54, v55
  v_exp_f32 v49, v249
  v_add_f32 v61, v61, v48
  v_exp_f32 v50, v250
  v_add_f32 v61, v61, v49
  v_cvt_pk_bf16_f32 v26, v48, v49
  v_exp_f32 v51, v251
  v_add_f32 v61, v61, v50
  v_exp_f32 v52, v252
  v_add_f32 v61, v61, v51
  v_cvt_pk_bf16_f32 v27, v50, v51
  v_exp_f32 v53, v253
  v_add_f32 v61, v61, v52
  v_exp_f32 v54, v254
  v_add_f32 v61, v61, v53
  v_cvt_pk_bf16_f32 v30, v52, v53
  v_exp_f32 v55, v255
  v_add_f32 v61, v61, v54
  v_add_f32 v61, v61, v55
  v_cvt_pk_bf16_f32 v31, v54, v55
  s_nop 1
  s_branch cont_56
fix_22:
  s_nop 15
  v_max3_f32 v56, v240, v241, v242
  v_max3_f32 v57, v244, v245, v246
  v_max3_f32 v56, v56, v243, v248
  v_max3_f32 v57, v57, v247, v252
  v_max3_f32 v56, v56, v249, v250
  v_max3_f32 v57, v57, v253, v254
  v_max_f32 v56, v56, v251
  v_max_f32 v57, v57, v255
  s_nop 1
  v_permlane16_swap_b32 v56, v57
  v_max_f32 v56, v56, v57
  v_mov_b32 v57, v56
  s_nop 1
  v_permlane32_swap_b32 v57, v56
  v_max_f32 v56, v56, v57
  v_max_f32 v56, 0, v56
  v_mov_b32 v57, v56
  s_nop 1
  v_permlane16_swap_b32 v56, v57
  v_sub_f32 v58, 0, v56
  v_sub_f32 v59, 0, v57
  v_exp_f32 v58, v58
  v_exp_f32 v59, v59
  v_sub_f32 v32, v32, v56
  v_sub_f32 v33, v33, v56
  v_sub_f32 v34, v34, v56
  v_sub_f32 v35, v35, v56
  v_sub_f32 v36, v36, v57
  v_sub_f32 v37, v37, v57
  v_sub_f32 v38, v38, v57
  v_sub_f32 v39, v39, v57
  v_sub_f32 v224, v224, v56
  v_sub_f32 v225, v225, v56
  v_sub_f32 v226, v226, v56
  v_sub_f32 v227, v227, v56
  v_sub_f32 v228, v228, v57
  v_sub_f32 v229, v229, v57
  v_sub_f32 v230, v230, v57
  v_sub_f32 v231, v231, v57
  v_sub_f32 v232, v232, v56
  v_sub_f32 v233, v233, v56
  v_sub_f32 v234, v234, v56
  v_sub_f32 v235, v235, v56
  v_sub_f32 v236, v236, v57
  v_sub_f32 v237, v237, v57
  v_sub_f32 v238, v238, v57
  v_sub_f32 v239, v239, v57
  v_sub_f32 v240, v240, v56
  v_sub_f32 v241, v241, v56
  v_sub_f32 v242, v242, v56
  v_sub_f32 v243, v243, v56
  v_sub_f32 v244, v244, v57
  v_sub_f32 v245, v245, v57
  v_sub_f32 v246, v246, v57
  v_sub_f32 v247, v247, v57
  v_sub_f32 v248, v248, v56
  v_sub_f32 v249, v249, v56
  v_sub_f32 v250, v250, v56
  v_sub_f32 v251, v251, v56
  v_sub_f32 v252, v252, v57
  v_sub_f32 v253, v253, v57
  v_sub_f32 v254, v254, v57
  v_sub_f32 v255, v255, v57
  v_mul_f32 v64, v64, v58
  v_mul_f32 v65, v65, v58
  v_mul_f32 v66, v66, v58
  v_mul_f32 v67, v67, v58
  v_mul_f32 v68, v68, v59
  v_mul_f32 v69, v69, v59
  v_mul_f32 v70, v70, v59
  v_mul_f32 v71, v71, v59
  v_mul_f32 v72, v72, v58
  v_mul_f32 v73, v73, v58
  v_mul_f32 v74, v74, v58
  v_mul_f32 v75, v75, v58
  v_mul_f32 v76, v76, v59
  v_mul_f32 v77, v77, v59
  v_mul_f32 v78, v78, v59
  v_mul_f32 v79, v79, v59
  v_mul_f32 v80, v80, v58
  v_mul_f32 v81, v81, v58
  v_mul_f32 v82, v82, v58
  v_mul_f32 v83, v83, v58
  v_mul_f32 v84, v84, v59
  v_mul_f32 v85, v85, v59
  v_mul_f32 v86, v86, v59
  v_mul_f32 v87, v87, v59
  v_mul_f32 v88, v88, v58
  v_mul_f32 v89, v89, v58
  v_mul_f32 v90, v90, v58
  v_mul_f32 v91, v91, v58
  v_mul_f32 v92, v92, v59
  v_mul_f32 v93, v93, v59
  v_mul_f32 v94, v94, v59
  v_mul_f32 v95, v95, v59
  v_mul_f32 v96, v96, v58
  v_mul_f32 v97, v97, v58
  v_mul_f32 v98, v98, v58
  v_mul_f32 v99, v99, v58
  v_mul_f32 v100, v100, v59
  v_mul_f32 v101, v101, v59
  v_mul_f32 v102, v102, v59
  v_mul_f32 v103, v103, v59
  v_mul_f32 v104, v104, v58
  v_mul_f32 v105, v105, v58
  v_mul_f32 v106, v106, v58
  v_mul_f32 v107, v107, v58
  v_mul_f32 v108, v108, v59
  v_mul_f32 v109, v109, v59
  v_mul_f32 v110, v110, v59
  v_mul_f32 v111, v111, v59
  v_mul_f32 v112, v112, v58
  v_mul_f32 v113, v113, v58
  v_mul_f32 v114, v114, v58
  v_mul_f32 v115, v115, v58
  v_mul_f32 v116, v116, v59
  v_mul_f32 v117, v117, v59
  v_mul_f32 v118, v118, v59
  v_mul_f32 v119, v119, v59
  v_mul_f32 v120, v120, v58
  v_mul_f32 v121, v121, v58
  v_mul_f32 v122, v122, v58
  v_mul_f32 v123, v123, v58
  v_mul_f32 v124, v124, v59
  v_mul_f32 v125, v125, v59
  v_mul_f32 v126, v126, v59
  v_mul_f32 v127, v127, v59
  v_mul_f32 v60, v60, v58
  v_mul_f32 v61, v61, v59
  v_exp_f32 v48, v240
  v_exp_f32 v49, v241
  v_exp_f32 v50, v242
  v_add_f32 v40, v48, v49
  v_cvt_pk_bf16_f32 v24, v48, v49
  v_exp_f32 v51, v243
  v_add_f32 v40, v40, v50
  v_exp_f32 v52, v244
  v_add_f32 v40, v40, v51
  v_cvt_pk_bf16_f32 v25, v50, v51
  v_exp_f32 v53, v245
  v_exp_f32 v54, v246
  v_add_f32 v41, v52, v53
  v_cvt_pk_bf16_f32 v28, v52, v53
  v_exp_f32 v55, v247
  v_add_f32 v41, v41, v54
  v_exp_f32 v48, v248
  v_add_f32 v41, v41, v55
  v_cvt_pk_bf16_f32 v29, v54, v55
  v_exp_f32 v49, v249
  v_add_f32 v40, v40, v48
  v_exp_f32 v50, v250
  v_add_f32 v40, v40, v49
  v_cvt_pk_bf16_f32 v26, v48, v49
  v_exp_f32 v51, v251
  v_add_f32 v40, v40, v50
  v_exp_f32 v52, v252
  v_add_f32 v40, v40, v51
  v_cvt_pk_bf16_f32 v27, v50, v51
  v_exp_f32 v53, v253
  v_add_f32 v41, v41, v52
  v_exp_f32 v54, v254
  v_add_f32 v41, v41, v53
  v_cvt_pk_bf16_f32 v30, v52, v53
  v_exp_f32 v55, v255
  v_add_f32 v41, v41, v54
  v_add_f32 v41, v41, v55
  v_cvt_pk_bf16_f32 v31, v54, v55
  s_nop 1
  s_branch cont_23
fix_24:
  s_nop 15
  v_max3_f32 v56, v224, v225, v226
  v_max3_f32 v57, v228, v229, v230
  v_max3_f32 v56, v56, v227, v232
  v_max3_f32 v57, v57, v231, v236
  v_max3_f32 v56, v56, v233, v234
  v_max3_f32 v57, v57, v237, v238
  v_max_f32 v56, v56, v235
  v_max_f32 v57, v57, v239
  s_nop 1
  v_permlane16_swap_b32 v56, v57
  v_max_f32 v56, v56, v57
  v_mov_b32 v57, v56
  s_nop 1
  v_permlane32_swap_b32 v57, v56
  v_max_f32 v56, v56, v57
  v_max_f32 v56, 0, v56
  v_mov_b32 v57, v56
  s_nop 1
  v_permlane16_swap_b32 v56, v57
  v_sub_f32 v58, 0, v56
  v_sub_f32 v59, 0, v57
  v_exp_f32 v58, v58
  v_exp_f32 v59, v59
  v_sub_f32 v32, v32, v56
  v_sub_f32 v33, v33, v56
  v_sub_f32 v34, v34, v56
  v_sub_f32 v35, v35, v56
  v_sub_f32 v36, v36, v57
  v_sub_f32 v37, v37, v57
  v_sub_f32 v38, v38, v57
  v_sub_f32 v39, v39, v57
  v_sub_f32 v224, v224, v56
  v_sub_f32 v225, v225, v56
  v_sub_f32 v226, v226, v56
  v_sub_f32 v227, v227, v56
  v_sub_f32 v228, v228, v57
  v_sub_f32 v229, v229, v57
  v_sub_f32 v230, v230, v57
  v_sub_f32 v231, v231, v57
  v_sub_f32 v232, v232, v56
  v_sub_f32 v233, v233, v56
  v_sub_f32 v234, v234, v56
  v_sub_f32 v235, v235, v56
  v_sub_f32 v236, v236, v57
  v_sub_f32 v237, v237, v57
  v_sub_f32 v238, v238, v57
  v_sub_f32 v239, v239, v57
  v_sub_f32 v240, v240, v56
  v_sub_f32 v241, v241, v56
  v_sub_f32 v242, v242, v56
  v_sub_f32 v243, v243, v56
  v_sub_f32 v244, v244, v57
  v_sub_f32 v245, v245, v57
  v_sub_f32 v246, v246, v57
  v_sub_f32 v247, v247, v57
  v_sub_f32 v248, v248, v56
  v_sub_f32 v249, v249, v56
  v_sub_f32 v250, v250, v56
  v_sub_f32 v251, v251, v56
  v_sub_f32 v252, v252, v57
  v_sub_f32 v253, v253, v57
  v_sub_f32 v254, v254, v57
  v_sub_f32 v255, v255, v57
  v_mul_f32 v64, v64, v58
  v_mul_f32 v65, v65, v58
  v_mul_f32 v66, v66, v58
  v_mul_f32 v67, v67, v58
  v_mul_f32 v68, v68, v59
  v_mul_f32 v69, v69, v59
  v_mul_f32 v70, v70, v59
  v_mul_f32 v71, v71, v59
  v_mul_f32 v72, v72, v58
  v_mul_f32 v73, v73, v58
  v_mul_f32 v74, v74, v58
  v_mul_f32 v75, v75, v58
  v_mul_f32 v76, v76, v59
  v_mul_f32 v77, v77, v59
  v_mul_f32 v78, v78, v59
  v_mul_f32 v79, v79, v59
  v_mul_f32 v80, v80, v58
  v_mul_f32 v81, v81, v58
  v_mul_f32 v82, v82, v58
  v_mul_f32 v83, v83, v58
  v_mul_f32 v84, v84, v59
  v_mul_f32 v85, v85, v59
  v_mul_f32 v86, v86, v59
  v_mul_f32 v87, v87, v59
  v_mul_f32 v88, v88, v58
  v_mul_f32 v89, v89, v58
  v_mul_f32 v90, v90, v58
  v_mul_f32 v91, v91, v58
  v_mul_f32 v92, v92, v59
  v_mul_f32 v93, v93, v59
  v_mul_f32 v94, v94, v59
  v_mul_f32 v95, v95, v59
  v_mul_f32 v96, v96, v58
  v_mul_f32 v97, v97, v58
  v_mul_f32 v98, v98, v58
  v_mul_f32 v99, v99, v58
  v_mul_f32 v100, v100, v59
  v_mul_f32 v101, v101, v59
  v_mul_f32 v102, v102, v59
  v_mul_f32 v103, v103, v59
  v_mul_f32 v104, v104, v58
  v_mul_f32 v105, v105, v58
  v_mul_f32 v106, v106, v58
  v_mul_f32 v107, v107, v58
  v_mul_f32 v108, v108, v59
  v_mul_f32 v109, v109, v59
  v_mul_f32 v110, v110, v59
  v_mul_f32 v111, v111, v59
  v_mul_f32 v112, v112, v58
  v_mul_f32 v113, v113, v58
  v_mul_f32 v114, v114, v58
  v_mul_f32 v115, v115, v58
  v_mul_f32 v116, v116, v59
  v_mul_f32 v117, v117, v59
  v_mul_f32 v118, v118, v59
  v_mul_f32 v119, v119, v59
  v_mul_f32 v120, v120, v58
  v_mul_f32 v121, v121, v58
  v_mul_f32 v122, v122, v58
  v_mul_f32 v123, v123, v58
  v_mul_f32 v124, v124, v59
  v_mul_f32 v125, v125, v59
  v_mul_f32 v126, v126, v59
  v_mul_f32 v127, v127, v59
  v_mul_f32 v60, v60, v58
  v_mul_f32 v61, v61, v59
  v_exp_f32 v48, v224
  v_exp_f32 v49, v225
  v_exp_f32 v50, v226
  v_add_f32 v40, v48, v49
  v_cvt_pk_bf16_f32 v16, v48, v49
  v_exp_f32 v51, v227
  v_add_f32 v40, v40, v50
  v_exp_f32 v52, v228
  v_add_f32 v40, v40, v51
  v_cvt_pk_bf16_f32 v17, v50, v51
  v_exp_f32 v53, v229
  v_exp_f32 v54, v230
  v_add_f32 v41, v52, v53
  v_cvt_pk_bf16_f32 v20, v52, v53
  v_exp_f32 v55, v231
  v_add_f32 v41, v41, v54
  v_exp_f32 v48, v232
  v_add_f32 v41, v41, v55
  v_cvt_pk_bf16_f32 v21, v54, v55
  v_exp_f32 v49, v233
  v_add_f32 v40, v40, v48
  v_exp_f32 v50, v234
  v_add_f32 v40, v40, v49
  v_cvt_pk_bf16_f32 v18, v48, v49
  v_exp_f32 v51, v235
  v_add_f32 v40, v40, v50
  v_exp_f32 v52, v236
  v_add_f32 v40, v40, v51
  v_cvt_pk_bf16_f32 v19, v50, v51
  v_exp_f32 v53, v237
  v_add_f32 v41, v41, v52
  v_exp_f32 v54, v238
  v_add_f32 v41, v41, v53
  v_cvt_pk_bf16_f32 v22, v52, v53
  v_exp_f32 v55, v239
  v_add_f32 v41, v41, v54
  v_add_f32 v41, v41, v55
  v_cvt_pk_bf16_f32 v23, v54, v55
  s_nop 1
  s_branch cont_25
fix_58:
  s_nop 15
  v_max3_f32 v56, v240, v241, v242
  v_max3_f32 v57, v244, v245, v246
  v_max3_f32 v56, v56, v243, v248
  v_max3_f32 v57, v57, v247, v252
  v_max3_f32 v56, v56, v249, v250
  v_max3_f32 v57, v57, v253, v254
  v_max_f32 v56, v56, v251
  v_max_f32 v57, v57, v255
  s_nop 1
  v_permlane16_swap_b32 v56, v57
  v_max_f32 v56, v56, v57
  v_mov_b32 v57, v56
  s_nop 1
  v_permlane32_swap_b32 v57, v56
  v_max_f32 v56, v56, v57
  v_max_f32 v56, 0, v56
  v_mov_b32 v57, v56
  s_nop 1
  v_permlane16_swap_b32 v56, v57
  v_sub_f32 v58, 0, v56
  v_sub_f32 v59, 0, v57
  v_exp_f32 v58, v58
  v_exp_f32 v59, v59
  v_sub_f32 v32, v32, v56
  v_sub_f32 v33, v33, v56
  v_sub_f32 v34, v34, v56
  v_sub_f32 v35, v35, v56
  v_sub_f32 v36, v36, v57
  v_sub_f32 v37, v37, v57
  v_sub_f32 v38, v38, v57
  v_sub_f32 v39, v39, v57
  v_sub_f32 v224, v224, v56
  v_sub_f32 v225, v225, v56
  v_sub_f32 v226, v226, v56
  v_sub_f32 v227, v227, v56
  v_sub_f32 v228, v228, v57
  v_sub_f32 v229, v229, v57
  v_sub_f32 v230, v230, v57
  v_sub_f32 v231, v231, v57
  v_sub_f32 v232, v232, v56
  v_sub_f32 v233, v233, v56
  v_sub_f32 v234, v234, v56
  v_sub_f32 v235, v235, v56
  v_sub_f32 v236, v236, v57
  v_sub_f32 v237, v237, v57
  v_sub_f32 v238, v238, v57
  v_sub_f32 v239, v239, v57
  v_sub_f32 v240, v240, v56
  v_sub_f32 v241, v241, v56
  v_sub_f32 v242, v242, v56
  v_sub_f32 v243, v243, v56
  v_sub_f32 v244, v244, v57
  v_sub_f32 v245, v245, v57
  v_sub_f32 v246, v246, v57
  v_sub_f32 v247, v247, v57
  v_sub_f32 v248, v248, v56
  v_sub_f32 v249, v249, v56
  v_sub_f32 v250, v250, v56
  v_sub_f32 v251, v251, v56
  v_sub_f32 v252, v252, v57
  v_sub_f32 v253, v253, v57
  v_sub_f32 v254, v254, v57
  v_sub_f32 v255, v255, v57
  v_mul_f32 v64, v64, v58
  v_mul_f32 v65, v65, v58
  v_mul_f32 v66, v66, v58
  v_mul_f32 v67, v67, v58
  v_mul_f32 v68, v68, v59
  v_mul_f32 v69, v69, v59
  v_mul_f32 v70, v70, v59
  v_mul_f32 v71, v71, v59
  v_mul_f32 v72, v72, v58
  v_mul_f32 v73, v73, v58
  v_mul_f32 v74, v74, v58
  v_mul_f32 v75, v75, v58
  v_mul_f32 v76, v76, v59
  v_mul_f32 v77, v77, v59
  v_mul_f32 v78, v78, v59
  v_mul_f32 v79, v79, v59
  v_mul_f32 v80, v80, v58
  v_mul_f32 v81, v81, v58
  v_mul_f32 v82, v82, v58
  v_mul_f32 v83, v83, v58
  v_mul_f32 v84, v84, v59
  v_mul_f32 v85, v85, v59
  v_mul_f32 v86, v86, v59
  v_mul_f32 v87, v87, v59
  v_mul_f32 v88, v88, v58
  v_mul_f32 v89, v89, v58
  v_mul_f32 v90, v90, v58
  v_mul_f32 v91, v91, v58
  v_mul_f32 v92, v92, v59
  v_mul_f32 v93, v93, v59
  v_mul_f32 v94, v94, v59
  v_mul_f32 v95, v95, v59
  v_mul_f32 v96, v96, v58
  v_mul_f32 v97, v97, v58
  v_mul_f32 v98, v98, v58
  v_mul_f32 v99, v99, v58
  v_mul_f32 v100, v100, v59
  v_mul_f32 v101, v101, v59
  v_mul_f32 v102, v102, v59
  v_mul_f32 v103, v103, v59
  v_mul_f32 v104, v104, v58
  v_mul_f32 v105, v105, v58
  v_mul_f32 v106, v106, v58
  v_mul_f32 v107, v107, v58
  v_mul_f32 v108, v108, v59
  v_mul_f32 v109, v109, v59
  v_mul_f32 v110, v110, v59
  v_mul_f32 v111, v111, v59
  v_mul_f32 v112, v112, v58
  v_mul_f32 v113, v113, v58
  v_mul_f32 v114, v114, v58
  v_mul_f32 v115, v115, v58
  v_mul_f32 v116, v116, v59
  v_mul_f32 v117, v117, v59
  v_mul_f32 v118, v118, v59
  v_mul_f32 v119, v119, v59
  v_mul_f32 v120, v120, v58
  v_mul_f32 v121, v121, v58
  v_mul_f32 v122, v122, v58
  v_mul_f32 v123, v123, v58
  v_mul_f32 v124, v124, v59
  v_mul_f32 v125, v125, v59
  v_mul_f32 v126, v126, v59
  v_mul_f32 v127, v127, v59
  v_mul_f32 v60, v60, v58
  v_mul_f32 v61, v61, v59
  v_exp_f32 v48, v240
  v_exp_f32 v49, v241
  v_exp_f32 v50, v242
  v_add_f32 v40, v48, v49
  v_cvt_pk_bf16_f32 v24, v48, v49
  v_exp_f32 v51, v243
  v_add_f32 v40, v40, v50
  v_exp_f32 v52, v244
  v_add_f32 v40, v40, v51
  v_cvt_pk_bf16_f32 v25, v50, v51
  v_exp_f32 v53, v245
  v_exp_f32 v54, v246
  v_add_f32 v41, v52, v53
  v_cvt_pk_bf16_f32 v28, v52, v53
  v_exp_f32 v55, v247
  v_add_f32 v41, v41, v54
  v_exp_f32 v48, v248
  v_add_f32 v41, v41, v55
  v_cvt_pk_bf16_f32 v29, v54, v55
  v_exp_f32 v49, v249
  v_add_f32 v40, v40, v48
  v_exp_f32 v50, v250
  v_add_f32 v40, v40, v49
  v_cvt_pk_bf16_f32 v26, v48, v49
  v_exp_f32 v51, v251
  v_add_f32 v40, v40, v50
  v_exp_f32 v52, v252
  v_add_f32 v40, v40, v51
  v_cvt_pk_bf16_f32 v27, v50, v51
  v_exp_f32 v53, v253
  v_add_f32 v41, v41, v52
  v_exp_f32 v54, v254
  v_add_f32 v41, v41, v53
  v_cvt_pk_bf16_f32 v30, v52, v53
  v_exp_f32 v55, v255
  v_add_f32 v41, v41, v54
  v_add_f32 v41, v41, v55
  v_cvt_pk_bf16_f32 v31, v54, v55
  s_nop 1
  s_branch cont_59
fix_60:
  s_nop 15
  v_max3_f32 v56, v224, v225, v226
  v_max3_f32 v57, v228, v229, v230
  v_max3_f32 v56, v56, v227, v232
  v_max3_f32 v57, v57, v231, v236
  v_max3_f32 v56, v56, v233, v234
  v_max3_f32 v57, v57, v237, v238
  v_max_f32 v56, v56, v235
  v_max_f32 v57, v57, v239
  s_nop 1
  v_permlane16_swap_b32 v56, v57
  v_max_f32 v56, v56, v57
  v_mov_b32 v57, v56
  s_nop 1
  v_permlane32_swap_b32 v57, v56
  v_max_f32 v56, v56, v57
  v_max_f32 v56, 0, v56
  v_mov_b32 v57, v56
  s_nop 1
  v_permlane16_swap_b32 v56, v57
  v_sub_f32 v58, 0, v56
  v_sub_f32 v59, 0, v57
  v_exp_f32 v58, v58
  v_exp_f32 v59, v59
  v_sub_f32 v32, v32, v56
  v_sub_f32 v33, v33, v56
  v_sub_f32 v34, v34, v56
  v_sub_f32 v35, v35, v56
  v_sub_f32 v36, v36, v57
  v_sub_f32 v37, v37, v57
  v_sub_f32 v38, v38, v57
  v_sub_f32 v39, v39, v57
  v_sub_f32 v224, v224, v56
  v_sub_f32 v225, v225, v56
  v_sub_f32 v226, v226, v56
  v_sub_f32 v227, v227, v56
  v_sub_f32 v228, v228, v57
  v_sub_f32 v229, v229, v57
  v_sub_f32 v230, v230, v57
  v_sub_f32 v231, v231, v57
  v_sub_f32 v232, v232, v56
  v_sub_f32 v233, v233, v56
  v_sub_f32 v234, v234, v56
  v_sub_f32 v235, v235, v56
  v_sub_f32 v236, v236, v57
  v_sub_f32 v237, v237, v57
  v_sub_f32 v238, v238, v57
  v_sub_f32 v239, v239, v57
  v_sub_f32 v240, v240, v56
  v_sub_f32 v241, v241, v56
  v_sub_f32 v242, v242, v56
  v_sub_f32 v243, v243, v56
  v_sub_f32 v244, v244, v57
  v_sub_f32 v245, v245, v57
  v_sub_f32 v246, v246, v57
  v_sub_f32 v247, v247, v57
  v_sub_f32 v248, v248, v56
  v_sub_f32 v249, v249, v56
  v_sub_f32 v250, v250, v56
  v_sub_f32 v251, v251, v56
  v_sub_f32 v252, v252, v57
  v_sub_f32 v253, v253, v57
  v_sub_f32 v254, v254, v57
  v_sub_f32 v255, v255, v57
  v_mul_f32 v64, v64, v58
  v_mul_f32 v65, v65, v58
  v_mul_f32 v66, v66, v58
  v_mul_f32 v67, v67, v58
  v_mul_f32 v68, v68, v59
  v_mul_f32 v69, v69, v59
  v_mul_f32 v70, v70, v59
  v_mul_f32 v71, v71, v59
  v_mul_f32 v72, v72, v58
  v_mul_f32 v73, v73, v58
  v_mul_f32 v74, v74, v58
  v_mul_f32 v75, v75, v58
  v_mul_f32 v76, v76, v59
  v_mul_f32 v77, v77, v59
  v_mul_f32 v78, v78, v59
  v_mul_f32 v79, v79, v59
  v_mul_f32 v80, v80, v58
  v_mul_f32 v81, v81, v58
  v_mul_f32 v82, v82, v58
  v_mul_f32 v83, v83, v58
  v_mul_f32 v84, v84, v59
  v_mul_f32 v85, v85, v59
  v_mul_f32 v86, v86, v59
  v_mul_f32 v87, v87, v59
  v_mul_f32 v88, v88, v58
  v_mul_f32 v89, v89, v58
  v_mul_f32 v90, v90, v58
  v_mul_f32 v91, v91, v58
  v_mul_f32 v92, v92, v59
  v_mul_f32 v93, v93, v59
  v_mul_f32 v94, v94, v59
  v_mul_f32 v95, v95, v59
  v_mul_f32 v96, v96, v58
  v_mul_f32 v97, v97, v58
  v_mul_f32 v98, v98, v58
  v_mul_f32 v99, v99, v58
  v_mul_f32 v100, v100, v59
  v_mul_f32 v101, v101, v59
  v_mul_f32 v102, v102, v59
  v_mul_f32 v103, v103, v59
  v_mul_f32 v104, v104, v58
  v_mul_f32 v105, v105, v58
  v_mul_f32 v106, v106, v58
  v_mul_f32 v107, v107, v58
  v_mul_f32 v108, v108, v59
  v_mul_f32 v109, v109, v59
  v_mul_f32 v110, v110, v59
  v_mul_f32 v111, v111, v59
  v_mul_f32 v112, v112, v58
  v_mul_f32 v113, v113, v58
  v_mul_f32 v114, v114, v58
  v_mul_f32 v115, v115, v58
  v_mul_f32 v116, v116, v59
  v_mul_f32 v117, v117, v59
  v_mul_f32 v118, v118, v59
  v_mul_f32 v119, v119, v59
  v_mul_f32 v120, v120, v58
  v_mul_f32 v121, v121, v58
  v_mul_f32 v122, v122, v58
  v_mul_f32 v123, v123, v58
  v_mul_f32 v124, v124, v59
  v_mul_f32 v125, v125, v59
  v_mul_f32 v126, v126, v59
  v_mul_f32 v127, v127, v59
  v_mul_f32 v60, v60, v58
  v_mul_f32 v61, v61, v59
  v_exp_f32 v48, v224
  v_exp_f32 v49, v225
  v_exp_f32 v50, v226
  v_add_f32 v40, v48, v49
  v_cvt_pk_bf16_f32 v16, v48, v49
  v_exp_f32 v51, v227
  v_add_f32 v40, v40, v50
  v_exp_f32 v52, v228
  v_add_f32 v40, v40, v51
  v_cvt_pk_bf16_f32 v17, v50, v51
  v_exp_f32 v53, v229
  v_exp_f32 v54, v230
  v_add_f32 v41, v52, v53
  v_cvt_pk_bf16_f32 v20, v52, v53
  v_exp_f32 v55, v231
  v_add_f32 v41, v41, v54
  v_exp_f32 v48, v232
  v_add_f32 v41, v41, v55
  v_cvt_pk_bf16_f32 v21, v54, v55
  v_exp_f32 v49, v233
  v_add_f32 v40, v40, v48
  v_exp_f32 v50, v234
  v_add_f32 v40, v40, v49
  v_cvt_pk_bf16_f32 v18, v48, v49
  v_exp_f32 v51, v235
  v_add_f32 v40, v40, v50
  v_exp_f32 v52, v236
  v_add_f32 v40, v40, v51
  v_cvt_pk_bf16_f32 v19, v50, v51
  v_exp_f32 v53, v237
  v_add_f32 v41, v41, v52
  v_exp_f32 v54, v238
  v_add_f32 v41, v41, v53
  v_cvt_pk_bf16_f32 v22, v52, v53
  v_exp_f32 v55, v239
  v_add_f32 v41, v41, v54
  v_add_f32 v41, v41, v55
  v_cvt_pk_bf16_f32 v23, v54, v55
  s_nop 1
  s_branch cont_61
fix_62:
  s_nop 15
  v_max3_f32 v56, v240, v241, v242
  v_max3_f32 v57, v244, v245, v246
  v_max3_f32 v56, v56, v243, v248
  v_max3_f32 v57, v57, v247, v252
  v_max3_f32 v56, v56, v249, v250
  v_max3_f32 v57, v57, v253, v254
  v_max_f32 v56, v56, v251
  v_max_f32 v57, v57, v255
  s_nop 1
  v_permlane16_swap_b32 v56, v57
  v_max_f32 v56, v56, v57
  v_mov_b32 v57, v56
  s_nop 1
  v_permlane32_swap_b32 v57, v56
  v_max_f32 v56, v56, v57
  v_max_f32 v56, 0, v56
  v_mov_b32 v57, v56
  s_nop 1
  v_permlane16_swap_b32 v56, v57
  v_sub_f32 v58, 0, v56
  v_sub_f32 v59, 0, v57
  v_exp_f32 v58, v58
  v_exp_f32 v59, v59
  v_sub_f32 v32, v32, v56
  v_sub_f32 v33, v33, v56
  v_sub_f32 v34, v34, v56
  v_sub_f32 v35, v35, v56
  v_sub_f32 v36, v36, v57
  v_sub_f32 v37, v37, v57
  v_sub_f32 v38, v38, v57
  v_sub_f32 v39, v39, v57
  v_sub_f32 v224, v224, v56
  v_sub_f32 v225, v225, v56
  v_sub_f32 v226, v226, v56
  v_sub_f32 v227, v227, v56
  v_sub_f32 v228, v228, v57
  v_sub_f32 v229, v229, v57
  v_sub_f32 v230, v230, v57
  v_sub_f32 v231, v231, v57
  v_sub_f32 v232, v232, v56
  v_sub_f32 v233, v233, v56
  v_sub_f32 v234, v234, v56
  v_sub_f32 v235, v235, v56
  v_sub_f32 v236, v236, v57
  v_sub_f32 v237, v237, v57
  v_sub_f32 v238, v238, v57
  v_sub_f32 v239, v239, v57
  v_sub_f32 v240, v240, v56
  v_sub_f32 v241, v241, v56
  v_sub_f32 v242, v242, v56
  v_sub_f32 v243, v243, v56
  v_sub_f32 v244, v244, v57
  v_sub_f32 v245, v245, v57
  v_sub_f32 v246, v246, v57
  v_sub_f32 v247, v247, v57
  v_sub_f32 v248, v248, v56
  v_sub_f32 v249, v249, v56
  v_sub_f32 v250, v250, v56
  v_sub_f32 v251, v251, v56
  v_sub_f32 v252, v252, v57
  v_sub_f32 v253, v253, v57
  v_sub_f32 v254, v254, v57
  v_sub_f32 v255, v255, v57
  v_mul_f32 v64, v64, v58
  v_mul_f32 v65, v65, v58
  v_mul_f32 v66, v66, v58
  v_mul_f32 v67, v67, v58
  v_mul_f32 v68, v68, v59
  v_mul_f32 v69, v69, v59
  v_mul_f32 v70, v70, v59
  v_mul_f32 v71, v71, v59
  v_mul_f32 v72, v72, v58
  v_mul_f32 v73, v73, v58
  v_mul_f32 v74, v74, v58
  v_mul_f32 v75, v75, v58
  v_mul_f32 v76, v76, v59
  v_mul_f32 v77, v77, v59
  v_mul_f32 v78, v78, v59
  v_mul_f32 v79, v79, v59
  v_mul_f32 v80, v80, v58
  v_mul_f32 v81, v81, v58
  v_mul_f32 v82, v82, v58
  v_mul_f32 v83, v83, v58
  v_mul_f32 v84, v84, v59
  v_mul_f32 v85, v85, v59
  v_mul_f32 v86, v86, v59
  v_mul_f32 v87, v87, v59
  v_mul_f32 v88, v88, v58
  v_mul_f32 v89, v89, v58
  v_mul_f32 v90, v90, v58
  v_mul_f32 v91, v91, v58
  v_mul_f32 v92, v92, v59
  v_mul_f32 v93, v93, v59
  v_mul_f32 v94, v94, v59
  v_mul_f32 v95, v95, v59
  v_mul_f32 v96, v96, v58
  v_mul_f32 v97, v97, v58
  v_mul_f32 v98, v98, v58
  v_mul_f32 v99, v99, v58
  v_mul_f32 v100, v100, v59
  v_mul_f32 v101, v101, v59
  v_mul_f32 v102, v102, v59
  v_mul_f32 v103, v103, v59
  v_mul_f32 v104, v104, v58
  v_mul_f32 v105, v105, v58
  v_mul_f32 v106, v106, v58
  v_mul_f32 v107, v107, v58
  v_mul_f32 v108, v108, v59
  v_mul_f32 v109, v109, v59
  v_mul_f32 v110, v110, v59
  v_mul_f32 v111, v111, v59
  v_mul_f32 v112, v112, v58
  v_mul_f32 v113, v113, v58
  v_mul_f32 v114, v114, v58
  v_mul_f32 v115, v115, v58
  v_mul_f32 v116, v116, v59
  v_mul_f32 v117, v117, v59
  v_mul_f32 v118, v118, v59
  v_mul_f32 v119, v119, v59
  v_mul_f32 v120, v120, v58
  v_mul_f32 v121, v121, v58
  v_mul_f32 v122, v122, v58
  v_mul_f32 v123, v123, v58
  v_mul_f32 v124, v124, v59
  v_mul_f32 v125, v125, v59
  v_mul_f32 v126, v126, v59
  v_mul_f32 v127, v127, v59
  v_mul_f32 v60, v60, v58
  v_mul_f32 v61, v61, v59
  v_exp_f32 v48, v240
  v_exp_f32 v49, v241
  v_exp_f32 v50, v242
  v_add_f32 v40, v48, v49
  v_cvt_pk_bf16_f32 v24, v48, v49
  v_exp_f32 v51, v243
  v_add_f32 v40, v40, v50
  v_exp_f32 v52, v244
  v_add_f32 v40, v40, v51
  v_cvt_pk_bf16_f32 v25, v50, v51
  v_exp_f32 v53, v245
  v_exp_f32 v54, v246
  v_add_f32 v41, v52, v53
  v_cvt_pk_bf16_f32 v28, v52, v53
  v_exp_f32 v55, v247
  v_add_f32 v41, v41, v54
  v_exp_f32 v48, v248
  v_add_f32 v41, v41, v55
  v_cvt_pk_bf16_f32 v29, v54, v55
  v_exp_f32 v49, v249
  v_add_f32 v40, v40, v48
  v_exp_f32 v50, v250
  v_add_f32 v40, v40, v49
  v_cvt_pk_bf16_f32 v26, v48, v49
  v_exp_f32 v51, v251
  v_add_f32 v40, v40, v50
  v_exp_f32 v52, v252
  v_add_f32 v40, v40, v51
  v_cvt_pk_bf16_f32 v27, v50, v51
  v_exp_f32 v53, v253
  v_add_f32 v41, v41, v52
  v_exp_f32 v54, v254
  v_add_f32 v41, v41, v53
  v_cvt_pk_bf16_f32 v30, v52, v53
  v_exp_f32 v55, v255
  v_add_f32 v41, v41, v54
  v_add_f32 v41, v41, v55
  v_cvt_pk_bf16_f32 v31, v54, v55
  s_nop 1
  s_branch cont_63
fix_64:
  s_nop 15
  v_max3_f32 v56, v224, v225, v226
  v_max3_f32 v57, v228, v229, v230
  v_max3_f32 v56, v56, v227, v232
  v_max3_f32 v57, v57, v231, v236
  v_max3_f32 v56, v56, v233, v234
  v_max3_f32 v57, v57, v237, v238
  v_max_f32 v56, v56, v235
  v_max_f32 v57, v57, v239
  s_nop 1
  v_permlane16_swap_b32 v56, v57
  v_max_f32 v56, v56, v57
  v_mov_b32 v57, v56
  s_nop 1
  v_permlane32_swap_b32 v57, v56
  v_max_f32 v56, v56, v57
  v_max_f32 v56, 0, v56
  v_mov_b32 v57, v56
  s_nop 1
  v_permlane16_swap_b32 v56, v57
  v_sub_f32 v58, 0, v56
  v_sub_f32 v59, 0, v57
  v_exp_f32 v58, v58
  v_exp_f32 v59, v59
  v_sub_f32 v32, v32, v56
  v_sub_f32 v33, v33, v56
  v_sub_f32 v34, v34, v56
  v_sub_f32 v35, v35, v56
  v_sub_f32 v36, v36, v57
  v_sub_f32 v37, v37, v57
  v_sub_f32 v38, v38, v57
  v_sub_f32 v39, v39, v57
  v_sub_f32 v224, v224, v56
  v_sub_f32 v225, v225, v56
  v_sub_f32 v226, v226, v56
  v_sub_f32 v227, v227, v56
  v_sub_f32 v228, v228, v57
  v_sub_f32 v229, v229, v57
  v_sub_f32 v230, v230, v57
  v_sub_f32 v231, v231, v57
  v_sub_f32 v232, v232, v56
  v_sub_f32 v233, v233, v56
  v_sub_f32 v234, v234, v56
  v_sub_f32 v235, v235, v56
  v_sub_f32 v236, v236, v57
  v_sub_f32 v237, v237, v57
  v_sub_f32 v238, v238, v57
  v_sub_f32 v239, v239, v57
  v_sub_f32 v240, v240, v56
  v_sub_f32 v241, v241, v56
  v_sub_f32 v242, v242, v56
  v_sub_f32 v243, v243, v56
  v_sub_f32 v244, v244, v57
  v_sub_f32 v245, v245, v57
  v_sub_f32 v246, v246, v57
  v_sub_f32 v247, v247, v57
  v_sub_f32 v248, v248, v56
  v_sub_f32 v249, v249, v56
  v_sub_f32 v250, v250, v56
  v_sub_f32 v251, v251, v56
  v_sub_f32 v252, v252, v57
  v_sub_f32 v253, v253, v57
  v_sub_f32 v254, v254, v57
  v_sub_f32 v255, v255, v57
  v_mul_f32 v64, v64, v58
  v_mul_f32 v65, v65, v58
  v_mul_f32 v66, v66, v58
  v_mul_f32 v67, v67, v58
  v_mul_f32 v68, v68, v59
  v_mul_f32 v69, v69, v59
  v_mul_f32 v70, v70, v59
  v_mul_f32 v71, v71, v59
  v_mul_f32 v72, v72, v58
  v_mul_f32 v73, v73, v58
  v_mul_f32 v74, v74, v58
  v_mul_f32 v75, v75, v58
  v_mul_f32 v76, v76, v59
  v_mul_f32 v77, v77, v59
  v_mul_f32 v78, v78, v59
  v_mul_f32 v79, v79, v59
  v_mul_f32 v80, v80, v58
  v_mul_f32 v81, v81, v58
  v_mul_f32 v82, v82, v58
  v_mul_f32 v83, v83, v58
  v_mul_f32 v84, v84, v59
  v_mul_f32 v85, v85, v59
  v_mul_f32 v86, v86, v59
  v_mul_f32 v87, v87, v59
  v_mul_f32 v88, v88, v58
  v_mul_f32 v89, v89, v58
  v_mul_f32 v90, v90, v58
  v_mul_f32 v91, v91, v58
  v_mul_f32 v92, v92, v59
  v_mul_f32 v93, v93, v59
  v_mul_f32 v94, v94, v59
  v_mul_f32 v95, v95, v59
  v_mul_f32 v96, v96, v58
  v_mul_f32 v97, v97, v58
  v_mul_f32 v98, v98, v58
  v_mul_f32 v99, v99, v58
  v_mul_f32 v100, v100, v59
  v_mul_f32 v101, v101, v59
  v_mul_f32 v102, v102, v59
  v_mul_f32 v103, v103, v59
  v_mul_f32 v104, v104, v58
  v_mul_f32 v105, v105, v58
  v_mul_f32 v106, v106, v58
  v_mul_f32 v107, v107, v58
  v_mul_f32 v108, v108, v59
  v_mul_f32 v109, v109, v59
  v_mul_f32 v110, v110, v59
  v_mul_f32 v111, v111, v59
  v_mul_f32 v112, v112, v58
  v_mul_f32 v113, v113, v58
  v_mul_f32 v114, v114, v58
  v_mul_f32 v115, v115, v58
  v_mul_f32 v116, v116, v59
  v_mul_f32 v117, v117, v59
  v_mul_f32 v118, v118, v59
  v_mul_f32 v119, v119, v59
  v_mul_f32 v120, v120, v58
  v_mul_f32 v121, v121, v58
  v_mul_f32 v122, v122, v58
  v_mul_f32 v123, v123, v58
  v_mul_f32 v124, v124, v59
  v_mul_f32 v125, v125, v59
  v_mul_f32 v126, v126, v59
  v_mul_f32 v127, v127, v59
  v_mul_f32 v60, v60, v58
  v_mul_f32 v61, v61, v59
  v_exp_f32 v48, v224
  v_exp_f32 v49, v225
  v_exp_f32 v50, v226
  v_add_f32 v40, v48, v49
  v_cvt_pk_bf16_f32 v16, v48, v49
  v_exp_f32 v51, v227
  v_add_f32 v40, v40, v50
  v_exp_f32 v52, v228
  v_add_f32 v40, v40, v51
  v_cvt_pk_bf16_f32 v17, v50, v51
  v_exp_f32 v53, v229
  v_exp_f32 v54, v230
  v_add_f32 v41, v52, v53
  v_cvt_pk_bf16_f32 v20, v52, v53
  v_exp_f32 v55, v231
  v_add_f32 v41, v41, v54
  v_exp_f32 v48, v232
  v_add_f32 v41, v41, v55
  v_cvt_pk_bf16_f32 v21, v54, v55
  v_exp_f32 v49, v233
  v_add_f32 v40, v40, v48
  v_exp_f32 v50, v234
  v_add_f32 v40, v40, v49
  v_cvt_pk_bf16_f32 v18, v48, v49
  v_exp_f32 v51, v235
  v_add_f32 v40, v40, v50
  v_exp_f32 v52, v236
  v_add_f32 v40, v40, v51
  v_cvt_pk_bf16_f32 v19, v50, v51
  v_exp_f32 v53, v237
  v_add_f32 v41, v41, v52
  v_exp_f32 v54, v238
  v_add_f32 v41, v41, v53
  v_cvt_pk_bf16_f32 v22, v52, v53
  v_exp_f32 v55, v239
  v_add_f32 v41, v41, v54
  v_add_f32 v41, v41, v55
  v_cvt_pk_bf16_f32 v23, v54, v55
  s_nop 1
  s_branch cont_65
fix_66:
  s_nop 15
  v_max3_f32 v56, v240, v241, v242
  v_max3_f32 v57, v244, v245, v246
  v_max3_f32 v56, v56, v243, v248
  v_max3_f32 v57, v57, v247, v252
  v_max3_f32 v56, v56, v249, v250
  v_max3_f32 v57, v57, v253, v254
  v_max_f32 v56, v56, v251
  v_max_f32 v57, v57, v255
  s_nop 1
  v_permlane16_swap_b32 v56, v57
  v_max_f32 v56, v56, v57
  v_mov_b32 v57, v56
  s_nop 1
  v_permlane32_swap_b32 v57, v56
  v_max_f32 v56, v56, v57
  v_max_f32 v56, 0, v56
  v_mov_b32 v57, v56
  s_nop 1
  v_permlane16_swap_b32 v56, v57
  v_sub_f32 v58, 0, v56
  v_sub_f32 v59, 0, v57
  v_exp_f32 v58, v58
  v_exp_f32 v59, v59
  v_sub_f32 v32, v32, v56
  v_sub_f32 v33, v33, v56
  v_sub_f32 v34, v34, v56
  v_sub_f32 v35, v35, v56
  v_sub_f32 v36, v36, v57
  v_sub_f32 v37, v37, v57
  v_sub_f32 v38, v38, v57
  v_sub_f32 v39, v39, v57
  v_sub_f32 v224, v224, v56
  v_sub_f32 v225, v225, v56
  v_sub_f32 v226, v226, v56
  v_sub_f32 v227, v227, v56
  v_sub_f32 v228, v228, v57
  v_sub_f32 v229, v229, v57
  v_sub_f32 v230, v230, v57
  v_sub_f32 v231, v231, v57
  v_sub_f32 v232, v232, v56
  v_sub_f32 v233, v233, v56
  v_sub_f32 v234, v234, v56
  v_sub_f32 v235, v235, v56
  v_sub_f32 v236, v236, v57
  v_sub_f32 v237, v237, v57
  v_sub_f32 v238, v238, v57
  v_sub_f32 v239, v239, v57
  v_sub_f32 v240, v240, v56
  v_sub_f32 v241, v241, v56
  v_sub_f32 v242, v242, v56
  v_sub_f32 v243, v243, v56
  v_sub_f32 v244, v244, v57
  v_sub_f32 v245, v245, v57
  v_sub_f32 v246, v246, v57
  v_sub_f32 v247, v247, v57
  v_sub_f32 v248, v248, v56
  v_sub_f32 v249, v249, v56
  v_sub_f32 v250, v250, v56
  v_sub_f32 v251, v251, v56
  v_sub_f32 v252, v252, v57
  v_sub_f32 v253, v253, v57
  v_sub_f32 v254, v254, v57
  v_sub_f32 v255, v255, v57
  v_mul_f32 v64, v64, v58
  v_mul_f32 v65, v65, v58
  v_mul_f32 v66, v66, v58
  v_mul_f32 v67, v67, v58
  v_mul_f32 v68, v68, v59
  v_mul_f32 v69, v69, v59
  v_mul_f32 v70, v70, v59
  v_mul_f32 v71, v71, v59
  v_mul_f32 v72, v72, v58
  v_mul_f32 v73, v73, v58
  v_mul_f32 v74, v74, v58
  v_mul_f32 v75, v75, v58
  v_mul_f32 v76, v76, v59
  v_mul_f32 v77, v77, v59
  v_mul_f32 v78, v78, v59
  v_mul_f32 v79, v79, v59
  v_mul_f32 v80, v80, v58
  v_mul_f32 v81, v81, v58
  v_mul_f32 v82, v82, v58
  v_mul_f32 v83, v83, v58
  v_mul_f32 v84, v84, v59
  v_mul_f32 v85, v85, v59
  v_mul_f32 v86, v86, v59
  v_mul_f32 v87, v87, v59
  v_mul_f32 v88, v88, v58
  v_mul_f32 v89, v89, v58
  v_mul_f32 v90, v90, v58
  v_mul_f32 v91, v91, v58
  v_mul_f32 v92, v92, v59
  v_mul_f32 v93, v93, v59
  v_mul_f32 v94, v94, v59
  v_mul_f32 v95, v95, v59
  v_mul_f32 v96, v96, v58
  v_mul_f32 v97, v97, v58
  v_mul_f32 v98, v98, v58
  v_mul_f32 v99, v99, v58
  v_mul_f32 v100, v100, v59
  v_mul_f32 v101, v101, v59
  v_mul_f32 v102, v102, v59
  v_mul_f32 v103, v103, v59
  v_mul_f32 v104, v104, v58
  v_mul_f32 v105, v105, v58
  v_mul_f32 v106, v106, v58
  v_mul_f32 v107, v107, v58
  v_mul_f32 v108, v108, v59
  v_mul_f32 v109, v109, v59
  v_mul_f32 v110, v110, v59
  v_mul_f32 v111, v111, v59
  v_mul_f32 v112, v112, v58
  v_mul_f32 v113, v113, v58
  v_mul_f32 v114, v114, v58
  v_mul_f32 v115, v115, v58
  v_mul_f32 v116, v116, v59
  v_mul_f32 v117, v117, v59
  v_mul_f32 v118, v118, v59
  v_mul_f32 v119, v119, v59
  v_mul_f32 v120, v120, v58
  v_mul_f32 v121, v121, v58
  v_mul_f32 v122, v122, v58
  v_mul_f32 v123, v123, v58
  v_mul_f32 v124, v124, v59
  v_mul_f32 v125, v125, v59
  v_mul_f32 v126, v126, v59
  v_mul_f32 v127, v127, v59
  v_mul_f32 v60, v60, v58
  v_mul_f32 v61, v61, v59
  v_exp_f32 v48, v240
  v_exp_f32 v49, v241
  v_exp_f32 v50, v242
  v_add_f32 v40, v48, v49
  v_cvt_pk_bf16_f32 v24, v48, v49
  v_exp_f32 v51, v243
  v_add_f32 v40, v40, v50
  v_exp_f32 v52, v244
  v_add_f32 v40, v40, v51
  v_cvt_pk_bf16_f32 v25, v50, v51
  v_exp_f32 v53, v245
  v_exp_f32 v54, v246
  v_add_f32 v41, v52, v53
  v_cvt_pk_bf16_f32 v28, v52, v53
  v_exp_f32 v55, v247
  v_add_f32 v41, v41, v54
  v_exp_f32 v48, v248
  v_add_f32 v41, v41, v55
  v_cvt_pk_bf16_f32 v29, v54, v55
  v_exp_f32 v49, v249
  v_add_f32 v40, v40, v48
  v_exp_f32 v50, v250
  v_add_f32 v40, v40, v49
  v_cvt_pk_bf16_f32 v26, v48, v49
  v_exp_f32 v51, v251
  v_add_f32 v40, v40, v50
  v_exp_f32 v52, v252
  v_add_f32 v40, v40, v51
  v_cvt_pk_bf16_f32 v27, v50, v51
  v_exp_f32 v53, v253
  v_add_f32 v41, v41, v52
  v_exp_f32 v54, v254
  v_add_f32 v41, v41, v53
  v_cvt_pk_bf16_f32 v30, v52, v53
  v_exp_f32 v55, v255
  v_add_f32 v41, v41, v54
  v_add_f32 v41, v41, v55
  v_cvt_pk_bf16_f32 v31, v54, v55
  s_nop 1
  s_branch cont_67
spin_4:
  s_mov_b32 s64, 262144
spin_4_l:
  s_sleep 8
  buffer_load_dword v3, v0, s[68:71], s6 offen sc1
  s_waitcnt vmcnt(0)
  v_readfirstlane_b32 s9, v3
  s_nop 0
  s_cmp_ge_u32 s9, 64
  s_cbranch_scc1 pw_3
  s_sub_u32 s64, s64, 1
  s_cmp_lg_u32 s64, 0
  s_cbranch_scc1 spin_4_l
  s_branch pw_3
spin_7:
  s_mov_b32 s64, 262144
spin_7_l:
  s_sleep 4
  s_load_dword s9, s[36:37], s6 glc
  s_waitcnt lgkmcnt(0)
  s_cmp_ge_u32 s9, 4
  s_cbranch_scc1 spc_8
  s_sub_u32 s64, s64, 1
  s_cmp_lg_u32 s64, 0
  s_cbranch_scc1 spin_7_l
  s_branch spc_8
spin_16:
  s_mov_b32 s64, 262144
spin_16_l:
  s_sleep 4
  s_load_dword s9, s[36:37], s6 glc
  s_waitcnt lgkmcnt(0)
  s_cmp_ge_u32 s9, 8
  s_cbranch_scc1 spc_17
  s_sub_u32 s64, s64, 1
  s_cmp_lg_u32 s64, 0
  s_cbranch_scc1 spin_16_l
  s_branch spc_17
spin_20:
  s_mov_b32 s64, 262144
spin_20_l:
  s_sleep 4
  s_load_dword s9, s[36:37], s75 glc
  s_waitcnt lgkmcnt(0)
  s_cmp_ge_u32 s9, 8
  s_cbranch_scc1 spc_21
  s_sub_u32 s64, s64, 1
  s_cmp_lg_u32 s64, 0
  s_cbranch_scc1 spin_20_l
  s_branch spc_21
spin_29:
  s_mov_b32 s64, 262144
spin_29_l:
  s_sleep 4
  s_load_dword s9, s[36:37], s75 glc
  s_waitcnt lgkmcnt(0)
  s_cmp_ge_u32 s9, 8
  s_cbranch_scc1 spc_30
  s_sub_u32 s64, s64, 1
  s_cmp_lg_u32 s64, 0
  s_cbranch_scc1 spin_29_l
  s_branch spc_30
spin_42:
  s_mov_b32 s64, 262144
spin_42_l:
  s_sleep 4
  s_load_dword s9, s[16:17], s34 glc
  s_waitcnt lgkmcnt(0)
  s_cmp_ge_u32 s9, 4
  s_cbranch_scc1 spc_43
  s_sub_u32 s64, s64, 1
  s_cmp_lg_u32 s64, 0
  s_cbranch_scc1 spin_42_l
  s_branch spc_43
spin_68:
  s_mov_b32 s64, 262144
spin_68_l:
  s_sleep 4
  s_load_dword s9, s[16:17], s34 glc
  s_waitcnt lgkmcnt(0)
  s_cmp_ge_u32 s9, 4
  s_cbranch_scc1 spc_69
  s_sub_u32 s64, s64, 1
  s_cmp_lg_u32 s64, 0
  s_cbranch_scc1 spin_68_l
  s_branch spc_69
spin_77:
  s_mov_b32 s64, 262144
spin_77_l:
  s_sleep 8
  buffer_load_dword v3, v0, s[68:71], s6 offen sc1
  s_waitcnt vmcnt(0)
  v_readfirstlane_b32 s9, v3
  s_nop 0
  s_cmp_ge_u32 s9, 128
  s_cbranch_scc1 spc_78
  s_sub_u32 s64, s64, 1
  s_cmp_lg_u32 s64, 0
  s_cbranch_scc1 spin_77_l
  s_branch spc_78
spin_81:
  s_mov_b32 s64, 262144
spin_81_l:
  s_sleep 4
  s_load_dword s9, s[16:17], s34 glc
  s_waitcnt lgkmcnt(0)
  s_cmp_ge_u32 s9, 4
  s_cbranch_scc1 spc_82
  s_sub_u32 s64, s64, 1
  s_cmp_lg_u32 s64, 0
  s_cbranch_scc1 spin_81_l
  s_branch spc_82
spin_89:
  s_mov_b32 s64, 262144
spin_89_l:
  s_sleep 8
  buffer_load_dword v3, v0, s[16:19], s73 offen sc1
  s_waitcnt vmcnt(0)
  v_readfirstlane_b32 s9, v3
  s_nop 0
  s_cmp_ge_u32 s9, 32
  s_cbranch_scc1 spc_90
  s_sub_u32 s64, s64, 1
  s_cmp_lg_u32 s64, 0
  s_cbranch_scc1 spin_89_l
  s_branch spc_90
spin_96:
  s_mov_b32 s64, 262144
spin_96_l:
  s_sleep 4
  s_load_dword s9, s[16:17], s60 glc
  s_waitcnt lgkmcnt(0)
  s_cmp_ge_u32 s9, 8
  s_cbranch_scc1 spc_97
  s_sub_u32 s64, s64, 1
  s_cmp_lg_u32 s64, 0
  s_cbranch_scc1 spin_96_l
  s_branch spc_97
spin_100:
  s_mov_b32 s64, 262144
spin_100_l:
  s_sleep 4
  s_load_dword s9, s[16:17], s60 glc
  s_waitcnt lgkmcnt(0)
  s_cmp_ge_u32 s9, 7
  s_cbranch_scc1 spc_101
  s_sub_u32 s64, s64, 1
  s_cmp_lg_u32 s64, 0
  s_cbranch_scc1 spin_100_l
  s_branch spc_101
fused_kernel_end:
  s_endpgm
.section .rodata,"a"
.p2align 6
.amdhsa_kernel fused_kernel
  .amdhsa_next_free_vgpr 256
  .amdhsa_next_free_sgpr 102
  .amdhsa_accum_offset 256
  .amdhsa_group_segment_fixed_size 0
  .amdhsa_kernarg_size 120
  .amdhsa_user_sgpr_count 2
  .amdhsa_user_sgpr_kernarg_segment_ptr 1
  .amdhsa_system_sgpr_workgroup_id_x 1
  .amdhsa_float_denorm_mode_32 3
.end_amdhsa_kernel
```
